```python
import torch

def _softmax(x, axis=-1):
    return torch.softmax(x, dim=axis)

def _gelu(x):
    return torch.nn.functional.gelu(x, approximate='tanh')

def _silu(x):
    return torch.nn.functional.silu(x)

def _sigmoid(x):
    return torch.sigmoid(x)

def _layernorm(x, axis=-1, eps=1e-05):
    m = x.mean(dim=axis, keepdim=True)
    v = x.var(dim=axis, keepdim=True, unbiased=False)
    return (x - m) / torch.sqrt(v + eps)

def _scatter_add(tgt, idx, src, axis=0):
    return tgt.clone().index_add_(axis, idx, src)

def _segment_sum(src, seg, n):
    out = torch.zeros((n,) + src.shape[1:], dtype=src.dtype)
    return out.index_add_(0, seg, src)

def _pad(x, pw):
    flat = tuple((v for pair in reversed(pw) for v in pair))
    return torch.nn.functional.pad(x, flat)
kernel_name = 'recurrent_scan__memory_aug_recurrent_mem_tr__dense_activation_squared_relu__prompt'

def setup_inputs():

    _w = lambda a: (lambda t: t.to(torch.bfloat16) if t.is_floating_point() else t)(torch.as_tensor(a))

    def _A_setup():
        B, S, Dm = (1, 2048, 448)
        H, Dh = (16, 256)
        M, seg = (8, 32)
        seg = min(seg, S)
        S = S // seg * seg
        return {'x': _w((lambda *s: torch.randn(*s, dtype=torch.bfloat16) * 0.05)(B, S, Dm)), 'mem0': _w((lambda *s: torch.randn(*s, dtype=torch.bfloat16) * 0.05)(B, M, Dm)), 'Wq': _w((lambda *s: torch.randn(*s, dtype=torch.bfloat16) * 1.6)(Dm, H, Dh) * Dm ** (-0.5)), 'Wk': _w((lambda *s: torch.randn(*s, dtype=torch.bfloat16) * 1.6)(Dm, H, Dh) * Dm ** (-0.5)), 'Wv': _w((lambda *s: torch.randn(*s, dtype=torch.bfloat16) * 0.05)(Dm, H, Dh) * Dm ** (-0.5)), 'Wo': _w((lambda *s: torch.randn(*s, dtype=torch.bfloat16) * 0.05)(H, Dh, Dm) * (H * Dh) ** (-0.5)), 'seg_len': seg}
    _A_in = _A_setup()

    def _B_setup():
        B, S, D, F = (1, 2048, 448, 1792)
        return {'x': _w((lambda *s: torch.randn(*s, dtype=torch.bfloat16) * 0.05)(B, S, D)), 'w1': _w((lambda *s: torch.randn(*s, dtype=torch.bfloat16) * 0.05)(D, F)), 'b1': _w((lambda *s: torch.randn(*s, dtype=torch.bfloat16) * 0.4)(F)), 'w2': _w((lambda *s: torch.randn(*s, dtype=torch.bfloat16) * 0.05)(F, D)), 'b2': _w((lambda *s: torch.randn(*s, dtype=torch.bfloat16) * 1.6)(D))}
    _B_in = _B_setup()
    return {'A_x': _A_in['x'], 'A_mem0': _A_in['mem0'], 'A_Wq': _A_in['Wq'], 'A_Wk': _A_in['Wk'], 'A_Wv': _A_in['Wv'], 'A_Wo': _A_in['Wo'], 'A_seg_len': _A_in['seg_len'], 'B_x': _B_in['x'], 'B_w1': _B_in['w1'], 'B_b1': _B_in['b1'], 'B_w2': _B_in['w2'], 'B_b2': _B_in['b2']}

def reference(A_x, A_mem0, A_Wq, A_Wk, A_Wv, A_Wo, A_seg_len, B_x, B_w1, B_b1, B_w2, B_b2):

    def _A_ref(x, mem0, Wq, Wk, Wv, Wo, seg_len):
        B, S, Dm = x.shape
        H, Dh = (Wq.shape[1], Wq.shape[2])
        M = mem0.shape[1]
        scale = Dh ** (-0.5)
        n_seg = S // seg_len
        L = M + seg_len
        idx = torch.arange(L)
        mask = (idx[:, None] < M) | (idx[:, None] >= idx[None, :])
        mem = mem0
        outs = []
        for s in range(n_seg):
            xs = x[:, s * seg_len:(s + 1) * seg_len, :].clone()
            h = torch.concatenate([mem, xs], axis=1)
            q = torch.einsum('btd,dhe->bhte', h, Wq)
            k = torch.einsum('btd,dhe->bhte', h, Wk)
            v = torch.einsum('btd,dhe->bhte', h, Wv)
            scores = torch.einsum('bhqe,bhke->bhqk', q, k) * scale
            scores = torch.where(mask[None, None], scores, -1000000000.0)
            p = _softmax(scores, axis=-1)
            o = torch.einsum('bhqk,bhke->bhqe', p, v)
            o = torch.einsum('bhte,hed->btd', o, Wo)
            mem = o[:, :M, :].clone()
            outs.append(o[:, M:, :])
        return torch.concatenate(outs, axis=1)

    def _B_ref(x, w1, b1, w2, b2):
        h = torch.einsum('bsd,df->bsf', x, w1) + b1
        zero = torch.zeros_like(h)
        r = torch.where(h > zero, h, zero)
        h = r * r
        out = torch.einsum('bsf,fd->bsd', h, w2) + b2
        return out
    x = A_x
    xn = _layernorm(x, axis=-1)
    s = _A_ref(xn, A_mem0, A_Wq, A_Wk, A_Wv, A_Wo, A_seg_len)
    g = _silu(_B_ref(xn, B_w1, B_b1, B_w2, B_b2))
    return x + s * g
```

```asm
; @launch grid=(256,1,1) block=(256,1,1) lds=163840
.amdgcn_target "amdgcn-amd-amdhsa--gfx950"
.text
.globl recurrent_scan__memory_aug_recurrent_mem_tr__dense_activation_squared_relu__prompt_kernel
.p2align 8
.type recurrent_scan__memory_aug_recurrent_mem_tr__dense_activation_squared_relu__prompt_kernel,@function
recurrent_scan__memory_aug_recurrent_mem_tr__dense_activation_squared_relu__prompt_kernel:
 s_cmp_ge_u32 s2, 256
 s_cbranch_scc1 L_end
 s_load_dwordx16 s[40:55], s[0:1], 0
 s_load_dwordx8 s[56:63], s[0:1], 64
 s_load_dwordx4 s[4:7], s[0:1], 96
 s_load_dwordx2 s[8:9], s[0:1], 112
 s_getreg_b32 s10, hwreg(HW_REG_XCC_ID, 0, 3)
 v_lshrrev_b32 v1, 6, v0
 v_and_b32 v0, 63, v0
 s_mov_b32 s99, s2
 s_waitcnt lgkmcnt(0)
 v_readfirstlane_b32 s12, v1
 s_mov_b32 s64, s8
 s_mov_b32 s65, s9
 s_mov_b32 s66, 54558720
 s_mov_b32 s67, 0x20000
 s_mov_b32 s68, s4
 s_mov_b32 s69, s5
 s_mov_b32 s70, 1835008
 s_mov_b32 s71, 0x20000
 s_mov_b32 s72, s6
 s_mov_b32 s73, s7
 s_mov_b32 s74, 256
 s_mov_b32 s75, 0x20000
 s_mov_b32 s76, s40
 s_mov_b32 s77, s41
 s_mov_b32 s78, 1835008
 s_mov_b32 s79, 0x20000
 s_cmp_lg_u32 s2, 0
 s_cbranch_scc1 L_cz_1
 s_cmp_lg_u32 s12, 3
 s_cbranch_scc1 L_cz_1
 v_lshlrev_b32 v250, 7, v0
 v_mov_b32 v251, 0
 s_mov_b32 s3, 53493760
 buffer_store_dword v251, v250, s[64:67], s3 offen sc1
 s_add_u32 s3, s3, 8192
 buffer_store_dword v251, v250, s[64:67], s3 offen sc1
 s_waitcnt vmcnt(0)
 v_lshlrev_b32 v250, 4, v0
 s_lshl_b32 s3, s10, 20
 s_add_u32 s3, s3, 0x10000
 v_mov_b32 v251, s3
 s_mov_b64 exec, 0xffff
 buffer_atomic_add v251, v250, s[72:75], 0 offen
 s_mov_b64 exec, -1
L_cz_1:
 s_and_b32 s13, s2, 7
 s_lshr_b32 s14, s2, 3
 s_cmp_lt_u32 s14, 28
 s_cbranch_scc1 L_isgemm
 s_lshl_b32 s13, s13, 2
 s_add_u32 s13, s13, s14
 s_sub_u32 s13, s13, 28
 s_branch L_ln
L_walk:
 s_lshr_b32 s3, s2, 3
 s_and_b32 s3, s3, 15
 s_cmp_eq_u32 s3, 0
 s_cbranch_scc1 L_pad0
 s_cmp_eq_u32 s3, 1
 s_cbranch_scc1 L_pad1
 s_cmp_eq_u32 s3, 2
 s_cbranch_scc1 L_pad2
 s_cmp_eq_u32 s3, 3
 s_cbranch_scc1 L_pad3
 s_cmp_eq_u32 s3, 4
 s_cbranch_scc1 L_pad4
 s_cmp_eq_u32 s3, 5
 s_cbranch_scc1 L_pad5
 s_cmp_eq_u32 s3, 6
 s_cbranch_scc1 L_pad6
 s_cmp_eq_u32 s3, 7
 s_cbranch_scc1 L_pad7
 s_cmp_eq_u32 s3, 8
 s_cbranch_scc1 L_pad8
 s_cmp_eq_u32 s3, 9
 s_cbranch_scc1 L_pad9
 s_cmp_eq_u32 s3, 10
 s_cbranch_scc1 L_pad10
 s_cmp_eq_u32 s3, 11
 s_cbranch_scc1 L_pad11
 s_cmp_eq_u32 s3, 12
 s_cbranch_scc1 L_pad12
 s_setpc_b64 s[94:95]
L_isgemm:
 s_mov_b32 s35, s13
 s_mov_b32 s38, s14
 s_mul_i32 s13, s13, 28
 s_add_u32 s13, s13, s14
 s_cmp_ge_u32 s38, 14
 s_cselect_b32 s16, 14, 0
 s_sub_u32 s15, s38, s16
 s_lshl_b32 s14, s35, 1
 s_cmp_ge_u32 s15, 7
 s_cselect_b32 s3, 7, 0
 s_addc_u32 s14, s14, 0
 s_sub_u32 s15, s15, s3
 s_cmp_lg_u32 s16, 0
 s_cbranch_scc1 L_gemmB
 s_mov_b32 s80, s44
 s_mov_b32 s81, s45
 s_mov_b32 s82, 3670016
 s_mov_b32 s83, 0x20000
 s_mov_b32 s84, s46
 s_mov_b32 s85, s47
 s_mov_b32 s86, 3670016
 s_mov_b32 s87, 0x20000
 v_lshlrev_b32 v236, 4, v0
 v_and_b32 v1, 7, v0
 v_lshrrev_b32 v2, 4, v0
 v_xor_b32 v1, v1, v2
 v_lshlrev_b32 v1, 4, v1
 v_bfe_u32 v3, v0, 3, 1
 v_bfe_u32 v4, v0, 4, 1
 v_bfe_u32 v5, v0, 5, 1
 v_lshlrev_b32 v6, 3, v4
 v_lshlrev_b32 v7, 2, v5
 v_add3_u32 v6, v6, v7, v3
 v_lshlrev_b32 v6, 13, v6
 v_add_u32 v232, v6, v1
 v_xor_b32 v233, 64, v232
 s_lshr_b32 s20, s12, 1
 s_lshl_b32 s20, s20, 5
 s_and_b32 s21, s12, 1
 s_lshl_b32 s21, s21, 1
 s_add_u32 s20, s20, s21
 s_lshl_b32 s21, s15, 6
 s_add_u32 s20, s20, s21
 s_lshl_b32 s20, s20, 13
 s_lshl_b32 s21, s14, 9
 s_add_u32 s20, s20, s21
 s_lshl_b32 s26, s12, 11
 s_add_u32 s26, s26, 65536
 s_lshl_b32 s27, s12, 14
 s_lshl_b32 s28, s15, 19
 s_add_u32 s28, s28, s21
 s_lshl_b32 s29, s12, 17
 s_add_u32 s28, s28, s29
 v_lshrrev_b32 v6, 2, v0
 v_lshlrev_b32 v6, 13, v6
 v_and_b32 v7, 3, v0
 v_lshl_add_u32 v6, v7, 7, v6
 buffer_load_dword v248, v6, s[84:87], s28 offen
 s_add_u32 m0, s26, 0
 s_add_u32 s28, s20, 0
 buffer_load_dwordx4 v232, s[80:83], s28 offen lds
 s_add_u32 m0, s26, 8192
 s_add_u32 s28, s20, 128
 buffer_load_dwordx4 v232, s[80:83], s28 offen lds
 s_add_u32 m0, s26, 16384
 s_add_u32 s28, s20, 256
 buffer_load_dwordx4 v232, s[80:83], s28 offen lds
 s_add_u32 m0, s26, 24576
 s_add_u32 s28, s20, 384
 buffer_load_dwordx4 v232, s[80:83], s28 offen lds
 s_add_u32 m0, s26, 1024
 s_add_u32 s28, s20, 131072
 buffer_load_dwordx4 v233, s[80:83], s28 offen lds
 s_add_u32 m0, s26, 9216
 s_add_u32 s28, s20, 131200
 buffer_load_dwordx4 v233, s[80:83], s28 offen lds
 s_add_u32 m0, s26, 17408
 s_add_u32 s28, s20, 131328
 buffer_load_dwordx4 v233, s[80:83], s28 offen lds
 s_add_u32 m0, s26, 25600
 s_add_u32 s28, s20, 131456
 buffer_load_dwordx4 v233, s[80:83], s28 offen lds
 s_cmp_lg_u32 s12, 3
 s_cbranch_scc1 L_wk_2
 s_call_b64 s[94:95], L_walk
L_wk_2:
 v_lshlrev_b32 v6, 4, v5
 v_lshlrev_b32 v7, 2, v4
 v_add3_u32 v6, v6, v7, v3
 v_lshlrev_b32 v6, 13, v6
 v_add_u32 v238, v6, v1
 v_xor_b32 v239, 64, v238
 v_lshlrev_b32 v6, 3, v5
 v_add3_u32 v6, v6, v7, v3
 v_lshlrev_b32 v6, 13, v6
 v_add_u32 v240, v6, v1
 v_xor_b32 v241, 64, v240
 s_lshr_b32 s22, s12, 1
 s_mul_i32 s22, s22, 224
 s_and_b32 s25, s12, 1
 s_lshl_b32 s23, s25, 5
 s_add_u32 s23, s23, s22
 s_add_u32 s23, s23, 128
 s_lshl_b32 s24, s25, 1
 s_add_u32 s24, s24, s22
 s_add_u32 s24, s24, 192
 s_lshl_b32 s25, s25, 6
 s_add_u32 s22, s22, s25
 s_lshl_b32 s22, s22, 13
 s_add_u32 s22, s22, s21
 s_lshl_b32 s23, s23, 13
 s_add_u32 s23, s23, s21
 s_lshl_b32 s24, s24, 13
 s_add_u32 s24, s24, s21
 s_add_u32 m0, s27, 0
 s_add_u32 s28, s22, 0
 buffer_load_dwordx4 v238, s[84:87], s28 offen lds
 s_add_u32 m0, s27, 4096
 s_add_u32 s28, s22, 128
 buffer_load_dwordx4 v238, s[84:87], s28 offen lds
 s_add_u32 m0, s27, 8192
 s_add_u32 s28, s22, 256
 buffer_load_dwordx4 v238, s[84:87], s28 offen lds
 s_add_u32 m0, s27, 12288
 s_add_u32 s28, s22, 384
 buffer_load_dwordx4 v238, s[84:87], s28 offen lds
 s_add_u32 m0, s27, 1024
 s_add_u32 s28, s22, 262144
 buffer_load_dwordx4 v239, s[84:87], s28 offen lds
 s_add_u32 m0, s27, 5120
 s_add_u32 s28, s22, 262272
 buffer_load_dwordx4 v239, s[84:87], s28 offen lds
 s_add_u32 m0, s27, 9216
 s_add_u32 s28, s22, 262400
 buffer_load_dwordx4 v239, s[84:87], s28 offen lds
 s_add_u32 m0, s27, 13312
 s_add_u32 s28, s22, 262528
 buffer_load_dwordx4 v239, s[84:87], s28 offen lds
 s_add_u32 m0, s27, 2048
 s_add_u32 s28, s22, 16384
 buffer_load_dwordx4 v238, s[84:87], s28 offen lds
 s_add_u32 m0, s27, 6144
 s_add_u32 s28, s22, 16512
 buffer_load_dwordx4 v238, s[84:87], s28 offen lds
 s_add_u32 m0, s27, 10240
 s_add_u32 s28, s22, 16640
 buffer_load_dwordx4 v238, s[84:87], s28 offen lds
 s_add_u32 m0, s27, 14336
 s_add_u32 s28, s22, 16768
 buffer_load_dwordx4 v238, s[84:87], s28 offen lds
 s_add_u32 m0, s27, 3072
 s_add_u32 s28, s22, 278528
 buffer_load_dwordx4 v239, s[84:87], s28 offen lds
 s_add_u32 m0, s27, 7168
 s_add_u32 s28, s22, 278656
 buffer_load_dwordx4 v239, s[84:87], s28 offen lds
 s_add_u32 m0, s27, 11264
 s_add_u32 s28, s22, 278784
 buffer_load_dwordx4 v239, s[84:87], s28 offen lds
 s_add_u32 m0, s27, 15360
 s_add_u32 s28, s22, 278912
 buffer_load_dwordx4 v239, s[84:87], s28 offen lds
 v_mov_b32 v244, -1
 v_mov_b32 v245, -1
 v_mov_b32 v246, -1
 v_mov_b32 v247, -1
 s_lshl_b32 s28, s2, 2
 s_add_u32 s28, s28, s12
 s_mul_i32 s28, s28, 3072
 s_add_u32 s28, s28, 50339840
 buffer_store_dwordx4 v[244:247], v236, s[64:67], s28 offen sc1
 buffer_store_dwordx4 v[244:247], v236, s[64:67], s28 offen offset:1024 sc1
 buffer_store_dwordx4 v[244:247], v236, s[64:67], s28 offen offset:2048 sc1
 v_and_b32 v1, 15, v0
 v_lshrrev_b32 v3, 1, v1
 v_xor_b32 v3, v3, v2
 v_lshlrev_b32 v3, 4, v3
 v_lshl_add_u32 v3, v1, 7, v3
 v_add_u32 v234, 65536, v3
 v_xor_b32 v235, 64, v234
 v_add_u32 v242, s27, v3
 v_xor_b32 v243, 64, v242
 s_waitcnt vmcnt(19)
 s_barrier
 ds_read_b128 v[8:11], v234
 ds_read_b128 v[12:15], v234 offset:2048
 ds_read_b128 v[16:19], v234 offset:4096
 ds_read_b128 v[20:23], v234 offset:6144
 ds_read_b128 v[24:27], v235
 ds_read_b128 v[28:31], v235 offset:2048
 ds_read_b128 v[32:35], v235 offset:4096
 ds_read_b128 v[36:39], v235 offset:6144
 ds_read_b128 v[40:43], v234 offset:8192
 ds_read_b128 v[44:47], v234 offset:10240
 ds_read_b128 v[48:51], v234 offset:12288
 ds_read_b128 v[52:55], v234 offset:14336
 ds_read_b128 v[56:59], v235 offset:8192
 ds_read_b128 v[60:63], v235 offset:10240
 ds_read_b128 v[64:67], v235 offset:12288
 ds_read_b128 v[68:71], v235 offset:14336
 ds_read_b128 v[72:75], v234 offset:16384
 ds_read_b128 v[76:79], v234 offset:18432
 ds_read_b128 v[80:83], v234 offset:20480
 ds_read_b128 v[84:87], v234 offset:22528
 ds_read_b128 v[88:91], v235 offset:16384
 ds_read_b128 v[92:95], v235 offset:18432
 ds_read_b128 v[96:99], v235 offset:20480
 ds_read_b128 v[100:103], v235 offset:22528
 ds_read_b128 v[104:107], v234 offset:24576
 ds_read_b128 v[108:111], v234 offset:26624
 ds_read_b128 v[112:115], v234 offset:28672
 ds_read_b128 v[116:119], v234 offset:30720
 ds_read_b128 v[120:123], v235 offset:24576
 ds_read_b128 v[124:127], v235 offset:26624
 ds_read_b128 v[128:131], v235 offset:28672
 ds_read_b128 v[132:135], v235 offset:30720
 s_mov_b32 s32, 0x3db8aa3b
 s_mov_b32 s33, s32
 s_lshl_b32 s29, s14, 2
 s_add_u32 s29, s29, s12
 s_mul_i32 s29, s29, 100352
 s_lshl_b32 s25, s15, 11
 s_add_u32 s29, s29, s25
 s_add_u32 s29, s29, 0
 s_waitcnt lgkmcnt(0)
 s_barrier
 s_waitcnt vmcnt(3)
 ds_read_b128 v[200:203], v242
 ds_read_b128 v[204:207], v242 offset:2048
 s_waitcnt lgkmcnt(0)
 v_mfma_f32_16x16x32_bf16 v[136:139], v[8:11], v[200:203], 0
 ds_read_b128 v[208:211], v243
 s_add_u32 m0, s27, 65536
 s_add_u32 s28, s22, 65536
 buffer_load_dwordx4 v238, s[84:87], s28 offen lds
 v_mfma_f32_16x16x32_bf16 v[140:143], v[12:15], v[200:203], 0
 ds_read_b128 v[212:215], v243 offset:2048
 v_mfma_f32_16x16x32_bf16 v[144:147], v[16:19], v[200:203], 0
 s_add_u32 m0, s27, 69632
 s_add_u32 s28, s22, 65664
 buffer_load_dwordx4 v238, s[84:87], s28 offen lds
 v_mfma_f32_16x16x32_bf16 v[148:151], v[20:23], v[200:203], 0
 v_mfma_f32_16x16x32_bf16 v[152:155], v[8:11], v[204:207], 0
 s_add_u32 m0, s27, 73728
 s_add_u32 s28, s22, 65792
 buffer_load_dwordx4 v238, s[84:87], s28 offen lds
 v_mfma_f32_16x16x32_bf16 v[156:159], v[12:15], v[204:207], 0
 v_mfma_f32_16x16x32_bf16 v[160:163], v[16:19], v[204:207], 0
 s_add_u32 m0, s27, 77824
 s_add_u32 s28, s22, 65920
 buffer_load_dwordx4 v238, s[84:87], s28 offen lds
 v_mfma_f32_16x16x32_bf16 v[164:167], v[20:23], v[204:207], 0
 s_waitcnt lgkmcnt(0)
 v_mfma_f32_16x16x32_bf16 v[136:139], v[24:27], v[208:211], v[136:139]
 ds_read_b128 v[200:203], v242 offset:4096
 s_add_u32 m0, s27, 66560
 s_add_u32 s28, s22, 327680
 buffer_load_dwordx4 v239, s[84:87], s28 offen lds
 v_mfma_f32_16x16x32_bf16 v[140:143], v[28:31], v[208:211], v[140:143]
 ds_read_b128 v[204:207], v242 offset:6144
 v_mfma_f32_16x16x32_bf16 v[144:147], v[32:35], v[208:211], v[144:147]
 s_add_u32 m0, s27, 70656
 s_add_u32 s28, s22, 327808
 buffer_load_dwordx4 v239, s[84:87], s28 offen lds
 v_mfma_f32_16x16x32_bf16 v[148:151], v[36:39], v[208:211], v[148:151]
 v_mfma_f32_16x16x32_bf16 v[152:155], v[24:27], v[212:215], v[152:155]
 s_add_u32 m0, s27, 74752
 s_add_u32 s28, s22, 327936
 buffer_load_dwordx4 v239, s[84:87], s28 offen lds
 v_mfma_f32_16x16x32_bf16 v[156:159], v[28:31], v[212:215], v[156:159]
 v_mfma_f32_16x16x32_bf16 v[160:163], v[32:35], v[212:215], v[160:163]
 s_add_u32 m0, s27, 78848
 s_add_u32 s28, s22, 328064
 buffer_load_dwordx4 v239, s[84:87], s28 offen lds
 v_mfma_f32_16x16x32_bf16 v[164:167], v[36:39], v[212:215], v[164:167]
 s_waitcnt lgkmcnt(0)
 v_mfma_f32_16x16x32_bf16 v[136:139], v[40:43], v[200:203], v[136:139]
 ds_read_b128 v[208:211], v243 offset:4096
 s_add_u32 m0, s27, 67584
 s_add_u32 s28, s22, 81920
 buffer_load_dwordx4 v238, s[84:87], s28 offen lds
 v_mfma_f32_16x16x32_bf16 v[140:143], v[44:47], v[200:203], v[140:143]
 ds_read_b128 v[212:215], v243 offset:6144
 v_mfma_f32_16x16x32_bf16 v[144:147], v[48:51], v[200:203], v[144:147]
 s_add_u32 m0, s27, 71680
 s_add_u32 s28, s22, 82048
 buffer_load_dwordx4 v238, s[84:87], s28 offen lds
 v_mfma_f32_16x16x32_bf16 v[148:151], v[52:55], v[200:203], v[148:151]
 v_mfma_f32_16x16x32_bf16 v[152:155], v[40:43], v[204:207], v[152:155]
 s_add_u32 m0, s27, 75776
 s_add_u32 s28, s22, 82176
 buffer_load_dwordx4 v238, s[84:87], s28 offen lds
 v_mfma_f32_16x16x32_bf16 v[156:159], v[44:47], v[204:207], v[156:159]
 v_mfma_f32_16x16x32_bf16 v[160:163], v[48:51], v[204:207], v[160:163]
 s_add_u32 m0, s27, 79872
 s_add_u32 s28, s22, 82304
 buffer_load_dwordx4 v238, s[84:87], s28 offen lds
 v_mfma_f32_16x16x32_bf16 v[164:167], v[52:55], v[204:207], v[164:167]
 s_waitcnt lgkmcnt(0)
 v_mfma_f32_16x16x32_bf16 v[136:139], v[56:59], v[208:211], v[136:139]
 ds_read_b128 v[200:203], v242 offset:8192
 s_add_u32 m0, s27, 68608
 s_add_u32 s28, s22, 344064
 buffer_load_dwordx4 v239, s[84:87], s28 offen lds
 v_mfma_f32_16x16x32_bf16 v[140:143], v[60:63], v[208:211], v[140:143]
 ds_read_b128 v[204:207], v242 offset:10240
 v_mfma_f32_16x16x32_bf16 v[144:147], v[64:67], v[208:211], v[144:147]
 s_add_u32 m0, s27, 72704
 s_add_u32 s28, s22, 344192
 buffer_load_dwordx4 v239, s[84:87], s28 offen lds
 v_mfma_f32_16x16x32_bf16 v[148:151], v[68:71], v[208:211], v[148:151]
 v_mfma_f32_16x16x32_bf16 v[152:155], v[56:59], v[212:215], v[152:155]
 s_add_u32 m0, s27, 76800
 s_add_u32 s28, s22, 344320
 buffer_load_dwordx4 v239, s[84:87], s28 offen lds
 v_mfma_f32_16x16x32_bf16 v[156:159], v[60:63], v[212:215], v[156:159]
 v_mfma_f32_16x16x32_bf16 v[160:163], v[64:67], v[212:215], v[160:163]
 s_add_u32 m0, s27, 80896
 s_add_u32 s28, s22, 344448
 buffer_load_dwordx4 v239, s[84:87], s28 offen lds
 v_mfma_f32_16x16x32_bf16 v[164:167], v[68:71], v[212:215], v[164:167]
 s_waitcnt lgkmcnt(0)
 v_mfma_f32_16x16x32_bf16 v[136:139], v[72:75], v[200:203], v[136:139]
 ds_read_b128 v[208:211], v243 offset:8192
 v_mfma_f32_16x16x32_bf16 v[140:143], v[76:79], v[200:203], v[140:143]
 ds_read_b128 v[212:215], v243 offset:10240
 v_mfma_f32_16x16x32_bf16 v[144:147], v[80:83], v[200:203], v[144:147]
 v_mfma_f32_16x16x32_bf16 v[148:151], v[84:87], v[200:203], v[148:151]
 v_mfma_f32_16x16x32_bf16 v[152:155], v[72:75], v[204:207], v[152:155]
 v_mfma_f32_16x16x32_bf16 v[156:159], v[76:79], v[204:207], v[156:159]
 v_mfma_f32_16x16x32_bf16 v[160:163], v[80:83], v[204:207], v[160:163]
 v_mfma_f32_16x16x32_bf16 v[164:167], v[84:87], v[204:207], v[164:167]
 s_waitcnt lgkmcnt(0)
 v_mfma_f32_16x16x32_bf16 v[136:139], v[88:91], v[208:211], v[136:139]
 ds_read_b128 v[200:203], v242 offset:12288
 v_mfma_f32_16x16x32_bf16 v[140:143], v[92:95], v[208:211], v[140:143]
 ds_read_b128 v[204:207], v242 offset:14336
 v_mfma_f32_16x16x32_bf16 v[144:147], v[96:99], v[208:211], v[144:147]
 v_mfma_f32_16x16x32_bf16 v[148:151], v[100:103], v[208:211], v[148:151]
 v_mfma_f32_16x16x32_bf16 v[152:155], v[88:91], v[212:215], v[152:155]
 v_mfma_f32_16x16x32_bf16 v[156:159], v[92:95], v[212:215], v[156:159]
 v_mfma_f32_16x16x32_bf16 v[160:163], v[96:99], v[212:215], v[160:163]
 v_mfma_f32_16x16x32_bf16 v[164:167], v[100:103], v[212:215], v[164:167]
 s_waitcnt lgkmcnt(0)
 v_mfma_f32_16x16x32_bf16 v[136:139], v[104:107], v[200:203], v[136:139]
 ds_read_b128 v[208:211], v243 offset:12288
 v_mfma_f32_16x16x32_bf16 v[140:143], v[108:111], v[200:203], v[140:143]
 ds_read_b128 v[212:215], v243 offset:14336
 v_mfma_f32_16x16x32_bf16 v[144:147], v[112:115], v[200:203], v[144:147]
 v_mfma_f32_16x16x32_bf16 v[148:151], v[116:119], v[200:203], v[148:151]
 v_mfma_f32_16x16x32_bf16 v[152:155], v[104:107], v[204:207], v[152:155]
 v_mfma_f32_16x16x32_bf16 v[156:159], v[108:111], v[204:207], v[156:159]
 v_mfma_f32_16x16x32_bf16 v[160:163], v[112:115], v[204:207], v[160:163]
 v_mfma_f32_16x16x32_bf16 v[164:167], v[116:119], v[204:207], v[164:167]
 s_waitcnt lgkmcnt(0)
 v_mfma_f32_16x16x32_bf16 v[136:139], v[120:123], v[208:211], v[136:139]
 v_mfma_f32_16x16x32_bf16 v[140:143], v[124:127], v[208:211], v[140:143]
 v_mfma_f32_16x16x32_bf16 v[144:147], v[128:131], v[208:211], v[144:147]
 v_mfma_f32_16x16x32_bf16 v[148:151], v[132:135], v[208:211], v[148:151]
 v_mfma_f32_16x16x32_bf16 v[152:155], v[120:123], v[212:215], v[152:155]
 v_mfma_f32_16x16x32_bf16 v[156:159], v[124:127], v[212:215], v[156:159]
 v_mfma_f32_16x16x32_bf16 v[160:163], v[128:131], v[212:215], v[160:163]
 v_mfma_f32_16x16x32_bf16 v[164:167], v[132:135], v[212:215], v[164:167]
 s_waitcnt vmcnt(0)
 v_xor_b32 v242, 0x10000, v242
 v_xor_b32 v243, 0x10000, v243
 ds_read_b128 v[200:203], v242
 ds_read_b128 v[204:207], v242 offset:2048
 s_waitcnt lgkmcnt(0)
 v_mfma_f32_16x16x32_bf16 v[168:171], v[8:11], v[200:203], 0
 ds_read_b128 v[208:211], v243
 s_add_u32 m0, s27, 0
 s_add_u32 s28, s23, 0
 buffer_load_dwordx4 v240, s[84:87], s28 offen lds
 v_mfma_f32_16x16x32_bf16 v[172:175], v[12:15], v[200:203], 0
 ds_read_b128 v[212:215], v243 offset:2048
 v_mfma_f32_16x16x32_bf16 v[176:179], v[16:19], v[200:203], 0
 s_add_u32 m0, s27, 4096
 s_add_u32 s28, s23, 128
 buffer_load_dwordx4 v240, s[84:87], s28 offen lds
 v_mfma_f32_16x16x32_bf16 v[180:183], v[20:23], v[200:203], 0
 v_pk_mul_f32 v[136:137], v[136:137], s[32:33]
 v_mfma_f32_16x16x32_bf16 v[184:187], v[8:11], v[204:207], 0
 s_add_u32 m0, s27, 8192
 s_add_u32 s28, s23, 256
 buffer_load_dwordx4 v240, s[84:87], s28 offen lds
 v_pk_mul_f32 v[138:139], v[138:139], s[32:33]
 v_mfma_f32_16x16x32_bf16 v[188:191], v[12:15], v[204:207], 0
 v_cvt_pk_bf16_f32 v216, v136, v137
 v_mfma_f32_16x16x32_bf16 v[192:195], v[16:19], v[204:207], 0
 s_add_u32 m0, s27, 12288
 s_add_u32 s28, s23, 384
 buffer_load_dwordx4 v240, s[84:87], s28 offen lds
 v_cvt_pk_bf16_f32 v217, v138, v139
 v_mfma_f32_16x16x32_bf16 v[196:199], v[20:23], v[204:207], 0
 v_pk_mul_f32 v[140:141], v[140:141], s[32:33]
 s_waitcnt lgkmcnt(0)
 v_mfma_f32_16x16x32_bf16 v[168:171], v[24:27], v[208:211], v[168:171]
 ds_read_b128 v[200:203], v242 offset:4096
 s_add_u32 m0, s27, 1024
 s_add_u32 s28, s23, 131072
 buffer_load_dwordx4 v241, s[84:87], s28 offen lds
 v_pk_mul_f32 v[142:143], v[142:143], s[32:33]
 v_mfma_f32_16x16x32_bf16 v[172:175], v[28:31], v[208:211], v[172:175]
 ds_read_b128 v[204:207], v242 offset:6144
 v_cvt_pk_bf16_f32 v218, v140, v141
 v_mfma_f32_16x16x32_bf16 v[176:179], v[32:35], v[208:211], v[176:179]
 s_add_u32 m0, s27, 5120
 s_add_u32 s28, s23, 131200
 buffer_load_dwordx4 v241, s[84:87], s28 offen lds
 v_cvt_pk_bf16_f32 v219, v142, v143
 v_mfma_f32_16x16x32_bf16 v[180:183], v[36:39], v[208:211], v[180:183]
 v_pk_mul_f32 v[144:145], v[144:145], s[32:33]
 v_mfma_f32_16x16x32_bf16 v[184:187], v[24:27], v[212:215], v[184:187]
 s_add_u32 m0, s27, 9216
 s_add_u32 s28, s23, 131328
 buffer_load_dwordx4 v241, s[84:87], s28 offen lds
 v_pk_mul_f32 v[146:147], v[146:147], s[32:33]
 v_mfma_f32_16x16x32_bf16 v[188:191], v[28:31], v[212:215], v[188:191]
 v_cvt_pk_bf16_f32 v220, v144, v145
 v_mfma_f32_16x16x32_bf16 v[192:195], v[32:35], v[212:215], v[192:195]
 s_add_u32 m0, s27, 13312
 s_add_u32 s28, s23, 131456
 buffer_load_dwordx4 v241, s[84:87], s28 offen lds
 v_cvt_pk_bf16_f32 v221, v146, v147
 v_mfma_f32_16x16x32_bf16 v[196:199], v[36:39], v[212:215], v[196:199]
 v_pk_mul_f32 v[148:149], v[148:149], s[32:33]
 s_waitcnt lgkmcnt(0)
 v_mfma_f32_16x16x32_bf16 v[168:171], v[40:43], v[200:203], v[168:171]
 ds_read_b128 v[208:211], v243 offset:4096
 s_add_u32 m0, s27, 2048
 s_add_u32 s28, s23, 16384
 buffer_load_dwordx4 v240, s[84:87], s28 offen lds
 v_pk_mul_f32 v[150:151], v[150:151], s[32:33]
 v_mfma_f32_16x16x32_bf16 v[172:175], v[44:47], v[200:203], v[172:175]
 ds_read_b128 v[212:215], v243 offset:6144
 v_cvt_pk_bf16_f32 v222, v148, v149
 v_mfma_f32_16x16x32_bf16 v[176:179], v[48:51], v[200:203], v[176:179]
 s_add_u32 m0, s27, 6144
 s_add_u32 s28, s23, 16512
 buffer_load_dwordx4 v240, s[84:87], s28 offen lds
 v_cvt_pk_bf16_f32 v223, v150, v151
 v_mfma_f32_16x16x32_bf16 v[180:183], v[52:55], v[200:203], v[180:183]
 s_add_u32 s34, s29, 0
 v_mfma_f32_16x16x32_bf16 v[184:187], v[40:43], v[204:207], v[184:187]
 s_add_u32 m0, s27, 10240
 s_add_u32 s28, s23, 16640
 buffer_load_dwordx4 v240, s[84:87], s28 offen lds
 buffer_store_dwordx4 v[216:219], v236, s[64:67], s34 offen sc1
 v_mfma_f32_16x16x32_bf16 v[188:191], v[44:47], v[204:207], v[188:191]
 buffer_store_dwordx4 v[220:223], v236, s[64:67], s34 offen offset:1024 sc1
 v_mfma_f32_16x16x32_bf16 v[192:195], v[48:51], v[204:207], v[192:195]
 s_add_u32 m0, s27, 14336
 s_add_u32 s28, s23, 16768
 buffer_load_dwordx4 v240, s[84:87], s28 offen lds
 v_pk_mul_f32 v[152:153], v[152:153], s[32:33]
 v_mfma_f32_16x16x32_bf16 v[196:199], v[52:55], v[204:207], v[196:199]
 v_pk_mul_f32 v[154:155], v[154:155], s[32:33]
 s_waitcnt lgkmcnt(0)
 v_mfma_f32_16x16x32_bf16 v[168:171], v[56:59], v[208:211], v[168:171]
 ds_read_b128 v[200:203], v242 offset:8192
 s_add_u32 m0, s27, 3072
 s_add_u32 s28, s23, 147456
 buffer_load_dwordx4 v241, s[84:87], s28 offen lds
 v_cvt_pk_bf16_f32 v224, v152, v153
 v_mfma_f32_16x16x32_bf16 v[172:175], v[60:63], v[208:211], v[172:175]
 ds_read_b128 v[204:207], v242 offset:10240
 v_cvt_pk_bf16_f32 v225, v154, v155
 v_mfma_f32_16x16x32_bf16 v[176:179], v[64:67], v[208:211], v[176:179]
 s_add_u32 m0, s27, 7168
 s_add_u32 s28, s23, 147584
 buffer_load_dwordx4 v241, s[84:87], s28 offen lds
 v_pk_mul_f32 v[156:157], v[156:157], s[32:33]
 v_mfma_f32_16x16x32_bf16 v[180:183], v[68:71], v[208:211], v[180:183]
 v_pk_mul_f32 v[158:159], v[158:159], s[32:33]
 v_mfma_f32_16x16x32_bf16 v[184:187], v[56:59], v[212:215], v[184:187]
 s_add_u32 m0, s27, 11264
 s_add_u32 s28, s23, 147712
 buffer_load_dwordx4 v241, s[84:87], s28 offen lds
 v_cvt_pk_bf16_f32 v226, v156, v157
 v_mfma_f32_16x16x32_bf16 v[188:191], v[60:63], v[212:215], v[188:191]
 v_cvt_pk_bf16_f32 v227, v158, v159
 v_mfma_f32_16x16x32_bf16 v[192:195], v[64:67], v[212:215], v[192:195]
 s_add_u32 m0, s27, 15360
 s_add_u32 s28, s23, 147840
 buffer_load_dwordx4 v241, s[84:87], s28 offen lds
 v_pk_mul_f32 v[160:161], v[160:161], s[32:33]
 v_mfma_f32_16x16x32_bf16 v[196:199], v[68:71], v[212:215], v[196:199]
 v_pk_mul_f32 v[162:163], v[162:163], s[32:33]
 s_waitcnt lgkmcnt(0)
 v_mfma_f32_16x16x32_bf16 v[168:171], v[72:75], v[200:203], v[168:171]
 ds_read_b128 v[208:211], v243 offset:8192
 v_cvt_pk_bf16_f32 v228, v160, v161
 v_mfma_f32_16x16x32_bf16 v[172:175], v[76:79], v[200:203], v[172:175]
 ds_read_b128 v[212:215], v243 offset:10240
 v_cvt_pk_bf16_f32 v229, v162, v163
 v_mfma_f32_16x16x32_bf16 v[176:179], v[80:83], v[200:203], v[176:179]
 v_pk_mul_f32 v[164:165], v[164:165], s[32:33]
 v_mfma_f32_16x16x32_bf16 v[180:183], v[84:87], v[200:203], v[180:183]
 v_pk_mul_f32 v[166:167], v[166:167], s[32:33]
 v_mfma_f32_16x16x32_bf16 v[184:187], v[72:75], v[204:207], v[184:187]
 v_cvt_pk_bf16_f32 v230, v164, v165
 v_mfma_f32_16x16x32_bf16 v[188:191], v[76:79], v[204:207], v[188:191]
 v_cvt_pk_bf16_f32 v231, v166, v167
 v_mfma_f32_16x16x32_bf16 v[192:195], v[80:83], v[204:207], v[192:195]
 s_add_u32 s34, s29, 14336
 v_mfma_f32_16x16x32_bf16 v[196:199], v[84:87], v[204:207], v[196:199]
 buffer_store_dwordx4 v[224:227], v236, s[64:67], s34 offen sc1
 s_waitcnt lgkmcnt(0)
 v_mfma_f32_16x16x32_bf16 v[168:171], v[88:91], v[208:211], v[168:171]
 ds_read_b128 v[200:203], v242 offset:12288
 buffer_store_dwordx4 v[228:231], v236, s[64:67], s34 offen offset:1024 sc1
 v_mfma_f32_16x16x32_bf16 v[172:175], v[92:95], v[208:211], v[172:175]
 ds_read_b128 v[204:207], v242 offset:14336
 v_mfma_f32_16x16x32_bf16 v[176:179], v[96:99], v[208:211], v[176:179]
 v_mfma_f32_16x16x32_bf16 v[180:183], v[100:103], v[208:211], v[180:183]
 v_mfma_f32_16x16x32_bf16 v[184:187], v[88:91], v[212:215], v[184:187]
 v_mfma_f32_16x16x32_bf16 v[188:191], v[92:95], v[212:215], v[188:191]
 v_mfma_f32_16x16x32_bf16 v[192:195], v[96:99], v[212:215], v[192:195]
 v_mfma_f32_16x16x32_bf16 v[196:199], v[100:103], v[212:215], v[196:199]
 s_waitcnt lgkmcnt(0)
 v_mfma_f32_16x16x32_bf16 v[168:171], v[104:107], v[200:203], v[168:171]
 ds_read_b128 v[208:211], v243 offset:12288
 v_mfma_f32_16x16x32_bf16 v[172:175], v[108:111], v[200:203], v[172:175]
 ds_read_b128 v[212:215], v243 offset:14336
 v_mfma_f32_16x16x32_bf16 v[176:179], v[112:115], v[200:203], v[176:179]
 v_mfma_f32_16x16x32_bf16 v[180:183], v[116:119], v[200:203], v[180:183]
 v_mfma_f32_16x16x32_bf16 v[184:187], v[104:107], v[204:207], v[184:187]
 v_mfma_f32_16x16x32_bf16 v[188:191], v[108:111], v[204:207], v[188:191]
 v_mfma_f32_16x16x32_bf16 v[192:195], v[112:115], v[204:207], v[192:195]
 v_mfma_f32_16x16x32_bf16 v[196:199], v[116:119], v[204:207], v[196:199]
 s_waitcnt lgkmcnt(0)
 v_mfma_f32_16x16x32_bf16 v[168:171], v[120:123], v[208:211], v[168:171]
 v_mfma_f32_16x16x32_bf16 v[172:175], v[124:127], v[208:211], v[172:175]
 v_mfma_f32_16x16x32_bf16 v[176:179], v[128:131], v[208:211], v[176:179]
 v_mfma_f32_16x16x32_bf16 v[180:183], v[132:135], v[208:211], v[180:183]
 v_mfma_f32_16x16x32_bf16 v[184:187], v[120:123], v[212:215], v[184:187]
 v_mfma_f32_16x16x32_bf16 v[188:191], v[124:127], v[212:215], v[188:191]
 v_mfma_f32_16x16x32_bf16 v[192:195], v[128:131], v[212:215], v[192:195]
 v_mfma_f32_16x16x32_bf16 v[196:199], v[132:135], v[212:215], v[196:199]
 s_waitcnt vmcnt(2)
 v_xor_b32 v242, 0x10000, v242
 v_xor_b32 v243, 0x10000, v243
 s_cmp_lg_u32 s12, 0
 s_cbranch_scc1 L_tk_3
 s_mov_b64 exec, 1
 s_lshr_b32 s3, s2, 7
 s_and_b32 s3, s3, 1
 s_lshl_b32 s31, s10, 1
 s_add_u32 s3, s3, s31
 s_lshl_b32 s3, s3, 4
 v_mov_b32 v254, s3
 v_mov_b32 v255, 1
 buffer_atomic_add v255, v254, s[72:75], 0 offen sc0
 s_mov_b64 exec, -1
L_tk_3:
 ds_read_b128 v[200:203], v242
 ds_read_b128 v[204:207], v242 offset:2048
 s_waitcnt lgkmcnt(0)
 v_mfma_f32_16x16x32_bf16 v[136:139], v[8:11], v[200:203], 0
 ds_read_b128 v[208:211], v243
 s_add_u32 m0, s27, 65536
 s_add_u32 s28, s24, 0
 buffer_load_dwordx4 v240, s[84:87], s28 offen lds
 v_mfma_f32_16x16x32_bf16 v[140:143], v[12:15], v[200:203], 0
 ds_read_b128 v[212:215], v243 offset:2048
 v_mfma_f32_16x16x32_bf16 v[144:147], v[16:19], v[200:203], 0
 s_add_u32 m0, s27, 69632
 s_add_u32 s28, s24, 128
 buffer_load_dwordx4 v240, s[84:87], s28 offen lds
 v_mfma_f32_16x16x32_bf16 v[148:151], v[20:23], v[200:203], 0
 v_pk_mul_f32 v[168:169], v[168:169], s[32:33]
 v_mfma_f32_16x16x32_bf16 v[152:155], v[8:11], v[204:207], 0
 s_add_u32 m0, s27, 73728
 s_add_u32 s28, s24, 256
 buffer_load_dwordx4 v240, s[84:87], s28 offen lds
 v_pk_mul_f32 v[170:171], v[170:171], s[32:33]
 v_mfma_f32_16x16x32_bf16 v[156:159], v[12:15], v[204:207], 0
 v_cvt_pk_bf16_f32 v216, v168, v169
 v_mfma_f32_16x16x32_bf16 v[160:163], v[16:19], v[204:207], 0
 s_add_u32 m0, s27, 77824
 s_add_u32 s28, s24, 384
 buffer_load_dwordx4 v240, s[84:87], s28 offen lds
 v_cvt_pk_bf16_f32 v217, v170, v171
 v_mfma_f32_16x16x32_bf16 v[164:167], v[20:23], v[204:207], 0
 v_pk_mul_f32 v[172:173], v[172:173], s[32:33]
 s_waitcnt lgkmcnt(0)
 v_mfma_f32_16x16x32_bf16 v[136:139], v[24:27], v[208:211], v[136:139]
 ds_read_b128 v[200:203], v242 offset:4096
 s_add_u32 m0, s27, 66560
 s_add_u32 s28, s24, 131072
 buffer_load_dwordx4 v241, s[84:87], s28 offen lds
 v_pk_mul_f32 v[174:175], v[174:175], s[32:33]
 v_mfma_f32_16x16x32_bf16 v[140:143], v[28:31], v[208:211], v[140:143]
 ds_read_b128 v[204:207], v242 offset:6144
 v_cvt_pk_bf16_f32 v218, v172, v173
 v_mfma_f32_16x16x32_bf16 v[144:147], v[32:35], v[208:211], v[144:147]
 s_add_u32 m0, s27, 70656
 s_add_u32 s28, s24, 131200
 buffer_load_dwordx4 v241, s[84:87], s28 offen lds
 v_cvt_pk_bf16_f32 v219, v174, v175
 v_mfma_f32_16x16x32_bf16 v[148:151], v[36:39], v[208:211], v[148:151]
 v_pk_mul_f32 v[176:177], v[176:177], s[32:33]
 v_mfma_f32_16x16x32_bf16 v[152:155], v[24:27], v[212:215], v[152:155]
 s_add_u32 m0, s27, 74752
 s_add_u32 s28, s24, 131328
 buffer_load_dwordx4 v241, s[84:87], s28 offen lds
 v_pk_mul_f32 v[178:179], v[178:179], s[32:33]
 v_mfma_f32_16x16x32_bf16 v[156:159], v[28:31], v[212:215], v[156:159]
 v_cvt_pk_bf16_f32 v220, v176, v177
 v_mfma_f32_16x16x32_bf16 v[160:163], v[32:35], v[212:215], v[160:163]
 s_add_u32 m0, s27, 78848
 s_add_u32 s28, s24, 131456
 buffer_load_dwordx4 v241, s[84:87], s28 offen lds
 v_cvt_pk_bf16_f32 v221, v178, v179
 v_mfma_f32_16x16x32_bf16 v[164:167], v[36:39], v[212:215], v[164:167]
 v_pk_mul_f32 v[180:181], v[180:181], s[32:33]
 s_waitcnt lgkmcnt(0)
 v_mfma_f32_16x16x32_bf16 v[136:139], v[40:43], v[200:203], v[136:139]
 ds_read_b128 v[208:211], v243 offset:4096
 v_pk_mul_f32 v[182:183], v[182:183], s[32:33]
 v_mfma_f32_16x16x32_bf16 v[140:143], v[44:47], v[200:203], v[140:143]
 ds_read_b128 v[212:215], v243 offset:6144
 v_cvt_pk_bf16_f32 v222, v180, v181
 v_mfma_f32_16x16x32_bf16 v[144:147], v[48:51], v[200:203], v[144:147]
 v_cvt_pk_bf16_f32 v223, v182, v183
 v_mfma_f32_16x16x32_bf16 v[148:151], v[52:55], v[200:203], v[148:151]
 s_add_u32 s34, s29, 28672
 v_mfma_f32_16x16x32_bf16 v[152:155], v[40:43], v[204:207], v[152:155]
 buffer_store_dwordx4 v[216:219], v236, s[64:67], s34 offen sc1
 v_mfma_f32_16x16x32_bf16 v[156:159], v[44:47], v[204:207], v[156:159]
 buffer_store_dwordx4 v[220:223], v236, s[64:67], s34 offen offset:1024 sc1
 v_mfma_f32_16x16x32_bf16 v[160:163], v[48:51], v[204:207], v[160:163]
 v_pk_mul_f32 v[184:185], v[184:185], s[32:33]
 v_mfma_f32_16x16x32_bf16 v[164:167], v[52:55], v[204:207], v[164:167]
 v_pk_mul_f32 v[186:187], v[186:187], s[32:33]
 s_waitcnt lgkmcnt(0)
 v_mfma_f32_16x16x32_bf16 v[136:139], v[56:59], v[208:211], v[136:139]
 ds_read_b128 v[200:203], v242 offset:8192
 v_cvt_pk_bf16_f32 v224, v184, v185
 v_mfma_f32_16x16x32_bf16 v[140:143], v[60:63], v[208:211], v[140:143]
 ds_read_b128 v[204:207], v242 offset:10240
 v_cvt_pk_bf16_f32 v225, v186, v187
 v_mfma_f32_16x16x32_bf16 v[144:147], v[64:67], v[208:211], v[144:147]
 v_pk_mul_f32 v[188:189], v[188:189], s[32:33]
 v_mfma_f32_16x16x32_bf16 v[148:151], v[68:71], v[208:211], v[148:151]
 v_pk_mul_f32 v[190:191], v[190:191], s[32:33]
 v_mfma_f32_16x16x32_bf16 v[152:155], v[56:59], v[212:215], v[152:155]
 v_cvt_pk_bf16_f32 v226, v188, v189
 v_mfma_f32_16x16x32_bf16 v[156:159], v[60:63], v[212:215], v[156:159]
 v_cvt_pk_bf16_f32 v227, v190, v191
 v_mfma_f32_16x16x32_bf16 v[160:163], v[64:67], v[212:215], v[160:163]
 v_pk_mul_f32 v[192:193], v[192:193], s[32:33]
 v_mfma_f32_16x16x32_bf16 v[164:167], v[68:71], v[212:215], v[164:167]
 v_pk_mul_f32 v[194:195], v[194:195], s[32:33]
 s_waitcnt lgkmcnt(0)
 v_mfma_f32_16x16x32_bf16 v[136:139], v[72:75], v[200:203], v[136:139]
 ds_read_b128 v[208:211], v243 offset:8192
 v_cvt_pk_bf16_f32 v228, v192, v193
 v_mfma_f32_16x16x32_bf16 v[140:143], v[76:79], v[200:203], v[140:143]
 ds_read_b128 v[212:215], v243 offset:10240
 v_cvt_pk_bf16_f32 v229, v194, v195
 v_mfma_f32_16x16x32_bf16 v[144:147], v[80:83], v[200:203], v[144:147]
 v_pk_mul_f32 v[196:197], v[196:197], s[32:33]
 v_mfma_f32_16x16x32_bf16 v[148:151], v[84:87], v[200:203], v[148:151]
 v_pk_mul_f32 v[198:199], v[198:199], s[32:33]
 v_mfma_f32_16x16x32_bf16 v[152:155], v[72:75], v[204:207], v[152:155]
 v_cvt_pk_bf16_f32 v230, v196, v197
 v_mfma_f32_16x16x32_bf16 v[156:159], v[76:79], v[204:207], v[156:159]
 v_cvt_pk_bf16_f32 v231, v198, v199
 v_mfma_f32_16x16x32_bf16 v[160:163], v[80:83], v[204:207], v[160:163]
 s_add_u32 s34, s29, 43008
 v_mfma_f32_16x16x32_bf16 v[164:167], v[84:87], v[204:207], v[164:167]
 buffer_store_dwordx4 v[224:227], v236, s[64:67], s34 offen sc1
 s_waitcnt lgkmcnt(0)
 v_mfma_f32_16x16x32_bf16 v[136:139], v[88:91], v[208:211], v[136:139]
 ds_read_b128 v[200:203], v242 offset:12288
 buffer_store_dwordx4 v[228:231], v236, s[64:67], s34 offen offset:1024 sc1
 v_mfma_f32_16x16x32_bf16 v[140:143], v[92:95], v[208:211], v[140:143]
 ds_read_b128 v[204:207], v242 offset:14336
 v_mfma_f32_16x16x32_bf16 v[144:147], v[96:99], v[208:211], v[144:147]
 v_mfma_f32_16x16x32_bf16 v[148:151], v[100:103], v[208:211], v[148:151]
 v_mfma_f32_16x16x32_bf16 v[152:155], v[88:91], v[212:215], v[152:155]
 v_mfma_f32_16x16x32_bf16 v[156:159], v[92:95], v[212:215], v[156:159]
 v_mfma_f32_16x16x32_bf16 v[160:163], v[96:99], v[212:215], v[160:163]
 v_mfma_f32_16x16x32_bf16 v[164:167], v[100:103], v[212:215], v[164:167]
 s_waitcnt lgkmcnt(0)
 v_mfma_f32_16x16x32_bf16 v[136:139], v[104:107], v[200:203], v[136:139]
 ds_read_b128 v[208:211], v243 offset:12288
 v_mfma_f32_16x16x32_bf16 v[140:143], v[108:111], v[200:203], v[140:143]
 ds_read_b128 v[212:215], v243 offset:14336
 v_mfma_f32_16x16x32_bf16 v[144:147], v[112:115], v[200:203], v[144:147]
 v_mfma_f32_16x16x32_bf16 v[148:151], v[116:119], v[200:203], v[148:151]
 v_mfma_f32_16x16x32_bf16 v[152:155], v[104:107], v[204:207], v[152:155]
 v_mfma_f32_16x16x32_bf16 v[156:159], v[108:111], v[204:207], v[156:159]
 v_mfma_f32_16x16x32_bf16 v[160:163], v[112:115], v[204:207], v[160:163]
 v_mfma_f32_16x16x32_bf16 v[164:167], v[116:119], v[204:207], v[164:167]
 s_waitcnt lgkmcnt(0)
 v_mfma_f32_16x16x32_bf16 v[136:139], v[120:123], v[208:211], v[136:139]
 v_mfma_f32_16x16x32_bf16 v[140:143], v[124:127], v[208:211], v[140:143]
 v_mfma_f32_16x16x32_bf16 v[144:147], v[128:131], v[208:211], v[144:147]
 v_mfma_f32_16x16x32_bf16 v[148:151], v[132:135], v[208:211], v[148:151]
 v_mfma_f32_16x16x32_bf16 v[152:155], v[120:123], v[212:215], v[152:155]
 v_mfma_f32_16x16x32_bf16 v[156:159], v[124:127], v[212:215], v[156:159]
 v_mfma_f32_16x16x32_bf16 v[160:163], v[128:131], v[212:215], v[160:163]
 v_mfma_f32_16x16x32_bf16 v[164:167], v[132:135], v[212:215], v[164:167]
 s_waitcnt vmcnt(4)
 v_xor_b32 v242, 0x10000, v242
 v_xor_b32 v243, 0x10000, v243
 ds_read_b128 v[200:203], v242
 s_waitcnt lgkmcnt(0)
 v_mfma_f32_16x16x32_bf16 v[168:171], v[8:11], v[200:203], 0
 ds_read_b128 v[208:211], v243
 v_mfma_f32_16x16x32_bf16 v[172:175], v[12:15], v[200:203], 0
 v_mfma_f32_16x16x32_bf16 v[176:179], v[16:19], v[200:203], 0
 v_mfma_f32_16x16x32_bf16 v[180:183], v[20:23], v[200:203], 0
 v_pk_mul_f32 v[136:137], v[136:137], s[32:33]
 v_pk_mul_f32 v[138:139], v[138:139], s[32:33]
 s_waitcnt lgkmcnt(0)
 v_mfma_f32_16x16x32_bf16 v[168:171], v[24:27], v[208:211], v[168:171]
 ds_read_b128 v[200:203], v242 offset:4096
 v_cvt_pk_bf16_f32 v216, v136, v137
 v_cvt_pk_bf16_f32 v217, v138, v139
 v_mfma_f32_16x16x32_bf16 v[172:175], v[28:31], v[208:211], v[172:175]
 v_pk_mul_f32 v[140:141], v[140:141], s[32:33]
 v_pk_mul_f32 v[142:143], v[142:143], s[32:33]
 v_mfma_f32_16x16x32_bf16 v[176:179], v[32:35], v[208:211], v[176:179]
 v_cvt_pk_bf16_f32 v218, v140, v141
 v_cvt_pk_bf16_f32 v219, v142, v143
 v_mfma_f32_16x16x32_bf16 v[180:183], v[36:39], v[208:211], v[180:183]
 v_pk_mul_f32 v[144:145], v[144:145], s[32:33]
 v_pk_mul_f32 v[146:147], v[146:147], s[32:33]
 s_waitcnt lgkmcnt(0)
 v_mfma_f32_16x16x32_bf16 v[168:171], v[40:43], v[200:203], v[168:171]
 ds_read_b128 v[208:211], v243 offset:4096
 v_cvt_pk_bf16_f32 v220, v144, v145
 v_cvt_pk_bf16_f32 v221, v146, v147
 v_mfma_f32_16x16x32_bf16 v[172:175], v[44:47], v[200:203], v[172:175]
 v_pk_mul_f32 v[148:149], v[148:149], s[32:33]
 v_pk_mul_f32 v[150:151], v[150:151], s[32:33]
 v_mfma_f32_16x16x32_bf16 v[176:179], v[48:51], v[200:203], v[176:179]
 v_cvt_pk_bf16_f32 v222, v148, v149
 v_cvt_pk_bf16_f32 v223, v150, v151
 v_mfma_f32_16x16x32_bf16 v[180:183], v[52:55], v[200:203], v[180:183]
 s_add_u32 s34, s29, 57344
 buffer_store_dwordx4 v[216:219], v236, s[64:67], s34 offen sc1
 s_waitcnt lgkmcnt(0)
 v_mfma_f32_16x16x32_bf16 v[168:171], v[56:59], v[208:211], v[168:171]
 ds_read_b128 v[200:203], v242 offset:8192
 buffer_store_dwordx4 v[220:223], v236, s[64:67], s34 offen offset:1024 sc1
 v_pk_mul_f32 v[152:153], v[152:153], s[32:33]
 v_mfma_f32_16x16x32_bf16 v[172:175], v[60:63], v[208:211], v[172:175]
 v_pk_mul_f32 v[154:155], v[154:155], s[32:33]
 v_cvt_pk_bf16_f32 v224, v152, v153
 v_mfma_f32_16x16x32_bf16 v[176:179], v[64:67], v[208:211], v[176:179]
 v_cvt_pk_bf16_f32 v225, v154, v155
 v_pk_mul_f32 v[156:157], v[156:157], s[32:33]
 v_mfma_f32_16x16x32_bf16 v[180:183], v[68:71], v[208:211], v[180:183]
 v_pk_mul_f32 v[158:159], v[158:159], s[32:33]
 v_cvt_pk_bf16_f32 v226, v156, v157
 s_waitcnt lgkmcnt(0)
 v_mfma_f32_16x16x32_bf16 v[168:171], v[72:75], v[200:203], v[168:171]
 ds_read_b128 v[208:211], v243 offset:8192
 v_cvt_pk_bf16_f32 v227, v158, v159
 v_pk_mul_f32 v[160:161], v[160:161], s[32:33]
 v_mfma_f32_16x16x32_bf16 v[172:175], v[76:79], v[200:203], v[172:175]
 v_pk_mul_f32 v[162:163], v[162:163], s[32:33]
 v_cvt_pk_bf16_f32 v228, v160, v161
 v_mfma_f32_16x16x32_bf16 v[176:179], v[80:83], v[200:203], v[176:179]
 v_cvt_pk_bf16_f32 v229, v162, v163
 v_pk_mul_f32 v[164:165], v[164:165], s[32:33]
 v_mfma_f32_16x16x32_bf16 v[180:183], v[84:87], v[200:203], v[180:183]
 v_pk_mul_f32 v[166:167], v[166:167], s[32:33]
 v_cvt_pk_bf16_f32 v230, v164, v165
 s_waitcnt lgkmcnt(0)
 v_mfma_f32_16x16x32_bf16 v[168:171], v[88:91], v[208:211], v[168:171]
 ds_read_b128 v[200:203], v242 offset:12288
 v_cvt_pk_bf16_f32 v231, v166, v167
 s_add_u32 s34, s29, 71680
 v_mfma_f32_16x16x32_bf16 v[172:175], v[92:95], v[208:211], v[172:175]
 buffer_store_dwordx4 v[224:227], v236, s[64:67], s34 offen sc1
 buffer_store_dwordx4 v[228:231], v236, s[64:67], s34 offen offset:1024 sc1
 v_mfma_f32_16x16x32_bf16 v[176:179], v[96:99], v[208:211], v[176:179]
 v_mfma_f32_16x16x32_bf16 v[180:183], v[100:103], v[208:211], v[180:183]
 s_waitcnt lgkmcnt(0)
 v_mfma_f32_16x16x32_bf16 v[168:171], v[104:107], v[200:203], v[168:171]
 ds_read_b128 v[208:211], v243 offset:12288
 v_mfma_f32_16x16x32_bf16 v[172:175], v[108:111], v[200:203], v[172:175]
 v_mfma_f32_16x16x32_bf16 v[176:179], v[112:115], v[200:203], v[176:179]
 v_mfma_f32_16x16x32_bf16 v[180:183], v[116:119], v[200:203], v[180:183]
 s_waitcnt lgkmcnt(0)
 v_mfma_f32_16x16x32_bf16 v[168:171], v[120:123], v[208:211], v[168:171]
 v_mfma_f32_16x16x32_bf16 v[172:175], v[124:127], v[208:211], v[172:175]
 v_mfma_f32_16x16x32_bf16 v[176:179], v[128:131], v[208:211], v[176:179]
 v_mfma_f32_16x16x32_bf16 v[180:183], v[132:135], v[208:211], v[180:183]
 s_nop 4
 v_pk_mul_f32 v[168:169], v[168:169], s[32:33]
 v_pk_mul_f32 v[170:171], v[170:171], s[32:33]
 v_cvt_pk_bf16_f32 v216, v168, v169
 v_cvt_pk_bf16_f32 v217, v170, v171
 v_pk_mul_f32 v[172:173], v[172:173], s[32:33]
 v_pk_mul_f32 v[174:175], v[174:175], s[32:33]
 v_cvt_pk_bf16_f32 v218, v172, v173
 v_cvt_pk_bf16_f32 v219, v174, v175
 v_pk_mul_f32 v[176:177], v[176:177], s[32:33]
 v_pk_mul_f32 v[178:179], v[178:179], s[32:33]
 v_cvt_pk_bf16_f32 v220, v176, v177
 v_cvt_pk_bf16_f32 v221, v178, v179
 v_pk_mul_f32 v[180:181], v[180:181], s[32:33]
 v_pk_mul_f32 v[182:183], v[182:183], s[32:33]
 v_cvt_pk_bf16_f32 v222, v180, v181
 v_cvt_pk_bf16_f32 v223, v182, v183
 s_add_u32 s34, s29, 86016
 buffer_store_dwordx4 v[216:219], v236, s[64:67], s34 offen sc1
 buffer_store_dwordx4 v[220:223], v236, s[64:67], s34 offen offset:1024 sc1
 s_mov_b32 s23, s14
 s_mov_b32 s24, 6
 s_branch L_prepdone
L_gemmB:
 s_mov_b32 s80, s48
 s_mov_b32 s81, s49
 s_mov_b32 s82, 3670016
 s_mov_b32 s83, 0x20000
 s_mov_b32 s84, s50
 s_mov_b32 s85, s51
 s_mov_b32 s86, 3670016
 s_mov_b32 s87, 0x20000
 v_lshlrev_b32 v212, 4, v0
 v_and_b32 v1, 7, v0
 v_lshrrev_b32 v2, 4, v0
 v_xor_b32 v1, v1, v2
 v_lshlrev_b32 v1, 4, v1
 v_bfe_u32 v3, v0, 3, 1
 v_bfe_u32 v4, v0, 4, 1
 v_bfe_u32 v5, v0, 5, 1
 v_lshlrev_b32 v6, 3, v4
 v_lshlrev_b32 v7, 2, v5
 v_add3_u32 v6, v6, v7, v3
 v_lshlrev_b32 v6, 13, v6
 v_add_u32 v208, v6, v1
 v_xor_b32 v209, 64, v208
 s_lshr_b32 s20, s12, 1
 s_lshl_b32 s20, s20, 5
 s_and_b32 s21, s12, 1
 s_lshl_b32 s21, s21, 1
 s_add_u32 s20, s20, s21
 s_lshl_b32 s21, s15, 6
 s_add_u32 s20, s20, s21
 s_lshl_b32 s20, s20, 13
 s_lshl_b32 s21, s14, 9
 s_add_u32 s20, s20, s21
 s_lshl_b32 s26, s12, 11
 s_mul_i32 s27, s12, 14336
 s_add_u32 s27, s27, 32768
 s_mul_i32 s22, s14, 229376
 s_lshl_b32 s28, s15, 15
 s_add_u32 s28, s28, s22
 s_lshl_b32 s29, s12, 13
 s_add_u32 s28, s28, s29
 v_lshlrev_b32 v6, 7, v0
 buffer_load_dword v244, v6, s[84:87], s28 offen
 s_add_u32 s29, s15, 0
 s_and_b32 s29, s29, 3
 s_mul_i32 s33, s29, 57344
 s_lshl_b32 s29, s29, 7
 s_add_u32 m0, s26, 0
 s_add_u32 s28, s20, 0
 s_add_u32 s28, s28, s29
 buffer_load_dwordx4 v208, s[80:83], s28 offen lds
 s_add_u32 m0, s26, 1024
 s_add_u32 s28, s20, 131072
 s_add_u32 s28, s28, s29
 buffer_load_dwordx4 v209, s[80:83], s28 offen lds
 s_add_u32 s29, s15, 1
 s_and_b32 s29, s29, 3
 s_mul_i32 s33, s29, 57344
 s_lshl_b32 s29, s29, 7
 s_add_u32 m0, s26, 8192
 s_add_u32 s28, s20, 0
 s_add_u32 s28, s28, s29
 buffer_load_dwordx4 v208, s[80:83], s28 offen lds
 s_add_u32 m0, s26, 9216
 s_add_u32 s28, s20, 131072
 s_add_u32 s28, s28, s29
 buffer_load_dwordx4 v209, s[80:83], s28 offen lds
 s_add_u32 s29, s15, 2
 s_and_b32 s29, s29, 3
 s_mul_i32 s33, s29, 57344
 s_lshl_b32 s29, s29, 7
 s_add_u32 m0, s26, 16384
 s_add_u32 s28, s20, 0
 s_add_u32 s28, s28, s29
 buffer_load_dwordx4 v208, s[80:83], s28 offen lds
 s_add_u32 m0, s26, 17408
 s_add_u32 s28, s20, 131072
 s_add_u32 s28, s28, s29
 buffer_load_dwordx4 v209, s[80:83], s28 offen lds
 s_add_u32 s29, s15, 3
 s_and_b32 s29, s29, 3
 s_mul_i32 s33, s29, 57344
 s_lshl_b32 s29, s29, 7
 s_add_u32 m0, s26, 24576
 s_add_u32 s28, s20, 0
 s_add_u32 s28, s28, s29
 buffer_load_dwordx4 v208, s[80:83], s28 offen lds
 s_add_u32 m0, s26, 25600
 s_add_u32 s28, s20, 131072
 s_add_u32 s28, s28, s29
 buffer_load_dwordx4 v209, s[80:83], s28 offen lds
 s_cmp_lg_u32 s12, 3
 s_cbranch_scc1 L_wk_4
 s_call_b64 s[94:95], L_walk
L_wk_4:
 s_mul_i32 s24, s12, 896
 s_mov_b32 s25, 0x4924925
 s_add_u32 s23, s24, 0
 v_add_u32 v6, s23, v0
 v_mul_hi_u32 v7, s25, v6
 v_mul_u32_u24 v8, 56, v7
 v_sub_u32 v6, v6, v8
 v_bfe_u32 v8, v7, 1, 1
 v_bfe_u32 v9, v7, 3, 1
 v_lshlrev_b32 v9, 1, v9
 v_or_b32 v8, v8, v9
 v_lshlrev_b32 v8, 1, v8
 v_xor_b32 v6, v6, v8
 v_lshlrev_b32 v6, 4, v6
 v_mul_u32_u24 v7, 896, v7
 v_add_u32 v214, v6, v7
 s_add_u32 s23, s24, 64
 v_add_u32 v6, s23, v0
 v_mul_hi_u32 v7, s25, v6
 v_mul_u32_u24 v8, 56, v7
 v_sub_u32 v6, v6, v8
 v_bfe_u32 v8, v7, 1, 1
 v_bfe_u32 v9, v7, 3, 1
 v_lshlrev_b32 v9, 1, v9
 v_or_b32 v8, v8, v9
 v_lshlrev_b32 v8, 1, v8
 v_xor_b32 v6, v6, v8
 v_lshlrev_b32 v6, 4, v6
 v_mul_u32_u24 v7, 896, v7
 v_add_u32 v215, v6, v7
 s_add_u32 s23, s24, 128
 v_add_u32 v6, s23, v0
 v_mul_hi_u32 v7, s25, v6
 v_mul_u32_u24 v8, 56, v7
 v_sub_u32 v6, v6, v8
 v_bfe_u32 v8, v7, 1, 1
 v_bfe_u32 v9, v7, 3, 1
 v_lshlrev_b32 v9, 1, v9
 v_or_b32 v8, v8, v9
 v_lshlrev_b32 v8, 1, v8
 v_xor_b32 v6, v6, v8
 v_lshlrev_b32 v6, 4, v6
 v_mul_u32_u24 v7, 896, v7
 v_add_u32 v216, v6, v7
 s_add_u32 s23, s24, 192
 v_add_u32 v6, s23, v0
 v_mul_hi_u32 v7, s25, v6
 v_mul_u32_u24 v8, 56, v7
 v_sub_u32 v6, v6, v8
 v_bfe_u32 v8, v7, 1, 1
 v_bfe_u32 v9, v7, 3, 1
 v_lshlrev_b32 v9, 1, v9
 v_or_b32 v8, v8, v9
 v_lshlrev_b32 v8, 1, v8
 v_xor_b32 v6, v6, v8
 v_lshlrev_b32 v6, 4, v6
 v_mul_u32_u24 v7, 896, v7
 v_add_u32 v217, v6, v7
 s_add_u32 s23, s24, 256
 v_add_u32 v6, s23, v0
 v_mul_hi_u32 v7, s25, v6
 v_mul_u32_u24 v8, 56, v7
 v_sub_u32 v6, v6, v8
 v_bfe_u32 v8, v7, 1, 1
 v_bfe_u32 v9, v7, 3, 1
 v_lshlrev_b32 v9, 1, v9
 v_or_b32 v8, v8, v9
 v_lshlrev_b32 v8, 1, v8
 v_xor_b32 v6, v6, v8
 v_lshlrev_b32 v6, 4, v6
 v_mul_u32_u24 v7, 896, v7
 v_add_u32 v218, v6, v7
 s_add_u32 s23, s24, 320
 v_add_u32 v6, s23, v0
 v_mul_hi_u32 v7, s25, v6
 v_mul_u32_u24 v8, 56, v7
 v_sub_u32 v6, v6, v8
 v_bfe_u32 v8, v7, 1, 1
 v_bfe_u32 v9, v7, 3, 1
 v_lshlrev_b32 v9, 1, v9
 v_or_b32 v8, v8, v9
 v_lshlrev_b32 v8, 1, v8
 v_xor_b32 v6, v6, v8
 v_lshlrev_b32 v6, 4, v6
 v_mul_u32_u24 v7, 896, v7
 v_add_u32 v219, v6, v7
 s_add_u32 s23, s24, 384
 v_add_u32 v6, s23, v0
 v_mul_hi_u32 v7, s25, v6
 v_mul_u32_u24 v8, 56, v7
 v_sub_u32 v6, v6, v8
 v_bfe_u32 v8, v7, 1, 1
 v_bfe_u32 v9, v7, 3, 1
 v_lshlrev_b32 v9, 1, v9
 v_or_b32 v8, v8, v9
 v_lshlrev_b32 v8, 1, v8
 v_xor_b32 v6, v6, v8
 v_lshlrev_b32 v6, 4, v6
 v_mul_u32_u24 v7, 896, v7
 v_add_u32 v220, v6, v7
 s_add_u32 s23, s24, 448
 v_add_u32 v6, s23, v0
 v_mul_hi_u32 v7, s25, v6
 v_mul_u32_u24 v8, 56, v7
 v_sub_u32 v6, v6, v8
 v_bfe_u32 v8, v7, 1, 1
 v_bfe_u32 v9, v7, 3, 1
 v_lshlrev_b32 v9, 1, v9
 v_or_b32 v8, v8, v9
 v_lshlrev_b32 v8, 1, v8
 v_xor_b32 v6, v6, v8
 v_lshlrev_b32 v6, 4, v6
 v_mul_u32_u24 v7, 896, v7
 v_add_u32 v221, v6, v7
 s_add_u32 s23, s24, 512
 v_add_u32 v6, s23, v0
 v_mul_hi_u32 v7, s25, v6
 v_mul_u32_u24 v8, 56, v7
 v_sub_u32 v6, v6, v8
 v_bfe_u32 v8, v7, 1, 1
 v_bfe_u32 v9, v7, 3, 1
 v_lshlrev_b32 v9, 1, v9
 v_or_b32 v8, v8, v9
 v_lshlrev_b32 v8, 1, v8
 v_xor_b32 v6, v6, v8
 v_lshlrev_b32 v6, 4, v6
 v_mul_u32_u24 v7, 896, v7
 v_add_u32 v222, v6, v7
 s_add_u32 s23, s24, 576
 v_add_u32 v6, s23, v0
 v_mul_hi_u32 v7, s25, v6
 v_mul_u32_u24 v8, 56, v7
 v_sub_u32 v6, v6, v8
 v_bfe_u32 v8, v7, 1, 1
 v_bfe_u32 v9, v7, 3, 1
 v_lshlrev_b32 v9, 1, v9
 v_or_b32 v8, v8, v9
 v_lshlrev_b32 v8, 1, v8
 v_xor_b32 v6, v6, v8
 v_lshlrev_b32 v6, 4, v6
 v_mul_u32_u24 v7, 896, v7
 v_add_u32 v223, v6, v7
 s_add_u32 s23, s24, 640
 v_add_u32 v6, s23, v0
 v_mul_hi_u32 v7, s25, v6
 v_mul_u32_u24 v8, 56, v7
 v_sub_u32 v6, v6, v8
 v_bfe_u32 v8, v7, 1, 1
 v_bfe_u32 v9, v7, 3, 1
 v_lshlrev_b32 v9, 1, v9
 v_or_b32 v8, v8, v9
 v_lshlrev_b32 v8, 1, v8
 v_xor_b32 v6, v6, v8
 v_lshlrev_b32 v6, 4, v6
 v_mul_u32_u24 v7, 896, v7
 v_add_u32 v224, v6, v7
 s_add_u32 s23, s24, 704
 v_add_u32 v6, s23, v0
 v_mul_hi_u32 v7, s25, v6
 v_mul_u32_u24 v8, 56, v7
 v_sub_u32 v6, v6, v8
 v_bfe_u32 v8, v7, 1, 1
 v_bfe_u32 v9, v7, 3, 1
 v_lshlrev_b32 v9, 1, v9
 v_or_b32 v8, v8, v9
 v_lshlrev_b32 v8, 1, v8
 v_xor_b32 v6, v6, v8
 v_lshlrev_b32 v6, 4, v6
 v_mul_u32_u24 v7, 896, v7
 v_add_u32 v225, v6, v7
 s_add_u32 s23, s24, 768
 v_add_u32 v6, s23, v0
 v_mul_hi_u32 v7, s25, v6
 v_mul_u32_u24 v8, 56, v7
 v_sub_u32 v6, v6, v8
 v_bfe_u32 v8, v7, 1, 1
 v_bfe_u32 v9, v7, 3, 1
 v_lshlrev_b32 v9, 1, v9
 v_or_b32 v8, v8, v9
 v_lshlrev_b32 v8, 1, v8
 v_xor_b32 v6, v6, v8
 v_lshlrev_b32 v6, 4, v6
 v_mul_u32_u24 v7, 896, v7
 v_add_u32 v226, v6, v7
 s_add_u32 s23, s24, 832
 v_add_u32 v6, s23, v0
 v_mul_hi_u32 v7, s25, v6
 v_mul_u32_u24 v8, 56, v7
 v_sub_u32 v6, v6, v8
 v_bfe_u32 v8, v7, 1, 1
 v_bfe_u32 v9, v7, 3, 1
 v_lshlrev_b32 v9, 1, v9
 v_or_b32 v8, v8, v9
 v_lshlrev_b32 v8, 1, v8
 v_xor_b32 v6, v6, v8
 v_lshlrev_b32 v6, 4, v6
 v_mul_u32_u24 v7, 896, v7
 v_add_u32 v227, v6, v7
 s_add_u32 s29, s15, 0
 s_and_b32 s29, s29, 3
 s_mul_i32 s33, s29, 57344
 s_lshl_b32 s29, s29, 7
 s_add_u32 s33, s22, s33
 s_add_u32 m0, s27, 0
 s_nop 0
 buffer_load_dwordx4 v214, s[84:87], s33 offen lds
 s_add_u32 m0, s27, 1024
 s_nop 0
 buffer_load_dwordx4 v215, s[84:87], s33 offen lds
 s_add_u32 m0, s27, 2048
 s_nop 0
 buffer_load_dwordx4 v216, s[84:87], s33 offen lds
 s_add_u32 m0, s27, 3072
 s_nop 0
 buffer_load_dwordx4 v217, s[84:87], s33 offen lds
 s_add_u32 m0, s27, 4096
 s_nop 0
 buffer_load_dwordx4 v218, s[84:87], s33 offen lds
 s_add_u32 m0, s27, 5120
 s_nop 0
 buffer_load_dwordx4 v219, s[84:87], s33 offen lds
 s_add_u32 m0, s27, 6144
 s_nop 0
 buffer_load_dwordx4 v220, s[84:87], s33 offen lds
 s_add_u32 m0, s27, 7168
 s_nop 0
 buffer_load_dwordx4 v221, s[84:87], s33 offen lds
 s_add_u32 m0, s27, 8192
 s_nop 0
 buffer_load_dwordx4 v222, s[84:87], s33 offen lds
 s_add_u32 m0, s27, 9216
 s_nop 0
 buffer_load_dwordx4 v223, s[84:87], s33 offen lds
 s_add_u32 m0, s27, 10240
 s_nop 0
 buffer_load_dwordx4 v224, s[84:87], s33 offen lds
 s_add_u32 m0, s27, 11264
 s_nop 0
 buffer_load_dwordx4 v225, s[84:87], s33 offen lds
 s_add_u32 m0, s27, 12288
 s_nop 0
 buffer_load_dwordx4 v226, s[84:87], s33 offen lds
 s_add_u32 m0, s27, 13312
 s_nop 0
 buffer_load_dwordx4 v227, s[84:87], s33 offen lds
 v_and_b32 v1, 15, v0
 v_lshrrev_b32 v2, 4, v0
 v_lshrrev_b32 v3, 1, v1
 v_xor_b32 v3, v3, v2
 v_lshlrev_b32 v3, 4, v3
 v_lshlrev_b32 v4, 7, v1
 v_add_u32 v210, v3, v4
 v_xor_b32 v211, 64, v210
 v_lshrrev_b32 v3, 2, v1
 v_and_b32 v4, 3, v0
 v_lshlrev_b32 v5, 3, v2
 v_add_u32 v5, v5, v3
 v_mul_u32_u24 v5, 896, v5
 v_lshlrev_b32 v4, 3, v4
 v_add_u32 v5, v5, v4
 v_add_u32 v5, 32768, v5
 v_lshrrev_b32 v3, 1, v3
 v_and_b32 v4, 1, v2
 v_lshlrev_b32 v4, 1, v4
 v_or_b32 v3, v3, v4
 s_mul_i32 s23, s12, 7
 s_add_u32 s24, s23, 0
 v_xor_b32 v4, s24, v3
 v_lshlrev_b32 v4, 5, v4
 v_add_u32 v230, v4, v5
 s_add_u32 s24, s23, 1
 v_xor_b32 v4, s24, v3
 v_lshlrev_b32 v4, 5, v4
 v_add_u32 v231, v4, v5
 s_add_u32 s24, s23, 2
 v_xor_b32 v4, s24, v3
 v_lshlrev_b32 v4, 5, v4
 v_add_u32 v232, v4, v5
 s_add_u32 s24, s23, 3
 v_xor_b32 v4, s24, v3
 v_lshlrev_b32 v4, 5, v4
 v_add_u32 v233, v4, v5
 s_add_u32 s24, s23, 4
 v_xor_b32 v4, s24, v3
 v_lshlrev_b32 v4, 5, v4
 v_add_u32 v234, v4, v5
 s_add_u32 s24, s23, 5
 v_xor_b32 v4, s24, v3
 v_lshlrev_b32 v4, 5, v4
 v_add_u32 v235, v4, v5
 s_add_u32 s24, s23, 6
 v_xor_b32 v4, s24, v3
 v_lshlrev_b32 v4, 5, v4
 v_add_u32 v236, v4, v5
 s_waitcnt vmcnt(0)
 s_barrier
 ds_read_b128 v[120:123], v210
 ds_read_b128 v[124:127], v210 offset:2048
 ds_read_b128 v[128:131], v210 offset:4096
 ds_read_b128 v[132:135], v210 offset:6144
 ds_read_b64_tr_b16 v[136:137], v230
 ds_read_b64_tr_b16 v[138:139], v230 offset:3584
 ds_read_b64_tr_b16 v[140:141], v231
 ds_read_b64_tr_b16 v[142:143], v231 offset:3584
 ds_read_b64_tr_b16 v[144:145], v232
 ds_read_b64_tr_b16 v[146:147], v232 offset:3584
 ds_read_b64_tr_b16 v[148:149], v233
 ds_read_b64_tr_b16 v[150:151], v233 offset:3584
 ds_read_b64_tr_b16 v[152:153], v234
 ds_read_b64_tr_b16 v[154:155], v234 offset:3584
 ds_read_b64_tr_b16 v[156:157], v235
 ds_read_b64_tr_b16 v[158:159], v235 offset:3584
 ds_read_b64_tr_b16 v[160:161], v236
 ds_read_b64_tr_b16 v[162:163], v236 offset:3584
 s_add_u32 s35, s15, 1
 s_and_b32 s35, s35, 3
 s_mul_i32 s36, s35, 57344
 s_lshl_b32 s35, s35, 7
 s_add_u32 s36, s22, s36
 s_add_u32 m0, s27, 57344
 s_nop 0
 buffer_load_dwordx4 v214, s[84:87], s36 offen lds
 s_add_u32 m0, s27, 58368
 s_nop 0
 buffer_load_dwordx4 v215, s[84:87], s36 offen lds
 s_waitcnt lgkmcnt(0)
 v_mfma_f32_16x16x32_bf16 v[8:11], v[120:123], v[136:139], 0
 ds_read_b128 v[164:167], v211
 s_add_u32 m0, s27, 59392
 s_nop 0
 buffer_load_dwordx4 v216, s[84:87], s36 offen lds
 v_mfma_f32_16x16x32_bf16 v[12:15], v[124:127], v[136:139], 0
 ds_read_b128 v[168:171], v211 offset:2048
 v_mfma_f32_16x16x32_bf16 v[16:19], v[128:131], v[136:139], 0
 ds_read_b128 v[172:175], v211 offset:4096
 v_mfma_f32_16x16x32_bf16 v[20:23], v[132:135], v[136:139], 0
 ds_read_b128 v[176:179], v211 offset:6144
 s_add_u32 m0, s27, 60416
 s_nop 0
 buffer_load_dwordx4 v217, s[84:87], s36 offen lds
 v_mfma_f32_16x16x32_bf16 v[24:27], v[120:123], v[140:143], 0
 ds_read_b64_tr_b16 v[180:181], v230 offset:28672
 v_mfma_f32_16x16x32_bf16 v[28:31], v[124:127], v[140:143], 0
 ds_read_b64_tr_b16 v[182:183], v230 offset:32256
 v_mfma_f32_16x16x32_bf16 v[32:35], v[128:131], v[140:143], 0
 ds_read_b64_tr_b16 v[184:185], v231 offset:28672
 s_add_u32 m0, s27, 61440
 s_nop 0
 buffer_load_dwordx4 v218, s[84:87], s36 offen lds
 v_mfma_f32_16x16x32_bf16 v[36:39], v[132:135], v[140:143], 0
 ds_read_b64_tr_b16 v[186:187], v231 offset:32256
 v_mfma_f32_16x16x32_bf16 v[40:43], v[120:123], v[144:147], 0
 ds_read_b64_tr_b16 v[188:189], v232 offset:28672
 v_mfma_f32_16x16x32_bf16 v[44:47], v[124:127], v[144:147], 0
 ds_read_b64_tr_b16 v[190:191], v232 offset:32256
 s_add_u32 m0, s27, 62464
 s_nop 0
 buffer_load_dwordx4 v219, s[84:87], s36 offen lds
 v_mfma_f32_16x16x32_bf16 v[48:51], v[128:131], v[144:147], 0
 ds_read_b64_tr_b16 v[192:193], v233 offset:28672
 v_mfma_f32_16x16x32_bf16 v[52:55], v[132:135], v[144:147], 0
 ds_read_b64_tr_b16 v[194:195], v233 offset:32256
 v_mfma_f32_16x16x32_bf16 v[56:59], v[120:123], v[148:151], 0
 ds_read_b64_tr_b16 v[196:197], v234 offset:28672
 s_add_u32 m0, s27, 63488
 s_nop 0
 buffer_load_dwordx4 v220, s[84:87], s36 offen lds
 v_mfma_f32_16x16x32_bf16 v[60:63], v[124:127], v[148:151], 0
 ds_read_b64_tr_b16 v[198:199], v234 offset:32256
 v_mfma_f32_16x16x32_bf16 v[64:67], v[128:131], v[148:151], 0
 ds_read_b64_tr_b16 v[200:201], v235 offset:28672
 v_mfma_f32_16x16x32_bf16 v[68:71], v[132:135], v[148:151], 0
 ds_read_b64_tr_b16 v[202:203], v235 offset:32256
 s_add_u32 m0, s27, 64512
 s_nop 0
 buffer_load_dwordx4 v221, s[84:87], s36 offen lds
 v_mfma_f32_16x16x32_bf16 v[72:75], v[120:123], v[152:155], 0
 ds_read_b64_tr_b16 v[204:205], v236 offset:28672
 v_mfma_f32_16x16x32_bf16 v[76:79], v[124:127], v[152:155], 0
 ds_read_b64_tr_b16 v[206:207], v236 offset:32256
 v_mfma_f32_16x16x32_bf16 v[80:83], v[128:131], v[152:155], 0
 s_add_u32 m0, s27, 65536
 s_nop 0
 buffer_load_dwordx4 v222, s[84:87], s36 offen lds
 v_mfma_f32_16x16x32_bf16 v[84:87], v[132:135], v[152:155], 0
 v_mfma_f32_16x16x32_bf16 v[88:91], v[120:123], v[156:159], 0
 v_mfma_f32_16x16x32_bf16 v[92:95], v[124:127], v[156:159], 0
 s_add_u32 m0, s27, 66560
 s_nop 0
 buffer_load_dwordx4 v223, s[84:87], s36 offen lds
 v_mfma_f32_16x16x32_bf16 v[96:99], v[128:131], v[156:159], 0
 v_mfma_f32_16x16x32_bf16 v[100:103], v[132:135], v[156:159], 0
 v_mfma_f32_16x16x32_bf16 v[104:107], v[120:123], v[160:163], 0
 s_add_u32 m0, s27, 67584
 s_nop 0
 buffer_load_dwordx4 v224, s[84:87], s36 offen lds
 v_mfma_f32_16x16x32_bf16 v[108:111], v[124:127], v[160:163], 0
 v_mfma_f32_16x16x32_bf16 v[112:115], v[128:131], v[160:163], 0
 v_mfma_f32_16x16x32_bf16 v[116:119], v[132:135], v[160:163], 0
 s_add_u32 m0, s27, 68608
 s_nop 0
 buffer_load_dwordx4 v225, s[84:87], s36 offen lds
 s_waitcnt lgkmcnt(0)
 v_mfma_f32_16x16x32_bf16 v[8:11], v[164:167], v[180:183], v[8:11]
 s_add_u32 m0, s27, 69632
 s_nop 0
 buffer_load_dwordx4 v226, s[84:87], s36 offen lds
 v_mfma_f32_16x16x32_bf16 v[12:15], v[168:171], v[180:183], v[12:15]
 v_mfma_f32_16x16x32_bf16 v[16:19], v[172:175], v[180:183], v[16:19]
 v_mfma_f32_16x16x32_bf16 v[20:23], v[176:179], v[180:183], v[20:23]
 s_add_u32 m0, s27, 70656
 s_nop 0
 buffer_load_dwordx4 v227, s[84:87], s36 offen lds
 v_mfma_f32_16x16x32_bf16 v[24:27], v[164:167], v[184:187], v[24:27]
 v_mfma_f32_16x16x32_bf16 v[28:31], v[168:171], v[184:187], v[28:31]
 v_mfma_f32_16x16x32_bf16 v[32:35], v[172:175], v[184:187], v[32:35]
 v_mfma_f32_16x16x32_bf16 v[36:39], v[176:179], v[184:187], v[36:39]
 v_mfma_f32_16x16x32_bf16 v[40:43], v[164:167], v[188:191], v[40:43]
 v_mfma_f32_16x16x32_bf16 v[44:47], v[168:171], v[188:191], v[44:47]
 v_mfma_f32_16x16x32_bf16 v[48:51], v[172:175], v[188:191], v[48:51]
 v_mfma_f32_16x16x32_bf16 v[52:55], v[176:179], v[188:191], v[52:55]
 v_mfma_f32_16x16x32_bf16 v[56:59], v[164:167], v[192:195], v[56:59]
 v_mfma_f32_16x16x32_bf16 v[60:63], v[168:171], v[192:195], v[60:63]
 v_mfma_f32_16x16x32_bf16 v[64:67], v[172:175], v[192:195], v[64:67]
 v_mfma_f32_16x16x32_bf16 v[68:71], v[176:179], v[192:195], v[68:71]
 v_mfma_f32_16x16x32_bf16 v[72:75], v[164:167], v[196:199], v[72:75]
 v_mfma_f32_16x16x32_bf16 v[76:79], v[168:171], v[196:199], v[76:79]
 v_mfma_f32_16x16x32_bf16 v[80:83], v[172:175], v[196:199], v[80:83]
 v_mfma_f32_16x16x32_bf16 v[84:87], v[176:179], v[196:199], v[84:87]
 v_mfma_f32_16x16x32_bf16 v[88:91], v[164:167], v[200:203], v[88:91]
 v_mfma_f32_16x16x32_bf16 v[92:95], v[168:171], v[200:203], v[92:95]
 v_mfma_f32_16x16x32_bf16 v[96:99], v[172:175], v[200:203], v[96:99]
 v_mfma_f32_16x16x32_bf16 v[100:103], v[176:179], v[200:203], v[100:103]
 v_mfma_f32_16x16x32_bf16 v[104:107], v[164:167], v[204:207], v[104:107]
 v_mfma_f32_16x16x32_bf16 v[108:111], v[168:171], v[204:207], v[108:111]
 v_mfma_f32_16x16x32_bf16 v[112:115], v[172:175], v[204:207], v[112:115]
 v_mfma_f32_16x16x32_bf16 v[116:119], v[176:179], v[204:207], v[116:119]
 v_add_u32 v230, 57344, v230
 v_add_u32 v231, 57344, v231
 v_add_u32 v232, 57344, v232
 v_add_u32 v233, 57344, v233
 v_add_u32 v234, 57344, v234
 v_add_u32 v235, 57344, v235
 v_add_u32 v236, 57344, v236
 s_waitcnt vmcnt(0)
 s_barrier
 ds_read_b128 v[120:123], v210 offset:8192
 ds_read_b128 v[124:127], v210 offset:10240
 ds_read_b128 v[128:131], v210 offset:12288
 ds_read_b128 v[132:135], v210 offset:14336
 ds_read_b64_tr_b16 v[136:137], v230
 ds_read_b64_tr_b16 v[138:139], v230 offset:3584
 ds_read_b64_tr_b16 v[140:141], v231
 ds_read_b64_tr_b16 v[142:143], v231 offset:3584
 ds_read_b64_tr_b16 v[144:145], v232
 ds_read_b64_tr_b16 v[146:147], v232 offset:3584
 ds_read_b64_tr_b16 v[148:149], v233
 ds_read_b64_tr_b16 v[150:151], v233 offset:3584
 ds_read_b64_tr_b16 v[152:153], v234
 ds_read_b64_tr_b16 v[154:155], v234 offset:3584
 ds_read_b64_tr_b16 v[156:157], v235
 ds_read_b64_tr_b16 v[158:159], v235 offset:3584
 ds_read_b64_tr_b16 v[160:161], v236
 ds_read_b64_tr_b16 v[162:163], v236 offset:3584
 s_add_u32 s29, s15, 2
 s_and_b32 s29, s29, 3
 s_mul_i32 s33, s29, 57344
 s_lshl_b32 s29, s29, 7
 s_add_u32 s33, s22, s33
 s_add_u32 m0, s27, 0
 s_nop 0
 buffer_load_dwordx4 v214, s[84:87], s33 offen lds
 s_add_u32 m0, s27, 1024
 s_nop 0
 buffer_load_dwordx4 v215, s[84:87], s33 offen lds
 s_waitcnt lgkmcnt(0)
 v_mfma_f32_16x16x32_bf16 v[8:11], v[120:123], v[136:139], v[8:11]
 ds_read_b128 v[164:167], v211 offset:8192
 s_add_u32 m0, s27, 2048
 s_nop 0
 buffer_load_dwordx4 v216, s[84:87], s33 offen lds
 v_mfma_f32_16x16x32_bf16 v[12:15], v[124:127], v[136:139], v[12:15]
 ds_read_b128 v[168:171], v211 offset:10240
 v_mfma_f32_16x16x32_bf16 v[16:19], v[128:131], v[136:139], v[16:19]
 ds_read_b128 v[172:175], v211 offset:12288
 v_mfma_f32_16x16x32_bf16 v[20:23], v[132:135], v[136:139], v[20:23]
 ds_read_b128 v[176:179], v211 offset:14336
 s_add_u32 m0, s27, 3072
 s_nop 0
 buffer_load_dwordx4 v217, s[84:87], s33 offen lds
 v_mfma_f32_16x16x32_bf16 v[24:27], v[120:123], v[140:143], v[24:27]
 ds_read_b64_tr_b16 v[180:181], v230 offset:28672
 v_mfma_f32_16x16x32_bf16 v[28:31], v[124:127], v[140:143], v[28:31]
 ds_read_b64_tr_b16 v[182:183], v230 offset:32256
 v_mfma_f32_16x16x32_bf16 v[32:35], v[128:131], v[140:143], v[32:35]
 ds_read_b64_tr_b16 v[184:185], v231 offset:28672
 s_add_u32 m0, s27, 4096
 s_nop 0
 buffer_load_dwordx4 v218, s[84:87], s33 offen lds
 v_mfma_f32_16x16x32_bf16 v[36:39], v[132:135], v[140:143], v[36:39]
 ds_read_b64_tr_b16 v[186:187], v231 offset:32256
 v_mfma_f32_16x16x32_bf16 v[40:43], v[120:123], v[144:147], v[40:43]
 ds_read_b64_tr_b16 v[188:189], v232 offset:28672
 v_mfma_f32_16x16x32_bf16 v[44:47], v[124:127], v[144:147], v[44:47]
 ds_read_b64_tr_b16 v[190:191], v232 offset:32256
 s_add_u32 m0, s27, 5120
 s_nop 0
 buffer_load_dwordx4 v219, s[84:87], s33 offen lds
 v_mfma_f32_16x16x32_bf16 v[48:51], v[128:131], v[144:147], v[48:51]
 ds_read_b64_tr_b16 v[192:193], v233 offset:28672
 v_mfma_f32_16x16x32_bf16 v[52:55], v[132:135], v[144:147], v[52:55]
 ds_read_b64_tr_b16 v[194:195], v233 offset:32256
 v_mfma_f32_16x16x32_bf16 v[56:59], v[120:123], v[148:151], v[56:59]
 ds_read_b64_tr_b16 v[196:197], v234 offset:28672
 s_add_u32 m0, s27, 6144
 s_nop 0
 buffer_load_dwordx4 v220, s[84:87], s33 offen lds
 v_mfma_f32_16x16x32_bf16 v[60:63], v[124:127], v[148:151], v[60:63]
 ds_read_b64_tr_b16 v[198:199], v234 offset:32256
 v_mfma_f32_16x16x32_bf16 v[64:67], v[128:131], v[148:151], v[64:67]
 ds_read_b64_tr_b16 v[200:201], v235 offset:28672
 v_mfma_f32_16x16x32_bf16 v[68:71], v[132:135], v[148:151], v[68:71]
 ds_read_b64_tr_b16 v[202:203], v235 offset:32256
 s_add_u32 m0, s27, 7168
 s_nop 0
 buffer_load_dwordx4 v221, s[84:87], s33 offen lds
 v_mfma_f32_16x16x32_bf16 v[72:75], v[120:123], v[152:155], v[72:75]
 ds_read_b64_tr_b16 v[204:205], v236 offset:28672
 v_mfma_f32_16x16x32_bf16 v[76:79], v[124:127], v[152:155], v[76:79]
 ds_read_b64_tr_b16 v[206:207], v236 offset:32256
 v_mfma_f32_16x16x32_bf16 v[80:83], v[128:131], v[152:155], v[80:83]
 s_add_u32 m0, s27, 8192
 s_nop 0
 buffer_load_dwordx4 v222, s[84:87], s33 offen lds
 v_mfma_f32_16x16x32_bf16 v[84:87], v[132:135], v[152:155], v[84:87]
 v_mfma_f32_16x16x32_bf16 v[88:91], v[120:123], v[156:159], v[88:91]
 v_mfma_f32_16x16x32_bf16 v[92:95], v[124:127], v[156:159], v[92:95]
 s_add_u32 m0, s27, 9216
 s_nop 0
 buffer_load_dwordx4 v223, s[84:87], s33 offen lds
 v_mfma_f32_16x16x32_bf16 v[96:99], v[128:131], v[156:159], v[96:99]
 v_mfma_f32_16x16x32_bf16 v[100:103], v[132:135], v[156:159], v[100:103]
 v_mfma_f32_16x16x32_bf16 v[104:107], v[120:123], v[160:163], v[104:107]
 s_add_u32 m0, s27, 10240
 s_nop 0
 buffer_load_dwordx4 v224, s[84:87], s33 offen lds
 v_mfma_f32_16x16x32_bf16 v[108:111], v[124:127], v[160:163], v[108:111]
 v_mfma_f32_16x16x32_bf16 v[112:115], v[128:131], v[160:163], v[112:115]
 v_mfma_f32_16x16x32_bf16 v[116:119], v[132:135], v[160:163], v[116:119]
 s_add_u32 m0, s27, 11264
 s_nop 0
 buffer_load_dwordx4 v225, s[84:87], s33 offen lds
 s_waitcnt lgkmcnt(0)
 v_mfma_f32_16x16x32_bf16 v[8:11], v[164:167], v[180:183], v[8:11]
 s_add_u32 m0, s27, 12288
 s_nop 0
 buffer_load_dwordx4 v226, s[84:87], s33 offen lds
 v_mfma_f32_16x16x32_bf16 v[12:15], v[168:171], v[180:183], v[12:15]
 v_mfma_f32_16x16x32_bf16 v[16:19], v[172:175], v[180:183], v[16:19]
 v_mfma_f32_16x16x32_bf16 v[20:23], v[176:179], v[180:183], v[20:23]
 s_add_u32 m0, s27, 13312
 s_nop 0
 buffer_load_dwordx4 v227, s[84:87], s33 offen lds
 v_mfma_f32_16x16x32_bf16 v[24:27], v[164:167], v[184:187], v[24:27]
 v_mfma_f32_16x16x32_bf16 v[28:31], v[168:171], v[184:187], v[28:31]
 v_mfma_f32_16x16x32_bf16 v[32:35], v[172:175], v[184:187], v[32:35]
 v_mfma_f32_16x16x32_bf16 v[36:39], v[176:179], v[184:187], v[36:39]
 v_mfma_f32_16x16x32_bf16 v[40:43], v[164:167], v[188:191], v[40:43]
 v_mfma_f32_16x16x32_bf16 v[44:47], v[168:171], v[188:191], v[44:47]
 v_mfma_f32_16x16x32_bf16 v[48:51], v[172:175], v[188:191], v[48:51]
 v_mfma_f32_16x16x32_bf16 v[52:55], v[176:179], v[188:191], v[52:55]
 v_mfma_f32_16x16x32_bf16 v[56:59], v[164:167], v[192:195], v[56:59]
 v_mfma_f32_16x16x32_bf16 v[60:63], v[168:171], v[192:195], v[60:63]
 v_mfma_f32_16x16x32_bf16 v[64:67], v[172:175], v[192:195], v[64:67]
 v_mfma_f32_16x16x32_bf16 v[68:71], v[176:179], v[192:195], v[68:71]
 v_mfma_f32_16x16x32_bf16 v[72:75], v[164:167], v[196:199], v[72:75]
 v_mfma_f32_16x16x32_bf16 v[76:79], v[168:171], v[196:199], v[76:79]
 v_mfma_f32_16x16x32_bf16 v[80:83], v[172:175], v[196:199], v[80:83]
 v_mfma_f32_16x16x32_bf16 v[84:87], v[176:179], v[196:199], v[84:87]
 v_mfma_f32_16x16x32_bf16 v[88:91], v[164:167], v[200:203], v[88:91]
 v_mfma_f32_16x16x32_bf16 v[92:95], v[168:171], v[200:203], v[92:95]
 v_mfma_f32_16x16x32_bf16 v[96:99], v[172:175], v[200:203], v[96:99]
 v_mfma_f32_16x16x32_bf16 v[100:103], v[176:179], v[200:203], v[100:103]
 v_mfma_f32_16x16x32_bf16 v[104:107], v[164:167], v[204:207], v[104:107]
 v_mfma_f32_16x16x32_bf16 v[108:111], v[168:171], v[204:207], v[108:111]
 v_mfma_f32_16x16x32_bf16 v[112:115], v[172:175], v[204:207], v[112:115]
 v_mfma_f32_16x16x32_bf16 v[116:119], v[176:179], v[204:207], v[116:119]
 v_add_u32 v230, -57344, v230
 v_add_u32 v231, -57344, v231
 v_add_u32 v232, -57344, v232
 v_add_u32 v233, -57344, v233
 v_add_u32 v234, -57344, v234
 v_add_u32 v235, -57344, v235
 v_add_u32 v236, -57344, v236
 s_waitcnt vmcnt(0)
 s_barrier
 ds_read_b128 v[120:123], v210 offset:16384
 ds_read_b128 v[124:127], v210 offset:18432
 ds_read_b128 v[128:131], v210 offset:20480
 ds_read_b128 v[132:135], v210 offset:22528
 ds_read_b64_tr_b16 v[136:137], v230
 ds_read_b64_tr_b16 v[138:139], v230 offset:3584
 ds_read_b64_tr_b16 v[140:141], v231
 ds_read_b64_tr_b16 v[142:143], v231 offset:3584
 ds_read_b64_tr_b16 v[144:145], v232
 ds_read_b64_tr_b16 v[146:147], v232 offset:3584
 ds_read_b64_tr_b16 v[148:149], v233
 ds_read_b64_tr_b16 v[150:151], v233 offset:3584
 ds_read_b64_tr_b16 v[152:153], v234
 ds_read_b64_tr_b16 v[154:155], v234 offset:3584
 ds_read_b64_tr_b16 v[156:157], v235
 ds_read_b64_tr_b16 v[158:159], v235 offset:3584
 ds_read_b64_tr_b16 v[160:161], v236
 ds_read_b64_tr_b16 v[162:163], v236 offset:3584
 s_add_u32 s35, s15, 3
 s_and_b32 s35, s35, 3
 s_mul_i32 s36, s35, 57344
 s_lshl_b32 s35, s35, 7
 s_add_u32 s36, s22, s36
 s_add_u32 m0, s27, 57344
 s_nop 0
 buffer_load_dwordx4 v214, s[84:87], s36 offen lds
 s_add_u32 m0, s27, 58368
 s_nop 0
 buffer_load_dwordx4 v215, s[84:87], s36 offen lds
 s_waitcnt lgkmcnt(0)
 v_mfma_f32_16x16x32_bf16 v[8:11], v[120:123], v[136:139], v[8:11]
 ds_read_b128 v[164:167], v211 offset:16384
 s_add_u32 m0, s27, 59392
 s_nop 0
 buffer_load_dwordx4 v216, s[84:87], s36 offen lds
 v_mfma_f32_16x16x32_bf16 v[12:15], v[124:127], v[136:139], v[12:15]
 ds_read_b128 v[168:171], v211 offset:18432
 v_mfma_f32_16x16x32_bf16 v[16:19], v[128:131], v[136:139], v[16:19]
 ds_read_b128 v[172:175], v211 offset:20480
 v_mfma_f32_16x16x32_bf16 v[20:23], v[132:135], v[136:139], v[20:23]
 ds_read_b128 v[176:179], v211 offset:22528
 s_add_u32 m0, s27, 60416
 s_nop 0
 buffer_load_dwordx4 v217, s[84:87], s36 offen lds
 v_mfma_f32_16x16x32_bf16 v[24:27], v[120:123], v[140:143], v[24:27]
 ds_read_b64_tr_b16 v[180:181], v230 offset:28672
 v_mfma_f32_16x16x32_bf16 v[28:31], v[124:127], v[140:143], v[28:31]
 ds_read_b64_tr_b16 v[182:183], v230 offset:32256
 v_mfma_f32_16x16x32_bf16 v[32:35], v[128:131], v[140:143], v[32:35]
 ds_read_b64_tr_b16 v[184:185], v231 offset:28672
 s_add_u32 m0, s27, 61440
 s_nop 0
 buffer_load_dwordx4 v218, s[84:87], s36 offen lds
 v_mfma_f32_16x16x32_bf16 v[36:39], v[132:135], v[140:143], v[36:39]
 ds_read_b64_tr_b16 v[186:187], v231 offset:32256
 v_mfma_f32_16x16x32_bf16 v[40:43], v[120:123], v[144:147], v[40:43]
 ds_read_b64_tr_b16 v[188:189], v232 offset:28672
 v_mfma_f32_16x16x32_bf16 v[44:47], v[124:127], v[144:147], v[44:47]
 ds_read_b64_tr_b16 v[190:191], v232 offset:32256
 s_add_u32 m0, s27, 62464
 s_nop 0
 buffer_load_dwordx4 v219, s[84:87], s36 offen lds
 v_mfma_f32_16x16x32_bf16 v[48:51], v[128:131], v[144:147], v[48:51]
 ds_read_b64_tr_b16 v[192:193], v233 offset:28672
 v_mfma_f32_16x16x32_bf16 v[52:55], v[132:135], v[144:147], v[52:55]
 ds_read_b64_tr_b16 v[194:195], v233 offset:32256
 v_mfma_f32_16x16x32_bf16 v[56:59], v[120:123], v[148:151], v[56:59]
 ds_read_b64_tr_b16 v[196:197], v234 offset:28672
 s_add_u32 m0, s27, 63488
 s_nop 0
 buffer_load_dwordx4 v220, s[84:87], s36 offen lds
 v_mfma_f32_16x16x32_bf16 v[60:63], v[124:127], v[148:151], v[60:63]
 ds_read_b64_tr_b16 v[198:199], v234 offset:32256
 v_mfma_f32_16x16x32_bf16 v[64:67], v[128:131], v[148:151], v[64:67]
 ds_read_b64_tr_b16 v[200:201], v235 offset:28672
 v_mfma_f32_16x16x32_bf16 v[68:71], v[132:135], v[148:151], v[68:71]
 ds_read_b64_tr_b16 v[202:203], v235 offset:32256
 s_add_u32 m0, s27, 64512
 s_nop 0
 buffer_load_dwordx4 v221, s[84:87], s36 offen lds
 v_mfma_f32_16x16x32_bf16 v[72:75], v[120:123], v[152:155], v[72:75]
 ds_read_b64_tr_b16 v[204:205], v236 offset:28672
 v_mfma_f32_16x16x32_bf16 v[76:79], v[124:127], v[152:155], v[76:79]
 ds_read_b64_tr_b16 v[206:207], v236 offset:32256
 v_mfma_f32_16x16x32_bf16 v[80:83], v[128:131], v[152:155], v[80:83]
 s_add_u32 m0, s27, 65536
 s_nop 0
 buffer_load_dwordx4 v222, s[84:87], s36 offen lds
 v_mfma_f32_16x16x32_bf16 v[84:87], v[132:135], v[152:155], v[84:87]
 v_mfma_f32_16x16x32_bf16 v[88:91], v[120:123], v[156:159], v[88:91]
 v_mfma_f32_16x16x32_bf16 v[92:95], v[124:127], v[156:159], v[92:95]
 s_add_u32 m0, s27, 66560
 s_nop 0
 buffer_load_dwordx4 v223, s[84:87], s36 offen lds
 v_mfma_f32_16x16x32_bf16 v[96:99], v[128:131], v[156:159], v[96:99]
 v_mfma_f32_16x16x32_bf16 v[100:103], v[132:135], v[156:159], v[100:103]
 v_mfma_f32_16x16x32_bf16 v[104:107], v[120:123], v[160:163], v[104:107]
 s_add_u32 m0, s27, 67584
 s_nop 0
 buffer_load_dwordx4 v224, s[84:87], s36 offen lds
 v_mfma_f32_16x16x32_bf16 v[108:111], v[124:127], v[160:163], v[108:111]
 v_mfma_f32_16x16x32_bf16 v[112:115], v[128:131], v[160:163], v[112:115]
 v_mfma_f32_16x16x32_bf16 v[116:119], v[132:135], v[160:163], v[116:119]
 s_add_u32 m0, s27, 68608
 s_nop 0
 buffer_load_dwordx4 v225, s[84:87], s36 offen lds
 s_waitcnt lgkmcnt(0)
 v_mfma_f32_16x16x32_bf16 v[8:11], v[164:167], v[180:183], v[8:11]
 s_add_u32 m0, s27, 69632
 s_nop 0
 buffer_load_dwordx4 v226, s[84:87], s36 offen lds
 v_mfma_f32_16x16x32_bf16 v[12:15], v[168:171], v[180:183], v[12:15]
 v_mfma_f32_16x16x32_bf16 v[16:19], v[172:175], v[180:183], v[16:19]
 v_mfma_f32_16x16x32_bf16 v[20:23], v[176:179], v[180:183], v[20:23]
 s_add_u32 m0, s27, 70656
 s_nop 0
 buffer_load_dwordx4 v227, s[84:87], s36 offen lds
 v_mfma_f32_16x16x32_bf16 v[24:27], v[164:167], v[184:187], v[24:27]
 v_mfma_f32_16x16x32_bf16 v[28:31], v[168:171], v[184:187], v[28:31]
 v_mfma_f32_16x16x32_bf16 v[32:35], v[172:175], v[184:187], v[32:35]
 v_mfma_f32_16x16x32_bf16 v[36:39], v[176:179], v[184:187], v[36:39]
 v_mfma_f32_16x16x32_bf16 v[40:43], v[164:167], v[188:191], v[40:43]
 v_mfma_f32_16x16x32_bf16 v[44:47], v[168:171], v[188:191], v[44:47]
 v_mfma_f32_16x16x32_bf16 v[48:51], v[172:175], v[188:191], v[48:51]
 v_mfma_f32_16x16x32_bf16 v[52:55], v[176:179], v[188:191], v[52:55]
 v_mfma_f32_16x16x32_bf16 v[56:59], v[164:167], v[192:195], v[56:59]
 v_mfma_f32_16x16x32_bf16 v[60:63], v[168:171], v[192:195], v[60:63]
 v_mfma_f32_16x16x32_bf16 v[64:67], v[172:175], v[192:195], v[64:67]
 v_mfma_f32_16x16x32_bf16 v[68:71], v[176:179], v[192:195], v[68:71]
 v_mfma_f32_16x16x32_bf16 v[72:75], v[164:167], v[196:199], v[72:75]
 v_mfma_f32_16x16x32_bf16 v[76:79], v[168:171], v[196:199], v[76:79]
 v_mfma_f32_16x16x32_bf16 v[80:83], v[172:175], v[196:199], v[80:83]
 v_mfma_f32_16x16x32_bf16 v[84:87], v[176:179], v[196:199], v[84:87]
 v_mfma_f32_16x16x32_bf16 v[88:91], v[164:167], v[200:203], v[88:91]
 v_mfma_f32_16x16x32_bf16 v[92:95], v[168:171], v[200:203], v[92:95]
 v_mfma_f32_16x16x32_bf16 v[96:99], v[172:175], v[200:203], v[96:99]
 v_mfma_f32_16x16x32_bf16 v[100:103], v[176:179], v[200:203], v[100:103]
 v_mfma_f32_16x16x32_bf16 v[104:107], v[164:167], v[204:207], v[104:107]
 v_mfma_f32_16x16x32_bf16 v[108:111], v[168:171], v[204:207], v[108:111]
 v_mfma_f32_16x16x32_bf16 v[112:115], v[172:175], v[204:207], v[112:115]
 v_mfma_f32_16x16x32_bf16 v[116:119], v[176:179], v[204:207], v[116:119]
 v_add_u32 v230, 57344, v230
 v_add_u32 v231, 57344, v231
 v_add_u32 v232, 57344, v232
 v_add_u32 v233, 57344, v233
 v_add_u32 v234, 57344, v234
 v_add_u32 v235, 57344, v235
 v_add_u32 v236, 57344, v236
 s_waitcnt vmcnt(0)
 s_barrier
 s_cmp_lg_u32 s12, 0
 s_cbranch_scc1 L_tk_5
 s_mov_b64 exec, 1
 s_lshr_b32 s3, s2, 7
 s_and_b32 s3, s3, 1
 s_lshl_b32 s31, s10, 1
 s_add_u32 s3, s3, s31
 s_lshl_b32 s3, s3, 4
 v_mov_b32 v254, s3
 v_mov_b32 v255, 1
 buffer_atomic_add v255, v254, s[72:75], 0 offen sc0
 s_mov_b64 exec, -1
L_tk_5:
 v_mov_b32 v240, -1
 v_mov_b32 v241, -1
 v_mov_b32 v242, -1
 v_mov_b32 v243, -1
 s_lshl_b32 s28, s2, 2
 s_add_u32 s28, s28, s12
 s_mul_i32 s28, s28, 3072
 s_add_u32 s28, s28, 50339840
 buffer_store_dwordx4 v[240:243], v212, s[64:67], s28 offen sc1
 buffer_store_dwordx4 v[240:243], v212, s[64:67], s28 offen offset:1024 sc1
 buffer_store_dwordx4 v[240:243], v212, s[64:67], s28 offen offset:2048 sc1
 ds_read_b128 v[120:123], v210 offset:24576
 ds_read_b128 v[124:127], v210 offset:26624
 ds_read_b128 v[128:131], v210 offset:28672
 ds_read_b128 v[132:135], v210 offset:30720
 ds_read_b64_tr_b16 v[136:137], v230
 ds_read_b64_tr_b16 v[138:139], v230 offset:3584
 ds_read_b64_tr_b16 v[140:141], v231
 ds_read_b64_tr_b16 v[142:143], v231 offset:3584
 ds_read_b64_tr_b16 v[144:145], v232
 ds_read_b64_tr_b16 v[146:147], v232 offset:3584
 ds_read_b64_tr_b16 v[148:149], v233
 ds_read_b64_tr_b16 v[150:151], v233 offset:3584
 ds_read_b64_tr_b16 v[152:153], v234
 ds_read_b64_tr_b16 v[154:155], v234 offset:3584
 ds_read_b64_tr_b16 v[156:157], v235
 ds_read_b64_tr_b16 v[158:159], v235 offset:3584
 ds_read_b64_tr_b16 v[160:161], v236
 ds_read_b64_tr_b16 v[162:163], v236 offset:3584
 s_waitcnt lgkmcnt(0)
 v_mfma_f32_16x16x32_bf16 v[8:11], v[120:123], v[136:139], v[8:11]
 ds_read_b128 v[164:167], v211 offset:24576
 v_mfma_f32_16x16x32_bf16 v[12:15], v[124:127], v[136:139], v[12:15]
 ds_read_b128 v[168:171], v211 offset:26624
 v_mfma_f32_16x16x32_bf16 v[16:19], v[128:131], v[136:139], v[16:19]
 ds_read_b128 v[172:175], v211 offset:28672
 v_mfma_f32_16x16x32_bf16 v[20:23], v[132:135], v[136:139], v[20:23]
 ds_read_b128 v[176:179], v211 offset:30720
 v_mfma_f32_16x16x32_bf16 v[24:27], v[120:123], v[140:143], v[24:27]
 ds_read_b64_tr_b16 v[180:181], v230 offset:28672
 v_mfma_f32_16x16x32_bf16 v[28:31], v[124:127], v[140:143], v[28:31]
 ds_read_b64_tr_b16 v[182:183], v230 offset:32256
 v_mfma_f32_16x16x32_bf16 v[32:35], v[128:131], v[140:143], v[32:35]
 ds_read_b64_tr_b16 v[184:185], v231 offset:28672
 v_mfma_f32_16x16x32_bf16 v[36:39], v[132:135], v[140:143], v[36:39]
 ds_read_b64_tr_b16 v[186:187], v231 offset:32256
 v_mfma_f32_16x16x32_bf16 v[40:43], v[120:123], v[144:147], v[40:43]
 ds_read_b64_tr_b16 v[188:189], v232 offset:28672
 v_mfma_f32_16x16x32_bf16 v[44:47], v[124:127], v[144:147], v[44:47]
 ds_read_b64_tr_b16 v[190:191], v232 offset:32256
 v_mfma_f32_16x16x32_bf16 v[48:51], v[128:131], v[144:147], v[48:51]
 ds_read_b64_tr_b16 v[192:193], v233 offset:28672
 v_mfma_f32_16x16x32_bf16 v[52:55], v[132:135], v[144:147], v[52:55]
 ds_read_b64_tr_b16 v[194:195], v233 offset:32256
 v_mfma_f32_16x16x32_bf16 v[56:59], v[120:123], v[148:151], v[56:59]
 ds_read_b64_tr_b16 v[196:197], v234 offset:28672
 v_mfma_f32_16x16x32_bf16 v[60:63], v[124:127], v[148:151], v[60:63]
 ds_read_b64_tr_b16 v[198:199], v234 offset:32256
 v_mfma_f32_16x16x32_bf16 v[64:67], v[128:131], v[148:151], v[64:67]
 ds_read_b64_tr_b16 v[200:201], v235 offset:28672
 v_mfma_f32_16x16x32_bf16 v[68:71], v[132:135], v[148:151], v[68:71]
 ds_read_b64_tr_b16 v[202:203], v235 offset:32256
 v_mfma_f32_16x16x32_bf16 v[72:75], v[120:123], v[152:155], v[72:75]
 ds_read_b64_tr_b16 v[204:205], v236 offset:28672
 v_mfma_f32_16x16x32_bf16 v[76:79], v[124:127], v[152:155], v[76:79]
 ds_read_b64_tr_b16 v[206:207], v236 offset:32256
 v_mfma_f32_16x16x32_bf16 v[80:83], v[128:131], v[152:155], v[80:83]
 v_mfma_f32_16x16x32_bf16 v[84:87], v[132:135], v[152:155], v[84:87]
 v_mfma_f32_16x16x32_bf16 v[88:91], v[120:123], v[156:159], v[88:91]
 v_mfma_f32_16x16x32_bf16 v[92:95], v[124:127], v[156:159], v[92:95]
 v_mfma_f32_16x16x32_bf16 v[96:99], v[128:131], v[156:159], v[96:99]
 v_mfma_f32_16x16x32_bf16 v[100:103], v[132:135], v[156:159], v[100:103]
 v_mfma_f32_16x16x32_bf16 v[104:107], v[120:123], v[160:163], v[104:107]
 v_mfma_f32_16x16x32_bf16 v[108:111], v[124:127], v[160:163], v[108:111]
 v_mfma_f32_16x16x32_bf16 v[112:115], v[128:131], v[160:163], v[112:115]
 v_mfma_f32_16x16x32_bf16 v[116:119], v[132:135], v[160:163], v[116:119]
 s_waitcnt lgkmcnt(0)
 s_mul_i32 s26, s14, 28672
 s_lshl_b32 s23, s15, 11
 s_add_u32 s26, s26, s23
 s_add_u32 s26, s26, 6422528
 s_mul_i32 s23, s12, 7
 v_mfma_f32_16x16x32_bf16 v[8:11], v[164:167], v[180:183], v[8:11]
 v_mfma_f32_16x16x32_bf16 v[12:15], v[168:171], v[180:183], v[12:15]
 v_mfma_f32_16x16x32_bf16 v[16:19], v[172:175], v[180:183], v[16:19]
 v_mfma_f32_16x16x32_bf16 v[20:23], v[176:179], v[180:183], v[20:23]
 v_mfma_f32_16x16x32_bf16 v[24:27], v[164:167], v[184:187], v[24:27]
 v_mfma_f32_16x16x32_bf16 v[28:31], v[168:171], v[184:187], v[28:31]
 v_mfma_f32_16x16x32_bf16 v[32:35], v[172:175], v[184:187], v[32:35]
 v_mfma_f32_16x16x32_bf16 v[36:39], v[176:179], v[184:187], v[36:39]
 v_mfma_f32_16x16x32_bf16 v[40:43], v[164:167], v[188:191], v[40:43]
 v_cvt_pk_bf16_f32 v120, v8, v9
 v_cvt_pk_bf16_f32 v121, v10, v11
 v_cvt_pk_bf16_f32 v122, v12, v13
 v_mfma_f32_16x16x32_bf16 v[44:47], v[168:171], v[188:191], v[44:47]
 v_cvt_pk_bf16_f32 v123, v14, v15
 v_cvt_pk_bf16_f32 v124, v16, v17
 v_cvt_pk_bf16_f32 v125, v18, v19
 v_mfma_f32_16x16x32_bf16 v[48:51], v[172:175], v[188:191], v[48:51]
 v_cvt_pk_bf16_f32 v126, v20, v21
 v_cvt_pk_bf16_f32 v127, v22, v23
 s_add_u32 s24, s23, 0
 s_lshr_b32 s25, s24, 1
 s_mul_i32 s25, s25, 458752
 s_and_b32 s24, s24, 1
 s_mul_i32 s24, s24, 14336
 s_add_u32 s22, s26, s25
 s_add_u32 s22, s22, s24
 v_mfma_f32_16x16x32_bf16 v[52:55], v[176:179], v[188:191], v[52:55]
 buffer_store_dwordx4 v[120:123], v212, s[64:67], s22 offen sc1
 buffer_store_dwordx4 v[124:127], v212, s[64:67], s22 offen offset:1024 sc1
 v_mfma_f32_16x16x32_bf16 v[56:59], v[164:167], v[192:195], v[56:59]
 v_cvt_pk_bf16_f32 v128, v24, v25
 v_cvt_pk_bf16_f32 v129, v26, v27
 v_cvt_pk_bf16_f32 v130, v28, v29
 v_mfma_f32_16x16x32_bf16 v[60:63], v[168:171], v[192:195], v[60:63]
 v_cvt_pk_bf16_f32 v131, v30, v31
 v_cvt_pk_bf16_f32 v132, v32, v33
 v_cvt_pk_bf16_f32 v133, v34, v35
 v_mfma_f32_16x16x32_bf16 v[64:67], v[172:175], v[192:195], v[64:67]
 v_cvt_pk_bf16_f32 v134, v36, v37
 v_cvt_pk_bf16_f32 v135, v38, v39
 s_add_u32 s24, s23, 1
 s_lshr_b32 s25, s24, 1
 s_mul_i32 s25, s25, 458752
 s_and_b32 s24, s24, 1
 s_mul_i32 s24, s24, 14336
 s_add_u32 s22, s26, s25
 s_add_u32 s22, s22, s24
 v_mfma_f32_16x16x32_bf16 v[68:71], v[176:179], v[192:195], v[68:71]
 buffer_store_dwordx4 v[128:131], v212, s[64:67], s22 offen sc1
 buffer_store_dwordx4 v[132:135], v212, s[64:67], s22 offen offset:1024 sc1
 v_mfma_f32_16x16x32_bf16 v[72:75], v[164:167], v[196:199], v[72:75]
 v_cvt_pk_bf16_f32 v120, v40, v41
 v_cvt_pk_bf16_f32 v121, v42, v43
 v_cvt_pk_bf16_f32 v122, v44, v45
 v_mfma_f32_16x16x32_bf16 v[76:79], v[168:171], v[196:199], v[76:79]
 v_cvt_pk_bf16_f32 v123, v46, v47
 v_cvt_pk_bf16_f32 v124, v48, v49
 v_cvt_pk_bf16_f32 v125, v50, v51
 v_mfma_f32_16x16x32_bf16 v[80:83], v[172:175], v[196:199], v[80:83]
 v_cvt_pk_bf16_f32 v126, v52, v53
 v_cvt_pk_bf16_f32 v127, v54, v55
 s_add_u32 s24, s23, 2
 s_lshr_b32 s25, s24, 1
 s_mul_i32 s25, s25, 458752
 s_and_b32 s24, s24, 1
 s_mul_i32 s24, s24, 14336
 s_add_u32 s22, s26, s25
 s_add_u32 s22, s22, s24
 v_mfma_f32_16x16x32_bf16 v[84:87], v[176:179], v[196:199], v[84:87]
 buffer_store_dwordx4 v[120:123], v212, s[64:67], s22 offen sc1
 buffer_store_dwordx4 v[124:127], v212, s[64:67], s22 offen offset:1024 sc1
 v_mfma_f32_16x16x32_bf16 v[88:91], v[164:167], v[200:203], v[88:91]
 v_cvt_pk_bf16_f32 v128, v56, v57
 v_cvt_pk_bf16_f32 v129, v58, v59
 v_cvt_pk_bf16_f32 v130, v60, v61
 v_mfma_f32_16x16x32_bf16 v[92:95], v[168:171], v[200:203], v[92:95]
 v_cvt_pk_bf16_f32 v131, v62, v63
 v_cvt_pk_bf16_f32 v132, v64, v65
 v_cvt_pk_bf16_f32 v133, v66, v67
 v_mfma_f32_16x16x32_bf16 v[96:99], v[172:175], v[200:203], v[96:99]
 v_cvt_pk_bf16_f32 v134, v68, v69
 v_cvt_pk_bf16_f32 v135, v70, v71
 s_add_u32 s24, s23, 3
 s_lshr_b32 s25, s24, 1
 s_mul_i32 s25, s25, 458752
 s_and_b32 s24, s24, 1
 s_mul_i32 s24, s24, 14336
 s_add_u32 s22, s26, s25
 s_add_u32 s22, s22, s24
 v_mfma_f32_16x16x32_bf16 v[100:103], v[176:179], v[200:203], v[100:103]
 buffer_store_dwordx4 v[128:131], v212, s[64:67], s22 offen sc1
 buffer_store_dwordx4 v[132:135], v212, s[64:67], s22 offen offset:1024 sc1
 v_mfma_f32_16x16x32_bf16 v[104:107], v[164:167], v[204:207], v[104:107]
 v_cvt_pk_bf16_f32 v120, v72, v73
 v_cvt_pk_bf16_f32 v121, v74, v75
 v_cvt_pk_bf16_f32 v122, v76, v77
 v_mfma_f32_16x16x32_bf16 v[108:111], v[168:171], v[204:207], v[108:111]
 v_cvt_pk_bf16_f32 v123, v78, v79
 v_cvt_pk_bf16_f32 v124, v80, v81
 v_cvt_pk_bf16_f32 v125, v82, v83
 v_mfma_f32_16x16x32_bf16 v[112:115], v[172:175], v[204:207], v[112:115]
 v_cvt_pk_bf16_f32 v126, v84, v85
 v_cvt_pk_bf16_f32 v127, v86, v87
 s_add_u32 s24, s23, 4
 s_lshr_b32 s25, s24, 1
 s_mul_i32 s25, s25, 458752
 s_and_b32 s24, s24, 1
 s_mul_i32 s24, s24, 14336
 s_add_u32 s22, s26, s25
 s_add_u32 s22, s22, s24
 v_mfma_f32_16x16x32_bf16 v[116:119], v[176:179], v[204:207], v[116:119]
 buffer_store_dwordx4 v[120:123], v212, s[64:67], s22 offen sc1
 buffer_store_dwordx4 v[124:127], v212, s[64:67], s22 offen offset:1024 sc1
 v_cvt_pk_bf16_f32 v128, v88, v89
 v_cvt_pk_bf16_f32 v129, v90, v91
 v_cvt_pk_bf16_f32 v130, v92, v93
 v_cvt_pk_bf16_f32 v131, v94, v95
 v_cvt_pk_bf16_f32 v132, v96, v97
 v_cvt_pk_bf16_f32 v133, v98, v99
 v_cvt_pk_bf16_f32 v134, v100, v101
 v_cvt_pk_bf16_f32 v135, v102, v103
 s_add_u32 s24, s23, 5
 s_lshr_b32 s25, s24, 1
 s_mul_i32 s25, s25, 458752
 s_and_b32 s24, s24, 1
 s_mul_i32 s24, s24, 14336
 s_add_u32 s22, s26, s25
 s_add_u32 s22, s22, s24
 buffer_store_dwordx4 v[128:131], v212, s[64:67], s22 offen sc1
 buffer_store_dwordx4 v[132:135], v212, s[64:67], s22 offen offset:1024 sc1
 v_cvt_pk_bf16_f32 v120, v104, v105
 v_cvt_pk_bf16_f32 v121, v106, v107
 v_cvt_pk_bf16_f32 v122, v108, v109
 v_cvt_pk_bf16_f32 v123, v110, v111
 v_cvt_pk_bf16_f32 v124, v112, v113
 v_cvt_pk_bf16_f32 v125, v114, v115
 v_cvt_pk_bf16_f32 v126, v116, v117
 v_cvt_pk_bf16_f32 v127, v118, v119
 s_add_u32 s24, s23, 6
 s_lshr_b32 s25, s24, 1
 s_mul_i32 s25, s25, 458752
 s_and_b32 s24, s24, 1
 s_mul_i32 s24, s24, 14336
 s_add_u32 s22, s26, s25
 s_add_u32 s22, s22, s24
 buffer_store_dwordx4 v[120:123], v212, s[64:67], s22 offen sc1
 buffer_store_dwordx4 v[124:127], v212, s[64:67], s22 offen offset:1024 sc1
 s_and_b32 s23, s14, 1
 s_add_u32 s23, s23, 16
 s_mov_b32 s24, 55
 s_branch L_prepdone
L_ln:
 v_lshlrev_b32 v1, 4, v0
 v_lshrrev_b32 v2, 2, v0
 v_and_b32 v3, 3, v0
 s_lshl_b32 s14, s13, 6
 s_lshl_b32 s15, s12, 4
 s_add_u32 s14, s14, s15
 s_mul_i32 s20, s14, 896
 v_mul_u32_u24 v176, 896, v2
 v_lshlrev_b32 v177, 4, v3
 v_add_u32 v176, v176, v177
 buffer_load_dwordx4 v[8:11], v176, s[76:79], s20 offen
 buffer_load_dwordx4 v[12:15], v176, s[76:79], s20 offen offset:64
 buffer_load_dwordx4 v[16:19], v176, s[76:79], s20 offen offset:128
 buffer_load_dwordx4 v[20:23], v176, s[76:79], s20 offen offset:192
 buffer_load_dwordx4 v[24:27], v176, s[76:79], s20 offen offset:256
 buffer_load_dwordx4 v[28:31], v176, s[76:79], s20 offen offset:320
 buffer_load_dwordx4 v[32:35], v176, s[76:79], s20 offen offset:384
 buffer_load_dwordx4 v[36:39], v176, s[76:79], s20 offen offset:448
 buffer_load_dwordx4 v[40:43], v176, s[76:79], s20 offen offset:512
 buffer_load_dwordx4 v[44:47], v176, s[76:79], s20 offen offset:576
 buffer_load_dwordx4 v[48:51], v176, s[76:79], s20 offen offset:640
 buffer_load_dwordx4 v[52:55], v176, s[76:79], s20 offen offset:704
 buffer_load_dwordx4 v[56:59], v176, s[76:79], s20 offen offset:768
 buffer_load_dwordx4 v[60:63], v176, s[76:79], s20 offen offset:832
 v_mov_b32 v4, -1
 v_mov_b32 v5, -1
 v_mov_b32 v6, -1
 v_mov_b32 v7, -1
 s_lshl_b32 s28, s2, 2
 s_add_u32 s28, s28, s12
 s_mul_i32 s28, s28, 3072
 s_add_u32 s28, s28, 50339840
 buffer_store_dwordx4 v[4:7], v1, s[64:67], s28 offen sc1
 buffer_store_dwordx4 v[4:7], v1, s[64:67], s28 offen offset:1024 sc1
 buffer_store_dwordx4 v[4:7], v1, s[64:67], s28 offen offset:2048 sc1
 s_cmp_lg_u32 s12, 3
 s_cbranch_scc1 L_wk_6
 s_call_b64 s[94:95], L_walk
L_wk_6:
 s_cmp_lg_u32 s13, 0
 s_cbranch_scc1 L_m0_7
 s_cmp_gt_u32 s12, 1
 s_cbranch_scc1 L_m0_7
 s_mov_b32 s80, s42
 s_mov_b32 s81, s43
 s_mov_b32 s82, 7168
 s_mov_b32 s83, 0x20000
 s_mov_b32 s22, 53485568
 s_cmp_eq_u32 s12, 0
 s_cselect_b32 s22, 50331648, s22
 v_bfe_u32 v178, v0, 2, 2
 v_lshlrev_b32 v178, 1, v178
 v_and_b32 v179, 1, v0
 v_add_u32 v178, v178, v179
 v_mul_u32_u24 v178, 896, v178
 v_lshrrev_b32 v179, 4, v0
 v_lshl_add_u32 v178, v179, 5, v178
 v_bfe_u32 v179, v0, 1, 1
 v_lshl_add_u32 v178, v179, 4, v178
 buffer_load_dwordx4 v[180:183], v178, s[80:83], 0 offen
 buffer_load_dwordx4 v[184:187], v178, s[80:83], 0 offen offset:128
 buffer_load_dwordx4 v[188:191], v178, s[80:83], 0 offen offset:256
 buffer_load_dwordx4 v[192:195], v178, s[80:83], 0 offen offset:384
 buffer_load_dwordx4 v[196:199], v178, s[80:83], 0 offen offset:512
 buffer_load_dwordx4 v[200:203], v178, s[80:83], 0 offen offset:640
 buffer_load_dwordx4 v[204:207], v178, s[80:83], 0 offen offset:768
 s_mov_b32 s34, 0xfffffffe
 s_waitcnt vmcnt(0)
 v_min_u32 v180, s34, v180
 v_min_u32 v181, s34, v181
 v_min_u32 v182, s34, v182
 v_min_u32 v183, s34, v183
 v_min_u32 v184, s34, v184
 v_min_u32 v185, s34, v185
 v_min_u32 v186, s34, v186
 v_min_u32 v187, s34, v187
 v_min_u32 v188, s34, v188
 v_min_u32 v189, s34, v189
 v_min_u32 v190, s34, v190
 v_min_u32 v191, s34, v191
 v_min_u32 v192, s34, v192
 v_min_u32 v193, s34, v193
 v_min_u32 v194, s34, v194
 v_min_u32 v195, s34, v195
 v_min_u32 v196, s34, v196
 v_min_u32 v197, s34, v197
 v_min_u32 v198, s34, v198
 v_min_u32 v199, s34, v199
 v_min_u32 v200, s34, v200
 v_min_u32 v201, s34, v201
 v_min_u32 v202, s34, v202
 v_min_u32 v203, s34, v203
 v_min_u32 v204, s34, v204
 v_min_u32 v205, s34, v205
 v_min_u32 v206, s34, v206
 v_min_u32 v207, s34, v207
 buffer_store_dwordx4 v[180:183], v1, s[64:67], s22 offen sc1
 buffer_store_dwordx4 v[184:187], v1, s[64:67], s22 offen offset:1024 sc1
 buffer_store_dwordx4 v[188:191], v1, s[64:67], s22 offen offset:2048 sc1
 buffer_store_dwordx4 v[192:195], v1, s[64:67], s22 offen offset:3072 sc1
 s_add_u32 s22, s22, 4096
 buffer_store_dwordx4 v[196:199], v1, s[64:67], s22 offen sc1
 buffer_store_dwordx4 v[200:203], v1, s[64:67], s22 offen offset:1024 sc1
 buffer_store_dwordx4 v[204:207], v1, s[64:67], s22 offen offset:2048 sc1
 s_waitcnt vmcnt(0)
L_m0_7:
 s_waitcnt vmcnt(3)
 s_mov_b32 s34, 0xffff0000
 s_mov_b32 s35, 0x3f803f80
 v_mov_b32 v208, 0
 v_mov_b32 v209, 0
 v_mov_b32 v210, s35
 v_dot2c_f32_bf16 v208, v8, v210
 v_dot2c_f32_bf16 v209, v9, v210
 v_dot2c_f32_bf16 v208, v10, v210
 v_dot2c_f32_bf16 v209, v11, v210
 v_dot2c_f32_bf16 v208, v12, v210
 v_dot2c_f32_bf16 v209, v13, v210
 v_dot2c_f32_bf16 v208, v14, v210
 v_dot2c_f32_bf16 v209, v15, v210
 v_dot2c_f32_bf16 v208, v16, v210
 v_dot2c_f32_bf16 v209, v17, v210
 v_dot2c_f32_bf16 v208, v18, v210
 v_dot2c_f32_bf16 v209, v19, v210
 v_dot2c_f32_bf16 v208, v20, v210
 v_dot2c_f32_bf16 v209, v21, v210
 v_dot2c_f32_bf16 v208, v22, v210
 v_dot2c_f32_bf16 v209, v23, v210
 v_dot2c_f32_bf16 v208, v24, v210
 v_dot2c_f32_bf16 v209, v25, v210
 v_dot2c_f32_bf16 v208, v26, v210
 v_dot2c_f32_bf16 v209, v27, v210
 v_dot2c_f32_bf16 v208, v28, v210
 v_dot2c_f32_bf16 v209, v29, v210
 v_dot2c_f32_bf16 v208, v30, v210
 v_dot2c_f32_bf16 v209, v31, v210
 v_dot2c_f32_bf16 v208, v32, v210
 v_dot2c_f32_bf16 v209, v33, v210
 v_dot2c_f32_bf16 v208, v34, v210
 v_dot2c_f32_bf16 v209, v35, v210
 v_dot2c_f32_bf16 v208, v36, v210
 v_dot2c_f32_bf16 v209, v37, v210
 v_dot2c_f32_bf16 v208, v38, v210
 v_dot2c_f32_bf16 v209, v39, v210
 v_dot2c_f32_bf16 v208, v40, v210
 v_dot2c_f32_bf16 v209, v41, v210
 v_dot2c_f32_bf16 v208, v42, v210
 v_dot2c_f32_bf16 v209, v43, v210
 v_dot2c_f32_bf16 v208, v44, v210
 v_dot2c_f32_bf16 v209, v45, v210
 v_dot2c_f32_bf16 v208, v46, v210
 v_dot2c_f32_bf16 v209, v47, v210
 v_dot2c_f32_bf16 v208, v48, v210
 v_dot2c_f32_bf16 v209, v49, v210
 v_dot2c_f32_bf16 v208, v50, v210
 v_dot2c_f32_bf16 v209, v51, v210
 v_dot2c_f32_bf16 v208, v52, v210
 v_dot2c_f32_bf16 v209, v53, v210
 v_dot2c_f32_bf16 v208, v54, v210
 v_dot2c_f32_bf16 v209, v55, v210
 v_dot2c_f32_bf16 v208, v56, v210
 v_dot2c_f32_bf16 v209, v57, v210
 v_dot2c_f32_bf16 v208, v58, v210
 v_dot2c_f32_bf16 v209, v59, v210
 v_dot2c_f32_bf16 v208, v60, v210
 v_dot2c_f32_bf16 v209, v61, v210
 v_dot2c_f32_bf16 v208, v62, v210
 v_dot2c_f32_bf16 v209, v63, v210
 v_lshlrev_b32 v64, 16, v8
 v_and_b32 v65, s34, v8
 v_lshlrev_b32 v66, 16, v9
 v_and_b32 v67, s34, v9
 v_lshlrev_b32 v68, 16, v10
 v_and_b32 v69, s34, v10
 v_lshlrev_b32 v70, 16, v11
 v_and_b32 v71, s34, v11
 v_lshlrev_b32 v72, 16, v12
 v_and_b32 v73, s34, v12
 v_lshlrev_b32 v74, 16, v13
 v_and_b32 v75, s34, v13
 v_lshlrev_b32 v76, 16, v14
 v_and_b32 v77, s34, v14
 v_lshlrev_b32 v78, 16, v15
 v_and_b32 v79, s34, v15
 v_lshlrev_b32 v80, 16, v16
 v_and_b32 v81, s34, v16
 v_lshlrev_b32 v82, 16, v17
 v_and_b32 v83, s34, v17
 v_lshlrev_b32 v84, 16, v18
 v_and_b32 v85, s34, v18
 v_lshlrev_b32 v86, 16, v19
 v_and_b32 v87, s34, v19
 v_lshlrev_b32 v88, 16, v20
 v_and_b32 v89, s34, v20
 v_lshlrev_b32 v90, 16, v21
 v_and_b32 v91, s34, v21
 v_lshlrev_b32 v92, 16, v22
 v_and_b32 v93, s34, v22
 v_lshlrev_b32 v94, 16, v23
 v_and_b32 v95, s34, v23
 v_lshlrev_b32 v96, 16, v24
 v_and_b32 v97, s34, v24
 v_lshlrev_b32 v98, 16, v25
 v_and_b32 v99, s34, v25
 v_lshlrev_b32 v100, 16, v26
 v_and_b32 v101, s34, v26
 v_lshlrev_b32 v102, 16, v27
 v_and_b32 v103, s34, v27
 v_lshlrev_b32 v104, 16, v28
 v_and_b32 v105, s34, v28
 v_lshlrev_b32 v106, 16, v29
 v_and_b32 v107, s34, v29
 v_lshlrev_b32 v108, 16, v30
 v_and_b32 v109, s34, v30
 v_lshlrev_b32 v110, 16, v31
 v_and_b32 v111, s34, v31
 v_lshlrev_b32 v112, 16, v32
 v_and_b32 v113, s34, v32
 v_lshlrev_b32 v114, 16, v33
 v_and_b32 v115, s34, v33
 v_lshlrev_b32 v116, 16, v34
 v_and_b32 v117, s34, v34
 v_lshlrev_b32 v118, 16, v35
 v_and_b32 v119, s34, v35
 v_lshlrev_b32 v120, 16, v36
 v_and_b32 v121, s34, v36
 v_lshlrev_b32 v122, 16, v37
 v_and_b32 v123, s34, v37
 v_lshlrev_b32 v124, 16, v38
 v_and_b32 v125, s34, v38
 v_lshlrev_b32 v126, 16, v39
 v_and_b32 v127, s34, v39
 v_lshlrev_b32 v128, 16, v40
 v_and_b32 v129, s34, v40
 v_lshlrev_b32 v130, 16, v41
 v_and_b32 v131, s34, v41
 v_lshlrev_b32 v132, 16, v42
 v_and_b32 v133, s34, v42
 v_lshlrev_b32 v134, 16, v43
 v_and_b32 v135, s34, v43
 v_lshlrev_b32 v136, 16, v44
 v_and_b32 v137, s34, v44
 v_lshlrev_b32 v138, 16, v45
 v_and_b32 v139, s34, v45
 v_lshlrev_b32 v140, 16, v46
 v_and_b32 v141, s34, v46
 v_lshlrev_b32 v142, 16, v47
 v_and_b32 v143, s34, v47
 v_lshlrev_b32 v144, 16, v48
 v_and_b32 v145, s34, v48
 v_lshlrev_b32 v146, 16, v49
 v_and_b32 v147, s34, v49
 v_lshlrev_b32 v148, 16, v50
 v_and_b32 v149, s34, v50
 v_lshlrev_b32 v150, 16, v51
 v_and_b32 v151, s34, v51
 v_lshlrev_b32 v152, 16, v52
 v_and_b32 v153, s34, v52
 v_lshlrev_b32 v154, 16, v53
 v_and_b32 v155, s34, v53
 v_lshlrev_b32 v156, 16, v54
 v_and_b32 v157, s34, v54
 v_lshlrev_b32 v158, 16, v55
 v_and_b32 v159, s34, v55
 v_lshlrev_b32 v160, 16, v56
 v_and_b32 v161, s34, v56
 v_lshlrev_b32 v162, 16, v57
 v_and_b32 v163, s34, v57
 v_lshlrev_b32 v164, 16, v58
 v_and_b32 v165, s34, v58
 v_lshlrev_b32 v166, 16, v59
 v_and_b32 v167, s34, v59
 v_lshlrev_b32 v168, 16, v60
 v_and_b32 v169, s34, v60
 v_lshlrev_b32 v170, 16, v61
 v_and_b32 v171, s34, v61
 v_lshlrev_b32 v172, 16, v62
 v_and_b32 v173, s34, v62
 v_lshlrev_b32 v174, 16, v63
 v_and_b32 v175, s34, v63
 v_add_f32 v8, v208, v209
 s_nop 1
 v_add_f32_dpp v8, v8, v8 quad_perm:[1,0,3,2] row_mask:0xf bank_mask:0xf
 s_nop 1
 v_add_f32_dpp v8, v8, v8 quad_perm:[2,3,0,1] row_mask:0xf bank_mask:0xf
 v_mul_f32 v8, 0x3b124925, v8
 v_mov_b32 v12, v8
 v_mov_b32 v13, v8
 v_cvt_pk_bf16_f32 v14, v8, v8
 v_and_b32 v14, s34, v14
 v_mov_b32 v15, v14
 v_mov_b32 v8, 0
 v_mov_b32 v9, 0
 v_mov_b32 v10, 0
 v_mov_b32 v11, 0
 v_pk_add_f32 v[16:17], v[64:65], v[12:13] neg_lo:[0,1] neg_hi:[0,1]
 v_pk_add_f32 v[18:19], v[66:67], v[12:13] neg_lo:[0,1] neg_hi:[0,1]
 v_pk_fma_f32 v[8:9], v[16:17], v[16:17], v[8:9]
 v_pk_fma_f32 v[10:11], v[18:19], v[18:19], v[10:11]
 v_pk_add_f32 v[16:17], v[68:69], v[12:13] neg_lo:[0,1] neg_hi:[0,1]
 v_pk_add_f32 v[18:19], v[70:71], v[12:13] neg_lo:[0,1] neg_hi:[0,1]
 v_pk_fma_f32 v[8:9], v[16:17], v[16:17], v[8:9]
 v_pk_fma_f32 v[10:11], v[18:19], v[18:19], v[10:11]
 v_pk_add_f32 v[16:17], v[72:73], v[12:13] neg_lo:[0,1] neg_hi:[0,1]
 v_pk_add_f32 v[18:19], v[74:75], v[12:13] neg_lo:[0,1] neg_hi:[0,1]
 v_pk_fma_f32 v[8:9], v[16:17], v[16:17], v[8:9]
 v_pk_fma_f32 v[10:11], v[18:19], v[18:19], v[10:11]
 v_pk_add_f32 v[16:17], v[76:77], v[12:13] neg_lo:[0,1] neg_hi:[0,1]
 v_pk_add_f32 v[18:19], v[78:79], v[12:13] neg_lo:[0,1] neg_hi:[0,1]
 v_pk_fma_f32 v[8:9], v[16:17], v[16:17], v[8:9]
 v_pk_fma_f32 v[10:11], v[18:19], v[18:19], v[10:11]
 v_pk_add_f32 v[16:17], v[80:81], v[12:13] neg_lo:[0,1] neg_hi:[0,1]
 v_pk_add_f32 v[18:19], v[82:83], v[12:13] neg_lo:[0,1] neg_hi:[0,1]
 v_pk_fma_f32 v[8:9], v[16:17], v[16:17], v[8:9]
 v_pk_fma_f32 v[10:11], v[18:19], v[18:19], v[10:11]
 v_pk_add_f32 v[16:17], v[84:85], v[12:13] neg_lo:[0,1] neg_hi:[0,1]
 v_pk_add_f32 v[18:19], v[86:87], v[12:13] neg_lo:[0,1] neg_hi:[0,1]
 v_pk_fma_f32 v[8:9], v[16:17], v[16:17], v[8:9]
 v_pk_fma_f32 v[10:11], v[18:19], v[18:19], v[10:11]
 v_pk_add_f32 v[16:17], v[88:89], v[12:13] neg_lo:[0,1] neg_hi:[0,1]
 v_pk_add_f32 v[18:19], v[90:91], v[12:13] neg_lo:[0,1] neg_hi:[0,1]
 v_pk_fma_f32 v[8:9], v[16:17], v[16:17], v[8:9]
 v_pk_fma_f32 v[10:11], v[18:19], v[18:19], v[10:11]
 v_pk_add_f32 v[16:17], v[92:93], v[12:13] neg_lo:[0,1] neg_hi:[0,1]
 v_pk_add_f32 v[18:19], v[94:95], v[12:13] neg_lo:[0,1] neg_hi:[0,1]
 v_pk_fma_f32 v[8:9], v[16:17], v[16:17], v[8:9]
 v_pk_fma_f32 v[10:11], v[18:19], v[18:19], v[10:11]
 v_pk_add_f32 v[16:17], v[96:97], v[12:13] neg_lo:[0,1] neg_hi:[0,1]
 v_pk_add_f32 v[18:19], v[98:99], v[12:13] neg_lo:[0,1] neg_hi:[0,1]
 v_pk_fma_f32 v[8:9], v[16:17], v[16:17], v[8:9]
 v_pk_fma_f32 v[10:11], v[18:19], v[18:19], v[10:11]
 v_pk_add_f32 v[16:17], v[100:101], v[12:13] neg_lo:[0,1] neg_hi:[0,1]
 v_pk_add_f32 v[18:19], v[102:103], v[12:13] neg_lo:[0,1] neg_hi:[0,1]
 v_pk_fma_f32 v[8:9], v[16:17], v[16:17], v[8:9]
 v_pk_fma_f32 v[10:11], v[18:19], v[18:19], v[10:11]
 v_pk_add_f32 v[16:17], v[104:105], v[12:13] neg_lo:[0,1] neg_hi:[0,1]
 v_pk_add_f32 v[18:19], v[106:107], v[12:13] neg_lo:[0,1] neg_hi:[0,1]
 v_pk_fma_f32 v[8:9], v[16:17], v[16:17], v[8:9]
 v_pk_fma_f32 v[10:11], v[18:19], v[18:19], v[10:11]
 v_pk_add_f32 v[16:17], v[108:109], v[12:13] neg_lo:[0,1] neg_hi:[0,1]
 v_pk_add_f32 v[18:19], v[110:111], v[12:13] neg_lo:[0,1] neg_hi:[0,1]
 v_pk_fma_f32 v[8:9], v[16:17], v[16:17], v[8:9]
 v_pk_fma_f32 v[10:11], v[18:19], v[18:19], v[10:11]
 v_pk_add_f32 v[16:17], v[112:113], v[12:13] neg_lo:[0,1] neg_hi:[0,1]
 v_pk_add_f32 v[18:19], v[114:115], v[12:13] neg_lo:[0,1] neg_hi:[0,1]
 v_pk_fma_f32 v[8:9], v[16:17], v[16:17], v[8:9]
 v_pk_fma_f32 v[10:11], v[18:19], v[18:19], v[10:11]
 v_pk_add_f32 v[16:17], v[116:117], v[12:13] neg_lo:[0,1] neg_hi:[0,1]
 v_pk_add_f32 v[18:19], v[118:119], v[12:13] neg_lo:[0,1] neg_hi:[0,1]
 v_pk_fma_f32 v[8:9], v[16:17], v[16:17], v[8:9]
 v_pk_fma_f32 v[10:11], v[18:19], v[18:19], v[10:11]
 v_pk_add_f32 v[16:17], v[120:121], v[12:13] neg_lo:[0,1] neg_hi:[0,1]
 v_pk_add_f32 v[18:19], v[122:123], v[12:13] neg_lo:[0,1] neg_hi:[0,1]
 v_pk_fma_f32 v[8:9], v[16:17], v[16:17], v[8:9]
 v_pk_fma_f32 v[10:11], v[18:19], v[18:19], v[10:11]
 v_pk_add_f32 v[16:17], v[124:125], v[12:13] neg_lo:[0,1] neg_hi:[0,1]
 v_pk_add_f32 v[18:19], v[126:127], v[12:13] neg_lo:[0,1] neg_hi:[0,1]
 v_pk_fma_f32 v[8:9], v[16:17], v[16:17], v[8:9]
 v_pk_fma_f32 v[10:11], v[18:19], v[18:19], v[10:11]
 v_pk_add_f32 v[16:17], v[128:129], v[12:13] neg_lo:[0,1] neg_hi:[0,1]
 v_pk_add_f32 v[18:19], v[130:131], v[12:13] neg_lo:[0,1] neg_hi:[0,1]
 v_pk_fma_f32 v[8:9], v[16:17], v[16:17], v[8:9]
 v_pk_fma_f32 v[10:11], v[18:19], v[18:19], v[10:11]
 v_pk_add_f32 v[16:17], v[132:133], v[12:13] neg_lo:[0,1] neg_hi:[0,1]
 v_pk_add_f32 v[18:19], v[134:135], v[12:13] neg_lo:[0,1] neg_hi:[0,1]
 v_pk_fma_f32 v[8:9], v[16:17], v[16:17], v[8:9]
 v_pk_fma_f32 v[10:11], v[18:19], v[18:19], v[10:11]
 v_pk_add_f32 v[16:17], v[136:137], v[12:13] neg_lo:[0,1] neg_hi:[0,1]
 v_pk_add_f32 v[18:19], v[138:139], v[12:13] neg_lo:[0,1] neg_hi:[0,1]
 v_pk_fma_f32 v[8:9], v[16:17], v[16:17], v[8:9]
 v_pk_fma_f32 v[10:11], v[18:19], v[18:19], v[10:11]
 v_pk_add_f32 v[16:17], v[140:141], v[12:13] neg_lo:[0,1] neg_hi:[0,1]
 v_pk_add_f32 v[18:19], v[142:143], v[12:13] neg_lo:[0,1] neg_hi:[0,1]
 v_pk_fma_f32 v[8:9], v[16:17], v[16:17], v[8:9]
 v_pk_fma_f32 v[10:11], v[18:19], v[18:19], v[10:11]
 v_pk_add_f32 v[16:17], v[144:145], v[12:13] neg_lo:[0,1] neg_hi:[0,1]
 v_pk_add_f32 v[18:19], v[146:147], v[12:13] neg_lo:[0,1] neg_hi:[0,1]
 v_pk_fma_f32 v[8:9], v[16:17], v[16:17], v[8:9]
 v_pk_fma_f32 v[10:11], v[18:19], v[18:19], v[10:11]
 v_pk_add_f32 v[16:17], v[148:149], v[12:13] neg_lo:[0,1] neg_hi:[0,1]
 v_pk_add_f32 v[18:19], v[150:151], v[12:13] neg_lo:[0,1] neg_hi:[0,1]
 v_pk_fma_f32 v[8:9], v[16:17], v[16:17], v[8:9]
 v_pk_fma_f32 v[10:11], v[18:19], v[18:19], v[10:11]
 v_pk_add_f32 v[16:17], v[152:153], v[12:13] neg_lo:[0,1] neg_hi:[0,1]
 v_pk_add_f32 v[18:19], v[154:155], v[12:13] neg_lo:[0,1] neg_hi:[0,1]
 v_pk_fma_f32 v[8:9], v[16:17], v[16:17], v[8:9]
 v_pk_fma_f32 v[10:11], v[18:19], v[18:19], v[10:11]
 v_pk_add_f32 v[16:17], v[156:157], v[12:13] neg_lo:[0,1] neg_hi:[0,1]
 v_pk_add_f32 v[18:19], v[158:159], v[12:13] neg_lo:[0,1] neg_hi:[0,1]
 v_pk_fma_f32 v[8:9], v[16:17], v[16:17], v[8:9]
 v_pk_fma_f32 v[10:11], v[18:19], v[18:19], v[10:11]
 v_pk_add_f32 v[16:17], v[160:161], v[12:13] neg_lo:[0,1] neg_hi:[0,1]
 v_pk_add_f32 v[18:19], v[162:163], v[12:13] neg_lo:[0,1] neg_hi:[0,1]
 v_pk_fma_f32 v[8:9], v[16:17], v[16:17], v[8:9]
 v_pk_fma_f32 v[10:11], v[18:19], v[18:19], v[10:11]
 v_pk_add_f32 v[16:17], v[164:165], v[12:13] neg_lo:[0,1] neg_hi:[0,1]
 v_pk_add_f32 v[18:19], v[166:167], v[12:13] neg_lo:[0,1] neg_hi:[0,1]
 v_pk_fma_f32 v[8:9], v[16:17], v[16:17], v[8:9]
 v_pk_fma_f32 v[10:11], v[18:19], v[18:19], v[10:11]
 v_pk_add_f32 v[16:17], v[168:169], v[12:13] neg_lo:[0,1] neg_hi:[0,1]
 v_pk_add_f32 v[18:19], v[170:171], v[12:13] neg_lo:[0,1] neg_hi:[0,1]
 v_pk_fma_f32 v[8:9], v[16:17], v[16:17], v[8:9]
 v_pk_fma_f32 v[10:11], v[18:19], v[18:19], v[10:11]
 v_pk_add_f32 v[16:17], v[172:173], v[12:13] neg_lo:[0,1] neg_hi:[0,1]
 v_pk_add_f32 v[18:19], v[174:175], v[12:13] neg_lo:[0,1] neg_hi:[0,1]
 v_pk_fma_f32 v[8:9], v[16:17], v[16:17], v[8:9]
 v_pk_fma_f32 v[10:11], v[18:19], v[18:19], v[10:11]
 v_pk_add_f32 v[8:9], v[8:9], v[10:11]
 v_add_f32 v8, v8, v9
 s_nop 1
 v_add_f32_dpp v8, v8, v8 quad_perm:[1,0,3,2] row_mask:0xf bank_mask:0xf
 s_nop 1
 v_add_f32_dpp v8, v8, v8 quad_perm:[2,3,0,1] row_mask:0xf bank_mask:0xf
 v_mul_f32 v8, 0x3b124925, v8
 v_cvt_pk_bf16_f32 v8, v8, v8
 v_and_b32 v8, s34, v8
 v_add_f32 v8, 0x3727c5ac, v8
 v_cvt_pk_bf16_f32 v8, v8, v8
 v_and_b32 v8, s34, v8
 v_sqrt_f32 v8, v8
 s_nop 0
 v_cvt_pk_bf16_f32 v8, v8, v8
 v_and_b32 v8, s34, v8
 v_rcp_f32 v12, v8
 s_nop 0
 v_mov_b32 v13, v12
 s_and_b32 s14, s12, 1
 s_lshl_b32 s14, s14, 4
 v_add_u32 v4, s14, v2
 v_and_b32 v6, 1, v4
 v_lshlrev_b32 v5, 4, v6
 v_and_b32 v6, 8, v4
 v_or_b32 v5, v5, v6
 v_and_b32 v6, 2, v4
 v_lshlrev_b32 v6, 1, v6
 v_and_b32 v7, 4, v4
 v_lshrrev_b32 v7, 1, v7
 v_or_b32 v6, v6, v7
 v_lshrrev_b32 v7, 4, v4
 v_or3_b32 v5, v5, v6, v7
 s_lshr_b32 s14, s12, 1
 s_mul_i32 s14, s14, 28672
 v_lshlrev_b32 v5, 4, v5
 v_lshlrev_b32 v6, 9, v3
 v_add3_u32 v178, v5, v6, s14
 s_and_b32 s15, s12, 1
 s_lshl_b32 s15, s15, 10
 s_add_u32 s14, s14, s15
 s_add_u32 s14, s14, 57344
 v_lshrrev_b32 v5, 1, v3
 v_lshlrev_b32 v5, 9, v5
 v_and_b32 v6, 1, v3
 v_lshlrev_b32 v6, 2, v6
 v_lshlrev_b32 v7, 4, v2
 v_add3_u32 v5, v5, v6, v7
 v_add_u32 v179, s14, v5
 v_pk_add_f32 v[64:65], v[64:65], v[14:15] neg_lo:[0,1] neg_hi:[0,1]
 v_cvt_pk_bf16_f32 v24, v64, v65
 v_lshlrev_b32 v64, 16, v24
 v_and_b32 v65, s34, v24
 v_pk_mul_f32 v[64:65], v[64:65], v[12:13]
 v_cvt_pk_bf16_f32 v16, v64, v65
 v_pk_add_f32 v[66:67], v[66:67], v[14:15] neg_lo:[0,1] neg_hi:[0,1]
 v_cvt_pk_bf16_f32 v24, v66, v67
 v_lshlrev_b32 v66, 16, v24
 v_and_b32 v67, s34, v24
 v_pk_mul_f32 v[66:67], v[66:67], v[12:13]
 v_cvt_pk_bf16_f32 v17, v66, v67
 v_pk_add_f32 v[68:69], v[68:69], v[14:15] neg_lo:[0,1] neg_hi:[0,1]
 v_cvt_pk_bf16_f32 v24, v68, v69
 v_lshlrev_b32 v68, 16, v24
 v_and_b32 v69, s34, v24
 v_pk_mul_f32 v[68:69], v[68:69], v[12:13]
 v_cvt_pk_bf16_f32 v18, v68, v69
 v_pk_add_f32 v[70:71], v[70:71], v[14:15] neg_lo:[0,1] neg_hi:[0,1]
 v_cvt_pk_bf16_f32 v24, v70, v71
 v_lshlrev_b32 v70, 16, v24
 v_and_b32 v71, s34, v24
 v_pk_mul_f32 v[70:71], v[70:71], v[12:13]
 v_cvt_pk_bf16_f32 v19, v70, v71
 ds_write_b128 v178, v[16:19]
 v_add_u32 v25, 0, v179
 ds_write2_b32 v25, v16, v17 offset0:0 offset1:2
 ds_write2_b32 v25, v18, v19 offset0:64 offset1:66
 v_pk_add_f32 v[72:73], v[72:73], v[14:15] neg_lo:[0,1] neg_hi:[0,1]
 v_cvt_pk_bf16_f32 v24, v72, v73
 v_lshlrev_b32 v72, 16, v24
 v_and_b32 v73, s34, v24
 v_pk_mul_f32 v[72:73], v[72:73], v[12:13]
 v_cvt_pk_bf16_f32 v20, v72, v73
 v_pk_add_f32 v[74:75], v[74:75], v[14:15] neg_lo:[0,1] neg_hi:[0,1]
 v_cvt_pk_bf16_f32 v24, v74, v75
 v_lshlrev_b32 v74, 16, v24
 v_and_b32 v75, s34, v24
 v_pk_mul_f32 v[74:75], v[74:75], v[12:13]
 v_cvt_pk_bf16_f32 v21, v74, v75
 v_pk_add_f32 v[76:77], v[76:77], v[14:15] neg_lo:[0,1] neg_hi:[0,1]
 v_cvt_pk_bf16_f32 v24, v76, v77
 v_lshlrev_b32 v76, 16, v24
 v_and_b32 v77, s34, v24
 v_pk_mul_f32 v[76:77], v[76:77], v[12:13]
 v_cvt_pk_bf16_f32 v22, v76, v77
 v_pk_add_f32 v[78:79], v[78:79], v[14:15] neg_lo:[0,1] neg_hi:[0,1]
 v_cvt_pk_bf16_f32 v24, v78, v79
 v_lshlrev_b32 v78, 16, v24
 v_and_b32 v79, s34, v24
 v_pk_mul_f32 v[78:79], v[78:79], v[12:13]
 v_cvt_pk_bf16_f32 v23, v78, v79
 ds_write_b128 v178, v[20:23] offset:2048
 v_add_u32 v25, 2048, v179
 ds_write2_b32 v25, v20, v21 offset0:0 offset1:2
 ds_write2_b32 v25, v22, v23 offset0:64 offset1:66
 v_pk_add_f32 v[80:81], v[80:81], v[14:15] neg_lo:[0,1] neg_hi:[0,1]
 v_cvt_pk_bf16_f32 v24, v80, v81
 v_lshlrev_b32 v80, 16, v24
 v_and_b32 v81, s34, v24
 v_pk_mul_f32 v[80:81], v[80:81], v[12:13]
 v_cvt_pk_bf16_f32 v16, v80, v81
 v_pk_add_f32 v[82:83], v[82:83], v[14:15] neg_lo:[0,1] neg_hi:[0,1]
 v_cvt_pk_bf16_f32 v24, v82, v83
 v_lshlrev_b32 v82, 16, v24
 v_and_b32 v83, s34, v24
 v_pk_mul_f32 v[82:83], v[82:83], v[12:13]
 v_cvt_pk_bf16_f32 v17, v82, v83
 v_pk_add_f32 v[84:85], v[84:85], v[14:15] neg_lo:[0,1] neg_hi:[0,1]
 v_cvt_pk_bf16_f32 v24, v84, v85
 v_lshlrev_b32 v84, 16, v24
 v_and_b32 v85, s34, v24
 v_pk_mul_f32 v[84:85], v[84:85], v[12:13]
 v_cvt_pk_bf16_f32 v18, v84, v85
 v_pk_add_f32 v[86:87], v[86:87], v[14:15] neg_lo:[0,1] neg_hi:[0,1]
 v_cvt_pk_bf16_f32 v24, v86, v87
 v_lshlrev_b32 v86, 16, v24
 v_and_b32 v87, s34, v24
 v_pk_mul_f32 v[86:87], v[86:87], v[12:13]
 v_cvt_pk_bf16_f32 v19, v86, v87
 ds_write_b128 v178, v[16:19] offset:4096
 v_add_u32 v25, 4096, v179
 ds_write2_b32 v25, v16, v17 offset0:0 offset1:2
 ds_write2_b32 v25, v18, v19 offset0:64 offset1:66
 v_pk_add_f32 v[88:89], v[88:89], v[14:15] neg_lo:[0,1] neg_hi:[0,1]
 v_cvt_pk_bf16_f32 v24, v88, v89
 v_lshlrev_b32 v88, 16, v24
 v_and_b32 v89, s34, v24
 v_pk_mul_f32 v[88:89], v[88:89], v[12:13]
 v_cvt_pk_bf16_f32 v20, v88, v89
 v_pk_add_f32 v[90:91], v[90:91], v[14:15] neg_lo:[0,1] neg_hi:[0,1]
 v_cvt_pk_bf16_f32 v24, v90, v91
 v_lshlrev_b32 v90, 16, v24
 v_and_b32 v91, s34, v24
 v_pk_mul_f32 v[90:91], v[90:91], v[12:13]
 v_cvt_pk_bf16_f32 v21, v90, v91
 v_pk_add_f32 v[92:93], v[92:93], v[14:15] neg_lo:[0,1] neg_hi:[0,1]
 v_cvt_pk_bf16_f32 v24, v92, v93
 v_lshlrev_b32 v92, 16, v24
 v_and_b32 v93, s34, v24
 v_pk_mul_f32 v[92:93], v[92:93], v[12:13]
 v_cvt_pk_bf16_f32 v22, v92, v93
 v_pk_add_f32 v[94:95], v[94:95], v[14:15] neg_lo:[0,1] neg_hi:[0,1]
 v_cvt_pk_bf16_f32 v24, v94, v95
 v_lshlrev_b32 v94, 16, v24
 v_and_b32 v95, s34, v24
 v_pk_mul_f32 v[94:95], v[94:95], v[12:13]
 v_cvt_pk_bf16_f32 v23, v94, v95
 ds_write_b128 v178, v[20:23] offset:6144
 v_add_u32 v25, 6144, v179
 ds_write2_b32 v25, v20, v21 offset0:0 offset1:2
 ds_write2_b32 v25, v22, v23 offset0:64 offset1:66
 v_pk_add_f32 v[96:97], v[96:97], v[14:15] neg_lo:[0,1] neg_hi:[0,1]
 v_cvt_pk_bf16_f32 v24, v96, v97
 v_lshlrev_b32 v96, 16, v24
 v_and_b32 v97, s34, v24
 v_pk_mul_f32 v[96:97], v[96:97], v[12:13]
 v_cvt_pk_bf16_f32 v16, v96, v97
 v_pk_add_f32 v[98:99], v[98:99], v[14:15] neg_lo:[0,1] neg_hi:[0,1]
 v_cvt_pk_bf16_f32 v24, v98, v99
 v_lshlrev_b32 v98, 16, v24
 v_and_b32 v99, s34, v24
 v_pk_mul_f32 v[98:99], v[98:99], v[12:13]
 v_cvt_pk_bf16_f32 v17, v98, v99
 v_pk_add_f32 v[100:101], v[100:101], v[14:15] neg_lo:[0,1] neg_hi:[0,1]
 v_cvt_pk_bf16_f32 v24, v100, v101
 v_lshlrev_b32 v100, 16, v24
 v_and_b32 v101, s34, v24
 v_pk_mul_f32 v[100:101], v[100:101], v[12:13]
 v_cvt_pk_bf16_f32 v18, v100, v101
 v_pk_add_f32 v[102:103], v[102:103], v[14:15] neg_lo:[0,1] neg_hi:[0,1]
 v_cvt_pk_bf16_f32 v24, v102, v103
 v_lshlrev_b32 v102, 16, v24
 v_and_b32 v103, s34, v24
 v_pk_mul_f32 v[102:103], v[102:103], v[12:13]
 v_cvt_pk_bf16_f32 v19, v102, v103
 ds_write_b128 v178, v[16:19] offset:8192
 v_add_u32 v25, 8192, v179
 ds_write2_b32 v25, v16, v17 offset0:0 offset1:2
 ds_write2_b32 v25, v18, v19 offset0:64 offset1:66
 v_pk_add_f32 v[104:105], v[104:105], v[14:15] neg_lo:[0,1] neg_hi:[0,1]
 v_cvt_pk_bf16_f32 v24, v104, v105
 v_lshlrev_b32 v104, 16, v24
 v_and_b32 v105, s34, v24
 v_pk_mul_f32 v[104:105], v[104:105], v[12:13]
 v_cvt_pk_bf16_f32 v20, v104, v105
 v_pk_add_f32 v[106:107], v[106:107], v[14:15] neg_lo:[0,1] neg_hi:[0,1]
 v_cvt_pk_bf16_f32 v24, v106, v107
 v_lshlrev_b32 v106, 16, v24
 v_and_b32 v107, s34, v24
 v_pk_mul_f32 v[106:107], v[106:107], v[12:13]
 v_cvt_pk_bf16_f32 v21, v106, v107
 v_pk_add_f32 v[108:109], v[108:109], v[14:15] neg_lo:[0,1] neg_hi:[0,1]
 v_cvt_pk_bf16_f32 v24, v108, v109
 v_lshlrev_b32 v108, 16, v24
 v_and_b32 v109, s34, v24
 v_pk_mul_f32 v[108:109], v[108:109], v[12:13]
 v_cvt_pk_bf16_f32 v22, v108, v109
 v_pk_add_f32 v[110:111], v[110:111], v[14:15] neg_lo:[0,1] neg_hi:[0,1]
 v_cvt_pk_bf16_f32 v24, v110, v111
 v_lshlrev_b32 v110, 16, v24
 v_and_b32 v111, s34, v24
 v_pk_mul_f32 v[110:111], v[110:111], v[12:13]
 v_cvt_pk_bf16_f32 v23, v110, v111
 ds_write_b128 v178, v[20:23] offset:10240
 v_add_u32 v25, 10240, v179
 ds_write2_b32 v25, v20, v21 offset0:0 offset1:2
 ds_write2_b32 v25, v22, v23 offset0:64 offset1:66
 v_pk_add_f32 v[112:113], v[112:113], v[14:15] neg_lo:[0,1] neg_hi:[0,1]
 v_cvt_pk_bf16_f32 v24, v112, v113
 v_lshlrev_b32 v112, 16, v24
 v_and_b32 v113, s34, v24
 v_pk_mul_f32 v[112:113], v[112:113], v[12:13]
 v_cvt_pk_bf16_f32 v16, v112, v113
 v_pk_add_f32 v[114:115], v[114:115], v[14:15] neg_lo:[0,1] neg_hi:[0,1]
 v_cvt_pk_bf16_f32 v24, v114, v115
 v_lshlrev_b32 v114, 16, v24
 v_and_b32 v115, s34, v24
 v_pk_mul_f32 v[114:115], v[114:115], v[12:13]
 v_cvt_pk_bf16_f32 v17, v114, v115
 v_pk_add_f32 v[116:117], v[116:117], v[14:15] neg_lo:[0,1] neg_hi:[0,1]
 v_cvt_pk_bf16_f32 v24, v116, v117
 v_lshlrev_b32 v116, 16, v24
 v_and_b32 v117, s34, v24
 v_pk_mul_f32 v[116:117], v[116:117], v[12:13]
 v_cvt_pk_bf16_f32 v18, v116, v117
 v_pk_add_f32 v[118:119], v[118:119], v[14:15] neg_lo:[0,1] neg_hi:[0,1]
 v_cvt_pk_bf16_f32 v24, v118, v119
 v_lshlrev_b32 v118, 16, v24
 v_and_b32 v119, s34, v24
 v_pk_mul_f32 v[118:119], v[118:119], v[12:13]
 v_cvt_pk_bf16_f32 v19, v118, v119
 ds_write_b128 v178, v[16:19] offset:12288
 v_add_u32 v25, 12288, v179
 ds_write2_b32 v25, v16, v17 offset0:0 offset1:2
 ds_write2_b32 v25, v18, v19 offset0:64 offset1:66
 v_pk_add_f32 v[120:121], v[120:121], v[14:15] neg_lo:[0,1] neg_hi:[0,1]
 v_cvt_pk_bf16_f32 v24, v120, v121
 v_lshlrev_b32 v120, 16, v24
 v_and_b32 v121, s34, v24
 v_pk_mul_f32 v[120:121], v[120:121], v[12:13]
 v_cvt_pk_bf16_f32 v20, v120, v121
 v_pk_add_f32 v[122:123], v[122:123], v[14:15] neg_lo:[0,1] neg_hi:[0,1]
 v_cvt_pk_bf16_f32 v24, v122, v123
 v_lshlrev_b32 v122, 16, v24
 v_and_b32 v123, s34, v24
 v_pk_mul_f32 v[122:123], v[122:123], v[12:13]
 v_cvt_pk_bf16_f32 v21, v122, v123
 v_pk_add_f32 v[124:125], v[124:125], v[14:15] neg_lo:[0,1] neg_hi:[0,1]
 v_cvt_pk_bf16_f32 v24, v124, v125
 v_lshlrev_b32 v124, 16, v24
 v_and_b32 v125, s34, v24
 v_pk_mul_f32 v[124:125], v[124:125], v[12:13]
 v_cvt_pk_bf16_f32 v22, v124, v125
 v_pk_add_f32 v[126:127], v[126:127], v[14:15] neg_lo:[0,1] neg_hi:[0,1]
 v_cvt_pk_bf16_f32 v24, v126, v127
 v_lshlrev_b32 v126, 16, v24
 v_and_b32 v127, s34, v24
 v_pk_mul_f32 v[126:127], v[126:127], v[12:13]
 v_cvt_pk_bf16_f32 v23, v126, v127
 ds_write_b128 v178, v[20:23] offset:14336
 v_add_u32 v25, 14336, v179
 ds_write2_b32 v25, v20, v21 offset0:0 offset1:2
 ds_write2_b32 v25, v22, v23 offset0:64 offset1:66
 v_pk_add_f32 v[128:129], v[128:129], v[14:15] neg_lo:[0,1] neg_hi:[0,1]
 v_cvt_pk_bf16_f32 v24, v128, v129
 v_lshlrev_b32 v128, 16, v24
 v_and_b32 v129, s34, v24
 v_pk_mul_f32 v[128:129], v[128:129], v[12:13]
 v_cvt_pk_bf16_f32 v16, v128, v129
 v_pk_add_f32 v[130:131], v[130:131], v[14:15] neg_lo:[0,1] neg_hi:[0,1]
 v_cvt_pk_bf16_f32 v24, v130, v131
 v_lshlrev_b32 v130, 16, v24
 v_and_b32 v131, s34, v24
 v_pk_mul_f32 v[130:131], v[130:131], v[12:13]
 v_cvt_pk_bf16_f32 v17, v130, v131
 v_pk_add_f32 v[132:133], v[132:133], v[14:15] neg_lo:[0,1] neg_hi:[0,1]
 v_cvt_pk_bf16_f32 v24, v132, v133
 v_lshlrev_b32 v132, 16, v24
 v_and_b32 v133, s34, v24
 v_pk_mul_f32 v[132:133], v[132:133], v[12:13]
 v_cvt_pk_bf16_f32 v18, v132, v133
 v_pk_add_f32 v[134:135], v[134:135], v[14:15] neg_lo:[0,1] neg_hi:[0,1]
 v_cvt_pk_bf16_f32 v24, v134, v135
 v_lshlrev_b32 v134, 16, v24
 v_and_b32 v135, s34, v24
 v_pk_mul_f32 v[134:135], v[134:135], v[12:13]
 v_cvt_pk_bf16_f32 v19, v134, v135
 ds_write_b128 v178, v[16:19] offset:16384
 v_add_u32 v25, 16384, v179
 ds_write2_b32 v25, v16, v17 offset0:0 offset1:2
 ds_write2_b32 v25, v18, v19 offset0:64 offset1:66
 v_pk_add_f32 v[136:137], v[136:137], v[14:15] neg_lo:[0,1] neg_hi:[0,1]
 v_cvt_pk_bf16_f32 v24, v136, v137
 v_lshlrev_b32 v136, 16, v24
 v_and_b32 v137, s34, v24
 v_pk_mul_f32 v[136:137], v[136:137], v[12:13]
 v_cvt_pk_bf16_f32 v20, v136, v137
 v_pk_add_f32 v[138:139], v[138:139], v[14:15] neg_lo:[0,1] neg_hi:[0,1]
 v_cvt_pk_bf16_f32 v24, v138, v139
 v_lshlrev_b32 v138, 16, v24
 v_and_b32 v139, s34, v24
 v_pk_mul_f32 v[138:139], v[138:139], v[12:13]
 v_cvt_pk_bf16_f32 v21, v138, v139
 v_pk_add_f32 v[140:141], v[140:141], v[14:15] neg_lo:[0,1] neg_hi:[0,1]
 v_cvt_pk_bf16_f32 v24, v140, v141
 v_lshlrev_b32 v140, 16, v24
 v_and_b32 v141, s34, v24
 v_pk_mul_f32 v[140:141], v[140:141], v[12:13]
 v_cvt_pk_bf16_f32 v22, v140, v141
 v_pk_add_f32 v[142:143], v[142:143], v[14:15] neg_lo:[0,1] neg_hi:[0,1]
 v_cvt_pk_bf16_f32 v24, v142, v143
 v_lshlrev_b32 v142, 16, v24
 v_and_b32 v143, s34, v24
 v_pk_mul_f32 v[142:143], v[142:143], v[12:13]
 v_cvt_pk_bf16_f32 v23, v142, v143
 ds_write_b128 v178, v[20:23] offset:18432
 v_add_u32 v25, 18432, v179
 ds_write2_b32 v25, v20, v21 offset0:0 offset1:2
 ds_write2_b32 v25, v22, v23 offset0:64 offset1:66
 v_pk_add_f32 v[144:145], v[144:145], v[14:15] neg_lo:[0,1] neg_hi:[0,1]
 v_cvt_pk_bf16_f32 v24, v144, v145
 v_lshlrev_b32 v144, 16, v24
 v_and_b32 v145, s34, v24
 v_pk_mul_f32 v[144:145], v[144:145], v[12:13]
 v_cvt_pk_bf16_f32 v16, v144, v145
 v_pk_add_f32 v[146:147], v[146:147], v[14:15] neg_lo:[0,1] neg_hi:[0,1]
 v_cvt_pk_bf16_f32 v24, v146, v147
 v_lshlrev_b32 v146, 16, v24
 v_and_b32 v147, s34, v24
 v_pk_mul_f32 v[146:147], v[146:147], v[12:13]
 v_cvt_pk_bf16_f32 v17, v146, v147
 v_pk_add_f32 v[148:149], v[148:149], v[14:15] neg_lo:[0,1] neg_hi:[0,1]
 v_cvt_pk_bf16_f32 v24, v148, v149
 v_lshlrev_b32 v148, 16, v24
 v_and_b32 v149, s34, v24
 v_pk_mul_f32 v[148:149], v[148:149], v[12:13]
 v_cvt_pk_bf16_f32 v18, v148, v149
 v_pk_add_f32 v[150:151], v[150:151], v[14:15] neg_lo:[0,1] neg_hi:[0,1]
 v_cvt_pk_bf16_f32 v24, v150, v151
 v_lshlrev_b32 v150, 16, v24
 v_and_b32 v151, s34, v24
 v_pk_mul_f32 v[150:151], v[150:151], v[12:13]
 v_cvt_pk_bf16_f32 v19, v150, v151
 ds_write_b128 v178, v[16:19] offset:20480
 v_add_u32 v25, 20480, v179
 ds_write2_b32 v25, v16, v17 offset0:0 offset1:2
 ds_write2_b32 v25, v18, v19 offset0:64 offset1:66
 v_pk_add_f32 v[152:153], v[152:153], v[14:15] neg_lo:[0,1] neg_hi:[0,1]
 v_cvt_pk_bf16_f32 v24, v152, v153
 v_lshlrev_b32 v152, 16, v24
 v_and_b32 v153, s34, v24
 v_pk_mul_f32 v[152:153], v[152:153], v[12:13]
 v_cvt_pk_bf16_f32 v20, v152, v153
 v_pk_add_f32 v[154:155], v[154:155], v[14:15] neg_lo:[0,1] neg_hi:[0,1]
 v_cvt_pk_bf16_f32 v24, v154, v155
 v_lshlrev_b32 v154, 16, v24
 v_and_b32 v155, s34, v24
 v_pk_mul_f32 v[154:155], v[154:155], v[12:13]
 v_cvt_pk_bf16_f32 v21, v154, v155
 v_pk_add_f32 v[156:157], v[156:157], v[14:15] neg_lo:[0,1] neg_hi:[0,1]
 v_cvt_pk_bf16_f32 v24, v156, v157
 v_lshlrev_b32 v156, 16, v24
 v_and_b32 v157, s34, v24
 v_pk_mul_f32 v[156:157], v[156:157], v[12:13]
 v_cvt_pk_bf16_f32 v22, v156, v157
 v_pk_add_f32 v[158:159], v[158:159], v[14:15] neg_lo:[0,1] neg_hi:[0,1]
 v_cvt_pk_bf16_f32 v24, v158, v159
 v_lshlrev_b32 v158, 16, v24
 v_and_b32 v159, s34, v24
 v_pk_mul_f32 v[158:159], v[158:159], v[12:13]
 v_cvt_pk_bf16_f32 v23, v158, v159
 ds_write_b128 v178, v[20:23] offset:22528
 v_add_u32 v25, 22528, v179
 ds_write2_b32 v25, v20, v21 offset0:0 offset1:2
 ds_write2_b32 v25, v22, v23 offset0:64 offset1:66
 v_pk_add_f32 v[160:161], v[160:161], v[14:15] neg_lo:[0,1] neg_hi:[0,1]
 v_cvt_pk_bf16_f32 v24, v160, v161
 v_lshlrev_b32 v160, 16, v24
 v_and_b32 v161, s34, v24
 v_pk_mul_f32 v[160:161], v[160:161], v[12:13]
 v_cvt_pk_bf16_f32 v16, v160, v161
 v_pk_add_f32 v[162:163], v[162:163], v[14:15] neg_lo:[0,1] neg_hi:[0,1]
 v_cvt_pk_bf16_f32 v24, v162, v163
 v_lshlrev_b32 v162, 16, v24
 v_and_b32 v163, s34, v24
 v_pk_mul_f32 v[162:163], v[162:163], v[12:13]
 v_cvt_pk_bf16_f32 v17, v162, v163
 v_pk_add_f32 v[164:165], v[164:165], v[14:15] neg_lo:[0,1] neg_hi:[0,1]
 v_cvt_pk_bf16_f32 v24, v164, v165
 v_lshlrev_b32 v164, 16, v24
 v_and_b32 v165, s34, v24
 v_pk_mul_f32 v[164:165], v[164:165], v[12:13]
 v_cvt_pk_bf16_f32 v18, v164, v165
 v_pk_add_f32 v[166:167], v[166:167], v[14:15] neg_lo:[0,1] neg_hi:[0,1]
 v_cvt_pk_bf16_f32 v24, v166, v167
 v_lshlrev_b32 v166, 16, v24
 v_and_b32 v167, s34, v24
 v_pk_mul_f32 v[166:167], v[166:167], v[12:13]
 v_cvt_pk_bf16_f32 v19, v166, v167
 ds_write_b128 v178, v[16:19] offset:24576
 v_add_u32 v25, 24576, v179
 ds_write2_b32 v25, v16, v17 offset0:0 offset1:2
 ds_write2_b32 v25, v18, v19 offset0:64 offset1:66
 v_pk_add_f32 v[168:169], v[168:169], v[14:15] neg_lo:[0,1] neg_hi:[0,1]
 v_cvt_pk_bf16_f32 v24, v168, v169
 v_lshlrev_b32 v168, 16, v24
 v_and_b32 v169, s34, v24
 v_pk_mul_f32 v[168:169], v[168:169], v[12:13]
 v_cvt_pk_bf16_f32 v20, v168, v169
 v_pk_add_f32 v[170:171], v[170:171], v[14:15] neg_lo:[0,1] neg_hi:[0,1]
 v_cvt_pk_bf16_f32 v24, v170, v171
 v_lshlrev_b32 v170, 16, v24
 v_and_b32 v171, s34, v24
 v_pk_mul_f32 v[170:171], v[170:171], v[12:13]
 v_cvt_pk_bf16_f32 v21, v170, v171
 v_pk_add_f32 v[172:173], v[172:173], v[14:15] neg_lo:[0,1] neg_hi:[0,1]
 v_cvt_pk_bf16_f32 v24, v172, v173
 v_lshlrev_b32 v172, 16, v24
 v_and_b32 v173, s34, v24
 v_pk_mul_f32 v[172:173], v[172:173], v[12:13]
 v_cvt_pk_bf16_f32 v22, v172, v173
 v_pk_add_f32 v[174:175], v[174:175], v[14:15] neg_lo:[0,1] neg_hi:[0,1]
 v_cvt_pk_bf16_f32 v24, v174, v175
 v_lshlrev_b32 v174, 16, v24
 v_and_b32 v175, s34, v24
 v_pk_mul_f32 v[174:175], v[174:175], v[12:13]
 v_cvt_pk_bf16_f32 v23, v174, v175
 ds_write_b128 v178, v[20:23] offset:26624
 v_add_u32 v25, 26624, v179
 ds_write2_b32 v25, v20, v21 offset0:0 offset1:2
 ds_write2_b32 v25, v22, v23 offset0:64 offset1:66
 s_waitcnt lgkmcnt(0)
 s_barrier
 s_mul_i32 s14, s12, 28672
 v_add_u32 v2, s14, v1
 s_mul_i32 s20, s13, 57344
 s_add_u32 s20, s20, s14
 s_mov_b32 s15, 43982848
 s_cmp_lt_u32 s12, 2
 s_cselect_b32 s15, 42205184, s15
 s_add_u32 s20, s20, s15
 ds_read_b128 v[8:11], v2
 ds_read_b128 v[12:15], v2 offset:1024
 ds_read_b128 v[16:19], v2 offset:2048
 ds_read_b128 v[20:23], v2 offset:3072
 ds_read_b128 v[24:27], v2 offset:4096
 ds_read_b128 v[28:31], v2 offset:5120
 ds_read_b128 v[32:35], v2 offset:6144
 ds_read_b128 v[36:39], v2 offset:7168
 ds_read_b128 v[40:43], v2 offset:8192
 ds_read_b128 v[44:47], v2 offset:9216
 ds_read_b128 v[48:51], v2 offset:10240
 ds_read_b128 v[52:55], v2 offset:11264
 ds_read_b128 v[56:59], v2 offset:12288
 ds_read_b128 v[60:63], v2 offset:13312
 ds_read_b128 v[64:67], v2 offset:14336
 ds_read_b128 v[68:71], v2 offset:15360
 ds_read_b128 v[72:75], v2 offset:16384
 ds_read_b128 v[76:79], v2 offset:17408
 ds_read_b128 v[80:83], v2 offset:18432
 ds_read_b128 v[84:87], v2 offset:19456
 ds_read_b128 v[88:91], v2 offset:20480
 ds_read_b128 v[92:95], v2 offset:21504
 ds_read_b128 v[96:99], v2 offset:22528
 ds_read_b128 v[100:103], v2 offset:23552
 ds_read_b128 v[104:107], v2 offset:24576
 ds_read_b128 v[108:111], v2 offset:25600
 ds_read_b128 v[112:115], v2 offset:26624
 ds_read_b128 v[116:119], v2 offset:27648
 s_waitcnt lgkmcnt(15)
 buffer_store_dwordx4 v[8:11], v1, s[64:67], s20 offen sc1
 buffer_store_dwordx4 v[12:15], v1, s[64:67], s20 offen offset:1024 sc1
 buffer_store_dwordx4 v[16:19], v1, s[64:67], s20 offen offset:2048 sc1
 buffer_store_dwordx4 v[20:23], v1, s[64:67], s20 offen offset:3072 sc1
 s_add_u32 s20, s20, 4096
 buffer_store_dwordx4 v[24:27], v1, s[64:67], s20 offen sc1
 buffer_store_dwordx4 v[28:31], v1, s[64:67], s20 offen offset:1024 sc1
 buffer_store_dwordx4 v[32:35], v1, s[64:67], s20 offen offset:2048 sc1
 s_waitcnt lgkmcnt(14)
 buffer_store_dwordx4 v[36:39], v1, s[64:67], s20 offen offset:3072 sc1
 s_add_u32 s20, s20, 4096
 buffer_store_dwordx4 v[40:43], v1, s[64:67], s20 offen sc1
 buffer_store_dwordx4 v[44:47], v1, s[64:67], s20 offen offset:1024 sc1
 buffer_store_dwordx4 v[48:51], v1, s[64:67], s20 offen offset:2048 sc1
 buffer_store_dwordx4 v[52:55], v1, s[64:67], s20 offen offset:3072 sc1
 s_add_u32 s20, s20, 4096
 buffer_store_dwordx4 v[56:59], v1, s[64:67], s20 offen sc1
 buffer_store_dwordx4 v[60:63], v1, s[64:67], s20 offen offset:1024 sc1
 s_waitcnt lgkmcnt(7)
 buffer_store_dwordx4 v[64:67], v1, s[64:67], s20 offen offset:2048 sc1
 buffer_store_dwordx4 v[68:71], v1, s[64:67], s20 offen offset:3072 sc1
 s_add_u32 s20, s20, 4096
 buffer_store_dwordx4 v[72:75], v1, s[64:67], s20 offen sc1
 buffer_store_dwordx4 v[76:79], v1, s[64:67], s20 offen offset:1024 sc1
 buffer_store_dwordx4 v[80:83], v1, s[64:67], s20 offen offset:2048 sc1
 buffer_store_dwordx4 v[84:87], v1, s[64:67], s20 offen offset:3072 sc1
 s_add_u32 s20, s20, 4096
 buffer_store_dwordx4 v[88:91], v1, s[64:67], s20 offen sc1
 s_waitcnt lgkmcnt(0)
 buffer_store_dwordx4 v[92:95], v1, s[64:67], s20 offen offset:1024 sc1
 buffer_store_dwordx4 v[96:99], v1, s[64:67], s20 offen offset:2048 sc1
 buffer_store_dwordx4 v[100:103], v1, s[64:67], s20 offen offset:3072 sc1
 s_add_u32 s20, s20, 4096
 buffer_store_dwordx4 v[104:107], v1, s[64:67], s20 offen sc1
 buffer_store_dwordx4 v[108:111], v1, s[64:67], s20 offen offset:1024 sc1
 buffer_store_dwordx4 v[112:115], v1, s[64:67], s20 offen offset:2048 sc1
 buffer_store_dwordx4 v[116:119], v1, s[64:67], s20 offen offset:3072 sc1
 s_add_u32 s20, s20, 4096
 s_cmp_lg_u32 s12, 0
 s_cbranch_scc1 L_tk_8
 s_mov_b64 exec, 1
 s_lshr_b32 s3, s2, 7
 s_and_b32 s3, s3, 1
 s_lshl_b32 s31, s10, 1
 s_add_u32 s3, s3, s31
 s_lshl_b32 s3, s3, 4
 v_mov_b32 v254, s3
 v_mov_b32 v255, 1
 buffer_atomic_add v255, v254, s[72:75], 0 offen sc0
 s_mov_b64 exec, -1
L_tk_8:
 s_mov_b32 s23, 32
 s_mov_b32 s24, 31
 s_branch L_prepdone
L_pad0:
 s_setpc_b64 s[94:95]
L_prepdone:
 s_waitcnt vmcnt(0) lgkmcnt(0)
 s_barrier
 s_cmp_lg_u32 s12, 0
 s_cbranch_scc1 L_role_w
 s_mov_b64 exec, 1
 v_cmp_lt_u32 vcc, 0xffff, v255
 s_cbranch_vccz L_czw
L_czok:
 s_lshl_b32 s23, s23, 7
 s_add_u32 s23, s23, 53493760
 v_mov_b32 v4, 0
 v_mov_b32 v5, 1
 buffer_atomic_add v5, v4, s[64:67], s23 offen sc0
 s_add_u32 s23, s23, 8192
 v_readfirstlane_b32 s11, v255
 s_and_b32 s11, s11, 0xffff
 s_lshl_b32 s13, s10, 5
 s_add_u32 s13, s13, s11
 s_lshr_b32 s14, s2, 3
 s_and_b32 s14, s14, 16
 s_add_u32 s13, s13, s14
 s_cmp_lt_u32 s11, 16
 s_cbranch_scc0 L_overflow
L_role_ok:
 v_readfirstlane_b32 s14, v255
 s_lshr_b32 s14, s14, 15
 s_and_b32 s14, s14, 0
 s_xor_b32 s13, s13, s14
 s_xor_b32 s13, s13, 96
 v_mov_b32 v2, s13
 ds_write_b32 v4, v2
 s_waitcnt vmcnt(0) lgkmcnt(0)
 v_cmp_ne_u32 vcc, s24, v5
 s_cbranch_vccnz L_notlast
 buffer_store_dword v5, v4, s[64:67], s23 offen sc1
L_notlast:
 s_mov_b64 exec, -1
L_role_w:
 s_barrier
 v_mov_b32 v1, 0
 ds_read_b32 v2, v1
 s_waitcnt lgkmcnt(0)
 v_readfirstlane_b32 s13, v2
 s_barrier
 s_and_b32 s11, s13, 31
 s_lshr_b32 s10, s13, 5
 s_and_b32 s10, s10, 7
 s_cmp_eq_u32 s10, 1
 s_cbranch_scc1 L_exit
 s_sub_u32 s13, s10, 6
 s_cmp_lt_u32 s13, 2
 s_cbranch_scc1 L_FFN
 s_sub_u32 s37, s10, 2
 s_lshr_b32 s14, s37, 1
 s_xor_b32 s37, s37, s14
 s_cmp_ge_u32 s11, 30
 s_cbranch_scc1 L_spare
 s_cmp_ge_u32 s11, 16
 s_cbranch_scc1 L_colrole
 s_cmp_lg_u32 s10, 0
 s_cbranch_scc1 L_TAw
 s_cmp_lg_u32 s12, 0
 s_cbranch_scc1 L_wg_9_done
 v_lshlrev_b32 v1, 7, v0
 s_mov_b32 s31, 0
 s_mov_b32 s3, 53501952
 s_lshl_b64 exec, 1, s11
L_wg_9:
 buffer_load_dword v2, v1, s[64:67], s3 offen sc1
 s_add_u32 s31, s31, 1
 s_cmp_gt_u32 s31, 524288
 s_cbranch_scc1 L_exit
 s_waitcnt vmcnt(0)
 v_cmp_eq_u32 vcc, 0, v2
 s_cbranch_vccz L_wg_9_ok
 s_sleep 2
 s_branch L_wg_9
L_wg_9_ok:
 s_mov_b64 exec, -1
L_wg_9_done:
 s_barrier
 s_cmp_eq_u32 s12, 0
 s_cbranch_scc1 L_A0
 s_cmp_eq_u32 s12, 1
 s_cbranch_scc1 L_A1
 s_cmp_eq_u32 s12, 2
 s_cbranch_scc1 L_A2
 s_branch L_A3
L_pad1:
 s_setpc_b64 s[94:95]
L_colrole:
 s_sub_u32 s11, s11, 16
 s_cmp_lg_u32 s12, 0
 s_cbranch_scc1 L_wg_10_done
 v_lshlrev_b32 v1, 7, v0
 s_mov_b32 s31, 0
 s_mov_b32 s3, 53501952
 s_mov_b32 exec_lo, 196608
 s_mov_b32 exec_hi, 0
L_wg_10:
 buffer_load_dword v2, v1, s[64:67], s3 offen sc1
 s_add_u32 s31, s31, 1
 s_cmp_gt_u32 s31, 524288
 s_cbranch_scc1 L_exit
 s_waitcnt vmcnt(0)
 v_cmp_eq_u32 vcc, 0, v2
 s_cbranch_vccz L_wg_10_ok
 s_sleep 2
 s_branch L_wg_10
L_wg_10_ok:
 s_mov_b64 exec, -1
L_wg_10_done:
 s_barrier
 s_cmp_lg_u32 s10, 0
 s_cbranch_scc1 L_TB
 s_cmp_eq_u32 s12, 0
 s_cbranch_scc1 L_B0
 s_cmp_eq_u32 s12, 1
 s_cbranch_scc1 L_B1
 s_cmp_eq_u32 s12, 2
 s_cbranch_scc1 L_B2
 s_branch L_B3
L_TAw:
 s_cmp_lg_u32 s12, 0
 s_cbranch_scc1 L_wg_11_done
 v_lshlrev_b32 v1, 7, v0
 s_mov_b32 s31, 0
 s_mov_b32 s3, 53501952
 s_mov_b32 exec_lo, 262143
 s_mov_b32 exec_hi, 1
L_wg_11:
 buffer_load_dword v2, v1, s[64:67], s3 offen sc1
 s_add_u32 s31, s31, 1
 s_cmp_gt_u32 s31, 524288
 s_cbranch_scc1 L_exit
 s_waitcnt vmcnt(0)
 v_cmp_eq_u32 vcc, 0, v2
 s_cbranch_vccz L_wg_11_ok
 s_sleep 48
 s_branch L_wg_11
L_wg_11_ok:
 s_mov_b64 exec, -1
L_wg_11_done:
 s_barrier
 s_branch L_TA
L_spare:
 s_cmp_lg_u32 s10, 0
 s_cbranch_scc1 L_exit
 s_sub_u32 s11, s11, 30
 s_cmp_lg_u32 s12, 0
 s_cbranch_scc1 L_wg_12_done
 v_lshlrev_b32 v1, 7, v0
 s_mov_b32 s31, 0
 s_mov_b32 s3, 53501952
 s_mov_b32 exec_lo, 262143
 s_mov_b32 exec_hi, 1
L_wg_12:
 buffer_load_dword v2, v1, s[64:67], s3 offen sc1
 s_add_u32 s31, s31, 1
 s_cmp_gt_u32 s31, 524288
 s_cbranch_scc1 L_exit
 s_waitcnt vmcnt(0)
 v_cmp_eq_u32 vcc, 0, v2
 s_cbranch_vccz L_wg_12_ok
 s_sleep 48
 s_branch L_wg_12
L_wg_12_ok:
 s_mov_b64 exec, -1
L_wg_12_done:
 s_barrier
 s_cmp_lg_u32 s12, 0
 s_cbranch_scc1 L_wd_13_done
 v_mov_b32 v1, 53501440
 s_mov_b32 s31, 0
 s_mov_b64 exec, 1
L_wd_13:
 buffer_load_dword v2, v1, s[64:67], 0 offen sc1
 s_add_u32 s31, s31, 1
 s_cmp_gt_u32 s31, 524288
 s_cbranch_scc1 L_exit
 s_waitcnt vmcnt(0)
 v_cmp_eq_u32 vcc, 0, v2
 s_cbranch_vccz L_wd_13_ok
 s_sleep 4
 s_branch L_wd_13
L_wd_13_ok:
 s_mov_b64 exec, -1
L_wd_13_done:
 s_barrier
 s_lshl_b32 s11, s11, 2
 s_add_u32 s11, s11, s12
 v_lshlrev_b32 v1, 7, v0
 s_mul_i32 s13, s11, 3584
 s_add_u32 s13, s13, 42205184
 v_add_u32 v2, s13, v1
 v_mov_b32 v3, 28672
 s_mul_i32 s13, s11, 1280
 s_add_u32 s13, s13, 50852352
 v_add_u32 v4, s13, v1
 v_mov_b32 v5, 10240
 v_cmp_lt_u32 vcc, 27, v0
 s_nop 1
 v_cndmask_b32 v2, v2, v4, vcc
 v_cndmask_b32 v3, v3, v5, vcc
 s_lshl_b32 s13, s11, 10
 s_add_u32 s13, s13, 50334976
 v_add_u32 v4, s13, v1
 v_mov_b32 v5, 8192
 v_cmp_lt_u32 vcc, 37, v0
 s_nop 1
 v_cndmask_b32 v2, v2, v4, vcc
 v_cndmask_b32 v3, v3, v5, vcc
 s_lshl_b32 s13, s11, 7
 s_add_u32 s13, s13, 52160768
 v_add_u32 v4, s13, v1
 v_mov_b32 v5, 1024
 v_cmp_lt_u32 vcc, 45, v0
 s_nop 1
 v_cndmask_b32 v2, v2, v4, vcc
 v_cndmask_b32 v3, v3, v5, vcc
 v_mov_b32 v6, 0
 s_mov_b32 s20, 52429824
 s_mov_b32 s30, 0
 v_lshrrev_b32 v9, 3, v0
 v_min_u32 v9, 6, v9
 v_lshlrev_b32 v9, 13, v9
 v_and_b32 v10, 7, v0
 v_lshl_add_u32 v9, v10, 7, v9
 s_mul_i32 s13, s11, 57344
 s_add_u32 s24, s13, 12853248
L_pf_14:
 s_cmp_le_u32 s30, 2
 s_cbranch_scc1 L_pf_14_go
 s_add_u32 s20, s20, 8192
 s_sub_u32 s21, s20, 2098176
 s_mov_b32 s31, 0
L_pf_14_poll:
 s_sleep 8
 s_mov_b64 exec, 1
 buffer_load_dword v7, v6, s[64:67], s21 offen sc1
 s_add_u32 s31, s31, 1
 s_cmp_ge_u32 s31, 16
 s_cselect_b32 s21, s20, s21
 s_cmp_gt_u32 s31, 524288
 s_cbranch_scc1 L_exit
 s_waitcnt vmcnt(0)
 v_cmp_eq_u32 vcc, -1, v7
 s_mov_b64 exec, -1
 s_cbranch_vccnz L_pf_14_poll
L_pf_14_go:
 s_mov_b32 exec_hi, 0x7fff
 buffer_load_dword v8, v2, s[64:67], 0 offen sc1
 v_add_u32 v2, v2, v3
 s_mov_b64 exec, -1
 s_add_u32 s24, s24, 458752
 s_add_u32 s30, s30, 1
 s_cmp_lt_u32 s30, 63
 s_cbranch_scc1 L_pf_14
 s_branch L_exit
L_exit:
 s_mov_b64 exec, -1
 s_waitcnt vmcnt(0) lgkmcnt(0)
 s_waitcnt vmcnt(0)
L_end:
 s_endpgm
L_czw:
 s_mov_b32 s31, 0
L_czl:
 v_mov_b32 v252, 0
 v_mov_b32 v253, 0
 buffer_atomic_add v253, v252, s[72:75], 0 offen sc0
 s_add_u32 s31, s31, 1
 s_cmp_gt_u32 s31, 524288
 s_cbranch_scc1 L_exit
 s_waitcnt vmcnt(0)
 v_cmp_lt_u32 vcc, 0xffff, v253
 s_cbranch_vccz L_czl
 v_and_b32 v253, 0xffff0000, v253
 v_or_b32 v255, v255, v253
 s_branch L_czok
L_overflow:
 v_mov_b32 v1, 8
 v_mov_b32 v3, 1
 buffer_atomic_add v3, v1, s[72:75], 0 offen sc0
 s_mov_b64 exec, 0xffff
 v_lshlrev_b32 v1, 4, v0
 s_mov_b32 s31, 0
L_ovf:
 buffer_load_dword v2, v1, s[72:75], 0 offen sc1
 s_add_u32 s31, s31, 1
 s_cmp_gt_u32 s31, 524288
 s_cbranch_scc1 L_exit
 s_waitcnt vmcnt(0)
 v_and_b32 v2, 0xffff, v2
 s_mov_b32 s14, 0
 v_readlane_b32 s15, v2, 0
 s_add_u32 s14, s14, s15
 v_readlane_b32 s15, v2, 1
 s_add_u32 s14, s14, s15
 v_readlane_b32 s15, v2, 2
 s_add_u32 s14, s14, s15
 v_readlane_b32 s15, v2, 3
 s_add_u32 s14, s14, s15
 v_readlane_b32 s15, v2, 4
 s_add_u32 s14, s14, s15
 v_readlane_b32 s15, v2, 5
 s_add_u32 s14, s14, s15
 v_readlane_b32 s15, v2, 6
 s_add_u32 s14, s14, s15
 v_readlane_b32 s15, v2, 7
 s_add_u32 s14, s14, s15
 v_readlane_b32 s15, v2, 8
 s_add_u32 s14, s14, s15
 v_readlane_b32 s15, v2, 9
 s_add_u32 s14, s14, s15
 v_readlane_b32 s15, v2, 10
 s_add_u32 s14, s14, s15
 v_readlane_b32 s15, v2, 11
 s_add_u32 s14, s14, s15
 v_readlane_b32 s15, v2, 12
 s_add_u32 s14, s14, s15
 v_readlane_b32 s15, v2, 13
 s_add_u32 s14, s14, s15
 v_readlane_b32 s15, v2, 14
 s_add_u32 s14, s14, s15
 v_readlane_b32 s15, v2, 15
 s_add_u32 s14, s14, s15
 s_cmp_lt_u32 s14, 256
 s_cbranch_scc1 L_ovf
 v_readfirstlane_b32 s15, v3
 s_mov_b64 exec, 1
 s_mov_b32 s13, 255
 v_readlane_b32 s14, v2, 0
 s_min_u32 s14, s14, 16
 s_add_u32 s16, s14, s15
 s_add_u32 s17, s16, 0
 s_cmp_lt_u32 s16, 16
 s_cselect_b32 s13, s17, s13
 s_cbranch_scc1 L_role_ok
 s_sub_u32 s15, s16, 16
 v_readlane_b32 s14, v2, 1
 s_min_u32 s14, s14, 16
 s_add_u32 s16, s14, s15
 s_add_u32 s17, s16, 16
 s_cmp_lt_u32 s16, 16
 s_cselect_b32 s13, s17, s13
 s_cbranch_scc1 L_role_ok
 s_sub_u32 s15, s16, 16
 v_readlane_b32 s14, v2, 2
 s_min_u32 s14, s14, 16
 s_add_u32 s16, s14, s15
 s_add_u32 s17, s16, 32
 s_cmp_lt_u32 s16, 16
 s_cselect_b32 s13, s17, s13
 s_cbranch_scc1 L_role_ok
 s_sub_u32 s15, s16, 16
 v_readlane_b32 s14, v2, 3
 s_min_u32 s14, s14, 16
 s_add_u32 s16, s14, s15
 s_add_u32 s17, s16, 48
 s_cmp_lt_u32 s16, 16
 s_cselect_b32 s13, s17, s13
 s_cbranch_scc1 L_role_ok
 s_sub_u32 s15, s16, 16
 v_readlane_b32 s14, v2, 4
 s_min_u32 s14, s14, 16
 s_add_u32 s16, s14, s15
 s_add_u32 s17, s16, 64
 s_cmp_lt_u32 s16, 16
 s_cselect_b32 s13, s17, s13
 s_cbranch_scc1 L_role_ok
 s_sub_u32 s15, s16, 16
 v_readlane_b32 s14, v2, 5
 s_min_u32 s14, s14, 16
 s_add_u32 s16, s14, s15
 s_add_u32 s17, s16, 80
 s_cmp_lt_u32 s16, 16
 s_cselect_b32 s13, s17, s13
 s_cbranch_scc1 L_role_ok
 s_sub_u32 s15, s16, 16
 v_readlane_b32 s14, v2, 6
 s_min_u32 s14, s14, 16
 s_add_u32 s16, s14, s15
 s_add_u32 s17, s16, 96
 s_cmp_lt_u32 s16, 16
 s_cselect_b32 s13, s17, s13
 s_cbranch_scc1 L_role_ok
 s_sub_u32 s15, s16, 16
 v_readlane_b32 s14, v2, 7
 s_min_u32 s14, s14, 16
 s_add_u32 s16, s14, s15
 s_add_u32 s17, s16, 112
 s_cmp_lt_u32 s16, 16
 s_cselect_b32 s13, s17, s13
 s_cbranch_scc1 L_role_ok
 s_sub_u32 s15, s16, 16
 v_readlane_b32 s14, v2, 8
 s_min_u32 s14, s14, 16
 s_add_u32 s16, s14, s15
 s_add_u32 s17, s16, 128
 s_cmp_lt_u32 s16, 16
 s_cselect_b32 s13, s17, s13
 s_cbranch_scc1 L_role_ok
 s_sub_u32 s15, s16, 16
 v_readlane_b32 s14, v2, 9
 s_min_u32 s14, s14, 16
 s_add_u32 s16, s14, s15
 s_add_u32 s17, s16, 144
 s_cmp_lt_u32 s16, 16
 s_cselect_b32 s13, s17, s13
 s_cbranch_scc1 L_role_ok
 s_sub_u32 s15, s16, 16
 v_readlane_b32 s14, v2, 10
 s_min_u32 s14, s14, 16
 s_add_u32 s16, s14, s15
 s_add_u32 s17, s16, 160
 s_cmp_lt_u32 s16, 16
 s_cselect_b32 s13, s17, s13
 s_cbranch_scc1 L_role_ok
 s_sub_u32 s15, s16, 16
 v_readlane_b32 s14, v2, 11
 s_min_u32 s14, s14, 16
 s_add_u32 s16, s14, s15
 s_add_u32 s17, s16, 176
 s_cmp_lt_u32 s16, 16
 s_cselect_b32 s13, s17, s13
 s_cbranch_scc1 L_role_ok
 s_sub_u32 s15, s16, 16
 v_readlane_b32 s14, v2, 12
 s_min_u32 s14, s14, 16
 s_add_u32 s16, s14, s15
 s_add_u32 s17, s16, 192
 s_cmp_lt_u32 s16, 16
 s_cselect_b32 s13, s17, s13
 s_cbranch_scc1 L_role_ok
 s_sub_u32 s15, s16, 16
 v_readlane_b32 s14, v2, 13
 s_min_u32 s14, s14, 16
 s_add_u32 s16, s14, s15
 s_add_u32 s17, s16, 208
 s_cmp_lt_u32 s16, 16
 s_cselect_b32 s13, s17, s13
 s_cbranch_scc1 L_role_ok
 s_sub_u32 s15, s16, 16
 v_readlane_b32 s14, v2, 14
 s_min_u32 s14, s14, 16
 s_add_u32 s16, s14, s15
 s_add_u32 s17, s16, 224
 s_cmp_lt_u32 s16, 16
 s_cselect_b32 s13, s17, s13
 s_cbranch_scc1 L_role_ok
 s_sub_u32 s15, s16, 16
 v_readlane_b32 s14, v2, 15
 s_min_u32 s14, s14, 16
 s_add_u32 s16, s14, s15
 s_add_u32 s17, s16, 240
 s_cmp_lt_u32 s16, 16
 s_cselect_b32 s13, s17, s13
 s_cbranch_scc1 L_role_ok
 s_sub_u32 s15, s16, 16
 s_branch L_role_ok
L_pad2:
 s_setpc_b64 s[94:95]
L_A0:
 v_lshlrev_b32 v107, 4, v0
 s_mul_i32 s13, s11, 401408
 s_add_u32 s13, s13, 0
 s_add_u32 s14, s13, 0
 buffer_load_dwordx4 a[0:3], v107, s[64:67], s14 offen sc1
 buffer_load_dwordx4 a[4:7], v107, s[64:67], s14 offen offset:1024 sc1
 s_add_u32 s14, s13, 2048
 buffer_load_dwordx4 a[8:11], v107, s[64:67], s14 offen sc1
 buffer_load_dwordx4 a[12:15], v107, s[64:67], s14 offen offset:1024 sc1
 s_add_u32 s14, s13, 4096
 buffer_load_dwordx4 a[16:19], v107, s[64:67], s14 offen sc1
 buffer_load_dwordx4 a[20:23], v107, s[64:67], s14 offen offset:1024 sc1
 s_add_u32 s14, s13, 6144
 buffer_load_dwordx4 a[24:27], v107, s[64:67], s14 offen sc1
 buffer_load_dwordx4 a[28:31], v107, s[64:67], s14 offen offset:1024 sc1
 s_add_u32 s14, s13, 8192
 buffer_load_dwordx4 a[32:35], v107, s[64:67], s14 offen sc1
 buffer_load_dwordx4 a[36:39], v107, s[64:67], s14 offen offset:1024 sc1
 s_add_u32 s14, s13, 10240
 buffer_load_dwordx4 a[40:43], v107, s[64:67], s14 offen sc1
 buffer_load_dwordx4 a[44:47], v107, s[64:67], s14 offen offset:1024 sc1
 s_add_u32 s14, s13, 12288
 buffer_load_dwordx4 a[48:51], v107, s[64:67], s14 offen sc1
 buffer_load_dwordx4 a[52:55], v107, s[64:67], s14 offen offset:1024 sc1
 s_add_u32 s14, s13, 14336
 buffer_load_dwordx4 a[56:59], v107, s[64:67], s14 offen sc1
 buffer_load_dwordx4 a[60:63], v107, s[64:67], s14 offen offset:1024 sc1
 s_add_u32 s14, s13, 16384
 buffer_load_dwordx4 a[64:67], v107, s[64:67], s14 offen sc1
 buffer_load_dwordx4 a[68:71], v107, s[64:67], s14 offen offset:1024 sc1
 s_add_u32 s14, s13, 18432
 buffer_load_dwordx4 a[72:75], v107, s[64:67], s14 offen sc1
 buffer_load_dwordx4 a[76:79], v107, s[64:67], s14 offen offset:1024 sc1
 s_add_u32 s14, s13, 20480
 buffer_load_dwordx4 a[80:83], v107, s[64:67], s14 offen sc1
 buffer_load_dwordx4 a[84:87], v107, s[64:67], s14 offen offset:1024 sc1
 s_add_u32 s14, s13, 22528
 buffer_load_dwordx4 a[88:91], v107, s[64:67], s14 offen sc1
 buffer_load_dwordx4 a[92:95], v107, s[64:67], s14 offen offset:1024 sc1
 s_add_u32 s14, s13, 24576
 buffer_load_dwordx4 a[96:99], v107, s[64:67], s14 offen sc1
 buffer_load_dwordx4 a[100:103], v107, s[64:67], s14 offen offset:1024 sc1
 s_add_u32 s14, s13, 26624
 buffer_load_dwordx4 a[104:107], v107, s[64:67], s14 offen sc1
 buffer_load_dwordx4 a[108:111], v107, s[64:67], s14 offen offset:1024 sc1
 s_add_u32 s14, s13, 28672
 buffer_load_dwordx4 a[112:115], v107, s[64:67], s14 offen sc1
 buffer_load_dwordx4 a[116:119], v107, s[64:67], s14 offen offset:1024 sc1
 s_add_u32 s14, s13, 30720
 buffer_load_dwordx4 a[120:123], v107, s[64:67], s14 offen sc1
 buffer_load_dwordx4 a[124:127], v107, s[64:67], s14 offen offset:1024 sc1
 s_add_u32 s14, s13, 32768
 buffer_load_dwordx4 a[128:131], v107, s[64:67], s14 offen sc1
 buffer_load_dwordx4 a[132:135], v107, s[64:67], s14 offen offset:1024 sc1
 s_add_u32 s14, s13, 34816
 buffer_load_dwordx4 a[136:139], v107, s[64:67], s14 offen sc1
 buffer_load_dwordx4 a[140:143], v107, s[64:67], s14 offen offset:1024 sc1
 s_add_u32 s14, s13, 36864
 buffer_load_dwordx4 a[144:147], v107, s[64:67], s14 offen sc1
 buffer_load_dwordx4 a[148:151], v107, s[64:67], s14 offen offset:1024 sc1
 s_add_u32 s14, s13, 38912
 buffer_load_dwordx4 a[152:155], v107, s[64:67], s14 offen sc1
 buffer_load_dwordx4 a[156:159], v107, s[64:67], s14 offen offset:1024 sc1
 s_add_u32 s14, s13, 40960
 buffer_load_dwordx4 a[160:163], v107, s[64:67], s14 offen sc1
 buffer_load_dwordx4 a[164:167], v107, s[64:67], s14 offen offset:1024 sc1
 s_add_u32 s14, s13, 43008
 buffer_load_dwordx4 a[168:171], v107, s[64:67], s14 offen sc1
 buffer_load_dwordx4 a[172:175], v107, s[64:67], s14 offen offset:1024 sc1
 s_add_u32 s14, s13, 45056
 buffer_load_dwordx4 a[176:179], v107, s[64:67], s14 offen sc1
 buffer_load_dwordx4 a[180:183], v107, s[64:67], s14 offen offset:1024 sc1
 s_add_u32 s14, s13, 47104
 buffer_load_dwordx4 a[184:187], v107, s[64:67], s14 offen sc1
 buffer_load_dwordx4 a[188:191], v107, s[64:67], s14 offen offset:1024 sc1
 s_add_u32 s14, s13, 49152
 buffer_load_dwordx4 a[192:195], v107, s[64:67], s14 offen sc1
 buffer_load_dwordx4 a[196:199], v107, s[64:67], s14 offen offset:1024 sc1
 s_add_u32 s14, s13, 51200
 buffer_load_dwordx4 a[200:203], v107, s[64:67], s14 offen sc1
 buffer_load_dwordx4 a[204:207], v107, s[64:67], s14 offen offset:1024 sc1
 s_add_u32 s14, s13, 53248
 buffer_load_dwordx4 a[208:211], v107, s[64:67], s14 offen sc1
 buffer_load_dwordx4 a[212:215], v107, s[64:67], s14 offen offset:1024 sc1
 s_add_u32 s14, s13, 55296
 buffer_load_dwordx4 a[216:219], v107, s[64:67], s14 offen sc1
 buffer_load_dwordx4 a[220:223], v107, s[64:67], s14 offen offset:1024 sc1
 s_add_u32 s14, s13, 57344
 buffer_load_dwordx4 a[224:227], v107, s[64:67], s14 offen sc1
 buffer_load_dwordx4 a[228:231], v107, s[64:67], s14 offen offset:1024 sc1
 s_add_u32 s14, s13, 59392
 buffer_load_dwordx4 a[232:235], v107, s[64:67], s14 offen sc1
 buffer_load_dwordx4 a[236:239], v107, s[64:67], s14 offen offset:1024 sc1
 s_add_u32 s14, s13, 61440
 buffer_load_dwordx4 a[240:243], v107, s[64:67], s14 offen sc1
 buffer_load_dwordx4 a[244:247], v107, s[64:67], s14 offen offset:1024 sc1
 s_add_u32 s14, s13, 63488
 buffer_load_dwordx4 a[248:251], v107, s[64:67], s14 offen sc1
 buffer_load_dwordx4 a[252:255], v107, s[64:67], s14 offen offset:1024 sc1
 s_add_u32 s14, s13, 65536
 buffer_load_dwordx4 v[120:123], v107, s[64:67], s14 offen sc1
 buffer_load_dwordx4 v[124:127], v107, s[64:67], s14 offen offset:1024 sc1
 s_add_u32 s14, s13, 67584
 buffer_load_dwordx4 v[128:131], v107, s[64:67], s14 offen sc1
 buffer_load_dwordx4 v[132:135], v107, s[64:67], s14 offen offset:1024 sc1
 s_add_u32 s14, s13, 69632
 buffer_load_dwordx4 v[136:139], v107, s[64:67], s14 offen sc1
 buffer_load_dwordx4 v[140:143], v107, s[64:67], s14 offen offset:1024 sc1
 s_add_u32 s14, s13, 71680
 buffer_load_dwordx4 v[144:147], v107, s[64:67], s14 offen sc1
 buffer_load_dwordx4 v[148:151], v107, s[64:67], s14 offen offset:1024 sc1
 s_add_u32 s14, s13, 73728
 buffer_load_dwordx4 v[152:155], v107, s[64:67], s14 offen sc1
 buffer_load_dwordx4 v[156:159], v107, s[64:67], s14 offen offset:1024 sc1
 s_add_u32 s14, s13, 75776
 buffer_load_dwordx4 v[160:163], v107, s[64:67], s14 offen sc1
 buffer_load_dwordx4 v[164:167], v107, s[64:67], s14 offen offset:1024 sc1
 s_add_u32 s14, s13, 77824
 buffer_load_dwordx4 v[168:171], v107, s[64:67], s14 offen sc1
 buffer_load_dwordx4 v[172:175], v107, s[64:67], s14 offen offset:1024 sc1
 s_add_u32 s14, s13, 79872
 buffer_load_dwordx4 v[176:179], v107, s[64:67], s14 offen sc1
 buffer_load_dwordx4 v[180:183], v107, s[64:67], s14 offen offset:1024 sc1
 s_add_u32 s14, s13, 81920
 buffer_load_dwordx4 v[184:187], v107, s[64:67], s14 offen sc1
 buffer_load_dwordx4 v[188:191], v107, s[64:67], s14 offen offset:1024 sc1
 s_add_u32 s14, s13, 83968
 buffer_load_dwordx4 v[192:195], v107, s[64:67], s14 offen sc1
 buffer_load_dwordx4 v[196:199], v107, s[64:67], s14 offen offset:1024 sc1
 s_add_u32 s14, s13, 86016
 buffer_load_dwordx4 v[200:203], v107, s[64:67], s14 offen sc1
 buffer_load_dwordx4 v[204:207], v107, s[64:67], s14 offen offset:1024 sc1
 s_add_u32 s14, s13, 88064
 buffer_load_dwordx4 v[208:211], v107, s[64:67], s14 offen sc1
 buffer_load_dwordx4 v[212:215], v107, s[64:67], s14 offen offset:1024 sc1
 s_add_u32 s14, s13, 90112
 buffer_load_dwordx4 v[216:219], v107, s[64:67], s14 offen sc1
 buffer_load_dwordx4 v[220:223], v107, s[64:67], s14 offen offset:1024 sc1
 s_add_u32 s14, s13, 92160
 buffer_load_dwordx4 v[224:227], v107, s[64:67], s14 offen sc1
 buffer_load_dwordx4 v[228:231], v107, s[64:67], s14 offen offset:1024 sc1
 s_add_u32 s14, s13, 94208
 buffer_load_dwordx4 v[232:235], v107, s[64:67], s14 offen sc1
 buffer_load_dwordx4 v[236:239], v107, s[64:67], s14 offen offset:1024 sc1
 s_add_u32 s14, s13, 96256
 buffer_load_dwordx4 v[240:243], v107, s[64:67], s14 offen sc1
 buffer_load_dwordx4 v[244:247], v107, s[64:67], s14 offen offset:1024 sc1
 s_add_u32 s14, s13, 98304
 buffer_load_dwordx4 v[248:251], v107, s[64:67], s14 offen sc1
 buffer_load_dwordx4 v[252:255], v107, s[64:67], s14 offen offset:1024 sc1
 v_lshrrev_b32 v1, 4, v0
 v_and_b32 v2, 15, v0
 v_and_b32 v3, 7, v0
 v_bfe_u32 v5, v0, 1, 1
 v_mov_b32 v6, 0x4444
 v_mov_b32 v7, 0xeeee
 v_cmp_eq_u32 vcc, 1, v5
 s_nop 1
 v_cndmask_b32 v106, v6, v7, vcc
 v_mov_b32 v6, 0x3f80
 v_mov_b32 v7, 0x3f800000
 v_and_b32 v4, 1, v0
 v_cmp_eq_u32 vcc, 1, v4
 s_nop 1
 v_cndmask_b32 v6, v6, v7, vcc
 v_lshrrev_b32 v4, 2, v2
 v_cmp_eq_u32 vcc, v4, v1
 s_nop 1
 v_cndmask_b32 v6, 0, v6, vcc
 v_cmp_eq_u32 vcc, 0, v5
 s_nop 1
 v_cndmask_b32 v100, 0, v6, vcc
 v_cndmask_b32 v101, 0, v6, vcc
 v_cmp_eq_u32 vcc, 1, v5
 s_nop 1
 v_cndmask_b32 v102, 0, v6, vcc
 v_cndmask_b32 v103, 0, v6, vcc
 v_mov_b32 v104, v100
 v_mov_b32 v105, v101
 v_add_u32 v4, 0, v1
 v_and_b32 v5, 1, v1
 v_mul_u32_u24 v5, 8, v5
 v_lshrrev_b32 v7, 1, v1
 v_add_u32 v5, v5, v7
 v_add_u32 v5, 16, v5
 v_lshrrev_b32 v6, 1, v4
 v_lshlrev_b32 v6, 8, v6
 v_and_b32 v7, 1, v4
 v_lshl_add_u32 v6, v7, 5, v6
 v_lshrrev_b32 v7, 1, v3
 v_lshl_add_u32 v6, v7, 6, v6
 v_and_b32 v7, 1, v3
 v_lshl_add_u32 v108, v7, 4, v6
 v_lshrrev_b32 v6, 1, v5
 v_lshlrev_b32 v6, 8, v6
 v_and_b32 v7, 1, v5
 v_lshl_add_u32 v6, v7, 5, v6
 v_lshrrev_b32 v7, 1, v3
 v_lshl_add_u32 v6, v7, 6, v6
 v_and_b32 v7, 1, v3
 v_lshl_add_u32 v109, v7, 4, v6
 v_lshlrev_b32 v6, 4, v2
 v_add_u32 v6, 13312, v6
 v_lshl_add_u32 v113, v4, 9, v6
 v_lshl_add_u32 v117, v5, 9, v6
 v_and_b32 v4, 1, v1
 v_lshrrev_b32 v5, 1, v1
 v_lshlrev_b32 v7, 8, v1
 v_lshlrev_b32 v3, 3, v2
 v_add_u32 v7, v7, v3
 v_add_u32 v110, 7168, v7
 v_lshlrev_b32 v7, 7, v4
 v_add_u32 v7, v7, v3
 v_add_u32 v111, 7168, v7
 v_lshlrev_b32 v7, 7, v1
 v_lshlrev_b32 v3, 2, v2
 v_add_u32 v7, v7, v3
 v_add_u32 v116, 11264, v7
 v_lshlrev_b32 v7, 6, v4
 v_add_u32 v7, v7, v3
 v_add_u32 v118, 11264, v7
 s_lshl_b32 s13, s11, 10
 s_add_u32 s13, s13, 0
 v_lshrrev_b32 v6, 2, v2
 v_lshlrev_b32 v6, 5, v6
 v_lshl_add_u32 v6, v4, 4, v6
 v_and_b32 v7, 3, v2
 v_lshl_add_u32 v6, v7, 2, v6
 v_add_u32 v112, s13, v6
 s_add_u32 s13, s13, 128
 v_bfe_u32 v6, v2, 2, 1
 v_lshlrev_b32 v6, 4, v6
 v_lshl_add_u32 v6, v4, 3, v6
 v_bfe_u32 v7, v2, 1, 1
 v_lshl_add_u32 v6, v7, 2, v6
 v_add_u32 v6, s13, v6
 v_and_b32 v3, 1, v2
 v_lshrrev_b32 v7, 3, v2
 v_lshl_add_u32 v3, v7, 1, v3
 v_lshl_add_u32 v6, v3, 5, v6
 v_mov_b32 v7, 0x7ffffff0
 v_cmp_eq_u32 vcc, 1, v5
 s_nop 1
 v_cndmask_b32 v112, v112, v6, vcc
 v_mov_b32 v1, 0
 v_mov_b32 v3, 0
 s_mov_b32 s23, 0x7ffffff0
 v_lshrrev_b32 v1, 4, v0
 v_lshlrev_b32 v7, 7, v1
 v_lshlrev_b32 v6, 3, v2
 v_add_u32 v7, v7, v6
 v_add_u32 v111, 7168, v7
 v_lshlrev_b32 v7, 6, v1
 v_lshlrev_b32 v6, 2, v2
 v_add_u32 v7, v7, v6
 v_add_u32 v118, 11264, v7
 s_lshl_b32 s13, s11, 10
 s_add_u32 s13, s13, 0
 v_lshrrev_b32 v4, 1, v1
 v_lshlrev_b32 v4, 8, v4
 v_add_u32 v4, s13, v4
 v_and_b32 v1, 1, v1
 v_lshrrev_b32 v6, 2, v2
 v_lshl_add_u32 v6, v6, 5, v4
 v_lshl_add_u32 v6, v1, 4, v6
 v_and_b32 v7, 3, v2
 v_lshl_add_u32 v112, v7, 2, v6
 v_bfe_u32 v6, v2, 2, 1
 v_lshl_add_u32 v6, v6, 4, v4
 v_lshl_add_u32 v6, v1, 3, v6
 v_bfe_u32 v7, v2, 1, 1
 v_lshl_add_u32 v6, v7, 2, v6
 v_and_b32 v7, 1, v2
 v_lshrrev_b32 v1, 3, v2
 v_lshl_add_u32 v7, v1, 1, v7
 v_lshl_add_u32 v6, v7, 5, v6
 v_add_u32 v5, 128, v6
 v_mov_b32 v1, 0
 v_mov_b32 v2, 0
 v_and_b32 v2, 15, v0
 v_lshrrev_b32 v1, 4, v0
 v_lshrrev_b32 v4, 1, v1
 v_and_b32 v1, 1, v1
 s_lshl_b32 s13, s11, 9
 s_add_u32 s13, s13, 0
 v_lshlrev_b32 v6, 7, v4
 v_add_u32 v6, s13, v6
 v_lshrrev_b32 v7, 2, v2
 v_lshl_add_u32 v6, v7, 5, v6
 v_lshl_add_u32 v6, v1, 4, v6
 v_and_b32 v7, 3, v2
 v_lshl_add_u32 v112, v7, 2, v6
 s_lshl_b32 s13, s11, 7
 s_add_u32 s13, s13, 8192
 v_lshlrev_b32 v6, 5, v4
 v_add_u32 v6, s13, v6
 v_bfe_u32 v7, v2, 2, 1
 v_lshl_add_u32 v6, v7, 4, v6
 v_lshl_add_u32 v6, v1, 3, v6
 v_bfe_u32 v7, v2, 1, 1
 v_lshl_add_u32 v6, v7, 2, v6
 v_and_b32 v7, 9, v2
 v_cmp_eq_u32 vcc, 0, v7
 v_mov_b32 v7, 0x7ffffff0
 s_nop 0
 v_cndmask_b32 v5, v7, v6, vcc
 v_mov_b32 v1, 0
 v_mov_b32 v2, 0
 v_mov_b32 v119, 0xff800000
 s_mov_b32 s16, 0xff00ff00
 s_mov_b32 s17, 0xff00ff00
 s_mov_b32 s18, 0
 s_mov_b32 s19, -1
 s_mov_b32 s35, 0x42800000
 s_mov_b32 s34, 0xfffffffe
 s_mov_b32 s25, 50331648
 s_mov_b32 s26, 53485568
 s_mov_b32 s22, 50855936
 s_mov_b32 s24, 42205184
 s_cmp_lg_u32 s12, 0
 s_cbranch_scc1 L_wg_15_done
 v_lshlrev_b32 v36, 7, v0
 s_mov_b32 s31, 0
 s_mov_b32 s3, 53501952
 s_mov_b32 exec_lo, 262143
 s_mov_b32 exec_hi, 1
L_wg_15:
 buffer_load_dword v37, v36, s[64:67], s3 offen sc1
 s_add_u32 s31, s31, 1
 s_cmp_gt_u32 s31, 524288
 s_cbranch_scc1 L_exit
 s_waitcnt vmcnt(0)
 v_cmp_eq_u32 vcc, 0, v37
 s_cbranch_vccz L_wg_15_ok
 s_sleep 4
 s_branch L_wg_15
L_wg_15_ok:
 s_mov_b64 exec, -1
L_wg_15_done:
 s_barrier
 s_mov_b32 s32, 0
 s_mov_b32 s33, 28672
 s_add_u32 m0, s32, 13312
 s_nop 0
 buffer_load_dwordx4 v107, s[64:67], s24 offen sc1 lds
 buffer_load_dwordx4 v107, s[64:67], s24 offen offset:1024 sc1 lds
 buffer_load_dwordx4 v107, s[64:67], s24 offen offset:2048 sc1 lds
 buffer_load_dwordx4 v107, s[64:67], s24 offen offset:3072 sc1 lds
 s_add_u32 s24, s24, 4096
 s_add_u32 m0, s32, 17408
 s_nop 0
 buffer_load_dwordx4 v107, s[64:67], s24 offen sc1 lds
 buffer_load_dwordx4 v107, s[64:67], s24 offen offset:1024 sc1 lds
 buffer_load_dwordx4 v107, s[64:67], s24 offen offset:2048 sc1 lds
 s_add_u32 s24, s24, 24576
 v_mov_b32 v36, 0
 v_mov_b32 v37, 0
 v_mov_b32 v38, 0
 v_mov_b32 v39, 0
 v_mov_b32 v40, 0
 v_mov_b32 v41, 0
 v_mov_b32 v42, 0
 v_mov_b32 v43, 0
 v_mov_b32 v44, 0
 v_mov_b32 v45, 0
 v_mov_b32 v46, 0
 v_mov_b32 v47, 0
 v_mov_b32 v48, 0
 v_mov_b32 v49, 0
 v_mov_b32 v50, 0
 v_mov_b32 v51, 0
 v_mov_b32 v52, 0
 v_mov_b32 v53, 0
 v_mov_b32 v54, 0
 v_mov_b32 v55, 0
 v_mov_b32 v56, 0
 v_mov_b32 v57, 0
 v_mov_b32 v58, 0
 v_mov_b32 v59, 0
 v_mov_b32 v60, 0
 v_mov_b32 v61, 0
 v_mov_b32 v62, 0
 v_mov_b32 v63, 0
 v_mov_b32 v64, 0
 v_mov_b32 v65, 0
 v_mov_b32 v66, 0
 v_mov_b32 v67, 0
 v_mov_b32 v68, 0
 v_mov_b32 v69, 0
 v_mov_b32 v70, 0
 v_mov_b32 v71, 0
 v_mov_b32 v72, 0
 v_mov_b32 v73, 0
 v_mov_b32 v74, 0
 v_mov_b32 v75, 0
 s_mov_b32 s30, 0
 s_waitcnt vmcnt(0) lgkmcnt(0)
 s_barrier
L_Aloop_16:
 s_add_u32 s20, s25, 0
 s_add_u32 s21, s25, 1024
 s_sleep 11
 s_mov_b32 s31, 0
 buffer_load_dwordx4 v[8:11], v107, s[64:67], s20 offen sc1
 buffer_load_dwordx4 v[12:15], v107, s[64:67], s21 offen sc1
 s_nop 15
 s_nop 15
 buffer_load_dwordx4 v[8:11], v107, s[64:67], s20 offen sc1
 buffer_load_dwordx4 v[12:15], v107, s[64:67], s21 offen sc1
L_q2_17_w:
 s_waitcnt vmcnt(2)
 v_max3_u32 v114, v8, v9, v10
 v_max3_u32 v114, v114, v11, v15
 v_cmp_eq_u32 vcc, -1, v114
 v_smfmac_f32_16x16x64_bf16 v[36:39], v[8:11], a[0:7], v106
 ds_write_b128 v107, v[8:11]
 s_cbranch_vccnz L_q2_17
 v_smfmac_f32_16x16x64_bf16 v[40:43], v[8:11], a[56:63], v106
 v_smfmac_f32_16x16x64_bf16 v[44:47], v[8:11], a[112:119], v106
 ds_write_b128 v107, v[12:15] offset:1024
 v_smfmac_f32_16x16x64_bf16 v[48:51], v[8:11], a[168:175], v106
 v_smfmac_f32_16x16x64_bf16 v[52:55], v[8:11], a[224:231], v106
 v_smfmac_f32_16x16x64_bf16 v[56:59], v[8:11], v[144:151], v106
 v_smfmac_f32_16x16x64_bf16 v[60:63], v[8:11], v[200:207], v106
 s_waitcnt lgkmcnt(0)
 s_barrier
 ds_read_b128 v[16:19], v107 offset:2048
 ds_read_b128 v[20:23], v107 offset:3072
 v_smfmac_f32_16x16x64_bf16 v[36:39], v[12:15], a[8:15], v106
 ds_read_b128 v[24:27], v107 offset:4096
 v_smfmac_f32_16x16x64_bf16 v[40:43], v[12:15], a[64:71], v106
 ds_read_b128 v[28:31], v107 offset:5120
 v_smfmac_f32_16x16x64_bf16 v[44:47], v[12:15], a[120:127], v106
 ds_read_b128 v[32:35], v107 offset:6144
 v_smfmac_f32_16x16x64_bf16 v[48:51], v[12:15], a[176:183], v106
 v_smfmac_f32_16x16x64_bf16 v[52:55], v[12:15], a[232:239], v106
 v_smfmac_f32_16x16x64_bf16 v[56:59], v[12:15], v[152:159], v106
 v_smfmac_f32_16x16x64_bf16 v[60:63], v[12:15], v[208:215], v106
 s_waitcnt lgkmcnt(4)
 v_smfmac_f32_16x16x64_bf16 v[36:39], v[16:19], a[16:23], v106
 s_add_u32 m0, s33, 13312
 s_nop 0
 buffer_load_dwordx4 v107, s[64:67], s24 offen sc1 lds
 s_waitcnt lgkmcnt(3)
 v_smfmac_f32_16x16x64_bf16 v[36:39], v[20:23], a[24:31], v106
 s_waitcnt lgkmcnt(2)
 v_smfmac_f32_16x16x64_bf16 v[36:39], v[24:27], a[32:39], v106
 s_waitcnt lgkmcnt(1)
 v_smfmac_f32_16x16x64_bf16 v[36:39], v[28:31], a[40:47], v106
 buffer_load_dwordx4 v107, s[64:67], s24 offen offset:1024 sc1 lds
 s_waitcnt lgkmcnt(0)
 v_smfmac_f32_16x16x64_bf16 v[36:39], v[32:35], a[48:55], v106
 v_smfmac_f32_16x16x64_bf16 v[40:43], v[16:19], a[72:79], v106
 ds_read_b128 v[76:79], v108
 v_smfmac_f32_16x16x64_bf16 v[40:43], v[20:23], a[80:87], v106
 buffer_load_dwordx4 v107, s[64:67], s24 offen offset:2048 sc1 lds
 ds_read_b128 v[80:83], v108 offset:512
 v_smfmac_f32_16x16x64_bf16 v[40:43], v[24:27], a[88:95], v106
 ds_read_b128 v[84:87], v113
 v_smfmac_f32_16x16x64_bf16 v[40:43], v[28:31], a[96:103], v106
 ds_read_b128 v[88:91], v113 offset:2048
 v_smfmac_f32_16x16x64_bf16 v[40:43], v[32:35], a[104:111], v106
 buffer_load_dwordx4 v107, s[64:67], s24 offen offset:3072 sc1 lds
 s_add_u32 s24, s24, 4096
 ds_read_b128 v[92:95], v113 offset:256
 v_cvt_pk_bf16_f32 v36, v36, v37
 v_smfmac_f32_16x16x64_bf16 v[44:47], v[16:19], a[128:135], v106
 ds_read_b128 v[96:99], v113 offset:2304
 v_cvt_pk_bf16_f32 v37, v38, v39
 v_smfmac_f32_16x16x64_bf16 v[44:47], v[20:23], a[136:143], v106
 v_smfmac_f32_16x16x64_bf16 v[44:47], v[24:27], a[144:151], v106
 s_add_u32 m0, s33, 17408
 s_nop 0
 buffer_load_dwordx4 v107, s[64:67], s24 offen sc1 lds
 v_smfmac_f32_16x16x64_bf16 v[44:47], v[28:31], a[152:159], v106
 v_smfmac_f32_16x16x64_bf16 v[44:47], v[32:35], a[160:167], v106
 v_cvt_pk_bf16_f32 v38, v40, v41
 v_smfmac_f32_16x16x64_bf16 v[48:51], v[16:19], a[184:191], v106
 buffer_load_dwordx4 v107, s[64:67], s24 offen offset:1024 sc1 lds
 v_cvt_pk_bf16_f32 v39, v42, v43
 v_smfmac_f32_16x16x64_bf16 v[48:51], v[20:23], a[192:199], v106
 v_smfmac_f32_16x16x64_bf16 v[48:51], v[24:27], a[200:207], v106
 v_mfma_f32_16x16x32_bf16 v[40:43], v[36:39], v[100:103], 0
 v_smfmac_f32_16x16x64_bf16 v[48:51], v[28:31], a[208:215], v106
 buffer_load_dwordx4 v107, s[64:67], s24 offen offset:2048 sc1 lds
 s_add_u32 s24, s24, 24576
 v_smfmac_f32_16x16x64_bf16 v[48:51], v[32:35], a[216:223], v106
 v_cvt_pk_bf16_f32 v44, v44, v45
 v_smfmac_f32_16x16x64_bf16 v[52:55], v[16:19], a[240:247], v106
 v_cvt_pk_bf16_f32 v45, v46, v47
 v_smfmac_f32_16x16x64_bf16 v[52:55], v[20:23], a[248:255], v106
 v_smfmac_f32_16x16x64_bf16 v[52:55], v[24:27], v[120:127], v106
 v_cvt_pk_bf16_f32 v36, v40, v41
 v_smfmac_f32_16x16x64_bf16 v[52:55], v[28:31], v[128:135], v106
 v_cvt_pk_bf16_f32 v37, v42, v43
 v_smfmac_f32_16x16x64_bf16 v[52:55], v[32:35], v[136:143], v106
 v_cvt_pk_bf16_f32 v46, v48, v49
 v_smfmac_f32_16x16x64_bf16 v[56:59], v[16:19], v[160:167], v106
 v_cvt_pk_bf16_f32 v47, v50, v51
 v_smfmac_f32_16x16x64_bf16 v[56:59], v[20:23], v[168:175], v106
 s_nop 0
 v_mfma_f32_16x16x32_bf16 v[48:51], v[44:47], v[100:103], 0
 v_smfmac_f32_16x16x64_bf16 v[56:59], v[24:27], v[176:183], v106
 s_nop 0
 v_cvt_pk_bf16_f32 v52, v52, v53
 v_smfmac_f32_16x16x64_bf16 v[56:59], v[28:31], v[184:191], v106
 v_cvt_pk_bf16_f32 v53, v54, v55
 v_smfmac_f32_16x16x64_bf16 v[56:59], v[32:35], v[192:199], v106
 s_nop 0
 v_smfmac_f32_16x16x64_bf16 v[60:63], v[16:19], v[216:223], v106
 s_nop 0
 v_cvt_pk_bf16_f32 v38, v48, v49
 v_smfmac_f32_16x16x64_bf16 v[60:63], v[20:23], v[224:231], v106
 s_nop 0
 v_cvt_pk_bf16_f32 v39, v50, v51
 v_smfmac_f32_16x16x64_bf16 v[60:63], v[24:27], v[232:239], v106
 s_nop 0
 v_cvt_pk_bf16_f32 v54, v56, v57
 v_smfmac_f32_16x16x64_bf16 v[60:63], v[28:31], v[240:247], v106
 v_cvt_pk_bf16_f32 v55, v58, v59
 v_smfmac_f32_16x16x64_bf16 v[60:63], v[32:35], v[248:255], v106
 s_waitcnt lgkmcnt(0)
 s_nop 0
 v_smfmac_f32_16x16x64_bf16 v[64:67], v[36:39], v[76:83], v106
 ds_read_b128 v[76:79], v109
 ds_read_b128 v[80:83], v109 offset:256
 s_nop 0
 v_mfma_f32_16x16x32_bf16 v[56:59], v[52:55], v[100:103], 0
 s_nop 0
 v_cvt_pk_bf16_f32 v60, v60, v61
 v_cvt_pk_bf16_f32 v61, v62, v63
 s_nop 1
 v_mfma_f32_16x16x16_bf16 v[40:43], v[60:61], v[104:105], 0
 s_nop 0
 s_nop 0
 v_smfmac_f32_16x16x64_bf16 v[68:71], v[36:39], v[84:91], v106
 ds_read_b128 v[84:87], v117
 ds_read_b128 v[88:91], v117 offset:1024
 v_cvt_pk_bf16_f32 v52, v56, v57
 v_smfmac_f32_16x16x64_bf16 v[72:75], v[36:39], v[92:99], v106
 ds_read_b128 v[92:95], v117 offset:256
 ds_read_b128 v[96:99], v117 offset:1280
 v_cvt_pk_bf16_f32 v53, v58, v59
 v_cvt_pk_bf16_f32 v54, v40, v41
 v_cvt_pk_bf16_f32 v55, v42, v43
 s_waitcnt lgkmcnt(4)
 s_nop 0
 v_smfmac_f32_16x16x64_bf16 v[64:67], v[52:55], v[76:83], v106
 s_waitcnt lgkmcnt(2)
 v_smfmac_f32_16x16x64_bf16 v[68:71], v[52:55], v[84:91], v106
 s_waitcnt lgkmcnt(0)
 v_smfmac_f32_16x16x64_bf16 v[72:75], v[52:55], v[92:99], v106
 s_nop 3
 v_pk_add_f32 v[64:65], v[64:65], v[66:67]
 s_nop 0
 v_add_f32 v36, v68, v70
 v_add_f32 v38, v69, v71
 ds_write2_b32 v116, v64, v65 offset0:0 offset1:16
 v_add_f32 v37, v72, v74
 v_add_f32 v39, v73, v75
 ds_write2_b64 v110, v[36:37], v[38:39] offset0:0 offset1:16
 s_waitcnt lgkmcnt(0)
 s_barrier
 ds_read2st64_b32 v[84:85], v118 offset0:0 offset1:2
 ds_read2st64_b32 v[86:87], v118 offset0:4 offset1:6
 ds_read_b64 v[76:77], v111
 ds_read_b64 v[78:79], v111 offset:1024
 ds_read_b64 v[80:81], v111 offset:2048
 ds_read_b64 v[82:83], v111 offset:3072
 s_waitcnt lgkmcnt(4)
 v_pk_add_f32 v[84:85], v[84:85], v[86:87]
 v_add_f32 v84, v84, v85
 v_exp_f32 v85, v84
 s_waitcnt lgkmcnt(2)
 v_pk_add_f32 v[76:77], v[76:77], v[78:79]
 v_cndmask_b32 v85, v85, 0, s[16:17]
 s_waitcnt lgkmcnt(0)
 v_pk_add_f32 v[80:81], v[80:81], v[82:83]
 v_pk_add_f32 v[76:77], v[76:77], v[80:81]
 v_max3_f32 v114, abs(v84), abs(v76), abs(v77)
 v_cmp_nge_f32 vcc, s35, v114
 v_exp_f32 v78, v76
 v_exp_f32 v79, v77
 s_cbranch_vccnz L_sm_18_max
L_sm_18:
 v_add_f32 v114, v85, v78
 v_add_f32 v114, v114, v79
 v_mov_b32_dpp v115, v85 quad_perm:[1,0,3,2] row_mask:0xf bank_mask:0xf
 v_mov_b32 v86, v85
 v_add_f32_dpp v114, v114, v114 row_ror:8 row_mask:0xf bank_mask:0xf
 s_nop 1
 v_add_f32_dpp v114, v114, v114 row_ror:4 row_mask:0xf bank_mask:0xf
 s_nop 1
 v_add_f32_dpp v114, v114, v114 row_ror:2 row_mask:0xf bank_mask:0xf
 s_nop 1
 v_add_f32_dpp v114, v114, v114 row_ror:1 row_mask:0xf bank_mask:0xf
 v_rcp_f32 v114, v114
 s_nop 0
 v_mul_f32 v78, v78, v114
 v_mul_f32 v79, v79, v114
 v_cvt_pk_bf16_f32 v3, v78, v79
 v_min_u32 v3, s34, v3
 buffer_store_dword v3, v112, s[64:67], s22 offen
 v_mul_f32 v86, v86, v114
 v_mul_f32 v115, v115, v114
 v_cvt_pk_bf16_f32 v2, v86, v115
 v_min_u32 v2, s34, v2
 buffer_store_dword v2, v5, s[64:67], s22 offen
 s_add_u32 s23, s22, 655360
 v_mov_b32 v36, 0
 v_mov_b32 v37, 0
 v_mov_b32 v38, 0
 v_mov_b32 v39, 0
 v_mov_b32 v40, 0
 v_mov_b32 v41, 0
 v_mov_b32 v42, 0
 v_mov_b32 v43, 0
 v_mov_b32 v44, 0
 v_mov_b32 v45, 0
 v_mov_b32 v46, 0
 v_mov_b32 v47, 0
 v_mov_b32 v48, 0
 v_mov_b32 v49, 0
 v_mov_b32 v50, 0
 v_mov_b32 v51, 0
 v_mov_b32 v52, 0
 v_mov_b32 v53, 0
 v_mov_b32 v54, 0
 v_mov_b32 v55, 0
 v_mov_b32 v56, 0
 v_mov_b32 v57, 0
 v_mov_b32 v58, 0
 v_mov_b32 v59, 0
 v_mov_b32 v60, 0
 v_mov_b32 v61, 0
 v_mov_b32 v62, 0
 v_mov_b32 v63, 0
 v_mov_b32 v64, 0
 v_mov_b32 v65, 0
 v_mov_b32 v66, 0
 v_mov_b32 v67, 0
 v_mov_b32 v68, 0
 v_mov_b32 v69, 0
 v_mov_b32 v70, 0
 v_mov_b32 v71, 0
 v_mov_b32 v72, 0
 v_mov_b32 v73, 0
 v_mov_b32 v74, 0
 v_mov_b32 v75, 0
 buffer_store_dword v3, v112, s[64:67], s23 offen sc1
 buffer_store_dword v2, v5, s[64:67], s23 offen sc1
 s_sub_u32 s36, s33, s32
 v_add_u32 v113, s36, v113
 v_add_u32 v117, s36, v117
 s_mov_b32 s36, s32
 s_mov_b32 s32, s33
 s_mov_b32 s33, s36
 s_add_u32 s25, s25, 8192
 s_add_u32 s26, s25, 2098176
 s_add_u32 s22, s22, 10240
 s_add_u32 s30, s30, 1
 s_cmp_lt_u32 s30, 63
 s_cbranch_scc1 L_Aloop_16
 buffer_store_dword v3, v112, s[64:67], s23 offen sc1
 buffer_store_dword v2, v5, s[64:67], s23 offen sc1
 s_branch L_exit
L_q2_17:
 buffer_load_dwordx4 v[8:11], v107, s[64:67], s20 offen sc1
 buffer_load_dwordx4 v[12:15], v107, s[64:67], s21 offen sc1
 s_nop 3
 v_mov_b32 v36, 0
 v_mov_b32 v37, 0
 v_mov_b32 v38, 0
 v_mov_b32 v39, 0
 s_add_u32 s31, s31, 1
 s_cmp_lt_u32 s31, 64
 s_cbranch_scc1 L_q2_17_w
 s_cmp_gt_u32 s31, 524288
 s_cbranch_scc1 L_exit
 s_cmp_lg_u32 s31, 64
 s_cbranch_scc1 L_q2_17_w
 s_waitcnt vmcnt(0)
 buffer_store_dword v3, v112, s[64:67], s23 offen sc1
 buffer_store_dword v2, v5, s[64:67], s23 offen sc1
 s_add_u32 s20, s26, 0
 s_add_u32 s21, s26, 1024
 buffer_load_dwordx4 v[8:11], v107, s[64:67], s20 offen sc1
 buffer_load_dwordx4 v[12:15], v107, s[64:67], s21 offen sc1
 buffer_load_dwordx4 v[8:11], v107, s[64:67], s20 offen sc1
 buffer_load_dwordx4 v[12:15], v107, s[64:67], s21 offen sc1
 s_branch L_q2_17_w
L_sm_18_max:
 v_cndmask_b32 v84, v84, v119, s[16:17]
 v_max3_f32 v114, v84, v76, v77
 s_nop 1
 v_max_f32_dpp v114, v114, v114 row_ror:8 row_mask:0xf bank_mask:0xf
 s_nop 1
 v_max_f32_dpp v114, v114, v114 row_ror:4 row_mask:0xf bank_mask:0xf
 s_nop 1
 v_max_f32_dpp v114, v114, v114 row_ror:2 row_mask:0xf bank_mask:0xf
 s_nop 1
 v_max_f32_dpp v114, v114, v114 row_ror:1 row_mask:0xf bank_mask:0xf
 v_sub_f32 v84, v84, v114
 v_sub_f32 v76, v76, v114
 v_sub_f32 v77, v77, v114
 v_exp_f32 v85, v84
 v_exp_f32 v78, v76
 v_exp_f32 v79, v77
 s_mov_b64 vcc, 0
 s_branch L_sm_18
L_pad3:
 s_setpc_b64 s[94:95]
L_A1:
 v_lshlrev_b32 v107, 4, v0
 s_mul_i32 s13, s11, 401408
 s_add_u32 s13, s13, 100352
 s_add_u32 s14, s13, 4096
 buffer_load_dwordx4 a[0:3], v107, s[64:67], s14 offen sc1
 buffer_load_dwordx4 a[4:7], v107, s[64:67], s14 offen offset:1024 sc1
 s_add_u32 s14, s13, 6144
 buffer_load_dwordx4 a[8:11], v107, s[64:67], s14 offen sc1
 buffer_load_dwordx4 a[12:15], v107, s[64:67], s14 offen offset:1024 sc1
 s_add_u32 s14, s13, 8192
 buffer_load_dwordx4 a[16:19], v107, s[64:67], s14 offen sc1
 buffer_load_dwordx4 a[20:23], v107, s[64:67], s14 offen offset:1024 sc1
 s_add_u32 s14, s13, 10240
 buffer_load_dwordx4 a[24:27], v107, s[64:67], s14 offen sc1
 buffer_load_dwordx4 a[28:31], v107, s[64:67], s14 offen offset:1024 sc1
 s_add_u32 s14, s13, 12288
 buffer_load_dwordx4 a[32:35], v107, s[64:67], s14 offen sc1
 buffer_load_dwordx4 a[36:39], v107, s[64:67], s14 offen offset:1024 sc1
 s_add_u32 s14, s13, 0
 buffer_load_dwordx4 a[40:43], v107, s[64:67], s14 offen sc1
 buffer_load_dwordx4 a[44:47], v107, s[64:67], s14 offen offset:1024 sc1
 s_add_u32 s14, s13, 2048
 buffer_load_dwordx4 a[48:51], v107, s[64:67], s14 offen sc1
 buffer_load_dwordx4 a[52:55], v107, s[64:67], s14 offen offset:1024 sc1
 s_add_u32 s14, s13, 18432
 buffer_load_dwordx4 a[56:59], v107, s[64:67], s14 offen sc1
 buffer_load_dwordx4 a[60:63], v107, s[64:67], s14 offen offset:1024 sc1
 s_add_u32 s14, s13, 20480
 buffer_load_dwordx4 a[64:67], v107, s[64:67], s14 offen sc1
 buffer_load_dwordx4 a[68:71], v107, s[64:67], s14 offen offset:1024 sc1
 s_add_u32 s14, s13, 22528
 buffer_load_dwordx4 a[72:75], v107, s[64:67], s14 offen sc1
 buffer_load_dwordx4 a[76:79], v107, s[64:67], s14 offen offset:1024 sc1
 s_add_u32 s14, s13, 24576
 buffer_load_dwordx4 a[80:83], v107, s[64:67], s14 offen sc1
 buffer_load_dwordx4 a[84:87], v107, s[64:67], s14 offen offset:1024 sc1
 s_add_u32 s14, s13, 26624
 buffer_load_dwordx4 a[88:91], v107, s[64:67], s14 offen sc1
 buffer_load_dwordx4 a[92:95], v107, s[64:67], s14 offen offset:1024 sc1
 s_add_u32 s14, s13, 14336
 buffer_load_dwordx4 a[96:99], v107, s[64:67], s14 offen sc1
 buffer_load_dwordx4 a[100:103], v107, s[64:67], s14 offen offset:1024 sc1
 s_add_u32 s14, s13, 16384
 buffer_load_dwordx4 a[104:107], v107, s[64:67], s14 offen sc1
 buffer_load_dwordx4 a[108:111], v107, s[64:67], s14 offen offset:1024 sc1
 s_add_u32 s14, s13, 32768
 buffer_load_dwordx4 a[112:115], v107, s[64:67], s14 offen sc1
 buffer_load_dwordx4 a[116:119], v107, s[64:67], s14 offen offset:1024 sc1
 s_add_u32 s14, s13, 34816
 buffer_load_dwordx4 a[120:123], v107, s[64:67], s14 offen sc1
 buffer_load_dwordx4 a[124:127], v107, s[64:67], s14 offen offset:1024 sc1
 s_add_u32 s14, s13, 36864
 buffer_load_dwordx4 a[128:131], v107, s[64:67], s14 offen sc1
 buffer_load_dwordx4 a[132:135], v107, s[64:67], s14 offen offset:1024 sc1
 s_add_u32 s14, s13, 38912
 buffer_load_dwordx4 a[136:139], v107, s[64:67], s14 offen sc1
 buffer_load_dwordx4 a[140:143], v107, s[64:67], s14 offen offset:1024 sc1
 s_add_u32 s14, s13, 40960
 buffer_load_dwordx4 a[144:147], v107, s[64:67], s14 offen sc1
 buffer_load_dwordx4 a[148:151], v107, s[64:67], s14 offen offset:1024 sc1
 s_add_u32 s14, s13, 28672
 buffer_load_dwordx4 a[152:155], v107, s[64:67], s14 offen sc1
 buffer_load_dwordx4 a[156:159], v107, s[64:67], s14 offen offset:1024 sc1
 s_add_u32 s14, s13, 30720
 buffer_load_dwordx4 a[160:163], v107, s[64:67], s14 offen sc1
 buffer_load_dwordx4 a[164:167], v107, s[64:67], s14 offen offset:1024 sc1
 s_add_u32 s14, s13, 47104
 buffer_load_dwordx4 a[168:171], v107, s[64:67], s14 offen sc1
 buffer_load_dwordx4 a[172:175], v107, s[64:67], s14 offen offset:1024 sc1
 s_add_u32 s14, s13, 49152
 buffer_load_dwordx4 a[176:179], v107, s[64:67], s14 offen sc1
 buffer_load_dwordx4 a[180:183], v107, s[64:67], s14 offen offset:1024 sc1
 s_add_u32 s14, s13, 51200
 buffer_load_dwordx4 a[184:187], v107, s[64:67], s14 offen sc1
 buffer_load_dwordx4 a[188:191], v107, s[64:67], s14 offen offset:1024 sc1
 s_add_u32 s14, s13, 53248
 buffer_load_dwordx4 a[192:195], v107, s[64:67], s14 offen sc1
 buffer_load_dwordx4 a[196:199], v107, s[64:67], s14 offen offset:1024 sc1
 s_add_u32 s14, s13, 55296
 buffer_load_dwordx4 a[200:203], v107, s[64:67], s14 offen sc1
 buffer_load_dwordx4 a[204:207], v107, s[64:67], s14 offen offset:1024 sc1
 s_add_u32 s14, s13, 43008
 buffer_load_dwordx4 a[208:211], v107, s[64:67], s14 offen sc1
 buffer_load_dwordx4 a[212:215], v107, s[64:67], s14 offen offset:1024 sc1
 s_add_u32 s14, s13, 45056
 buffer_load_dwordx4 a[216:219], v107, s[64:67], s14 offen sc1
 buffer_load_dwordx4 a[220:223], v107, s[64:67], s14 offen offset:1024 sc1
 s_add_u32 s14, s13, 61440
 buffer_load_dwordx4 a[224:227], v107, s[64:67], s14 offen sc1
 buffer_load_dwordx4 a[228:231], v107, s[64:67], s14 offen offset:1024 sc1
 s_add_u32 s14, s13, 63488
 buffer_load_dwordx4 a[232:235], v107, s[64:67], s14 offen sc1
 buffer_load_dwordx4 a[236:239], v107, s[64:67], s14 offen offset:1024 sc1
 s_add_u32 s14, s13, 65536
 buffer_load_dwordx4 a[240:243], v107, s[64:67], s14 offen sc1
 buffer_load_dwordx4 a[244:247], v107, s[64:67], s14 offen offset:1024 sc1
 s_add_u32 s14, s13, 67584
 buffer_load_dwordx4 a[248:251], v107, s[64:67], s14 offen sc1
 buffer_load_dwordx4 a[252:255], v107, s[64:67], s14 offen offset:1024 sc1
 s_add_u32 s14, s13, 69632
 buffer_load_dwordx4 v[120:123], v107, s[64:67], s14 offen sc1
 buffer_load_dwordx4 v[124:127], v107, s[64:67], s14 offen offset:1024 sc1
 s_add_u32 s14, s13, 57344
 buffer_load_dwordx4 v[128:131], v107, s[64:67], s14 offen sc1
 buffer_load_dwordx4 v[132:135], v107, s[64:67], s14 offen offset:1024 sc1
 s_add_u32 s14, s13, 59392
 buffer_load_dwordx4 v[136:139], v107, s[64:67], s14 offen sc1
 buffer_load_dwordx4 v[140:143], v107, s[64:67], s14 offen offset:1024 sc1
 s_add_u32 s14, s13, 75776
 buffer_load_dwordx4 v[144:147], v107, s[64:67], s14 offen sc1
 buffer_load_dwordx4 v[148:151], v107, s[64:67], s14 offen offset:1024 sc1
 s_add_u32 s14, s13, 77824
 buffer_load_dwordx4 v[152:155], v107, s[64:67], s14 offen sc1
 buffer_load_dwordx4 v[156:159], v107, s[64:67], s14 offen offset:1024 sc1
 s_add_u32 s14, s13, 79872
 buffer_load_dwordx4 v[160:163], v107, s[64:67], s14 offen sc1
 buffer_load_dwordx4 v[164:167], v107, s[64:67], s14 offen offset:1024 sc1
 s_add_u32 s14, s13, 81920
 buffer_load_dwordx4 v[168:171], v107, s[64:67], s14 offen sc1
 buffer_load_dwordx4 v[172:175], v107, s[64:67], s14 offen offset:1024 sc1
 s_add_u32 s14, s13, 83968
 buffer_load_dwordx4 v[176:179], v107, s[64:67], s14 offen sc1
 buffer_load_dwordx4 v[180:183], v107, s[64:67], s14 offen offset:1024 sc1
 s_add_u32 s14, s13, 71680
 buffer_load_dwordx4 v[184:187], v107, s[64:67], s14 offen sc1
 buffer_load_dwordx4 v[188:191], v107, s[64:67], s14 offen offset:1024 sc1
 s_add_u32 s14, s13, 73728
 buffer_load_dwordx4 v[192:195], v107, s[64:67], s14 offen sc1
 buffer_load_dwordx4 v[196:199], v107, s[64:67], s14 offen offset:1024 sc1
 s_add_u32 s14, s13, 90112
 buffer_load_dwordx4 v[200:203], v107, s[64:67], s14 offen sc1
 buffer_load_dwordx4 v[204:207], v107, s[64:67], s14 offen offset:1024 sc1
 s_add_u32 s14, s13, 92160
 buffer_load_dwordx4 v[208:211], v107, s[64:67], s14 offen sc1
 buffer_load_dwordx4 v[212:215], v107, s[64:67], s14 offen offset:1024 sc1
 s_add_u32 s14, s13, 94208
 buffer_load_dwordx4 v[216:219], v107, s[64:67], s14 offen sc1
 buffer_load_dwordx4 v[220:223], v107, s[64:67], s14 offen offset:1024 sc1
 s_add_u32 s14, s13, 96256
 buffer_load_dwordx4 v[224:227], v107, s[64:67], s14 offen sc1
 buffer_load_dwordx4 v[228:231], v107, s[64:67], s14 offen offset:1024 sc1
 s_add_u32 s14, s13, 98304
 buffer_load_dwordx4 v[232:235], v107, s[64:67], s14 offen sc1
 buffer_load_dwordx4 v[236:239], v107, s[64:67], s14 offen offset:1024 sc1
 s_add_u32 s14, s13, 86016
 buffer_load_dwordx4 v[240:243], v107, s[64:67], s14 offen sc1
 buffer_load_dwordx4 v[244:247], v107, s[64:67], s14 offen offset:1024 sc1
 s_add_u32 s14, s13, 88064
 buffer_load_dwordx4 v[248:251], v107, s[64:67], s14 offen sc1
 buffer_load_dwordx4 v[252:255], v107, s[64:67], s14 offen offset:1024 sc1
 v_lshrrev_b32 v1, 4, v0
 v_and_b32 v2, 15, v0
 v_and_b32 v3, 7, v0
 v_bfe_u32 v5, v0, 1, 1
 v_mov_b32 v6, 0x4444
 v_mov_b32 v7, 0xeeee
 v_cmp_eq_u32 vcc, 1, v5
 s_nop 1
 v_cndmask_b32 v106, v6, v7, vcc
 v_mov_b32 v6, 0x3f80
 v_mov_b32 v7, 0x3f800000
 v_and_b32 v4, 1, v0
 v_cmp_eq_u32 vcc, 1, v4
 s_nop 1
 v_cndmask_b32 v6, v6, v7, vcc
 v_lshrrev_b32 v4, 2, v2
 v_cmp_eq_u32 vcc, v4, v1
 s_nop 1
 v_cndmask_b32 v6, 0, v6, vcc
 v_cmp_eq_u32 vcc, 0, v5
 s_nop 1
 v_cndmask_b32 v100, 0, v6, vcc
 v_cndmask_b32 v101, 0, v6, vcc
 v_cmp_eq_u32 vcc, 1, v5
 s_nop 1
 v_cndmask_b32 v102, 0, v6, vcc
 v_cndmask_b32 v103, 0, v6, vcc
 v_mov_b32 v104, v102
 v_mov_b32 v105, v103
 v_add_u32 v4, 8, v1
 v_and_b32 v5, 1, v1
 v_mul_u32_u24 v5, 4, v5
 v_lshrrev_b32 v7, 1, v1
 v_add_u32 v5, v5, v7
 v_add_u32 v5, 20, v5
 v_lshrrev_b32 v6, 1, v4
 v_lshlrev_b32 v6, 8, v6
 v_and_b32 v7, 1, v4
 v_lshl_add_u32 v6, v7, 5, v6
 v_lshrrev_b32 v7, 1, v3
 v_lshl_add_u32 v6, v7, 6, v6
 v_and_b32 v7, 1, v3
 v_lshl_add_u32 v108, v7, 4, v6
 v_lshrrev_b32 v6, 1, v5
 v_lshlrev_b32 v6, 8, v6
 v_and_b32 v7, 1, v5
 v_lshl_add_u32 v6, v7, 5, v6
 v_lshrrev_b32 v7, 1, v3
 v_lshl_add_u32 v6, v7, 6, v6
 v_and_b32 v7, 1, v3
 v_lshl_add_u32 v109, v7, 4, v6
 v_lshlrev_b32 v6, 4, v2
 v_add_u32 v6, 13312, v6
 v_lshl_add_u32 v113, v4, 9, v6
 v_lshl_add_u32 v117, v5, 9, v6
 v_and_b32 v4, 1, v1
 v_lshrrev_b32 v5, 1, v1
 v_lshlrev_b32 v7, 8, v1
 v_lshlrev_b32 v3, 3, v2
 v_add_u32 v7, v7, v3
 v_add_u32 v110, 8192, v7
 v_lshlrev_b32 v7, 7, v4
 v_add_u32 v7, v7, v3
 v_add_u32 v111, 7424, v7
 v_lshlrev_b32 v7, 7, v1
 v_lshlrev_b32 v3, 2, v2
 v_add_u32 v7, v7, v3
 v_add_u32 v116, 11776, v7
 v_lshlrev_b32 v7, 6, v4
 v_add_u32 v7, v7, v3
 v_add_u32 v118, 11392, v7
 s_lshl_b32 s13, s11, 10
 s_add_u32 s13, s13, 256
 v_lshrrev_b32 v6, 2, v2
 v_lshlrev_b32 v6, 5, v6
 v_lshl_add_u32 v6, v4, 4, v6
 v_and_b32 v7, 3, v2
 v_lshl_add_u32 v6, v7, 2, v6
 v_add_u32 v112, s13, v6
 s_add_u32 s13, s13, 128
 v_bfe_u32 v6, v2, 2, 1
 v_lshlrev_b32 v6, 4, v6
 v_lshl_add_u32 v6, v4, 3, v6
 v_bfe_u32 v7, v2, 1, 1
 v_lshl_add_u32 v6, v7, 2, v6
 v_add_u32 v6, s13, v6
 v_and_b32 v3, 1, v2
 v_lshrrev_b32 v7, 3, v2
 v_lshl_add_u32 v3, v7, 1, v3
 v_lshl_add_u32 v6, v3, 5, v6
 v_mov_b32 v7, 0x7ffffff0
 v_cmp_eq_u32 vcc, 1, v5
 s_nop 1
 v_cndmask_b32 v112, v112, v6, vcc
 v_mov_b32 v1, 0
 v_mov_b32 v3, 0
 s_mov_b32 s23, 0x7ffffff0
 v_lshrrev_b32 v1, 4, v0
 v_lshlrev_b32 v7, 7, v1
 v_lshlrev_b32 v6, 3, v2
 v_add_u32 v7, v7, v6
 v_add_u32 v111, 7680, v7
 v_lshlrev_b32 v7, 6, v1
 v_lshlrev_b32 v6, 2, v2
 v_add_u32 v7, v7, v6
 v_add_u32 v118, 11520, v7
 s_lshl_b32 s13, s11, 10
 s_add_u32 s13, s13, 512
 v_lshrrev_b32 v4, 1, v1
 v_lshlrev_b32 v4, 8, v4
 v_add_u32 v4, s13, v4
 v_and_b32 v1, 1, v1
 v_lshrrev_b32 v6, 2, v2
 v_lshl_add_u32 v6, v6, 5, v4
 v_lshl_add_u32 v6, v1, 4, v6
 v_and_b32 v7, 3, v2
 v_lshl_add_u32 v112, v7, 2, v6
 v_bfe_u32 v6, v2, 2, 1
 v_lshl_add_u32 v6, v6, 4, v4
 v_lshl_add_u32 v6, v1, 3, v6
 v_bfe_u32 v7, v2, 1, 1
 v_lshl_add_u32 v6, v7, 2, v6
 v_and_b32 v7, 1, v2
 v_lshrrev_b32 v1, 3, v2
 v_lshl_add_u32 v7, v1, 1, v7
 v_lshl_add_u32 v6, v7, 5, v6
 v_add_u32 v5, 128, v6
 v_mov_b32 v1, 0
 v_mov_b32 v2, 0
 v_and_b32 v2, 15, v0
 v_lshrrev_b32 v1, 4, v0
 v_lshrrev_b32 v4, 1, v1
 v_and_b32 v1, 1, v1
 s_lshl_b32 s13, s11, 9
 s_add_u32 s13, s13, 256
 v_lshlrev_b32 v6, 7, v4
 v_add_u32 v6, s13, v6
 v_lshrrev_b32 v7, 2, v2
 v_lshl_add_u32 v6, v7, 5, v6
 v_lshl_add_u32 v6, v1, 4, v6
 v_and_b32 v7, 3, v2
 v_lshl_add_u32 v112, v7, 2, v6
 s_lshl_b32 s13, s11, 7
 s_add_u32 s13, s13, 8256
 v_lshlrev_b32 v6, 5, v4
 v_add_u32 v6, s13, v6
 v_bfe_u32 v7, v2, 2, 1
 v_lshl_add_u32 v6, v7, 4, v6
 v_lshl_add_u32 v6, v1, 3, v6
 v_bfe_u32 v7, v2, 1, 1
 v_lshl_add_u32 v6, v7, 2, v6
 v_and_b32 v7, 9, v2
 v_cmp_eq_u32 vcc, 0, v7
 v_mov_b32 v7, 0x7ffffff0
 s_nop 0
 v_cndmask_b32 v5, v7, v6, vcc
 v_mov_b32 v1, 0
 v_mov_b32 v2, 0
 v_mov_b32 v119, 0xff800000
 s_mov_b32 s16, 0xff00ff00
 s_mov_b32 s17, 0xff00ff00
 s_mov_b32 s18, 0
 s_mov_b32 s19, -1
 s_mov_b32 s35, 0x42800000
 s_mov_b32 s34, 0xfffffffe
 s_mov_b32 s25, 50331648
 s_mov_b32 s26, 53485568
 s_mov_b32 s22, 50855936
 s_mov_b32 s24, 42212352
 s_cmp_lg_u32 s12, 0
 s_cbranch_scc1 L_wg_19_done
 v_lshlrev_b32 v36, 7, v0
 s_mov_b32 s31, 0
 s_mov_b32 s3, 53501952
 s_mov_b32 exec_lo, 262143
 s_mov_b32 exec_hi, 1
L_wg_19:
 buffer_load_dword v37, v36, s[64:67], s3 offen sc1
 s_add_u32 s31, s31, 1
 s_cmp_gt_u32 s31, 524288
 s_cbranch_scc1 L_exit
 s_waitcnt vmcnt(0)
 v_cmp_eq_u32 vcc, 0, v37
 s_cbranch_vccz L_wg_19_ok
 s_sleep 4
 s_branch L_wg_19
L_wg_19_ok:
 s_mov_b64 exec, -1
L_wg_19_done:
 s_barrier
 s_mov_b32 s32, 0
 s_mov_b32 s33, 28672
 s_add_u32 m0, s32, 20480
 s_nop 0
 buffer_load_dwordx4 v107, s[64:67], s24 offen sc1 lds
 buffer_load_dwordx4 v107, s[64:67], s24 offen offset:1024 sc1 lds
 buffer_load_dwordx4 v107, s[64:67], s24 offen offset:2048 sc1 lds
 buffer_load_dwordx4 v107, s[64:67], s24 offen offset:3072 sc1 lds
 s_add_u32 s24, s24, 4096
 s_add_u32 m0, s32, 24576
 s_nop 0
 buffer_load_dwordx4 v107, s[64:67], s24 offen sc1 lds
 buffer_load_dwordx4 v107, s[64:67], s24 offen offset:1024 sc1 lds
 buffer_load_dwordx4 v107, s[64:67], s24 offen offset:2048 sc1 lds
 s_add_u32 s24, s24, 24576
 v_mov_b32 v36, 0
 v_mov_b32 v37, 0
 v_mov_b32 v38, 0
 v_mov_b32 v39, 0
 v_mov_b32 v40, 0
 v_mov_b32 v41, 0
 v_mov_b32 v42, 0
 v_mov_b32 v43, 0
 v_mov_b32 v44, 0
 v_mov_b32 v45, 0
 v_mov_b32 v46, 0
 v_mov_b32 v47, 0
 v_mov_b32 v48, 0
 v_mov_b32 v49, 0
 v_mov_b32 v50, 0
 v_mov_b32 v51, 0
 v_mov_b32 v52, 0
 v_mov_b32 v53, 0
 v_mov_b32 v54, 0
 v_mov_b32 v55, 0
 v_mov_b32 v56, 0
 v_mov_b32 v57, 0
 v_mov_b32 v58, 0
 v_mov_b32 v59, 0
 v_mov_b32 v60, 0
 v_mov_b32 v61, 0
 v_mov_b32 v62, 0
 v_mov_b32 v63, 0
 v_mov_b32 v64, 0
 v_mov_b32 v65, 0
 v_mov_b32 v66, 0
 v_mov_b32 v67, 0
 v_mov_b32 v68, 0
 v_mov_b32 v69, 0
 v_mov_b32 v70, 0
 v_mov_b32 v71, 0
 v_mov_b32 v72, 0
 v_mov_b32 v73, 0
 v_mov_b32 v74, 0
 v_mov_b32 v75, 0
 s_mov_b32 s30, 0
 s_waitcnt vmcnt(0) lgkmcnt(0)
 s_barrier
L_Aloop_20:
 s_add_u32 s20, s25, 2048
 s_add_u32 s21, s25, 3072
 s_sleep 11
 s_mov_b32 s31, 0
 buffer_load_dwordx4 v[8:11], v107, s[64:67], s20 offen sc1
 buffer_load_dwordx4 v[12:15], v107, s[64:67], s21 offen sc1
 s_nop 15
 s_nop 15
 buffer_load_dwordx4 v[8:11], v107, s[64:67], s20 offen sc1
 buffer_load_dwordx4 v[12:15], v107, s[64:67], s21 offen sc1
L_q2_21_w:
 s_waitcnt vmcnt(2)
 v_max3_u32 v114, v8, v9, v10
 v_max3_u32 v114, v114, v11, v15
 v_cmp_eq_u32 vcc, -1, v114
 v_smfmac_f32_16x16x64_bf16 v[36:39], v[8:11], a[0:7], v106
 ds_write_b128 v107, v[8:11] offset:2048
 s_cbranch_vccnz L_q2_21
 v_smfmac_f32_16x16x64_bf16 v[40:43], v[8:11], a[56:63], v106
 v_smfmac_f32_16x16x64_bf16 v[44:47], v[8:11], a[112:119], v106
 ds_write_b128 v107, v[12:15] offset:3072
 v_smfmac_f32_16x16x64_bf16 v[48:51], v[8:11], a[168:175], v106
 v_smfmac_f32_16x16x64_bf16 v[52:55], v[8:11], a[224:231], v106
 v_smfmac_f32_16x16x64_bf16 v[56:59], v[8:11], v[144:151], v106
 v_smfmac_f32_16x16x64_bf16 v[60:63], v[8:11], v[200:207], v106
 s_waitcnt lgkmcnt(0)
 s_barrier
 ds_read_b128 v[16:19], v107 offset:4096
 ds_read_b128 v[20:23], v107 offset:5120
 v_smfmac_f32_16x16x64_bf16 v[36:39], v[12:15], a[8:15], v106
 ds_read_b128 v[24:27], v107 offset:6144
 v_smfmac_f32_16x16x64_bf16 v[40:43], v[12:15], a[64:71], v106
 ds_read_b128 v[28:31], v107
 v_smfmac_f32_16x16x64_bf16 v[44:47], v[12:15], a[120:127], v106
 ds_read_b128 v[32:35], v107 offset:1024
 v_smfmac_f32_16x16x64_bf16 v[48:51], v[12:15], a[176:183], v106
 v_smfmac_f32_16x16x64_bf16 v[52:55], v[12:15], a[232:239], v106
 v_smfmac_f32_16x16x64_bf16 v[56:59], v[12:15], v[152:159], v106
 v_smfmac_f32_16x16x64_bf16 v[60:63], v[12:15], v[208:215], v106
 s_waitcnt lgkmcnt(4)
 v_smfmac_f32_16x16x64_bf16 v[36:39], v[16:19], a[16:23], v106
 s_waitcnt lgkmcnt(3)
 v_smfmac_f32_16x16x64_bf16 v[36:39], v[20:23], a[24:31], v106
 s_add_u32 m0, s33, 20480
 s_nop 0
 buffer_load_dwordx4 v107, s[64:67], s24 offen sc1 lds
 s_waitcnt lgkmcnt(2)
 v_smfmac_f32_16x16x64_bf16 v[36:39], v[24:27], a[32:39], v106
 s_waitcnt lgkmcnt(1)
 v_smfmac_f32_16x16x64_bf16 v[36:39], v[28:31], a[40:47], v106
 s_waitcnt lgkmcnt(0)
 v_smfmac_f32_16x16x64_bf16 v[36:39], v[32:35], a[48:55], v106
 buffer_load_dwordx4 v107, s[64:67], s24 offen offset:1024 sc1 lds
 v_smfmac_f32_16x16x64_bf16 v[40:43], v[16:19], a[72:79], v106
 ds_read_b128 v[76:79], v108
 v_smfmac_f32_16x16x64_bf16 v[40:43], v[20:23], a[80:87], v106
 ds_read_b128 v[80:83], v108 offset:512
 v_smfmac_f32_16x16x64_bf16 v[40:43], v[24:27], a[88:95], v106
 buffer_load_dwordx4 v107, s[64:67], s24 offen offset:2048 sc1 lds
 ds_read_b128 v[84:87], v113
 v_smfmac_f32_16x16x64_bf16 v[40:43], v[28:31], a[96:103], v106
 ds_read_b128 v[88:91], v113 offset:2048
 v_smfmac_f32_16x16x64_bf16 v[40:43], v[32:35], a[104:111], v106
 ds_read_b128 v[92:95], v113 offset:256
 v_cvt_pk_bf16_f32 v36, v36, v37
 v_smfmac_f32_16x16x64_bf16 v[44:47], v[16:19], a[128:135], v106
 buffer_load_dwordx4 v107, s[64:67], s24 offen offset:3072 sc1 lds
 s_add_u32 s24, s24, 4096
 ds_read_b128 v[96:99], v113 offset:2304
 v_cvt_pk_bf16_f32 v37, v38, v39
 v_smfmac_f32_16x16x64_bf16 v[44:47], v[20:23], a[136:143], v106
 v_smfmac_f32_16x16x64_bf16 v[44:47], v[24:27], a[144:151], v106
 v_smfmac_f32_16x16x64_bf16 v[44:47], v[28:31], a[152:159], v106
 s_add_u32 m0, s33, 24576
 s_nop 0
 buffer_load_dwordx4 v107, s[64:67], s24 offen sc1 lds
 v_smfmac_f32_16x16x64_bf16 v[44:47], v[32:35], a[160:167], v106
 v_cvt_pk_bf16_f32 v38, v40, v41
 v_smfmac_f32_16x16x64_bf16 v[48:51], v[16:19], a[184:191], v106
 v_cvt_pk_bf16_f32 v39, v42, v43
 v_smfmac_f32_16x16x64_bf16 v[48:51], v[20:23], a[192:199], v106
 buffer_load_dwordx4 v107, s[64:67], s24 offen offset:1024 sc1 lds
 v_smfmac_f32_16x16x64_bf16 v[48:51], v[24:27], a[200:207], v106
 v_mfma_f32_16x16x32_bf16 v[40:43], v[36:39], v[100:103], 0
 v_smfmac_f32_16x16x64_bf16 v[48:51], v[28:31], a[208:215], v106
 v_smfmac_f32_16x16x64_bf16 v[48:51], v[32:35], a[216:223], v106
 buffer_load_dwordx4 v107, s[64:67], s24 offen offset:2048 sc1 lds
 s_add_u32 s24, s24, 24576
 v_cvt_pk_bf16_f32 v44, v44, v45
 v_smfmac_f32_16x16x64_bf16 v[52:55], v[16:19], a[240:247], v106
 v_cvt_pk_bf16_f32 v45, v46, v47
 v_smfmac_f32_16x16x64_bf16 v[52:55], v[20:23], a[248:255], v106
 v_smfmac_f32_16x16x64_bf16 v[52:55], v[24:27], v[120:127], v106
 v_cvt_pk_bf16_f32 v36, v40, v41
 v_smfmac_f32_16x16x64_bf16 v[52:55], v[28:31], v[128:135], v106
 v_cvt_pk_bf16_f32 v37, v42, v43
 v_smfmac_f32_16x16x64_bf16 v[52:55], v[32:35], v[136:143], v106
 v_cvt_pk_bf16_f32 v46, v48, v49
 v_smfmac_f32_16x16x64_bf16 v[56:59], v[16:19], v[160:167], v106
 v_cvt_pk_bf16_f32 v47, v50, v51
 v_smfmac_f32_16x16x64_bf16 v[56:59], v[20:23], v[168:175], v106
 s_nop 0
 v_mfma_f32_16x16x32_bf16 v[48:51], v[44:47], v[100:103], 0
 v_smfmac_f32_16x16x64_bf16 v[56:59], v[24:27], v[176:183], v106
 s_nop 0
 v_cvt_pk_bf16_f32 v52, v52, v53
 v_smfmac_f32_16x16x64_bf16 v[56:59], v[28:31], v[184:191], v106
 v_cvt_pk_bf16_f32 v53, v54, v55
 v_smfmac_f32_16x16x64_bf16 v[56:59], v[32:35], v[192:199], v106
 s_nop 0
 v_smfmac_f32_16x16x64_bf16 v[60:63], v[16:19], v[216:223], v106
 s_nop 0
 v_cvt_pk_bf16_f32 v38, v48, v49
 v_smfmac_f32_16x16x64_bf16 v[60:63], v[20:23], v[224:231], v106
 s_nop 0
 v_cvt_pk_bf16_f32 v39, v50, v51
 v_smfmac_f32_16x16x64_bf16 v[60:63], v[24:27], v[232:239], v106
 s_nop 0
 v_cvt_pk_bf16_f32 v54, v56, v57
 v_smfmac_f32_16x16x64_bf16 v[60:63], v[28:31], v[240:247], v106
 v_cvt_pk_bf16_f32 v55, v58, v59
 v_smfmac_f32_16x16x64_bf16 v[60:63], v[32:35], v[248:255], v106
 s_waitcnt lgkmcnt(0)
 s_nop 0
 v_smfmac_f32_16x16x64_bf16 v[64:67], v[36:39], v[76:83], v106
 ds_read_b128 v[76:79], v109
 ds_read_b128 v[80:83], v109 offset:256
 s_nop 0
 v_mfma_f32_16x16x32_bf16 v[56:59], v[52:55], v[100:103], 0
 s_nop 0
 v_cvt_pk_bf16_f32 v60, v60, v61
 v_cvt_pk_bf16_f32 v61, v62, v63
 s_nop 1
 v_mfma_f32_16x16x16_bf16 v[40:43], v[60:61], v[104:105], 0
 s_nop 0
 s_nop 0
 v_smfmac_f32_16x16x64_bf16 v[68:71], v[36:39], v[84:91], v106
 ds_read_b128 v[84:87], v117
 ds_read_b128 v[88:91], v117 offset:1024
 v_cvt_pk_bf16_f32 v52, v56, v57
 v_smfmac_f32_16x16x64_bf16 v[72:75], v[36:39], v[92:99], v106
 ds_read_b128 v[92:95], v117 offset:256
 ds_read_b128 v[96:99], v117 offset:1280
 v_cvt_pk_bf16_f32 v53, v58, v59
 v_cvt_pk_bf16_f32 v54, v40, v41
 v_cvt_pk_bf16_f32 v55, v42, v43
 s_waitcnt lgkmcnt(4)
 s_nop 0
 v_smfmac_f32_16x16x64_bf16 v[64:67], v[52:55], v[76:83], v106
 s_waitcnt lgkmcnt(2)
 v_smfmac_f32_16x16x64_bf16 v[68:71], v[52:55], v[84:91], v106
 s_waitcnt lgkmcnt(0)
 v_smfmac_f32_16x16x64_bf16 v[72:75], v[52:55], v[92:99], v106
 s_nop 3
 v_pk_add_f32 v[64:65], v[64:65], v[66:67]
 s_nop 0
 v_add_f32 v36, v68, v70
 v_add_f32 v38, v69, v71
 ds_write2_b32 v116, v64, v65 offset0:0 offset1:16
 v_add_f32 v37, v72, v74
 v_add_f32 v39, v73, v75
 ds_write2_b64 v110, v[36:37], v[38:39] offset0:0 offset1:16
 s_waitcnt lgkmcnt(0)
 s_barrier
 ds_read2st64_b32 v[84:85], v118 offset0:0 offset1:2
 ds_read2st64_b32 v[86:87], v118 offset0:4 offset1:6
 ds_read_b64 v[76:77], v111
 ds_read_b64 v[78:79], v111 offset:1024
 ds_read_b64 v[80:81], v111 offset:2048
 ds_read_b64 v[82:83], v111 offset:3072
 s_waitcnt lgkmcnt(4)
 v_pk_add_f32 v[84:85], v[84:85], v[86:87]
 v_add_f32 v84, v84, v85
 v_exp_f32 v85, v84
 s_waitcnt lgkmcnt(2)
 v_pk_add_f32 v[76:77], v[76:77], v[78:79]
 v_cndmask_b32 v85, v85, 0, s[16:17]
 s_waitcnt lgkmcnt(0)
 v_pk_add_f32 v[80:81], v[80:81], v[82:83]
 v_pk_add_f32 v[76:77], v[76:77], v[80:81]
 v_max3_f32 v114, abs(v84), abs(v76), abs(v77)
 v_cmp_nge_f32 vcc, s35, v114
 v_exp_f32 v78, v76
 v_exp_f32 v79, v77
 s_cbranch_vccnz L_sm_22_max
L_sm_22:
 v_add_f32 v114, v85, v78
 v_add_f32 v114, v114, v79
 v_mov_b32_dpp v115, v85 quad_perm:[1,0,3,2] row_mask:0xf bank_mask:0xf
 v_mov_b32 v86, v85
 v_add_f32_dpp v114, v114, v114 row_ror:8 row_mask:0xf bank_mask:0xf
 s_nop 1
 v_add_f32_dpp v114, v114, v114 row_ror:4 row_mask:0xf bank_mask:0xf
 s_nop 1
 v_add_f32_dpp v114, v114, v114 row_ror:2 row_mask:0xf bank_mask:0xf
 s_nop 1
 v_add_f32_dpp v114, v114, v114 row_ror:1 row_mask:0xf bank_mask:0xf
 v_rcp_f32 v114, v114
 s_nop 0
 v_mul_f32 v78, v78, v114
 v_mul_f32 v79, v79, v114
 v_cvt_pk_bf16_f32 v3, v78, v79
 v_min_u32 v3, s34, v3
 buffer_store_dword v3, v112, s[64:67], s22 offen
 v_mul_f32 v86, v86, v114
 v_mul_f32 v115, v115, v114
 v_cvt_pk_bf16_f32 v2, v86, v115
 v_min_u32 v2, s34, v2
 buffer_store_dword v2, v5, s[64:67], s22 offen
 s_add_u32 s23, s22, 655360
 v_mov_b32 v36, 0
 v_mov_b32 v37, 0
 v_mov_b32 v38, 0
 v_mov_b32 v39, 0
 v_mov_b32 v40, 0
 v_mov_b32 v41, 0
 v_mov_b32 v42, 0
 v_mov_b32 v43, 0
 v_mov_b32 v44, 0
 v_mov_b32 v45, 0
 v_mov_b32 v46, 0
 v_mov_b32 v47, 0
 v_mov_b32 v48, 0
 v_mov_b32 v49, 0
 v_mov_b32 v50, 0
 v_mov_b32 v51, 0
 v_mov_b32 v52, 0
 v_mov_b32 v53, 0
 v_mov_b32 v54, 0
 v_mov_b32 v55, 0
 v_mov_b32 v56, 0
 v_mov_b32 v57, 0
 v_mov_b32 v58, 0
 v_mov_b32 v59, 0
 v_mov_b32 v60, 0
 v_mov_b32 v61, 0
 v_mov_b32 v62, 0
 v_mov_b32 v63, 0
 v_mov_b32 v64, 0
 v_mov_b32 v65, 0
 v_mov_b32 v66, 0
 v_mov_b32 v67, 0
 v_mov_b32 v68, 0
 v_mov_b32 v69, 0
 v_mov_b32 v70, 0
 v_mov_b32 v71, 0
 v_mov_b32 v72, 0
 v_mov_b32 v73, 0
 v_mov_b32 v74, 0
 v_mov_b32 v75, 0
 buffer_store_dword v3, v112, s[64:67], s23 offen sc1
 buffer_store_dword v2, v5, s[64:67], s23 offen sc1
 s_sub_u32 s36, s33, s32
 v_add_u32 v113, s36, v113
 v_add_u32 v117, s36, v117
 s_mov_b32 s36, s32
 s_mov_b32 s32, s33
 s_mov_b32 s33, s36
 s_add_u32 s25, s25, 8192
 s_add_u32 s26, s25, 2098176
 s_add_u32 s22, s22, 10240
 s_add_u32 s30, s30, 1
 s_cmp_lt_u32 s30, 63
 s_cbranch_scc1 L_Aloop_20
 buffer_store_dword v3, v112, s[64:67], s23 offen sc1
 buffer_store_dword v2, v5, s[64:67], s23 offen sc1
 s_branch L_exit
L_q2_21:
 buffer_load_dwordx4 v[8:11], v107, s[64:67], s20 offen sc1
 buffer_load_dwordx4 v[12:15], v107, s[64:67], s21 offen sc1
 s_nop 3
 v_mov_b32 v36, 0
 v_mov_b32 v37, 0
 v_mov_b32 v38, 0
 v_mov_b32 v39, 0
 s_add_u32 s31, s31, 1
 s_cmp_lt_u32 s31, 64
 s_cbranch_scc1 L_q2_21_w
 s_cmp_gt_u32 s31, 524288
 s_cbranch_scc1 L_exit
 s_cmp_lg_u32 s31, 64
 s_cbranch_scc1 L_q2_21_w
 s_waitcnt vmcnt(0)
 buffer_store_dword v3, v112, s[64:67], s23 offen sc1
 buffer_store_dword v2, v5, s[64:67], s23 offen sc1
 s_add_u32 s20, s26, 2048
 s_add_u32 s21, s26, 3072
 buffer_load_dwordx4 v[8:11], v107, s[64:67], s20 offen sc1
 buffer_load_dwordx4 v[12:15], v107, s[64:67], s21 offen sc1
 buffer_load_dwordx4 v[8:11], v107, s[64:67], s20 offen sc1
 buffer_load_dwordx4 v[12:15], v107, s[64:67], s21 offen sc1
 s_branch L_q2_21_w
L_sm_22_max:
 v_cndmask_b32 v84, v84, v119, s[16:17]
 v_max3_f32 v114, v84, v76, v77
 s_nop 1
 v_max_f32_dpp v114, v114, v114 row_ror:8 row_mask:0xf bank_mask:0xf
 s_nop 1
 v_max_f32_dpp v114, v114, v114 row_ror:4 row_mask:0xf bank_mask:0xf
 s_nop 1
 v_max_f32_dpp v114, v114, v114 row_ror:2 row_mask:0xf bank_mask:0xf
 s_nop 1
 v_max_f32_dpp v114, v114, v114 row_ror:1 row_mask:0xf bank_mask:0xf
 v_sub_f32 v84, v84, v114
 v_sub_f32 v76, v76, v114
 v_sub_f32 v77, v77, v114
 v_exp_f32 v85, v84
 v_exp_f32 v78, v76
 v_exp_f32 v79, v77
 s_mov_b64 vcc, 0
 s_branch L_sm_22
L_pad4:
 s_setpc_b64 s[94:95]
L_A2:
 v_lshlrev_b32 v107, 4, v0
 s_mul_i32 s13, s11, 401408
 s_add_u32 s13, s13, 200704
 s_add_u32 s14, s13, 8192
 buffer_load_dwordx4 a[0:3], v107, s[64:67], s14 offen sc1
 buffer_load_dwordx4 a[4:7], v107, s[64:67], s14 offen offset:1024 sc1
 s_add_u32 s14, s13, 10240
 buffer_load_dwordx4 a[8:11], v107, s[64:67], s14 offen sc1
 buffer_load_dwordx4 a[12:15], v107, s[64:67], s14 offen offset:1024 sc1
 s_add_u32 s14, s13, 12288
 buffer_load_dwordx4 a[16:19], v107, s[64:67], s14 offen sc1
 buffer_load_dwordx4 a[20:23], v107, s[64:67], s14 offen offset:1024 sc1
 s_add_u32 s14, s13, 0
 buffer_load_dwordx4 a[24:27], v107, s[64:67], s14 offen sc1
 buffer_load_dwordx4 a[28:31], v107, s[64:67], s14 offen offset:1024 sc1
 s_add_u32 s14, s13, 2048
 buffer_load_dwordx4 a[32:35], v107, s[64:67], s14 offen sc1
 buffer_load_dwordx4 a[36:39], v107, s[64:67], s14 offen offset:1024 sc1
 s_add_u32 s14, s13, 4096
 buffer_load_dwordx4 a[40:43], v107, s[64:67], s14 offen sc1
 buffer_load_dwordx4 a[44:47], v107, s[64:67], s14 offen offset:1024 sc1
 s_add_u32 s14, s13, 6144
 buffer_load_dwordx4 a[48:51], v107, s[64:67], s14 offen sc1
 buffer_load_dwordx4 a[52:55], v107, s[64:67], s14 offen offset:1024 sc1
 s_add_u32 s14, s13, 22528
 buffer_load_dwordx4 a[56:59], v107, s[64:67], s14 offen sc1
 buffer_load_dwordx4 a[60:63], v107, s[64:67], s14 offen offset:1024 sc1
 s_add_u32 s14, s13, 24576
 buffer_load_dwordx4 a[64:67], v107, s[64:67], s14 offen sc1
 buffer_load_dwordx4 a[68:71], v107, s[64:67], s14 offen offset:1024 sc1
 s_add_u32 s14, s13, 26624
 buffer_load_dwordx4 a[72:75], v107, s[64:67], s14 offen sc1
 buffer_load_dwordx4 a[76:79], v107, s[64:67], s14 offen offset:1024 sc1
 s_add_u32 s14, s13, 14336
 buffer_load_dwordx4 a[80:83], v107, s[64:67], s14 offen sc1
 buffer_load_dwordx4 a[84:87], v107, s[64:67], s14 offen offset:1024 sc1
 s_add_u32 s14, s13, 16384
 buffer_load_dwordx4 a[88:91], v107, s[64:67], s14 offen sc1
 buffer_load_dwordx4 a[92:95], v107, s[64:67], s14 offen offset:1024 sc1
 s_add_u32 s14, s13, 18432
 buffer_load_dwordx4 a[96:99], v107, s[64:67], s14 offen sc1
 buffer_load_dwordx4 a[100:103], v107, s[64:67], s14 offen offset:1024 sc1
 s_add_u32 s14, s13, 20480
 buffer_load_dwordx4 a[104:107], v107, s[64:67], s14 offen sc1
 buffer_load_dwordx4 a[108:111], v107, s[64:67], s14 offen offset:1024 sc1
 s_add_u32 s14, s13, 36864
 buffer_load_dwordx4 a[112:115], v107, s[64:67], s14 offen sc1
 buffer_load_dwordx4 a[116:119], v107, s[64:67], s14 offen offset:1024 sc1
 s_add_u32 s14, s13, 38912
 buffer_load_dwordx4 a[120:123], v107, s[64:67], s14 offen sc1
 buffer_load_dwordx4 a[124:127], v107, s[64:67], s14 offen offset:1024 sc1
 s_add_u32 s14, s13, 40960
 buffer_load_dwordx4 a[128:131], v107, s[64:67], s14 offen sc1
 buffer_load_dwordx4 a[132:135], v107, s[64:67], s14 offen offset:1024 sc1
 s_add_u32 s14, s13, 28672
 buffer_load_dwordx4 a[136:139], v107, s[64:67], s14 offen sc1
 buffer_load_dwordx4 a[140:143], v107, s[64:67], s14 offen offset:1024 sc1
 s_add_u32 s14, s13, 30720
 buffer_load_dwordx4 a[144:147], v107, s[64:67], s14 offen sc1
 buffer_load_dwordx4 a[148:151], v107, s[64:67], s14 offen offset:1024 sc1
 s_add_u32 s14, s13, 32768
 buffer_load_dwordx4 a[152:155], v107, s[64:67], s14 offen sc1
 buffer_load_dwordx4 a[156:159], v107, s[64:67], s14 offen offset:1024 sc1
 s_add_u32 s14, s13, 34816
 buffer_load_dwordx4 a[160:163], v107, s[64:67], s14 offen sc1
 buffer_load_dwordx4 a[164:167], v107, s[64:67], s14 offen offset:1024 sc1
 s_add_u32 s14, s13, 51200
 buffer_load_dwordx4 a[168:171], v107, s[64:67], s14 offen sc1
 buffer_load_dwordx4 a[172:175], v107, s[64:67], s14 offen offset:1024 sc1
 s_add_u32 s14, s13, 53248
 buffer_load_dwordx4 a[176:179], v107, s[64:67], s14 offen sc1
 buffer_load_dwordx4 a[180:183], v107, s[64:67], s14 offen offset:1024 sc1
 s_add_u32 s14, s13, 55296
 buffer_load_dwordx4 a[184:187], v107, s[64:67], s14 offen sc1
 buffer_load_dwordx4 a[188:191], v107, s[64:67], s14 offen offset:1024 sc1
 s_add_u32 s14, s13, 43008
 buffer_load_dwordx4 a[192:195], v107, s[64:67], s14 offen sc1
 buffer_load_dwordx4 a[196:199], v107, s[64:67], s14 offen offset:1024 sc1
 s_add_u32 s14, s13, 45056
 buffer_load_dwordx4 a[200:203], v107, s[64:67], s14 offen sc1
 buffer_load_dwordx4 a[204:207], v107, s[64:67], s14 offen offset:1024 sc1
 s_add_u32 s14, s13, 47104
 buffer_load_dwordx4 a[208:211], v107, s[64:67], s14 offen sc1
 buffer_load_dwordx4 a[212:215], v107, s[64:67], s14 offen offset:1024 sc1
 s_add_u32 s14, s13, 49152
 buffer_load_dwordx4 a[216:219], v107, s[64:67], s14 offen sc1
 buffer_load_dwordx4 a[220:223], v107, s[64:67], s14 offen offset:1024 sc1
 s_add_u32 s14, s13, 65536
 buffer_load_dwordx4 a[224:227], v107, s[64:67], s14 offen sc1
 buffer_load_dwordx4 a[228:231], v107, s[64:67], s14 offen offset:1024 sc1
 s_add_u32 s14, s13, 67584
 buffer_load_dwordx4 a[232:235], v107, s[64:67], s14 offen sc1
 buffer_load_dwordx4 a[236:239], v107, s[64:67], s14 offen offset:1024 sc1
 s_add_u32 s14, s13, 69632
 buffer_load_dwordx4 a[240:243], v107, s[64:67], s14 offen sc1
 buffer_load_dwordx4 a[244:247], v107, s[64:67], s14 offen offset:1024 sc1
 s_add_u32 s14, s13, 57344
 buffer_load_dwordx4 a[248:251], v107, s[64:67], s14 offen sc1
 buffer_load_dwordx4 a[252:255], v107, s[64:67], s14 offen offset:1024 sc1
 s_add_u32 s14, s13, 59392
 buffer_load_dwordx4 v[120:123], v107, s[64:67], s14 offen sc1
 buffer_load_dwordx4 v[124:127], v107, s[64:67], s14 offen offset:1024 sc1
 s_add_u32 s14, s13, 61440
 buffer_load_dwordx4 v[128:131], v107, s[64:67], s14 offen sc1
 buffer_load_dwordx4 v[132:135], v107, s[64:67], s14 offen offset:1024 sc1
 s_add_u32 s14, s13, 63488
 buffer_load_dwordx4 v[136:139], v107, s[64:67], s14 offen sc1
 buffer_load_dwordx4 v[140:143], v107, s[64:67], s14 offen offset:1024 sc1
 s_add_u32 s14, s13, 79872
 buffer_load_dwordx4 v[144:147], v107, s[64:67], s14 offen sc1
 buffer_load_dwordx4 v[148:151], v107, s[64:67], s14 offen offset:1024 sc1
 s_add_u32 s14, s13, 81920
 buffer_load_dwordx4 v[152:155], v107, s[64:67], s14 offen sc1
 buffer_load_dwordx4 v[156:159], v107, s[64:67], s14 offen offset:1024 sc1
 s_add_u32 s14, s13, 83968
 buffer_load_dwordx4 v[160:163], v107, s[64:67], s14 offen sc1
 buffer_load_dwordx4 v[164:167], v107, s[64:67], s14 offen offset:1024 sc1
 s_add_u32 s14, s13, 71680
 buffer_load_dwordx4 v[168:171], v107, s[64:67], s14 offen sc1
 buffer_load_dwordx4 v[172:175], v107, s[64:67], s14 offen offset:1024 sc1
 s_add_u32 s14, s13, 73728
 buffer_load_dwordx4 v[176:179], v107, s[64:67], s14 offen sc1
 buffer_load_dwordx4 v[180:183], v107, s[64:67], s14 offen offset:1024 sc1
 s_add_u32 s14, s13, 75776
 buffer_load_dwordx4 v[184:187], v107, s[64:67], s14 offen sc1
 buffer_load_dwordx4 v[188:191], v107, s[64:67], s14 offen offset:1024 sc1
 s_add_u32 s14, s13, 77824
 buffer_load_dwordx4 v[192:195], v107, s[64:67], s14 offen sc1
 buffer_load_dwordx4 v[196:199], v107, s[64:67], s14 offen offset:1024 sc1
 s_add_u32 s14, s13, 94208
 buffer_load_dwordx4 v[200:203], v107, s[64:67], s14 offen sc1
 buffer_load_dwordx4 v[204:207], v107, s[64:67], s14 offen offset:1024 sc1
 s_add_u32 s14, s13, 96256
 buffer_load_dwordx4 v[208:211], v107, s[64:67], s14 offen sc1
 buffer_load_dwordx4 v[212:215], v107, s[64:67], s14 offen offset:1024 sc1
 s_add_u32 s14, s13, 98304
 buffer_load_dwordx4 v[216:219], v107, s[64:67], s14 offen sc1
 buffer_load_dwordx4 v[220:223], v107, s[64:67], s14 offen offset:1024 sc1
 s_add_u32 s14, s13, 86016
 buffer_load_dwordx4 v[224:227], v107, s[64:67], s14 offen sc1
 buffer_load_dwordx4 v[228:231], v107, s[64:67], s14 offen offset:1024 sc1
 s_add_u32 s14, s13, 88064
 buffer_load_dwordx4 v[232:235], v107, s[64:67], s14 offen sc1
 buffer_load_dwordx4 v[236:239], v107, s[64:67], s14 offen offset:1024 sc1
 s_add_u32 s14, s13, 90112
 buffer_load_dwordx4 v[240:243], v107, s[64:67], s14 offen sc1
 buffer_load_dwordx4 v[244:247], v107, s[64:67], s14 offen offset:1024 sc1
 s_add_u32 s14, s13, 92160
 buffer_load_dwordx4 v[248:251], v107, s[64:67], s14 offen sc1
 buffer_load_dwordx4 v[252:255], v107, s[64:67], s14 offen offset:1024 sc1
 v_lshrrev_b32 v1, 4, v0
 v_and_b32 v2, 15, v0
 v_and_b32 v3, 7, v0
 v_bfe_u32 v5, v0, 1, 1
 v_mov_b32 v6, 0x4444
 v_mov_b32 v7, 0xeeee
 v_cmp_eq_u32 vcc, 1, v5
 s_nop 1
 v_cndmask_b32 v106, v6, v7, vcc
 v_mov_b32 v6, 0x3f80
 v_mov_b32 v7, 0x3f800000
 v_and_b32 v4, 1, v0
 v_cmp_eq_u32 vcc, 1, v4
 s_nop 1
 v_cndmask_b32 v6, v6, v7, vcc
 v_lshrrev_b32 v4, 2, v2
 v_cmp_eq_u32 vcc, v4, v1
 s_nop 1
 v_cndmask_b32 v6, 0, v6, vcc
 v_cmp_eq_u32 vcc, 0, v5
 s_nop 1
 v_cndmask_b32 v100, 0, v6, vcc
 v_cndmask_b32 v101, 0, v6, vcc
 v_cmp_eq_u32 vcc, 1, v5
 s_nop 1
 v_cndmask_b32 v102, 0, v6, vcc
 v_cndmask_b32 v103, 0, v6, vcc
 v_mov_b32 v104, v100
 v_mov_b32 v105, v101
 v_add_u32 v4, 28, v1
 v_and_b32 v5, 1, v1
 v_mul_u32_u24 v5, 8, v5
 v_lshrrev_b32 v7, 1, v1
 v_add_u32 v5, v5, v7
 v_add_u32 v5, 44, v5
 v_lshrrev_b32 v6, 1, v4
 v_lshlrev_b32 v6, 8, v6
 v_and_b32 v7, 1, v4
 v_lshl_add_u32 v6, v7, 5, v6
 v_lshrrev_b32 v7, 1, v3
 v_lshl_add_u32 v6, v7, 6, v6
 v_and_b32 v7, 1, v3
 v_lshl_add_u32 v108, v7, 4, v6
 v_lshrrev_b32 v6, 1, v5
 v_lshlrev_b32 v6, 8, v6
 v_and_b32 v7, 1, v5
 v_lshl_add_u32 v6, v7, 5, v6
 v_lshrrev_b32 v7, 1, v3
 v_lshl_add_u32 v6, v7, 6, v6
 v_and_b32 v7, 1, v3
 v_lshl_add_u32 v109, v7, 4, v6
 v_lshlrev_b32 v6, 4, v2
 v_add_u32 v6, 13312, v6
 v_lshl_add_u32 v113, v4, 9, v6
 v_lshl_add_u32 v117, v5, 9, v6
 v_and_b32 v4, 1, v1
 v_lshrrev_b32 v5, 1, v1
 v_lshlrev_b32 v7, 8, v1
 v_lshlrev_b32 v3, 3, v2
 v_add_u32 v7, v7, v3
 v_add_u32 v110, 9216, v7
 v_lshlrev_b32 v7, 7, v4
 v_add_u32 v7, v7, v3
 v_add_u32 v111, 7680, v7
 v_lshlrev_b32 v7, 7, v1
 v_lshlrev_b32 v3, 2, v2
 v_add_u32 v7, v7, v3
 v_add_u32 v116, 12288, v7
 v_lshlrev_b32 v7, 6, v4
 v_add_u32 v7, v7, v3
 v_add_u32 v118, 11520, v7
 s_lshl_b32 s13, s11, 10
 s_add_u32 s13, s13, 512
 v_lshrrev_b32 v6, 2, v2
 v_lshlrev_b32 v6, 5, v6
 v_lshl_add_u32 v6, v4, 4, v6
 v_and_b32 v7, 3, v2
 v_lshl_add_u32 v6, v7, 2, v6
 v_add_u32 v112, s13, v6
 s_add_u32 s13, s13, 128
 v_bfe_u32 v6, v2, 2, 1
 v_lshlrev_b32 v6, 4, v6
 v_lshl_add_u32 v6, v4, 3, v6
 v_bfe_u32 v7, v2, 1, 1
 v_lshl_add_u32 v6, v7, 2, v6
 v_add_u32 v6, s13, v6
 v_and_b32 v3, 1, v2
 v_lshrrev_b32 v7, 3, v2
 v_lshl_add_u32 v3, v7, 1, v3
 v_lshl_add_u32 v6, v3, 5, v6
 v_mov_b32 v7, 0x7ffffff0
 v_cmp_eq_u32 vcc, 1, v5
 s_nop 1
 v_cndmask_b32 v112, v112, v6, vcc
 v_mov_b32 v1, 0
 v_mov_b32 v3, 0
 s_mov_b32 s23, 0x7ffffff0
 v_lshrrev_b32 v1, 4, v0
 v_lshlrev_b32 v7, 7, v1
 v_lshlrev_b32 v6, 3, v2
 v_add_u32 v7, v7, v6
 v_add_u32 v111, 7168, v7
 v_lshlrev_b32 v7, 6, v1
 v_lshlrev_b32 v6, 2, v2
 v_add_u32 v7, v7, v6
 v_add_u32 v118, 11264, v7
 s_lshl_b32 s13, s11, 10
 s_add_u32 s13, s13, 0
 v_lshrrev_b32 v4, 1, v1
 v_lshlrev_b32 v4, 8, v4
 v_add_u32 v4, s13, v4
 v_and_b32 v1, 1, v1
 v_lshrrev_b32 v6, 2, v2
 v_lshl_add_u32 v6, v6, 5, v4
 v_lshl_add_u32 v6, v1, 4, v6
 v_and_b32 v7, 3, v2
 v_lshl_add_u32 v112, v7, 2, v6
 v_bfe_u32 v6, v2, 2, 1
 v_lshl_add_u32 v6, v6, 4, v4
 v_lshl_add_u32 v6, v1, 3, v6
 v_bfe_u32 v7, v2, 1, 1
 v_lshl_add_u32 v6, v7, 2, v6
 v_and_b32 v7, 1, v2
 v_lshrrev_b32 v1, 3, v2
 v_lshl_add_u32 v7, v1, 1, v7
 v_lshl_add_u32 v6, v7, 5, v6
 v_add_u32 v5, 128, v6
 v_mov_b32 v1, 0
 v_mov_b32 v2, 0
 v_and_b32 v2, 15, v0
 v_lshrrev_b32 v1, 4, v0
 v_lshrrev_b32 v4, 1, v1
 v_and_b32 v1, 1, v1
 s_lshl_b32 s13, s11, 9
 s_add_u32 s13, s13, 0
 v_lshlrev_b32 v6, 7, v4
 v_add_u32 v6, s13, v6
 v_lshrrev_b32 v7, 2, v2
 v_lshl_add_u32 v6, v7, 5, v6
 v_lshl_add_u32 v6, v1, 4, v6
 v_and_b32 v7, 3, v2
 v_lshl_add_u32 v112, v7, 2, v6
 s_lshl_b32 s13, s11, 7
 s_add_u32 s13, s13, 8192
 v_lshlrev_b32 v6, 5, v4
 v_add_u32 v6, s13, v6
 v_bfe_u32 v7, v2, 2, 1
 v_lshl_add_u32 v6, v7, 4, v6
 v_lshl_add_u32 v6, v1, 3, v6
 v_bfe_u32 v7, v2, 1, 1
 v_lshl_add_u32 v6, v7, 2, v6
 v_and_b32 v7, 9, v2
 v_cmp_eq_u32 vcc, 0, v7
 v_mov_b32 v7, 0x7ffffff0
 s_nop 0
 v_cndmask_b32 v5, v7, v6, vcc
 v_mov_b32 v1, 0
 v_mov_b32 v2, 0
 v_mov_b32 v119, 0xff800000
 s_mov_b32 s16, 0xff00ff00
 s_mov_b32 s17, 0xff00ff00
 s_mov_b32 s18, 0
 s_mov_b32 s19, -1
 s_mov_b32 s35, 0x42800000
 s_mov_b32 s34, 0xfffffffe
 s_mov_b32 s25, 50331648
 s_mov_b32 s26, 53485568
 s_mov_b32 s22, 50855936
 s_mov_b32 s24, 42219520
 s_cmp_lg_u32 s12, 0
 s_cbranch_scc1 L_wg_23_done
 v_lshlrev_b32 v36, 7, v0
 s_mov_b32 s31, 0
 s_mov_b32 s3, 53501952
 s_mov_b32 exec_lo, 262143
 s_mov_b32 exec_hi, 1
L_wg_23:
 buffer_load_dword v37, v36, s[64:67], s3 offen sc1
 s_add_u32 s31, s31, 1
 s_cmp_gt_u32 s31, 524288
 s_cbranch_scc1 L_exit
 s_waitcnt vmcnt(0)
 v_cmp_eq_u32 vcc, 0, v37
 s_cbranch_vccz L_wg_23_ok
 s_sleep 4
 s_branch L_wg_23
L_wg_23_ok:
 s_mov_b64 exec, -1
L_wg_23_done:
 s_barrier
 s_mov_b32 s32, 0
 s_mov_b32 s33, 28672
 s_add_u32 m0, s32, 27648
 s_nop 0
 buffer_load_dwordx4 v107, s[64:67], s24 offen sc1 lds
 buffer_load_dwordx4 v107, s[64:67], s24 offen offset:1024 sc1 lds
 buffer_load_dwordx4 v107, s[64:67], s24 offen offset:2048 sc1 lds
 buffer_load_dwordx4 v107, s[64:67], s24 offen offset:3072 sc1 lds
 s_add_u32 s24, s24, 4096
 s_add_u32 m0, s32, 31744
 s_nop 0
 buffer_load_dwordx4 v107, s[64:67], s24 offen sc1 lds
 buffer_load_dwordx4 v107, s[64:67], s24 offen offset:1024 sc1 lds
 buffer_load_dwordx4 v107, s[64:67], s24 offen offset:2048 sc1 lds
 s_add_u32 s24, s24, 24576
 v_mov_b32 v36, 0
 v_mov_b32 v37, 0
 v_mov_b32 v38, 0
 v_mov_b32 v39, 0
 v_mov_b32 v40, 0
 v_mov_b32 v41, 0
 v_mov_b32 v42, 0
 v_mov_b32 v43, 0
 v_mov_b32 v44, 0
 v_mov_b32 v45, 0
 v_mov_b32 v46, 0
 v_mov_b32 v47, 0
 v_mov_b32 v48, 0
 v_mov_b32 v49, 0
 v_mov_b32 v50, 0
 v_mov_b32 v51, 0
 v_mov_b32 v52, 0
 v_mov_b32 v53, 0
 v_mov_b32 v54, 0
 v_mov_b32 v55, 0
 v_mov_b32 v56, 0
 v_mov_b32 v57, 0
 v_mov_b32 v58, 0
 v_mov_b32 v59, 0
 v_mov_b32 v60, 0
 v_mov_b32 v61, 0
 v_mov_b32 v62, 0
 v_mov_b32 v63, 0
 v_mov_b32 v64, 0
 v_mov_b32 v65, 0
 v_mov_b32 v66, 0
 v_mov_b32 v67, 0
 v_mov_b32 v68, 0
 v_mov_b32 v69, 0
 v_mov_b32 v70, 0
 v_mov_b32 v71, 0
 v_mov_b32 v72, 0
 v_mov_b32 v73, 0
 v_mov_b32 v74, 0
 v_mov_b32 v75, 0
 s_mov_b32 s30, 0
 s_waitcnt vmcnt(0) lgkmcnt(0)
 s_barrier
L_Aloop_24:
 s_add_u32 s20, s25, 4096
 s_add_u32 s21, s25, 5120
 s_sleep 11
 s_mov_b32 s31, 0
 buffer_load_dwordx4 v[8:11], v107, s[64:67], s20 offen sc1
 buffer_load_dwordx4 v[12:15], v107, s[64:67], s21 offen sc1
 s_nop 15
 s_nop 15
 buffer_load_dwordx4 v[8:11], v107, s[64:67], s20 offen sc1
 buffer_load_dwordx4 v[12:15], v107, s[64:67], s21 offen sc1
L_q2_25_w:
 s_waitcnt vmcnt(2)
 v_max3_u32 v114, v8, v9, v10
 v_max3_u32 v114, v114, v11, v15
 v_cmp_eq_u32 vcc, -1, v114
 v_smfmac_f32_16x16x64_bf16 v[36:39], v[8:11], a[0:7], v106
 ds_write_b128 v107, v[8:11] offset:4096
 s_cbranch_vccnz L_q2_25
 v_smfmac_f32_16x16x64_bf16 v[40:43], v[8:11], a[56:63], v106
 v_smfmac_f32_16x16x64_bf16 v[44:47], v[8:11], a[112:119], v106
 ds_write_b128 v107, v[12:15] offset:5120
 v_smfmac_f32_16x16x64_bf16 v[48:51], v[8:11], a[168:175], v106
 v_smfmac_f32_16x16x64_bf16 v[52:55], v[8:11], a[224:231], v106
 v_smfmac_f32_16x16x64_bf16 v[56:59], v[8:11], v[144:151], v106
 v_smfmac_f32_16x16x64_bf16 v[60:63], v[8:11], v[200:207], v106
 s_waitcnt lgkmcnt(0)
 s_barrier
 ds_read_b128 v[16:19], v107 offset:6144
 ds_read_b128 v[20:23], v107
 v_smfmac_f32_16x16x64_bf16 v[36:39], v[12:15], a[8:15], v106
 ds_read_b128 v[24:27], v107 offset:1024
 v_smfmac_f32_16x16x64_bf16 v[40:43], v[12:15], a[64:71], v106
 ds_read_b128 v[28:31], v107 offset:2048
 v_smfmac_f32_16x16x64_bf16 v[44:47], v[12:15], a[120:127], v106
 ds_read_b128 v[32:35], v107 offset:3072
 v_smfmac_f32_16x16x64_bf16 v[48:51], v[12:15], a[176:183], v106
 v_smfmac_f32_16x16x64_bf16 v[52:55], v[12:15], a[232:239], v106
 v_smfmac_f32_16x16x64_bf16 v[56:59], v[12:15], v[152:159], v106
 v_smfmac_f32_16x16x64_bf16 v[60:63], v[12:15], v[208:215], v106
 s_waitcnt lgkmcnt(4)
 v_smfmac_f32_16x16x64_bf16 v[36:39], v[16:19], a[16:23], v106
 s_waitcnt lgkmcnt(3)
 v_smfmac_f32_16x16x64_bf16 v[36:39], v[20:23], a[24:31], v106
 s_waitcnt lgkmcnt(2)
 v_smfmac_f32_16x16x64_bf16 v[36:39], v[24:27], a[32:39], v106
 s_add_u32 m0, s33, 27648
 s_nop 0
 buffer_load_dwordx4 v107, s[64:67], s24 offen sc1 lds
 s_waitcnt lgkmcnt(1)
 v_smfmac_f32_16x16x64_bf16 v[36:39], v[28:31], a[40:47], v106
 s_waitcnt lgkmcnt(0)
 v_smfmac_f32_16x16x64_bf16 v[36:39], v[32:35], a[48:55], v106
 v_smfmac_f32_16x16x64_bf16 v[40:43], v[16:19], a[72:79], v106
 buffer_load_dwordx4 v107, s[64:67], s24 offen offset:1024 sc1 lds
 ds_read_b128 v[76:79], v108
 v_smfmac_f32_16x16x64_bf16 v[40:43], v[20:23], a[80:87], v106
 ds_read_b128 v[80:83], v108 offset:512
 v_smfmac_f32_16x16x64_bf16 v[40:43], v[24:27], a[88:95], v106
 ds_read_b128 v[84:87], v113
 v_smfmac_f32_16x16x64_bf16 v[40:43], v[28:31], a[96:103], v106
 buffer_load_dwordx4 v107, s[64:67], s24 offen offset:2048 sc1 lds
 ds_read_b128 v[88:91], v113 offset:2048
 v_smfmac_f32_16x16x64_bf16 v[40:43], v[32:35], a[104:111], v106
 ds_read_b128 v[92:95], v113 offset:256
 v_cvt_pk_bf16_f32 v36, v36, v37
 v_smfmac_f32_16x16x64_bf16 v[44:47], v[16:19], a[128:135], v106
 ds_read_b128 v[96:99], v113 offset:2304
 v_cvt_pk_bf16_f32 v37, v38, v39
 v_smfmac_f32_16x16x64_bf16 v[44:47], v[20:23], a[136:143], v106
 buffer_load_dwordx4 v107, s[64:67], s24 offen offset:3072 sc1 lds
 s_add_u32 s24, s24, 4096
 v_smfmac_f32_16x16x64_bf16 v[44:47], v[24:27], a[144:151], v106
 v_smfmac_f32_16x16x64_bf16 v[44:47], v[28:31], a[152:159], v106
 v_smfmac_f32_16x16x64_bf16 v[44:47], v[32:35], a[160:167], v106
 s_add_u32 m0, s33, 31744
 s_nop 0
 buffer_load_dwordx4 v107, s[64:67], s24 offen sc1 lds
 v_cvt_pk_bf16_f32 v38, v40, v41
 v_smfmac_f32_16x16x64_bf16 v[48:51], v[16:19], a[184:191], v106
 v_cvt_pk_bf16_f32 v39, v42, v43
 v_smfmac_f32_16x16x64_bf16 v[48:51], v[20:23], a[192:199], v106
 v_smfmac_f32_16x16x64_bf16 v[48:51], v[24:27], a[200:207], v106
 buffer_load_dwordx4 v107, s[64:67], s24 offen offset:1024 sc1 lds
 v_mfma_f32_16x16x32_bf16 v[40:43], v[36:39], v[100:103], 0
 v_smfmac_f32_16x16x64_bf16 v[48:51], v[28:31], a[208:215], v106
 v_smfmac_f32_16x16x64_bf16 v[48:51], v[32:35], a[216:223], v106
 v_cvt_pk_bf16_f32 v44, v44, v45
 v_smfmac_f32_16x16x64_bf16 v[52:55], v[16:19], a[240:247], v106
 buffer_load_dwordx4 v107, s[64:67], s24 offen offset:2048 sc1 lds
 s_add_u32 s24, s24, 24576
 v_cvt_pk_bf16_f32 v45, v46, v47
 v_smfmac_f32_16x16x64_bf16 v[52:55], v[20:23], a[248:255], v106
 v_smfmac_f32_16x16x64_bf16 v[52:55], v[24:27], v[120:127], v106
 v_cvt_pk_bf16_f32 v36, v40, v41
 v_smfmac_f32_16x16x64_bf16 v[52:55], v[28:31], v[128:135], v106
 v_cvt_pk_bf16_f32 v37, v42, v43
 v_smfmac_f32_16x16x64_bf16 v[52:55], v[32:35], v[136:143], v106
 v_cvt_pk_bf16_f32 v46, v48, v49
 v_smfmac_f32_16x16x64_bf16 v[56:59], v[16:19], v[160:167], v106
 v_cvt_pk_bf16_f32 v47, v50, v51
 v_smfmac_f32_16x16x64_bf16 v[56:59], v[20:23], v[168:175], v106
 s_nop 0
 v_mfma_f32_16x16x32_bf16 v[48:51], v[44:47], v[100:103], 0
 v_smfmac_f32_16x16x64_bf16 v[56:59], v[24:27], v[176:183], v106
 s_nop 0
 v_cvt_pk_bf16_f32 v52, v52, v53
 v_smfmac_f32_16x16x64_bf16 v[56:59], v[28:31], v[184:191], v106
 v_cvt_pk_bf16_f32 v53, v54, v55
 v_smfmac_f32_16x16x64_bf16 v[56:59], v[32:35], v[192:199], v106
 s_nop 0
 v_smfmac_f32_16x16x64_bf16 v[60:63], v[16:19], v[216:223], v106
 s_nop 0
 v_cvt_pk_bf16_f32 v38, v48, v49
 v_smfmac_f32_16x16x64_bf16 v[60:63], v[20:23], v[224:231], v106
 s_nop 0
 v_cvt_pk_bf16_f32 v39, v50, v51
 v_smfmac_f32_16x16x64_bf16 v[60:63], v[24:27], v[232:239], v106
 s_nop 0
 v_cvt_pk_bf16_f32 v54, v56, v57
 v_smfmac_f32_16x16x64_bf16 v[60:63], v[28:31], v[240:247], v106
 v_cvt_pk_bf16_f32 v55, v58, v59
 v_smfmac_f32_16x16x64_bf16 v[60:63], v[32:35], v[248:255], v106
 s_waitcnt lgkmcnt(0)
 s_nop 0
 v_smfmac_f32_16x16x64_bf16 v[64:67], v[36:39], v[76:83], v106
 ds_read_b128 v[76:79], v109
 ds_read_b128 v[80:83], v109 offset:256
 s_nop 0
 v_mfma_f32_16x16x32_bf16 v[56:59], v[52:55], v[100:103], 0
 s_nop 0
 v_cvt_pk_bf16_f32 v60, v60, v61
 v_cvt_pk_bf16_f32 v61, v62, v63
 s_nop 1
 v_mfma_f32_16x16x16_bf16 v[40:43], v[60:61], v[104:105], 0
 s_nop 0
 s_nop 0
 v_smfmac_f32_16x16x64_bf16 v[68:71], v[36:39], v[84:91], v106
 ds_read_b128 v[84:87], v117
 ds_read_b128 v[88:91], v117 offset:1024
 v_cvt_pk_bf16_f32 v52, v56, v57
 v_smfmac_f32_16x16x64_bf16 v[72:75], v[36:39], v[92:99], v106
 ds_read_b128 v[92:95], v117 offset:256
 ds_read_b128 v[96:99], v117 offset:1280
 v_cvt_pk_bf16_f32 v53, v58, v59
 v_cvt_pk_bf16_f32 v54, v40, v41
 v_cvt_pk_bf16_f32 v55, v42, v43
 s_waitcnt lgkmcnt(4)
 s_nop 0
 v_smfmac_f32_16x16x64_bf16 v[64:67], v[52:55], v[76:83], v106
 s_waitcnt lgkmcnt(2)
 v_smfmac_f32_16x16x64_bf16 v[68:71], v[52:55], v[84:91], v106
 s_waitcnt lgkmcnt(0)
 v_smfmac_f32_16x16x64_bf16 v[72:75], v[52:55], v[92:99], v106
 s_nop 3
 v_pk_add_f32 v[64:65], v[64:65], v[66:67]
 s_nop 0
 v_add_f32 v36, v68, v70
 v_add_f32 v38, v69, v71
 ds_write2_b32 v116, v64, v65 offset0:0 offset1:16
 v_add_f32 v37, v72, v74
 v_add_f32 v39, v73, v75
 ds_write2_b64 v110, v[36:37], v[38:39] offset0:0 offset1:16
 s_waitcnt lgkmcnt(0)
 s_barrier
 s_add_u32 s23, s22, 655360
 s_sleep 4
 v_mov_b32 v36, 0
 v_mov_b32 v37, 0
 v_mov_b32 v38, 0
 v_mov_b32 v39, 0
 v_mov_b32 v40, 0
 v_mov_b32 v41, 0
 v_mov_b32 v42, 0
 v_mov_b32 v43, 0
 v_mov_b32 v44, 0
 v_mov_b32 v45, 0
 v_mov_b32 v46, 0
 v_mov_b32 v47, 0
 v_mov_b32 v48, 0
 v_mov_b32 v49, 0
 v_mov_b32 v50, 0
 v_mov_b32 v51, 0
 v_mov_b32 v52, 0
 v_mov_b32 v53, 0
 v_mov_b32 v54, 0
 v_mov_b32 v55, 0
 v_mov_b32 v56, 0
 v_mov_b32 v57, 0
 v_mov_b32 v58, 0
 v_mov_b32 v59, 0
 v_mov_b32 v60, 0
 v_mov_b32 v61, 0
 v_mov_b32 v62, 0
 v_mov_b32 v63, 0
 v_mov_b32 v64, 0
 v_mov_b32 v65, 0
 v_mov_b32 v66, 0
 v_mov_b32 v67, 0
 v_mov_b32 v68, 0
 v_mov_b32 v69, 0
 v_mov_b32 v70, 0
 v_mov_b32 v71, 0
 v_mov_b32 v72, 0
 v_mov_b32 v73, 0
 v_mov_b32 v74, 0
 v_mov_b32 v75, 0
 s_nop 0
 s_sub_u32 s36, s33, s32
 v_add_u32 v113, s36, v113
 v_add_u32 v117, s36, v117
 s_mov_b32 s36, s32
 s_mov_b32 s32, s33
 s_mov_b32 s33, s36
 s_add_u32 s25, s25, 8192
 s_add_u32 s26, s25, 2098176
 s_add_u32 s22, s22, 10240
 s_add_u32 s30, s30, 1
 s_cmp_lt_u32 s30, 63
 s_cbranch_scc1 L_Aloop_24
 s_nop 0
 s_branch L_exit
L_q2_25:
 buffer_load_dwordx4 v[8:11], v107, s[64:67], s20 offen sc1
 buffer_load_dwordx4 v[12:15], v107, s[64:67], s21 offen sc1
 s_nop 3
 v_mov_b32 v36, 0
 v_mov_b32 v37, 0
 v_mov_b32 v38, 0
 v_mov_b32 v39, 0
 s_add_u32 s31, s31, 1
 s_cmp_lt_u32 s31, 64
 s_cbranch_scc1 L_q2_25_w
 s_cmp_gt_u32 s31, 524288
 s_cbranch_scc1 L_exit
 s_cmp_lg_u32 s31, 64
 s_cbranch_scc1 L_q2_25_w
 s_waitcnt vmcnt(0)
 s_nop 0
 s_add_u32 s20, s26, 4096
 s_add_u32 s21, s26, 5120
 buffer_load_dwordx4 v[8:11], v107, s[64:67], s20 offen sc1
 buffer_load_dwordx4 v[12:15], v107, s[64:67], s21 offen sc1
 buffer_load_dwordx4 v[8:11], v107, s[64:67], s20 offen sc1
 buffer_load_dwordx4 v[12:15], v107, s[64:67], s21 offen sc1
 s_branch L_q2_25_w
L_pad5:
 s_setpc_b64 s[94:95]
L_A3:
 v_lshlrev_b32 v107, 4, v0
 s_mul_i32 s13, s11, 401408
 s_add_u32 s13, s13, 301056
 s_add_u32 s14, s13, 12288
 buffer_load_dwordx4 a[0:3], v107, s[64:67], s14 offen sc1
 buffer_load_dwordx4 a[4:7], v107, s[64:67], s14 offen offset:1024 sc1
 s_add_u32 s14, s13, 0
 buffer_load_dwordx4 a[8:11], v107, s[64:67], s14 offen sc1
 buffer_load_dwordx4 a[12:15], v107, s[64:67], s14 offen offset:1024 sc1
 s_add_u32 s14, s13, 2048
 buffer_load_dwordx4 a[16:19], v107, s[64:67], s14 offen sc1
 buffer_load_dwordx4 a[20:23], v107, s[64:67], s14 offen offset:1024 sc1
 s_add_u32 s14, s13, 4096
 buffer_load_dwordx4 a[24:27], v107, s[64:67], s14 offen sc1
 buffer_load_dwordx4 a[28:31], v107, s[64:67], s14 offen offset:1024 sc1
 s_add_u32 s14, s13, 6144
 buffer_load_dwordx4 a[32:35], v107, s[64:67], s14 offen sc1
 buffer_load_dwordx4 a[36:39], v107, s[64:67], s14 offen offset:1024 sc1
 s_add_u32 s14, s13, 8192
 buffer_load_dwordx4 a[40:43], v107, s[64:67], s14 offen sc1
 buffer_load_dwordx4 a[44:47], v107, s[64:67], s14 offen offset:1024 sc1
 s_add_u32 s14, s13, 10240
 buffer_load_dwordx4 a[48:51], v107, s[64:67], s14 offen sc1
 buffer_load_dwordx4 a[52:55], v107, s[64:67], s14 offen offset:1024 sc1
 s_add_u32 s14, s13, 26624
 buffer_load_dwordx4 a[56:59], v107, s[64:67], s14 offen sc1
 buffer_load_dwordx4 a[60:63], v107, s[64:67], s14 offen offset:1024 sc1
 s_add_u32 s14, s13, 14336
 buffer_load_dwordx4 a[64:67], v107, s[64:67], s14 offen sc1
 buffer_load_dwordx4 a[68:71], v107, s[64:67], s14 offen offset:1024 sc1
 s_add_u32 s14, s13, 16384
 buffer_load_dwordx4 a[72:75], v107, s[64:67], s14 offen sc1
 buffer_load_dwordx4 a[76:79], v107, s[64:67], s14 offen offset:1024 sc1
 s_add_u32 s14, s13, 18432
 buffer_load_dwordx4 a[80:83], v107, s[64:67], s14 offen sc1
 buffer_load_dwordx4 a[84:87], v107, s[64:67], s14 offen offset:1024 sc1
 s_add_u32 s14, s13, 20480
 buffer_load_dwordx4 a[88:91], v107, s[64:67], s14 offen sc1
 buffer_load_dwordx4 a[92:95], v107, s[64:67], s14 offen offset:1024 sc1
 s_add_u32 s14, s13, 22528
 buffer_load_dwordx4 a[96:99], v107, s[64:67], s14 offen sc1
 buffer_load_dwordx4 a[100:103], v107, s[64:67], s14 offen offset:1024 sc1
 s_add_u32 s14, s13, 24576
 buffer_load_dwordx4 a[104:107], v107, s[64:67], s14 offen sc1
 buffer_load_dwordx4 a[108:111], v107, s[64:67], s14 offen offset:1024 sc1
 s_add_u32 s14, s13, 40960
 buffer_load_dwordx4 a[112:115], v107, s[64:67], s14 offen sc1
 buffer_load_dwordx4 a[116:119], v107, s[64:67], s14 offen offset:1024 sc1
 s_add_u32 s14, s13, 28672
 buffer_load_dwordx4 a[120:123], v107, s[64:67], s14 offen sc1
 buffer_load_dwordx4 a[124:127], v107, s[64:67], s14 offen offset:1024 sc1
 s_add_u32 s14, s13, 30720
 buffer_load_dwordx4 a[128:131], v107, s[64:67], s14 offen sc1
 buffer_load_dwordx4 a[132:135], v107, s[64:67], s14 offen offset:1024 sc1
 s_add_u32 s14, s13, 32768
 buffer_load_dwordx4 a[136:139], v107, s[64:67], s14 offen sc1
 buffer_load_dwordx4 a[140:143], v107, s[64:67], s14 offen offset:1024 sc1
 s_add_u32 s14, s13, 34816
 buffer_load_dwordx4 a[144:147], v107, s[64:67], s14 offen sc1
 buffer_load_dwordx4 a[148:151], v107, s[64:67], s14 offen offset:1024 sc1
 s_add_u32 s14, s13, 36864
 buffer_load_dwordx4 a[152:155], v107, s[64:67], s14 offen sc1
 buffer_load_dwordx4 a[156:159], v107, s[64:67], s14 offen offset:1024 sc1
 s_add_u32 s14, s13, 38912
 buffer_load_dwordx4 a[160:163], v107, s[64:67], s14 offen sc1
 buffer_load_dwordx4 a[164:167], v107, s[64:67], s14 offen offset:1024 sc1
 s_add_u32 s14, s13, 55296
 buffer_load_dwordx4 a[168:171], v107, s[64:67], s14 offen sc1
 buffer_load_dwordx4 a[172:175], v107, s[64:67], s14 offen offset:1024 sc1
 s_add_u32 s14, s13, 43008
 buffer_load_dwordx4 a[176:179], v107, s[64:67], s14 offen sc1
 buffer_load_dwordx4 a[180:183], v107, s[64:67], s14 offen offset:1024 sc1
 s_add_u32 s14, s13, 45056
 buffer_load_dwordx4 a[184:187], v107, s[64:67], s14 offen sc1
 buffer_load_dwordx4 a[188:191], v107, s[64:67], s14 offen offset:1024 sc1
 s_add_u32 s14, s13, 47104
 buffer_load_dwordx4 a[192:195], v107, s[64:67], s14 offen sc1
 buffer_load_dwordx4 a[196:199], v107, s[64:67], s14 offen offset:1024 sc1
 s_add_u32 s14, s13, 49152
 buffer_load_dwordx4 a[200:203], v107, s[64:67], s14 offen sc1
 buffer_load_dwordx4 a[204:207], v107, s[64:67], s14 offen offset:1024 sc1
 s_add_u32 s14, s13, 51200
 buffer_load_dwordx4 a[208:211], v107, s[64:67], s14 offen sc1
 buffer_load_dwordx4 a[212:215], v107, s[64:67], s14 offen offset:1024 sc1
 s_add_u32 s14, s13, 53248
 buffer_load_dwordx4 a[216:219], v107, s[64:67], s14 offen sc1
 buffer_load_dwordx4 a[220:223], v107, s[64:67], s14 offen offset:1024 sc1
 s_add_u32 s14, s13, 69632
 buffer_load_dwordx4 a[224:227], v107, s[64:67], s14 offen sc1
 buffer_load_dwordx4 a[228:231], v107, s[64:67], s14 offen offset:1024 sc1
 s_add_u32 s14, s13, 57344
 buffer_load_dwordx4 a[232:235], v107, s[64:67], s14 offen sc1
 buffer_load_dwordx4 a[236:239], v107, s[64:67], s14 offen offset:1024 sc1
 s_add_u32 s14, s13, 59392
 buffer_load_dwordx4 a[240:243], v107, s[64:67], s14 offen sc1
 buffer_load_dwordx4 a[244:247], v107, s[64:67], s14 offen offset:1024 sc1
 s_add_u32 s14, s13, 61440
 buffer_load_dwordx4 a[248:251], v107, s[64:67], s14 offen sc1
 buffer_load_dwordx4 a[252:255], v107, s[64:67], s14 offen offset:1024 sc1
 s_add_u32 s14, s13, 63488
 buffer_load_dwordx4 v[120:123], v107, s[64:67], s14 offen sc1
 buffer_load_dwordx4 v[124:127], v107, s[64:67], s14 offen offset:1024 sc1
 s_add_u32 s14, s13, 65536
 buffer_load_dwordx4 v[128:131], v107, s[64:67], s14 offen sc1
 buffer_load_dwordx4 v[132:135], v107, s[64:67], s14 offen offset:1024 sc1
 s_add_u32 s14, s13, 67584
 buffer_load_dwordx4 v[136:139], v107, s[64:67], s14 offen sc1
 buffer_load_dwordx4 v[140:143], v107, s[64:67], s14 offen offset:1024 sc1
 s_add_u32 s14, s13, 83968
 buffer_load_dwordx4 v[144:147], v107, s[64:67], s14 offen sc1
 buffer_load_dwordx4 v[148:151], v107, s[64:67], s14 offen offset:1024 sc1
 s_add_u32 s14, s13, 71680
 buffer_load_dwordx4 v[152:155], v107, s[64:67], s14 offen sc1
 buffer_load_dwordx4 v[156:159], v107, s[64:67], s14 offen offset:1024 sc1
 s_add_u32 s14, s13, 73728
 buffer_load_dwordx4 v[160:163], v107, s[64:67], s14 offen sc1
 buffer_load_dwordx4 v[164:167], v107, s[64:67], s14 offen offset:1024 sc1
 s_add_u32 s14, s13, 75776
 buffer_load_dwordx4 v[168:171], v107, s[64:67], s14 offen sc1
 buffer_load_dwordx4 v[172:175], v107, s[64:67], s14 offen offset:1024 sc1
 s_add_u32 s14, s13, 77824
 buffer_load_dwordx4 v[176:179], v107, s[64:67], s14 offen sc1
 buffer_load_dwordx4 v[180:183], v107, s[64:67], s14 offen offset:1024 sc1
 s_add_u32 s14, s13, 79872
 buffer_load_dwordx4 v[184:187], v107, s[64:67], s14 offen sc1
 buffer_load_dwordx4 v[188:191], v107, s[64:67], s14 offen offset:1024 sc1
 s_add_u32 s14, s13, 81920
 buffer_load_dwordx4 v[192:195], v107, s[64:67], s14 offen sc1
 buffer_load_dwordx4 v[196:199], v107, s[64:67], s14 offen offset:1024 sc1
 s_add_u32 s14, s13, 98304
 buffer_load_dwordx4 v[200:203], v107, s[64:67], s14 offen sc1
 buffer_load_dwordx4 v[204:207], v107, s[64:67], s14 offen offset:1024 sc1
 s_add_u32 s14, s13, 86016
 buffer_load_dwordx4 v[208:211], v107, s[64:67], s14 offen sc1
 buffer_load_dwordx4 v[212:215], v107, s[64:67], s14 offen offset:1024 sc1
 s_add_u32 s14, s13, 88064
 buffer_load_dwordx4 v[216:219], v107, s[64:67], s14 offen sc1
 buffer_load_dwordx4 v[220:223], v107, s[64:67], s14 offen offset:1024 sc1
 s_add_u32 s14, s13, 90112
 buffer_load_dwordx4 v[224:227], v107, s[64:67], s14 offen sc1
 buffer_load_dwordx4 v[228:231], v107, s[64:67], s14 offen offset:1024 sc1
 s_add_u32 s14, s13, 92160
 buffer_load_dwordx4 v[232:235], v107, s[64:67], s14 offen sc1
 buffer_load_dwordx4 v[236:239], v107, s[64:67], s14 offen offset:1024 sc1
 s_add_u32 s14, s13, 94208
 buffer_load_dwordx4 v[240:243], v107, s[64:67], s14 offen sc1
 buffer_load_dwordx4 v[244:247], v107, s[64:67], s14 offen offset:1024 sc1
 s_add_u32 s14, s13, 96256
 buffer_load_dwordx4 v[248:251], v107, s[64:67], s14 offen sc1
 buffer_load_dwordx4 v[252:255], v107, s[64:67], s14 offen offset:1024 sc1
 v_lshrrev_b32 v1, 4, v0
 v_and_b32 v2, 15, v0
 v_and_b32 v3, 7, v0
 v_bfe_u32 v5, v0, 1, 1
 v_mov_b32 v6, 0x4444
 v_mov_b32 v7, 0xeeee
 v_cmp_eq_u32 vcc, 1, v5
 s_nop 1
 v_cndmask_b32 v106, v6, v7, vcc
 v_mov_b32 v6, 0x3f80
 v_mov_b32 v7, 0x3f800000
 v_and_b32 v4, 1, v0
 v_cmp_eq_u32 vcc, 1, v4
 s_nop 1
 v_cndmask_b32 v6, v6, v7, vcc
 v_lshrrev_b32 v4, 2, v2
 v_cmp_eq_u32 vcc, v4, v1
 s_nop 1
 v_cndmask_b32 v6, 0, v6, vcc
 v_cmp_eq_u32 vcc, 0, v5
 s_nop 1
 v_cndmask_b32 v100, 0, v6, vcc
 v_cndmask_b32 v101, 0, v6, vcc
 v_cmp_eq_u32 vcc, 1, v5
 s_nop 1
 v_cndmask_b32 v102, 0, v6, vcc
 v_cndmask_b32 v103, 0, v6, vcc
 v_mov_b32 v104, v102
 v_mov_b32 v105, v103
 v_add_u32 v4, 36, v1
 v_and_b32 v5, 1, v1
 v_mul_u32_u24 v5, 4, v5
 v_lshrrev_b32 v7, 1, v1
 v_add_u32 v5, v5, v7
 v_add_u32 v5, 48, v5
 v_lshrrev_b32 v6, 1, v4
 v_lshlrev_b32 v6, 8, v6
 v_and_b32 v7, 1, v4
 v_lshl_add_u32 v6, v7, 5, v6
 v_lshrrev_b32 v7, 1, v3
 v_lshl_add_u32 v6, v7, 6, v6
 v_and_b32 v7, 1, v3
 v_lshl_add_u32 v108, v7, 4, v6
 v_lshrrev_b32 v6, 1, v5
 v_lshlrev_b32 v6, 8, v6
 v_and_b32 v7, 1, v5
 v_lshl_add_u32 v6, v7, 5, v6
 v_lshrrev_b32 v7, 1, v3
 v_lshl_add_u32 v6, v7, 6, v6
 v_and_b32 v7, 1, v3
 v_lshl_add_u32 v109, v7, 4, v6
 v_lshlrev_b32 v6, 4, v2
 v_add_u32 v6, 13312, v6
 v_lshl_add_u32 v113, v4, 9, v6
 v_lshl_add_u32 v117, v5, 9, v6
 v_and_b32 v4, 1, v1
 v_lshrrev_b32 v5, 1, v1
 v_lshlrev_b32 v7, 8, v1
 v_lshlrev_b32 v3, 3, v2
 v_add_u32 v7, v7, v3
 v_add_u32 v110, 10240, v7
 v_lshlrev_b32 v7, 7, v4
 v_add_u32 v7, v7, v3
 v_add_u32 v111, 7936, v7
 v_lshlrev_b32 v7, 7, v1
 v_lshlrev_b32 v3, 2, v2
 v_add_u32 v7, v7, v3
 v_add_u32 v116, 12800, v7
 v_lshlrev_b32 v7, 6, v4
 v_add_u32 v7, v7, v3
 v_add_u32 v118, 11648, v7
 s_lshl_b32 s13, s11, 10
 s_add_u32 s13, s13, 768
 v_lshrrev_b32 v6, 2, v2
 v_lshlrev_b32 v6, 5, v6
 v_lshl_add_u32 v6, v4, 4, v6
 v_and_b32 v7, 3, v2
 v_lshl_add_u32 v6, v7, 2, v6
 v_add_u32 v112, s13, v6
 s_add_u32 s13, s13, 128
 v_bfe_u32 v6, v2, 2, 1
 v_lshlrev_b32 v6, 4, v6
 v_lshl_add_u32 v6, v4, 3, v6
 v_bfe_u32 v7, v2, 1, 1
 v_lshl_add_u32 v6, v7, 2, v6
 v_add_u32 v6, s13, v6
 v_and_b32 v3, 1, v2
 v_lshrrev_b32 v7, 3, v2
 v_lshl_add_u32 v3, v7, 1, v3
 v_lshl_add_u32 v6, v3, 5, v6
 v_mov_b32 v7, 0x7ffffff0
 v_cmp_eq_u32 vcc, 1, v5
 s_nop 1
 v_cndmask_b32 v112, v112, v6, vcc
 v_mov_b32 v1, 0
 v_mov_b32 v3, 0
 s_mov_b32 s23, 0x7ffffff0
 v_lshrrev_b32 v1, 4, v0
 v_lshlrev_b32 v7, 7, v1
 v_lshlrev_b32 v6, 3, v2
 v_add_u32 v7, v7, v6
 v_add_u32 v111, 7680, v7
 v_lshlrev_b32 v7, 6, v1
 v_lshlrev_b32 v6, 2, v2
 v_add_u32 v7, v7, v6
 v_add_u32 v118, 11520, v7
 s_lshl_b32 s13, s11, 10
 s_add_u32 s13, s13, 512
 v_lshrrev_b32 v4, 1, v1
 v_lshlrev_b32 v4, 8, v4
 v_add_u32 v4, s13, v4
 v_and_b32 v1, 1, v1
 v_lshrrev_b32 v6, 2, v2
 v_lshl_add_u32 v6, v6, 5, v4
 v_lshl_add_u32 v6, v1, 4, v6
 v_and_b32 v7, 3, v2
 v_lshl_add_u32 v112, v7, 2, v6
 v_bfe_u32 v6, v2, 2, 1
 v_lshl_add_u32 v6, v6, 4, v4
 v_lshl_add_u32 v6, v1, 3, v6
 v_bfe_u32 v7, v2, 1, 1
 v_lshl_add_u32 v6, v7, 2, v6
 v_and_b32 v7, 1, v2
 v_lshrrev_b32 v1, 3, v2
 v_lshl_add_u32 v7, v1, 1, v7
 v_lshl_add_u32 v6, v7, 5, v6
 v_add_u32 v5, 128, v6
 v_mov_b32 v1, 0
 v_mov_b32 v2, 0
 v_and_b32 v2, 15, v0
 v_lshrrev_b32 v1, 4, v0
 v_lshrrev_b32 v4, 1, v1
 v_and_b32 v1, 1, v1
 s_lshl_b32 s13, s11, 9
 s_add_u32 s13, s13, 256
 v_lshlrev_b32 v6, 7, v4
 v_add_u32 v6, s13, v6
 v_lshrrev_b32 v7, 2, v2
 v_lshl_add_u32 v6, v7, 5, v6
 v_lshl_add_u32 v6, v1, 4, v6
 v_and_b32 v7, 3, v2
 v_lshl_add_u32 v112, v7, 2, v6
 s_lshl_b32 s13, s11, 7
 s_add_u32 s13, s13, 8256
 v_lshlrev_b32 v6, 5, v4
 v_add_u32 v6, s13, v6
 v_bfe_u32 v7, v2, 2, 1
 v_lshl_add_u32 v6, v7, 4, v6
 v_lshl_add_u32 v6, v1, 3, v6
 v_bfe_u32 v7, v2, 1, 1
 v_lshl_add_u32 v6, v7, 2, v6
 v_and_b32 v7, 9, v2
 v_cmp_eq_u32 vcc, 0, v7
 v_mov_b32 v7, 0x7ffffff0
 s_nop 0
 v_cndmask_b32 v5, v7, v6, vcc
 v_mov_b32 v1, 0
 v_mov_b32 v2, 0
 v_mov_b32 v119, 0xff800000
 s_mov_b32 s16, 0xff00ff00
 s_mov_b32 s17, 0xff00ff00
 s_mov_b32 s18, 0
 s_mov_b32 s19, -1
 s_mov_b32 s35, 0x42800000
 s_mov_b32 s34, 0xfffffffe
 s_mov_b32 s25, 50331648
 s_mov_b32 s26, 53485568
 s_mov_b32 s22, 50855936
 s_mov_b32 s24, 42226688
 s_cmp_lg_u32 s12, 0
 s_cbranch_scc1 L_wg_27_done
 v_lshlrev_b32 v36, 7, v0
 s_mov_b32 s31, 0
 s_mov_b32 s3, 53501952
 s_mov_b32 exec_lo, 262143
 s_mov_b32 exec_hi, 1
L_wg_27:
 buffer_load_dword v37, v36, s[64:67], s3 offen sc1
 s_add_u32 s31, s31, 1
 s_cmp_gt_u32 s31, 524288
 s_cbranch_scc1 L_exit
 s_waitcnt vmcnt(0)
 v_cmp_eq_u32 vcc, 0, v37
 s_cbranch_vccz L_wg_27_ok
 s_sleep 4
 s_branch L_wg_27
L_wg_27_ok:
 s_mov_b64 exec, -1
L_wg_27_done:
 s_barrier
 s_mov_b32 s32, 0
 s_mov_b32 s33, 28672
 s_add_u32 m0, s32, 34816
 s_nop 0
 buffer_load_dwordx4 v107, s[64:67], s24 offen sc1 lds
 buffer_load_dwordx4 v107, s[64:67], s24 offen offset:1024 sc1 lds
 buffer_load_dwordx4 v107, s[64:67], s24 offen offset:2048 sc1 lds
 buffer_load_dwordx4 v107, s[64:67], s24 offen offset:3072 sc1 lds
 s_add_u32 s24, s24, 4096
 s_add_u32 m0, s32, 38912
 s_nop 0
 buffer_load_dwordx4 v107, s[64:67], s24 offen sc1 lds
 buffer_load_dwordx4 v107, s[64:67], s24 offen offset:1024 sc1 lds
 buffer_load_dwordx4 v107, s[64:67], s24 offen offset:2048 sc1 lds
 s_add_u32 s24, s24, 24576
 v_mov_b32 v36, 0
 v_mov_b32 v37, 0
 v_mov_b32 v38, 0
 v_mov_b32 v39, 0
 v_mov_b32 v40, 0
 v_mov_b32 v41, 0
 v_mov_b32 v42, 0
 v_mov_b32 v43, 0
 v_mov_b32 v44, 0
 v_mov_b32 v45, 0
 v_mov_b32 v46, 0
 v_mov_b32 v47, 0
 v_mov_b32 v48, 0
 v_mov_b32 v49, 0
 v_mov_b32 v50, 0
 v_mov_b32 v51, 0
 v_mov_b32 v52, 0
 v_mov_b32 v53, 0
 v_mov_b32 v54, 0
 v_mov_b32 v55, 0
 v_mov_b32 v56, 0
 v_mov_b32 v57, 0
 v_mov_b32 v58, 0
 v_mov_b32 v59, 0
 v_mov_b32 v60, 0
 v_mov_b32 v61, 0
 v_mov_b32 v62, 0
 v_mov_b32 v63, 0
 v_mov_b32 v64, 0
 v_mov_b32 v65, 0
 v_mov_b32 v66, 0
 v_mov_b32 v67, 0
 v_mov_b32 v68, 0
 v_mov_b32 v69, 0
 v_mov_b32 v70, 0
 v_mov_b32 v71, 0
 v_mov_b32 v72, 0
 v_mov_b32 v73, 0
 v_mov_b32 v74, 0
 v_mov_b32 v75, 0
 s_mov_b32 s30, 0
 s_waitcnt vmcnt(0) lgkmcnt(0)
 s_barrier
L_Aloop_28:
 s_add_u32 s20, s25, 6144
 s_add_u32 s21, s25, 0
 s_sleep 11
 s_mov_b32 s31, 0
 buffer_load_dwordx4 v[8:11], v107, s[64:67], s20 offen sc1
 s_nop 15
 s_nop 15
 buffer_load_dwordx4 v[8:11], v107, s[64:67], s20 offen sc1
L_q2_29_w:
 s_waitcnt vmcnt(1)
 v_max3_u32 v114, v8, v9, v10
 v_max_u32 v114, v114, v11
 v_cmp_eq_u32 vcc, -1, v114
 v_smfmac_f32_16x16x64_bf16 v[36:39], v[8:11], a[0:7], v106
 ds_write_b128 v107, v[8:11] offset:6144
 s_cbranch_vccnz L_q2_29
 v_smfmac_f32_16x16x64_bf16 v[40:43], v[8:11], a[56:63], v106
 v_smfmac_f32_16x16x64_bf16 v[44:47], v[8:11], a[112:119], v106
 v_smfmac_f32_16x16x64_bf16 v[48:51], v[8:11], a[168:175], v106
 v_smfmac_f32_16x16x64_bf16 v[52:55], v[8:11], a[224:231], v106
 v_smfmac_f32_16x16x64_bf16 v[56:59], v[8:11], v[144:151], v106
 v_smfmac_f32_16x16x64_bf16 v[60:63], v[8:11], v[200:207], v106
 s_waitcnt lgkmcnt(0)
 s_barrier
 ds_read_b128 v[12:15], v107
 ds_read_b128 v[16:19], v107 offset:1024
 ds_read_b128 v[20:23], v107 offset:2048
 ds_read_b128 v[24:27], v107 offset:3072
 ds_read_b128 v[28:31], v107 offset:4096
 ds_read_b128 v[32:35], v107 offset:5120
 s_waitcnt lgkmcnt(5)
 v_smfmac_f32_16x16x64_bf16 v[36:39], v[12:15], a[8:15], v106
 v_smfmac_f32_16x16x64_bf16 v[40:43], v[12:15], a[64:71], v106
 v_smfmac_f32_16x16x64_bf16 v[44:47], v[12:15], a[120:127], v106
 v_smfmac_f32_16x16x64_bf16 v[48:51], v[12:15], a[176:183], v106
 v_smfmac_f32_16x16x64_bf16 v[52:55], v[12:15], a[232:239], v106
 v_smfmac_f32_16x16x64_bf16 v[56:59], v[12:15], v[152:159], v106
 v_smfmac_f32_16x16x64_bf16 v[60:63], v[12:15], v[208:215], v106
 s_waitcnt lgkmcnt(4)
 v_smfmac_f32_16x16x64_bf16 v[36:39], v[16:19], a[16:23], v106
 s_add_u32 m0, s33, 34816
 s_nop 0
 buffer_load_dwordx4 v107, s[64:67], s24 offen sc1 lds
 s_waitcnt lgkmcnt(3)
 v_smfmac_f32_16x16x64_bf16 v[36:39], v[20:23], a[24:31], v106
 s_waitcnt lgkmcnt(2)
 v_smfmac_f32_16x16x64_bf16 v[36:39], v[24:27], a[32:39], v106
 s_waitcnt lgkmcnt(1)
 v_smfmac_f32_16x16x64_bf16 v[36:39], v[28:31], a[40:47], v106
 buffer_load_dwordx4 v107, s[64:67], s24 offen offset:1024 sc1 lds
 s_waitcnt lgkmcnt(0)
 v_smfmac_f32_16x16x64_bf16 v[36:39], v[32:35], a[48:55], v106
 v_smfmac_f32_16x16x64_bf16 v[40:43], v[16:19], a[72:79], v106
 ds_read_b128 v[76:79], v108
 v_smfmac_f32_16x16x64_bf16 v[40:43], v[20:23], a[80:87], v106
 buffer_load_dwordx4 v107, s[64:67], s24 offen offset:2048 sc1 lds
 ds_read_b128 v[80:83], v108 offset:512
 v_smfmac_f32_16x16x64_bf16 v[40:43], v[24:27], a[88:95], v106
 ds_read_b128 v[84:87], v113
 v_smfmac_f32_16x16x64_bf16 v[40:43], v[28:31], a[96:103], v106
 ds_read_b128 v[88:91], v113 offset:2048
 v_smfmac_f32_16x16x64_bf16 v[40:43], v[32:35], a[104:111], v106
 buffer_load_dwordx4 v107, s[64:67], s24 offen offset:3072 sc1 lds
 s_add_u32 s24, s24, 4096
 ds_read_b128 v[92:95], v113 offset:256
 v_cvt_pk_bf16_f32 v36, v36, v37
 v_smfmac_f32_16x16x64_bf16 v[44:47], v[16:19], a[128:135], v106
 ds_read_b128 v[96:99], v113 offset:2304
 v_cvt_pk_bf16_f32 v37, v38, v39
 v_smfmac_f32_16x16x64_bf16 v[44:47], v[20:23], a[136:143], v106
 v_smfmac_f32_16x16x64_bf16 v[44:47], v[24:27], a[144:151], v106
 s_add_u32 m0, s33, 38912
 s_nop 0
 buffer_load_dwordx4 v107, s[64:67], s24 offen sc1 lds
 v_smfmac_f32_16x16x64_bf16 v[44:47], v[28:31], a[152:159], v106
 v_smfmac_f32_16x16x64_bf16 v[44:47], v[32:35], a[160:167], v106
 v_cvt_pk_bf16_f32 v38, v40, v41
 v_smfmac_f32_16x16x64_bf16 v[48:51], v[16:19], a[184:191], v106
 buffer_load_dwordx4 v107, s[64:67], s24 offen offset:1024 sc1 lds
 v_cvt_pk_bf16_f32 v39, v42, v43
 v_smfmac_f32_16x16x64_bf16 v[48:51], v[20:23], a[192:199], v106
 v_smfmac_f32_16x16x64_bf16 v[48:51], v[24:27], a[200:207], v106
 v_mfma_f32_16x16x32_bf16 v[40:43], v[36:39], v[100:103], 0
 v_smfmac_f32_16x16x64_bf16 v[48:51], v[28:31], a[208:215], v106
 buffer_load_dwordx4 v107, s[64:67], s24 offen offset:2048 sc1 lds
 s_add_u32 s24, s24, 24576
 v_smfmac_f32_16x16x64_bf16 v[48:51], v[32:35], a[216:223], v106
 v_cvt_pk_bf16_f32 v44, v44, v45
 v_smfmac_f32_16x16x64_bf16 v[52:55], v[16:19], a[240:247], v106
 v_cvt_pk_bf16_f32 v45, v46, v47
 v_smfmac_f32_16x16x64_bf16 v[52:55], v[20:23], a[248:255], v106
 v_smfmac_f32_16x16x64_bf16 v[52:55], v[24:27], v[120:127], v106
 v_cvt_pk_bf16_f32 v36, v40, v41
 v_smfmac_f32_16x16x64_bf16 v[52:55], v[28:31], v[128:135], v106
 v_cvt_pk_bf16_f32 v37, v42, v43
 v_smfmac_f32_16x16x64_bf16 v[52:55], v[32:35], v[136:143], v106
 v_cvt_pk_bf16_f32 v46, v48, v49
 v_smfmac_f32_16x16x64_bf16 v[56:59], v[16:19], v[160:167], v106
 v_cvt_pk_bf16_f32 v47, v50, v51
 v_smfmac_f32_16x16x64_bf16 v[56:59], v[20:23], v[168:175], v106
 s_nop 0
 v_mfma_f32_16x16x32_bf16 v[48:51], v[44:47], v[100:103], 0
 v_smfmac_f32_16x16x64_bf16 v[56:59], v[24:27], v[176:183], v106
 s_nop 0
 v_cvt_pk_bf16_f32 v52, v52, v53
 v_smfmac_f32_16x16x64_bf16 v[56:59], v[28:31], v[184:191], v106
 v_cvt_pk_bf16_f32 v53, v54, v55
 v_smfmac_f32_16x16x64_bf16 v[56:59], v[32:35], v[192:199], v106
 s_nop 0
 v_smfmac_f32_16x16x64_bf16 v[60:63], v[16:19], v[216:223], v106
 s_nop 0
 v_cvt_pk_bf16_f32 v38, v48, v49
 v_smfmac_f32_16x16x64_bf16 v[60:63], v[20:23], v[224:231], v106
 s_nop 0
 v_cvt_pk_bf16_f32 v39, v50, v51
 v_smfmac_f32_16x16x64_bf16 v[60:63], v[24:27], v[232:239], v106
 s_nop 0
 v_cvt_pk_bf16_f32 v54, v56, v57
 v_smfmac_f32_16x16x64_bf16 v[60:63], v[28:31], v[240:247], v106
 v_cvt_pk_bf16_f32 v55, v58, v59
 v_smfmac_f32_16x16x64_bf16 v[60:63], v[32:35], v[248:255], v106
 s_waitcnt lgkmcnt(0)
 s_nop 0
 v_smfmac_f32_16x16x64_bf16 v[64:67], v[36:39], v[76:83], v106
 ds_read_b128 v[76:79], v109
 ds_read_b128 v[80:83], v109 offset:256
 s_nop 0
 v_mfma_f32_16x16x32_bf16 v[56:59], v[52:55], v[100:103], 0
 s_nop 0
 v_cvt_pk_bf16_f32 v60, v60, v61
 v_cvt_pk_bf16_f32 v61, v62, v63
 s_nop 1
 v_mfma_f32_16x16x16_bf16 v[40:43], v[60:61], v[104:105], 0
 s_nop 0
 s_nop 0
 v_smfmac_f32_16x16x64_bf16 v[68:71], v[36:39], v[84:91], v106
 ds_read_b128 v[84:87], v117
 ds_read_b128 v[88:91], v117 offset:1024
 v_cvt_pk_bf16_f32 v52, v56, v57
 v_smfmac_f32_16x16x64_bf16 v[72:75], v[36:39], v[92:99], v106
 ds_read_b128 v[92:95], v117 offset:256
 ds_read_b128 v[96:99], v117 offset:1280
 v_cvt_pk_bf16_f32 v53, v58, v59
 v_cvt_pk_bf16_f32 v54, v40, v41
 v_cvt_pk_bf16_f32 v55, v42, v43
 s_waitcnt lgkmcnt(4)
 s_nop 0
 v_smfmac_f32_16x16x64_bf16 v[64:67], v[52:55], v[76:83], v106
 s_waitcnt lgkmcnt(2)
 v_smfmac_f32_16x16x64_bf16 v[68:71], v[52:55], v[84:91], v106
 s_waitcnt lgkmcnt(0)
 v_smfmac_f32_16x16x64_bf16 v[72:75], v[52:55], v[92:99], v106
 s_nop 3
 v_pk_add_f32 v[64:65], v[64:65], v[66:67]
 s_nop 0
 v_add_f32 v36, v68, v70
 v_add_f32 v38, v69, v71
 ds_write2_b32 v116, v64, v65 offset0:0 offset1:16
 v_add_f32 v37, v72, v74
 v_add_f32 v39, v73, v75
 ds_write2_b64 v110, v[36:37], v[38:39] offset0:0 offset1:16
 s_waitcnt lgkmcnt(0)
 s_barrier
 s_add_u32 s23, s22, 655360
 s_sleep 4
 v_mov_b32 v36, 0
 v_mov_b32 v37, 0
 v_mov_b32 v38, 0
 v_mov_b32 v39, 0
 v_mov_b32 v40, 0
 v_mov_b32 v41, 0
 v_mov_b32 v42, 0
 v_mov_b32 v43, 0
 v_mov_b32 v44, 0
 v_mov_b32 v45, 0
 v_mov_b32 v46, 0
 v_mov_b32 v47, 0
 v_mov_b32 v48, 0
 v_mov_b32 v49, 0
 v_mov_b32 v50, 0
 v_mov_b32 v51, 0
 v_mov_b32 v52, 0
 v_mov_b32 v53, 0
 v_mov_b32 v54, 0
 v_mov_b32 v55, 0
 v_mov_b32 v56, 0
 v_mov_b32 v57, 0
 v_mov_b32 v58, 0
 v_mov_b32 v59, 0
 v_mov_b32 v60, 0
 v_mov_b32 v61, 0
 v_mov_b32 v62, 0
 v_mov_b32 v63, 0
 v_mov_b32 v64, 0
 v_mov_b32 v65, 0
 v_mov_b32 v66, 0
 v_mov_b32 v67, 0
 v_mov_b32 v68, 0
 v_mov_b32 v69, 0
 v_mov_b32 v70, 0
 v_mov_b32 v71, 0
 v_mov_b32 v72, 0
 v_mov_b32 v73, 0
 v_mov_b32 v74, 0
 v_mov_b32 v75, 0
 s_nop 0
 s_sub_u32 s36, s33, s32
 v_add_u32 v113, s36, v113
 v_add_u32 v117, s36, v117
 s_mov_b32 s36, s32
 s_mov_b32 s32, s33
 s_mov_b32 s33, s36
 s_add_u32 s25, s25, 8192
 s_add_u32 s26, s25, 2098176
 s_add_u32 s22, s22, 10240
 s_add_u32 s30, s30, 1
 s_cmp_lt_u32 s30, 63
 s_cbranch_scc1 L_Aloop_28
 s_nop 0
 s_branch L_exit
L_q2_29:
 buffer_load_dwordx4 v[8:11], v107, s[64:67], s20 offen sc1
 s_nop 4
 v_mov_b32 v36, 0
 v_mov_b32 v37, 0
 v_mov_b32 v38, 0
 v_mov_b32 v39, 0
 s_add_u32 s31, s31, 1
 s_cmp_lt_u32 s31, 64
 s_cbranch_scc1 L_q2_29_w
 s_cmp_gt_u32 s31, 524288
 s_cbranch_scc1 L_exit
 s_cmp_lg_u32 s31, 64
 s_cbranch_scc1 L_q2_29_w
 s_waitcnt vmcnt(0)
 s_nop 0
 s_add_u32 s20, s26, 6144
 s_add_u32 s21, s26, 0
 buffer_load_dwordx4 v[8:11], v107, s[64:67], s20 offen sc1
 buffer_load_dwordx4 v[8:11], v107, s[64:67], s20 offen sc1
 s_branch L_q2_29_w
L_pad6:
 s_setpc_b64 s[94:95]
L_B0:
 v_lshlrev_b32 v169, 4, v0
 s_mul_i32 s13, s11, 458752
 s_add_u32 s13, s13, 6422528
 s_mov_b32 s15, 12288
 s_add_u32 s14, s13, 0
 buffer_load_dwordx4 a[0:3], v169, s[64:67], s14 offen sc1
 buffer_load_dwordx4 a[4:7], v169, s[64:67], s14 offen offset:1024 sc1
 s_add_u32 s14, s13, 2048
 buffer_load_dwordx4 a[8:11], v169, s[64:67], s14 offen sc1
 buffer_load_dwordx4 a[12:15], v169, s[64:67], s14 offen offset:1024 sc1
 s_add_u32 s14, s13, 4096
 buffer_load_dwordx4 a[16:19], v169, s[64:67], s14 offen sc1
 buffer_load_dwordx4 a[20:23], v169, s[64:67], s14 offen offset:1024 sc1
 s_add_u32 s14, s13, 6144
 buffer_load_dwordx4 a[24:27], v169, s[64:67], s14 offen sc1
 buffer_load_dwordx4 a[28:31], v169, s[64:67], s14 offen offset:1024 sc1
 s_add_u32 s14, s13, 8192
 buffer_load_dwordx4 a[32:35], v169, s[64:67], s14 offen sc1
 buffer_load_dwordx4 a[36:39], v169, s[64:67], s14 offen offset:1024 sc1
 s_add_u32 s14, s13, 10240
 buffer_load_dwordx4 a[40:43], v169, s[64:67], s14 offen sc1
 buffer_load_dwordx4 a[44:47], v169, s[64:67], s14 offen offset:1024 sc1
 s_add_u32 s14, s13, 12288
 buffer_load_dwordx4 a[48:51], v169, s[64:67], s14 offen sc1
 buffer_load_dwordx4 a[52:55], v169, s[64:67], s14 offen offset:1024 sc1
 s_add_u32 s14, s13, 14336
 buffer_load_dwordx4 a[56:59], v169, s[64:67], s14 offen sc1
 buffer_load_dwordx4 a[60:63], v169, s[64:67], s14 offen offset:1024 sc1
 s_add_u32 s14, s13, 16384
 buffer_load_dwordx4 a[64:67], v169, s[64:67], s14 offen sc1
 buffer_load_dwordx4 a[68:71], v169, s[64:67], s14 offen offset:1024 sc1
 s_add_u32 s14, s13, 18432
 buffer_load_dwordx4 a[72:75], v169, s[64:67], s14 offen sc1
 buffer_load_dwordx4 a[76:79], v169, s[64:67], s14 offen offset:1024 sc1
 s_add_u32 s14, s13, 20480
 buffer_load_dwordx4 a[80:83], v169, s[64:67], s14 offen sc1
 buffer_load_dwordx4 a[84:87], v169, s[64:67], s14 offen offset:1024 sc1
 s_add_u32 s14, s13, 22528
 buffer_load_dwordx4 a[88:91], v169, s[64:67], s14 offen sc1
 buffer_load_dwordx4 a[92:95], v169, s[64:67], s14 offen offset:1024 sc1
 s_add_u32 s14, s13, 24576
 buffer_load_dwordx4 a[96:99], v169, s[64:67], s14 offen sc1
 buffer_load_dwordx4 a[100:103], v169, s[64:67], s14 offen offset:1024 sc1
 s_add_u32 s14, s13, 26624
 buffer_load_dwordx4 a[104:107], v169, s[64:67], s14 offen sc1
 buffer_load_dwordx4 a[108:111], v169, s[64:67], s14 offen offset:1024 sc1
 s_add_u32 s14, s13, 28672
 buffer_load_dwordx4 a[112:115], v169, s[64:67], s14 offen sc1
 buffer_load_dwordx4 a[116:119], v169, s[64:67], s14 offen offset:1024 sc1
 s_add_u32 s14, s13, 30720
 buffer_load_dwordx4 a[120:123], v169, s[64:67], s14 offen sc1
 buffer_load_dwordx4 a[124:127], v169, s[64:67], s14 offen offset:1024 sc1
 s_add_u32 s14, s13, 32768
 buffer_load_dwordx4 a[128:131], v169, s[64:67], s14 offen sc1
 buffer_load_dwordx4 a[132:135], v169, s[64:67], s14 offen offset:1024 sc1
 s_add_u32 s14, s13, 34816
 buffer_load_dwordx4 a[136:139], v169, s[64:67], s14 offen sc1
 buffer_load_dwordx4 a[140:143], v169, s[64:67], s14 offen offset:1024 sc1
 s_add_u32 s14, s13, 36864
 buffer_load_dwordx4 a[144:147], v169, s[64:67], s14 offen sc1
 buffer_load_dwordx4 a[148:151], v169, s[64:67], s14 offen offset:1024 sc1
 s_add_u32 s14, s13, 38912
 buffer_load_dwordx4 a[152:155], v169, s[64:67], s14 offen sc1
 buffer_load_dwordx4 a[156:159], v169, s[64:67], s14 offen offset:1024 sc1
 s_add_u32 s14, s13, 40960
 buffer_load_dwordx4 a[160:163], v169, s[64:67], s14 offen sc1
 buffer_load_dwordx4 a[164:167], v169, s[64:67], s14 offen offset:1024 sc1
 s_add_u32 s14, s13, 43008
 buffer_load_dwordx4 a[168:171], v169, s[64:67], s14 offen sc1
 buffer_load_dwordx4 a[172:175], v169, s[64:67], s14 offen offset:1024 sc1
 s_add_u32 s14, s13, 45056
 buffer_load_dwordx4 a[176:179], v169, s[64:67], s14 offen sc1
 buffer_load_dwordx4 a[180:183], v169, s[64:67], s14 offen offset:1024 sc1
 s_add_u32 s14, s13, 47104
 buffer_load_dwordx4 a[184:187], v169, s[64:67], s14 offen sc1
 buffer_load_dwordx4 a[188:191], v169, s[64:67], s14 offen offset:1024 sc1
 s_add_u32 s14, s13, 49152
 buffer_load_dwordx4 a[192:195], v169, s[64:67], s14 offen sc1
 buffer_load_dwordx4 a[196:199], v169, s[64:67], s14 offen offset:1024 sc1
 s_add_u32 s14, s13, 51200
 buffer_load_dwordx4 a[200:203], v169, s[64:67], s14 offen sc1
 buffer_load_dwordx4 a[204:207], v169, s[64:67], s14 offen offset:1024 sc1
 s_add_u32 s14, s13, 53248
 buffer_load_dwordx4 a[208:211], v169, s[64:67], s14 offen sc1
 buffer_load_dwordx4 a[212:215], v169, s[64:67], s14 offen offset:1024 sc1
 s_add_u32 s14, s13, 55296
 buffer_load_dwordx4 a[216:219], v169, s[64:67], s14 offen sc1
 buffer_load_dwordx4 a[220:223], v169, s[64:67], s14 offen offset:1024 sc1
 s_add_u32 s14, s13, 57344
 buffer_load_dwordx4 a[224:227], v169, s[64:67], s14 offen sc1
 buffer_load_dwordx4 a[228:231], v169, s[64:67], s14 offen offset:1024 sc1
 s_add_u32 s14, s13, 59392
 buffer_load_dwordx4 a[232:235], v169, s[64:67], s14 offen sc1
 buffer_load_dwordx4 a[236:239], v169, s[64:67], s14 offen offset:1024 sc1
 s_add_u32 s14, s13, 61440
 buffer_load_dwordx4 a[240:243], v169, s[64:67], s14 offen sc1
 buffer_load_dwordx4 a[244:247], v169, s[64:67], s14 offen offset:1024 sc1
 s_add_u32 s14, s13, 63488
 buffer_load_dwordx4 a[248:251], v169, s[64:67], s14 offen sc1
 buffer_load_dwordx4 a[252:255], v169, s[64:67], s14 offen offset:1024 sc1
 s_add_u32 s14, s13, 65536
 buffer_load_dwordx4 v[176:179], v169, s[64:67], s14 offen sc1
 buffer_load_dwordx4 v[180:183], v169, s[64:67], s14 offen offset:1024 sc1
 s_add_u32 s14, s13, 67584
 buffer_load_dwordx4 v[184:187], v169, s[64:67], s14 offen sc1
 buffer_load_dwordx4 v[188:191], v169, s[64:67], s14 offen offset:1024 sc1
 s_add_u32 s14, s13, 69632
 buffer_load_dwordx4 v[192:195], v169, s[64:67], s14 offen sc1
 buffer_load_dwordx4 v[196:199], v169, s[64:67], s14 offen offset:1024 sc1
 s_add_u32 s14, s13, 71680
 buffer_load_dwordx4 v[200:203], v169, s[64:67], s14 offen sc1
 buffer_load_dwordx4 v[204:207], v169, s[64:67], s14 offen offset:1024 sc1
 s_add_u32 s14, s13, 73728
 buffer_load_dwordx4 v[208:211], v169, s[64:67], s14 offen sc1
 buffer_load_dwordx4 v[212:215], v169, s[64:67], s14 offen offset:1024 sc1
 s_add_u32 s14, s13, 75776
 buffer_load_dwordx4 v[216:219], v169, s[64:67], s14 offen sc1
 buffer_load_dwordx4 v[220:223], v169, s[64:67], s14 offen offset:1024 sc1
 s_add_u32 s14, s13, 77824
 buffer_load_dwordx4 v[224:227], v169, s[64:67], s14 offen sc1
 buffer_load_dwordx4 v[228:231], v169, s[64:67], s14 offen offset:1024 sc1
 s_add_u32 s14, s13, 79872
 buffer_load_dwordx4 v[232:235], v169, s[64:67], s14 offen sc1
 buffer_load_dwordx4 v[236:239], v169, s[64:67], s14 offen offset:1024 sc1
 s_add_u32 s14, s13, 81920
 buffer_load_dwordx4 v[240:243], v169, s[64:67], s14 offen sc1
 buffer_load_dwordx4 v[244:247], v169, s[64:67], s14 offen offset:1024 sc1
 s_add_u32 s14, s13, 83968
 buffer_load_dwordx4 v[248:251], v169, s[64:67], s14 offen sc1
 buffer_load_dwordx4 v[252:255], v169, s[64:67], s14 offen offset:1024 sc1
 s_add_u32 m0, s15, 0
 s_add_u32 s14, s13, 86016
 buffer_load_dwordx4 v169, s[64:67], s14 offen sc1 lds
 buffer_load_dwordx4 v169, s[64:67], s14 offen offset:1024 sc1 lds
 buffer_load_dwordx4 v169, s[64:67], s14 offen offset:2048 sc1 lds
 buffer_load_dwordx4 v169, s[64:67], s14 offen offset:3072 sc1 lds
 s_add_u32 m0, s15, 4096
 s_add_u32 s14, s13, 90112
 buffer_load_dwordx4 v169, s[64:67], s14 offen sc1 lds
 buffer_load_dwordx4 v169, s[64:67], s14 offen offset:1024 sc1 lds
 buffer_load_dwordx4 v169, s[64:67], s14 offen offset:2048 sc1 lds
 buffer_load_dwordx4 v169, s[64:67], s14 offen offset:3072 sc1 lds
 s_add_u32 m0, s15, 8192
 s_add_u32 s14, s13, 94208
 buffer_load_dwordx4 v169, s[64:67], s14 offen sc1 lds
 buffer_load_dwordx4 v169, s[64:67], s14 offen offset:1024 sc1 lds
 buffer_load_dwordx4 v169, s[64:67], s14 offen offset:2048 sc1 lds
 buffer_load_dwordx4 v169, s[64:67], s14 offen offset:3072 sc1 lds
 s_add_u32 m0, s15, 12288
 s_add_u32 s14, s13, 98304
 buffer_load_dwordx4 v169, s[64:67], s14 offen sc1 lds
 buffer_load_dwordx4 v169, s[64:67], s14 offen offset:1024 sc1 lds
 buffer_load_dwordx4 v169, s[64:67], s14 offen offset:2048 sc1 lds
 buffer_load_dwordx4 v169, s[64:67], s14 offen offset:3072 sc1 lds
 s_add_u32 m0, s15, 16384
 s_add_u32 s14, s13, 102400
 buffer_load_dwordx4 v169, s[64:67], s14 offen sc1 lds
 buffer_load_dwordx4 v169, s[64:67], s14 offen offset:1024 sc1 lds
 buffer_load_dwordx4 v169, s[64:67], s14 offen offset:2048 sc1 lds
 buffer_load_dwordx4 v169, s[64:67], s14 offen offset:3072 sc1 lds
 s_add_u32 m0, s15, 20480
 s_add_u32 s14, s13, 106496
 buffer_load_dwordx4 v169, s[64:67], s14 offen sc1 lds
 buffer_load_dwordx4 v169, s[64:67], s14 offen offset:1024 sc1 lds
 buffer_load_dwordx4 v169, s[64:67], s14 offen offset:2048 sc1 lds
 buffer_load_dwordx4 v169, s[64:67], s14 offen offset:3072 sc1 lds
 s_cmp_lg_u32 s11, 0
 s_cbranch_scc1 L_go3_31
 s_mov_b32 s14, 53501440
 s_mov_b64 exec, 1
 v_mov_b32 v1, 0
 v_mov_b32 v2, 1
 buffer_store_dword v2, v1, s[64:67], s14 offen sc1
 s_mov_b64 exec, -1
L_go3_31:
 s_add_u32 m0, s15, 24576
 s_add_u32 s14, s13, 110592
 buffer_load_dwordx4 v169, s[64:67], s14 offen sc1 lds
 buffer_load_dwordx4 v169, s[64:67], s14 offen offset:1024 sc1 lds
 buffer_load_dwordx4 v169, s[64:67], s14 offen offset:2048 sc1 lds
 buffer_load_dwordx4 v169, s[64:67], s14 offen offset:3072 sc1 lds
 v_add_u32 v175, 12288, v169
 v_bfe_u32 v5, v0, 1, 1
 v_mov_b32 v6, 0x4444
 v_mov_b32 v7, 0xeeee
 v_cmp_eq_u32 vcc, 1, v5
 s_nop 1
 v_cndmask_b32 v168, v6, v7, vcc
 v_lshrrev_b32 v1, 4, v0
 v_and_b32 v2, 15, v0
 v_lshrrev_b32 v4, 2, v2
 v_lshlrev_b32 v4, 8, v4
 v_add_u32 v4, 0, v4
 v_and_b32 v6, 3, v0
 v_lshl_add_u32 v171, v6, 3, v4
 v_lshl_add_u32 v171, v1, 10, v171
 v_add_u32 v171, 128, v171
 v_lshl_add_u32 v4, v6, 4, v4
 v_lshrrev_b32 v6, 1, v1
 v_lshl_add_u32 v4, v6, 10, v4
 v_and_b32 v6, 1, v1
 v_lshl_add_u32 v170, v6, 6, v4
 v_mul_u32_u24 v4, 320, v1
 v_lshlrev_b32 v6, 2, v2
 v_add_u32 v4, v4, v6
 v_add_u32 v172, 7168, v4
 v_lshlrev_b32 v4, 1, v1
 v_bfe_u32 v6, v0, 2, 1
 v_add_u32 v4, v4, v6
 v_mul_u32_u24 v4, 160, v4
 v_bfe_u32 v6, v0, 3, 1
 v_lshlrev_b32 v6, 5, v6
 v_and_b32 v7, 3, v0
 v_lshlrev_b32 v7, 3, v7
 v_add3_u32 v4, v4, v6, v7
 v_add_u32 v173, 7168, v4
 v_lshlrev_b32 v174, 2, v0
 v_add_u32 v174, 0, v174
 v_lshlrev_b32 v171, 3, v0
 v_add_u32 v171, 8192, v171
 v_lshrrev_b32 v4, 2, v2
 v_lshlrev_b32 v4, 7, v4
 v_add_u32 v4, 0, v4
 v_and_b32 v6, 3, v0
 v_lshl_add_u32 v4, v6, 4, v4
 v_lshrrev_b32 v6, 1, v1
 v_lshl_add_u32 v4, v6, 9, v4
 v_and_b32 v6, 1, v1
 v_lshl_add_u32 v170, v6, 6, v4
 s_mov_b32 s34, 0xfffffffe
 v_mov_b32 v4, 0
 v_mov_b32 v5, 0
 s_mov_b32 s25, 50331648
 s_mov_b32 s26, 53485568
 s_mov_b32 s27, 50855936
 s_mul_i32 s13, s11, 32768
 s_add_u32 s24, s13, 12845056
 s_lshl_b32 s13, s11, 9
 s_add_u32 s28, s13, 50339840
 s_mov_b32 s29, 0x7ffffff0
 s_lshl_b32 s13, s11, 6
 s_add_u32 s33, s13, 52166656
 v_mov_b32 v36, 0
 v_mov_b32 v37, 0
 v_mov_b32 v38, 0
 v_mov_b32 v39, 0
 v_mov_b32 v40, 0
 v_mov_b32 v41, 0
 v_mov_b32 v42, 0
 v_mov_b32 v43, 0
 v_mov_b32 v44, 0
 v_mov_b32 v45, 0
 v_mov_b32 v46, 0
 v_mov_b32 v47, 0
 v_mov_b32 v48, 0
 v_mov_b32 v49, 0
 v_mov_b32 v50, 0
 v_mov_b32 v51, 0
 v_mov_b32 v52, 0
 v_mov_b32 v53, 0
 v_mov_b32 v54, 0
 v_mov_b32 v55, 0
 v_mov_b32 v56, 0
 v_mov_b32 v57, 0
 v_mov_b32 v58, 0
 v_mov_b32 v59, 0
 v_mov_b32 v60, 0
 v_mov_b32 v61, 0
 v_mov_b32 v62, 0
 v_mov_b32 v63, 0
 v_mov_b32 v64, 0
 v_mov_b32 v65, 0
 v_mov_b32 v66, 0
 v_mov_b32 v67, 0
 v_mov_b32 v128, 0
 v_mov_b32 v129, 0
 v_mov_b32 v130, 0
 v_mov_b32 v131, 0
 v_mov_b32 v132, 0
 v_mov_b32 v133, 0
 v_mov_b32 v134, 0
 v_mov_b32 v135, 0
 s_cmp_lg_u32 s12, 0
 s_cbranch_scc1 L_wg_32_done
 v_lshlrev_b32 v1, 7, v0
 s_mov_b32 s31, 0
 s_mov_b32 s3, 53501952
 s_mov_b32 exec_lo, 262143
 s_mov_b32 exec_hi, 1
L_wg_32:
 buffer_load_dword v2, v1, s[64:67], s3 offen sc1
 s_add_u32 s31, s31, 1
 s_cmp_gt_u32 s31, 524288
 s_cbranch_scc1 L_exit
 s_waitcnt vmcnt(0)
 v_cmp_eq_u32 vcc, 0, v2
 s_cbranch_vccz L_wg_32_ok
 s_sleep 4
 s_branch L_wg_32
L_wg_32_ok:
 s_mov_b64 exec, -1
L_wg_32_done:
 s_barrier
 s_cmp_lg_u32 s11, 0
 s_cbranch_scc1 L_go2_33
 s_mov_b32 s13, 52273152
 s_mov_b64 exec, 1
 buffer_store_dword v4, v4, s[64:67], s13 offen sc1
 s_mov_b64 exec, -1
L_go2_33:
 s_mov_b32 s31, 0
 s_branch L_sp_34_go
L_sp_34:
 s_sleep 2
 s_add_u32 s31, s31, 1
 s_cmp_gt_u32 s31, 524288
 s_cbranch_scc1 L_exit
L_sp_34_go:
 buffer_load_dword v7, v4, s[64:67], s33 offen sc1
 s_waitcnt vmcnt(0)
 v_cmp_eq_u32 vcc, -1, v7
 s_cbranch_vccnz L_sp_34
 s_mov_b32 s30, 0
 s_waitcnt vmcnt(0) lgkmcnt(0)
 s_barrier
L_Bloop_35:
 s_add_u32 s20, s25, 0
 s_add_u32 s21, s25, 1024
 s_mov_b32 s22, s27
 ds_read_b128 v[136:139], v175
 ds_read_b128 v[140:143], v175 offset:1024
 ds_read_b128 v[144:147], v175 offset:14336
 ds_read_b128 v[148:151], v175 offset:15360
 ds_read_b128 v[152:155], v175 offset:2048
 ds_read_b128 v[156:159], v175 offset:3072
 ds_read_b128 v[160:163], v175 offset:16384
 ds_read_b128 v[164:167], v175 offset:17408
 s_sleep 2
 s_mov_b32 s31, 0
 buffer_load_dwordx4 v[8:11], v169, s[64:67], s20 offen sc1
 buffer_load_dwordx4 v[12:15], v169, s[64:67], s21 offen sc1
 buffer_load_dword v7, v4, s[64:67], s33 offen sc1
L_fp_36_w:
 s_waitcnt vmcnt(0)
 v_max3_u32 v6, v8, v9, v10
 v_max3_u32 v6, v6, v11, v12
 v_max3_u32 v6, v6, v13, v14
 v_max3_u32 v6, v6, v15, v7
 v_cmp_eq_u32 vcc, -1, v6
 s_cbranch_vccnz L_fp_36
 s_waitcnt lgkmcnt(0)
 ds_write_b128 v169, v[8:11]
 ds_write_b128 v169, v[12:15] offset:1024
 v_smfmac_f32_16x16x64_bf16 v[60:63], v[8:11], v[136:143], v168
 v_smfmac_f32_16x16x64_bf16 v[64:67], v[8:11], v[144:151], v168
 buffer_load_dwordx4 v[84:87], v169, s[64:67], s24 offen sc1
 v_smfmac_f32_16x16x64_bf16 v[36:39], v[8:11], a[0:7], v168
 v_smfmac_f32_16x16x64_bf16 v[40:43], v[8:11], a[56:63], v168
 buffer_load_dwordx4 v[88:91], v169, s[64:67], s24 offen offset:1024 sc1
 v_smfmac_f32_16x16x64_bf16 v[44:47], v[8:11], a[112:119], v168
 v_smfmac_f32_16x16x64_bf16 v[48:51], v[8:11], a[168:175], v168
 buffer_load_dwordx4 v[92:95], v169, s[64:67], s24 offen offset:2048 sc1
 v_smfmac_f32_16x16x64_bf16 v[52:55], v[8:11], a[224:231], v168
 v_smfmac_f32_16x16x64_bf16 v[56:59], v[8:11], v[200:207], v168
 buffer_load_dwordx4 v[96:99], v169, s[64:67], s24 offen offset:3072 sc1
 s_add_u32 s24, s24, 4096
 buffer_store_dword v5, v174, s[64:67], s29 offen sc1
 s_waitcnt lgkmcnt(0)
 s_barrier
 ds_read_b128 v[16:19], v169 offset:2048
 ds_read_b128 v[20:23], v169 offset:3072
 ds_read_b128 v[24:27], v169 offset:4096
 ds_read_b128 v[28:31], v169 offset:5120
 ds_read_b128 v[32:35], v169 offset:6144
 ds_read_b128 v[136:139], v175 offset:4096
 ds_read_b128 v[140:143], v175 offset:5120
 ds_read_b128 v[144:147], v175 offset:18432
 ds_read_b128 v[148:151], v175 offset:19456
 v_smfmac_f32_16x16x64_bf16 v[60:63], v[12:15], v[152:159], v168
 v_smfmac_f32_16x16x64_bf16 v[64:67], v[12:15], v[160:167], v168
 buffer_load_dwordx4 v[100:103], v169, s[64:67], s24 offen sc1
 v_smfmac_f32_16x16x64_bf16 v[36:39], v[12:15], a[8:15], v168
 ds_read_b128 v[152:155], v175 offset:6144
 v_smfmac_f32_16x16x64_bf16 v[40:43], v[12:15], a[64:71], v168
 ds_read_b128 v[156:159], v175 offset:7168
 buffer_load_dwordx4 v[104:107], v169, s[64:67], s24 offen offset:1024 sc1
 v_smfmac_f32_16x16x64_bf16 v[44:47], v[12:15], a[120:127], v168
 ds_read_b128 v[160:163], v175 offset:20480
 v_smfmac_f32_16x16x64_bf16 v[48:51], v[12:15], a[176:183], v168
 ds_read_b128 v[164:167], v175 offset:21504
 buffer_load_dwordx4 v[108:111], v169, s[64:67], s24 offen offset:2048 sc1
 v_smfmac_f32_16x16x64_bf16 v[52:55], v[12:15], a[232:239], v168
 v_smfmac_f32_16x16x64_bf16 v[56:59], v[12:15], v[208:215], v168
 buffer_load_dwordx4 v[112:115], v169, s[64:67], s24 offen offset:3072 sc1
 s_add_u32 s24, s24, 454656
 s_waitcnt lgkmcnt(4)
 v_smfmac_f32_16x16x64_bf16 v[60:63], v[16:19], v[136:143], v168
 v_smfmac_f32_16x16x64_bf16 v[64:67], v[16:19], v[144:151], v168
 v_smfmac_f32_16x16x64_bf16 v[36:39], v[16:19], a[16:23], v168
 ds_read_b128 v[136:139], v175 offset:8192
 v_smfmac_f32_16x16x64_bf16 v[40:43], v[16:19], a[72:79], v168
 ds_read_b128 v[140:143], v175 offset:9216
 v_smfmac_f32_16x16x64_bf16 v[44:47], v[16:19], a[128:135], v168
 ds_read_b128 v[144:147], v175 offset:22528
 v_smfmac_f32_16x16x64_bf16 v[48:51], v[16:19], a[184:191], v168
 ds_read_b128 v[148:151], v175 offset:23552
 v_smfmac_f32_16x16x64_bf16 v[52:55], v[16:19], a[240:247], v168
 v_smfmac_f32_16x16x64_bf16 v[56:59], v[16:19], v[216:223], v168
 s_waitcnt lgkmcnt(4)
 v_smfmac_f32_16x16x64_bf16 v[60:63], v[20:23], v[152:159], v168
 v_smfmac_f32_16x16x64_bf16 v[64:67], v[20:23], v[160:167], v168
 v_smfmac_f32_16x16x64_bf16 v[36:39], v[20:23], a[24:31], v168
 ds_read_b128 v[152:155], v175 offset:10240
 v_smfmac_f32_16x16x64_bf16 v[40:43], v[20:23], a[80:87], v168
 ds_read_b128 v[156:159], v175 offset:11264
 v_smfmac_f32_16x16x64_bf16 v[44:47], v[20:23], a[136:143], v168
 ds_read_b128 v[160:163], v175 offset:24576
 v_smfmac_f32_16x16x64_bf16 v[48:51], v[20:23], a[192:199], v168
 ds_read_b128 v[164:167], v175 offset:25600
 v_smfmac_f32_16x16x64_bf16 v[52:55], v[20:23], a[248:255], v168
 v_smfmac_f32_16x16x64_bf16 v[56:59], v[20:23], v[224:231], v168
 s_waitcnt lgkmcnt(4)
 v_smfmac_f32_16x16x64_bf16 v[60:63], v[24:27], v[136:143], v168
 v_smfmac_f32_16x16x64_bf16 v[64:67], v[24:27], v[144:151], v168
 v_smfmac_f32_16x16x64_bf16 v[36:39], v[24:27], a[32:39], v168
 ds_read_b128 v[136:139], v175 offset:12288
 v_smfmac_f32_16x16x64_bf16 v[40:43], v[24:27], a[88:95], v168
 ds_read_b128 v[140:143], v175 offset:13312
 v_smfmac_f32_16x16x64_bf16 v[44:47], v[24:27], a[144:151], v168
 ds_read_b128 v[144:147], v175 offset:26624
 v_smfmac_f32_16x16x64_bf16 v[48:51], v[24:27], a[200:207], v168
 ds_read_b128 v[148:151], v175 offset:27648
 v_smfmac_f32_16x16x64_bf16 v[52:55], v[24:27], v[176:183], v168
 v_smfmac_f32_16x16x64_bf16 v[56:59], v[24:27], v[232:239], v168
 s_waitcnt lgkmcnt(4)
 v_smfmac_f32_16x16x64_bf16 v[60:63], v[28:31], v[152:159], v168
 v_smfmac_f32_16x16x64_bf16 v[64:67], v[28:31], v[160:167], v168
 v_smfmac_f32_16x16x64_bf16 v[36:39], v[28:31], a[40:47], v168
 v_smfmac_f32_16x16x64_bf16 v[40:43], v[28:31], a[96:103], v168
 v_smfmac_f32_16x16x64_bf16 v[44:47], v[28:31], a[152:159], v168
 v_smfmac_f32_16x16x64_bf16 v[48:51], v[28:31], a[208:215], v168
 v_smfmac_f32_16x16x64_bf16 v[52:55], v[28:31], v[184:191], v168
 v_smfmac_f32_16x16x64_bf16 v[56:59], v[28:31], v[240:247], v168
 s_waitcnt lgkmcnt(0)
 v_smfmac_f32_16x16x64_bf16 v[60:63], v[32:35], v[136:143], v168
 v_smfmac_f32_16x16x64_bf16 v[64:67], v[32:35], v[144:151], v168
 v_smfmac_f32_16x16x64_bf16 v[36:39], v[32:35], a[48:55], v168
 v_smfmac_f32_16x16x64_bf16 v[40:43], v[32:35], a[104:111], v168
 v_smfmac_f32_16x16x64_bf16 v[44:47], v[32:35], a[160:167], v168
 v_smfmac_f32_16x16x64_bf16 v[48:51], v[32:35], a[216:223], v168
 v_smfmac_f32_16x16x64_bf16 v[52:55], v[32:35], v[192:199], v168
 v_smfmac_f32_16x16x64_bf16 v[56:59], v[32:35], v[248:255], v168
 s_nop 0
 v_pk_add_f32 v[60:61], v[60:61], v[62:63]
 v_pk_add_f32 v[64:65], v[64:65], v[66:67]
 v_pk_add_f32 v[36:37], v[36:37], v[38:39]
 v_pk_add_f32 v[40:41], v[40:41], v[42:43]
 v_pk_add_f32 v[44:45], v[44:45], v[46:47]
 v_pk_add_f32 v[48:49], v[48:49], v[50:51]
 v_pk_add_f32 v[52:53], v[52:53], v[54:55]
 v_pk_add_f32 v[56:57], v[56:57], v[58:59]
 v_cvt_pk_bf16_f32 v71, v60, v61
 v_cvt_pk_bf16_f32 v75, v64, v65
 v_cvt_pk_bf16_f32 v68, v36, v37
 v_cvt_pk_bf16_f32 v72, v40, v41
 v_cvt_pk_bf16_f32 v70, v44, v45
 v_cvt_pk_bf16_f32 v74, v48, v49
 v_cvt_pk_bf16_f32 v69, v52, v53
 v_cvt_pk_bf16_f32 v73, v56, v57
 s_nop 0
 v_permlane32_swap_b32 v68, v69
 v_permlane32_swap_b32 v70, v71
 v_permlane32_swap_b32 v72, v73
 v_permlane32_swap_b32 v74, v75
 v_permlane16_swap_b32 v68, v70
 v_permlane16_swap_b32 v69, v71
 v_permlane16_swap_b32 v72, v74
 v_permlane16_swap_b32 v73, v75
 s_sleep 2
 s_mov_b32 s31, 0
 buffer_load_dwordx4 v[116:119], v170, s[64:67], s22 offen sc1
 buffer_load_dwordx4 v[120:123], v170, s[64:67], s22 offen offset:1024 sc1
 buffer_load_dwordx2 v[124:125], v171, s[64:67], s22 offen sc1
 s_nop 15
 s_nop 15
 buffer_load_dwordx4 v[116:119], v170, s[64:67], s22 offen sc1
 buffer_load_dwordx4 v[120:123], v170, s[64:67], s22 offen offset:1024 sc1
 buffer_load_dwordx2 v[124:125], v171, s[64:67], s22 offen sc1
L_q2_37_w:
 s_waitcnt vmcnt(3)
 v_max3_u32 v6, v119, v123, v124
 v_max_u32 v6, v6, v125
 v_cmp_eq_u32 vcc, -1, v6
 v_smfmac_f32_16x16x32_bf16 v[128:131], v[124:125], v[68:71], v168
 v_smfmac_f32_16x16x32_bf16 v[132:135], v[124:125], v[72:75], v168
 s_cbranch_vccnz L_q2_37
 s_nop 3
 v_smfmac_f32_16x16x64_bf16 v[128:131], v[116:119], v[84:91], v168
 v_smfmac_f32_16x16x64_bf16 v[128:131], v[120:123], v[100:107], v168
 v_smfmac_f32_16x16x64_bf16 v[132:135], v[116:119], v[92:99], v168
 v_smfmac_f32_16x16x64_bf16 v[132:135], v[120:123], v[108:115], v168
 s_nop 5
 v_pk_add_f32 v[128:129], v[128:129], v[130:131]
 ds_write2_b32 v172, v128, v129 offset0:0 offset1:40
 v_pk_add_f32 v[132:133], v[132:133], v[134:135]
 ds_write2_b32 v172, v132, v133 offset0:16 offset1:56
 s_waitcnt lgkmcnt(0)
 s_barrier
 ds_read_b64 v[36:37], v173
 ds_read_b64 v[38:39], v173 offset:1280
 ds_read_b64 v[40:41], v173 offset:2560
 ds_read_b64 v[42:43], v173 offset:3840
 s_waitcnt lgkmcnt(2)
 v_pk_add_f32 v[36:37], v[36:37], v[38:39]
 s_waitcnt lgkmcnt(0)
 v_pk_add_f32 v[40:41], v[40:41], v[42:43]
 v_pk_add_f32 v[36:37], v[36:37], v[40:41]
 v_cvt_pk_bf16_f32 v5, v36, v37
 v_min_u32 v5, s34, v5
 buffer_store_dword v5, v174, s[64:67], s28 offen
 s_add_u32 s29, s28, 2098176
 s_add_u32 s28, s28, 8192
 s_cmp_eq_u32 s30, 62
 s_cbranch_scc1 L_Bloop_35_x
 v_mov_b32 v36, 0
 v_mov_b32 v37, 0
 v_mov_b32 v38, 0
 v_mov_b32 v39, 0
 v_mov_b32 v40, 0
 v_mov_b32 v41, 0
 v_mov_b32 v42, 0
 v_mov_b32 v43, 0
 v_mov_b32 v44, 0
 v_mov_b32 v45, 0
 v_mov_b32 v46, 0
 v_mov_b32 v47, 0
 v_mov_b32 v48, 0
 v_mov_b32 v49, 0
 v_mov_b32 v50, 0
 v_mov_b32 v51, 0
 v_mov_b32 v52, 0
 v_mov_b32 v53, 0
 v_mov_b32 v54, 0
 v_mov_b32 v55, 0
 v_mov_b32 v56, 0
 v_mov_b32 v57, 0
 v_mov_b32 v58, 0
 v_mov_b32 v59, 0
 v_mov_b32 v60, 0
 v_mov_b32 v61, 0
 v_mov_b32 v62, 0
 v_mov_b32 v63, 0
 v_mov_b32 v64, 0
 v_mov_b32 v65, 0
 v_mov_b32 v66, 0
 v_mov_b32 v67, 0
 v_mov_b32 v128, 0
 v_mov_b32 v129, 0
 v_mov_b32 v130, 0
 v_mov_b32 v131, 0
 v_mov_b32 v132, 0
 v_mov_b32 v133, 0
 v_mov_b32 v134, 0
 v_mov_b32 v135, 0
 s_add_u32 s25, s25, 8192
 s_add_u32 s26, s25, 2098176
 s_add_u32 s27, s27, 10240
 s_add_u32 s33, s33, 1024
 s_add_u32 s30, s30, 1
 s_cmp_lt_u32 s30, 63
 s_cbranch_scc1 L_Bloop_35
L_Bloop_35_x:
 buffer_store_dword v5, v174, s[64:67], s29 offen sc1
 s_branch L_exit
L_fp_36:
 s_add_u32 s31, s31, 1
 s_cmp_ge_u32 s31, 48
 s_cbranch_scc1 L_fp_36_sw
L_fp_36_r:
 buffer_load_dwordx4 v[8:11], v169, s[64:67], s20 offen sc1
 buffer_load_dwordx4 v[12:15], v169, s[64:67], s21 offen sc1
 buffer_load_dword v7, v4, s[64:67], s33 offen sc1
 s_branch L_fp_36_w
L_fp_36_sw:
 s_cmp_gt_u32 s31, 524288
 s_cbranch_scc1 L_exit
 s_cmp_lg_u32 s31, 48
 s_cbranch_scc1 L_fp_36_r
 s_waitcnt vmcnt(0)
 buffer_store_dword v5, v174, s[64:67], s29 offen sc1
 s_add_u32 s20, s26, 0
 s_add_u32 s21, s26, 1024
 s_branch L_fp_36_r
L_q2_37:
 buffer_load_dwordx4 v[116:119], v170, s[64:67], s22 offen sc1
 buffer_load_dwordx4 v[120:123], v170, s[64:67], s22 offen offset:1024 sc1
 buffer_load_dwordx2 v[124:125], v171, s[64:67], s22 offen sc1
 s_nop 2
 v_mov_b32 v128, 0
 v_mov_b32 v129, 0
 v_mov_b32 v130, 0
 v_mov_b32 v131, 0
 v_mov_b32 v132, 0
 v_mov_b32 v133, 0
 v_mov_b32 v134, 0
 v_mov_b32 v135, 0
 s_add_u32 s31, s31, 1
 s_cmp_lt_u32 s31, 64
 s_cbranch_scc1 L_q2_37_w
 s_cmp_gt_u32 s31, 524288
 s_cbranch_scc1 L_exit
 s_cmp_lg_u32 s31, 64
 s_cbranch_scc1 L_q2_37_w
 s_waitcnt vmcnt(0)
 s_add_u32 s22, s27, 655360
 buffer_load_dwordx4 v[116:119], v170, s[64:67], s22 offen sc1
 buffer_load_dwordx4 v[120:123], v170, s[64:67], s22 offen offset:1024 sc1
 buffer_load_dwordx2 v[124:125], v171, s[64:67], s22 offen sc1
 buffer_load_dwordx4 v[116:119], v170, s[64:67], s22 offen sc1
 buffer_load_dwordx4 v[120:123], v170, s[64:67], s22 offen offset:1024 sc1
 buffer_load_dwordx2 v[124:125], v171, s[64:67], s22 offen sc1
 s_branch L_q2_37_w
L_pad7:
 s_setpc_b64 s[94:95]
L_B1:
 v_lshlrev_b32 v169, 4, v0
 s_mul_i32 s13, s11, 458752
 s_add_u32 s13, s13, 6537216
 s_mov_b32 s15, 40960
 s_add_u32 s14, s13, 4096
 buffer_load_dwordx4 a[0:3], v169, s[64:67], s14 offen sc1
 buffer_load_dwordx4 a[4:7], v169, s[64:67], s14 offen offset:1024 sc1
 s_add_u32 s14, s13, 6144
 buffer_load_dwordx4 a[8:11], v169, s[64:67], s14 offen sc1
 buffer_load_dwordx4 a[12:15], v169, s[64:67], s14 offen offset:1024 sc1
 s_add_u32 s14, s13, 8192
 buffer_load_dwordx4 a[16:19], v169, s[64:67], s14 offen sc1
 buffer_load_dwordx4 a[20:23], v169, s[64:67], s14 offen offset:1024 sc1
 s_add_u32 s14, s13, 10240
 buffer_load_dwordx4 a[24:27], v169, s[64:67], s14 offen sc1
 buffer_load_dwordx4 a[28:31], v169, s[64:67], s14 offen offset:1024 sc1
 s_add_u32 s14, s13, 12288
 buffer_load_dwordx4 a[32:35], v169, s[64:67], s14 offen sc1
 buffer_load_dwordx4 a[36:39], v169, s[64:67], s14 offen offset:1024 sc1
 s_add_u32 s14, s13, 0
 buffer_load_dwordx4 a[40:43], v169, s[64:67], s14 offen sc1
 buffer_load_dwordx4 a[44:47], v169, s[64:67], s14 offen offset:1024 sc1
 s_add_u32 s14, s13, 2048
 buffer_load_dwordx4 a[48:51], v169, s[64:67], s14 offen sc1
 buffer_load_dwordx4 a[52:55], v169, s[64:67], s14 offen offset:1024 sc1
 s_add_u32 s14, s13, 18432
 buffer_load_dwordx4 a[56:59], v169, s[64:67], s14 offen sc1
 buffer_load_dwordx4 a[60:63], v169, s[64:67], s14 offen offset:1024 sc1
 s_add_u32 s14, s13, 20480
 buffer_load_dwordx4 a[64:67], v169, s[64:67], s14 offen sc1
 buffer_load_dwordx4 a[68:71], v169, s[64:67], s14 offen offset:1024 sc1
 s_add_u32 s14, s13, 22528
 buffer_load_dwordx4 a[72:75], v169, s[64:67], s14 offen sc1
 buffer_load_dwordx4 a[76:79], v169, s[64:67], s14 offen offset:1024 sc1
 s_add_u32 s14, s13, 24576
 buffer_load_dwordx4 a[80:83], v169, s[64:67], s14 offen sc1
 buffer_load_dwordx4 a[84:87], v169, s[64:67], s14 offen offset:1024 sc1
 s_add_u32 s14, s13, 26624
 buffer_load_dwordx4 a[88:91], v169, s[64:67], s14 offen sc1
 buffer_load_dwordx4 a[92:95], v169, s[64:67], s14 offen offset:1024 sc1
 s_add_u32 s14, s13, 14336
 buffer_load_dwordx4 a[96:99], v169, s[64:67], s14 offen sc1
 buffer_load_dwordx4 a[100:103], v169, s[64:67], s14 offen offset:1024 sc1
 s_add_u32 s14, s13, 16384
 buffer_load_dwordx4 a[104:107], v169, s[64:67], s14 offen sc1
 buffer_load_dwordx4 a[108:111], v169, s[64:67], s14 offen offset:1024 sc1
 s_add_u32 s14, s13, 32768
 buffer_load_dwordx4 a[112:115], v169, s[64:67], s14 offen sc1
 buffer_load_dwordx4 a[116:119], v169, s[64:67], s14 offen offset:1024 sc1
 s_add_u32 s14, s13, 34816
 buffer_load_dwordx4 a[120:123], v169, s[64:67], s14 offen sc1
 buffer_load_dwordx4 a[124:127], v169, s[64:67], s14 offen offset:1024 sc1
 s_add_u32 s14, s13, 36864
 buffer_load_dwordx4 a[128:131], v169, s[64:67], s14 offen sc1
 buffer_load_dwordx4 a[132:135], v169, s[64:67], s14 offen offset:1024 sc1
 s_add_u32 s14, s13, 38912
 buffer_load_dwordx4 a[136:139], v169, s[64:67], s14 offen sc1
 buffer_load_dwordx4 a[140:143], v169, s[64:67], s14 offen offset:1024 sc1
 s_add_u32 s14, s13, 40960
 buffer_load_dwordx4 a[144:147], v169, s[64:67], s14 offen sc1
 buffer_load_dwordx4 a[148:151], v169, s[64:67], s14 offen offset:1024 sc1
 s_add_u32 s14, s13, 28672
 buffer_load_dwordx4 a[152:155], v169, s[64:67], s14 offen sc1
 buffer_load_dwordx4 a[156:159], v169, s[64:67], s14 offen offset:1024 sc1
 s_add_u32 s14, s13, 30720
 buffer_load_dwordx4 a[160:163], v169, s[64:67], s14 offen sc1
 buffer_load_dwordx4 a[164:167], v169, s[64:67], s14 offen offset:1024 sc1
 s_add_u32 s14, s13, 47104
 buffer_load_dwordx4 a[168:171], v169, s[64:67], s14 offen sc1
 buffer_load_dwordx4 a[172:175], v169, s[64:67], s14 offen offset:1024 sc1
 s_add_u32 s14, s13, 49152
 buffer_load_dwordx4 a[176:179], v169, s[64:67], s14 offen sc1
 buffer_load_dwordx4 a[180:183], v169, s[64:67], s14 offen offset:1024 sc1
 s_add_u32 s14, s13, 51200
 buffer_load_dwordx4 a[184:187], v169, s[64:67], s14 offen sc1
 buffer_load_dwordx4 a[188:191], v169, s[64:67], s14 offen offset:1024 sc1
 s_add_u32 s14, s13, 53248
 buffer_load_dwordx4 a[192:195], v169, s[64:67], s14 offen sc1
 buffer_load_dwordx4 a[196:199], v169, s[64:67], s14 offen offset:1024 sc1
 s_add_u32 s14, s13, 55296
 buffer_load_dwordx4 a[200:203], v169, s[64:67], s14 offen sc1
 buffer_load_dwordx4 a[204:207], v169, s[64:67], s14 offen offset:1024 sc1
 s_add_u32 s14, s13, 43008
 buffer_load_dwordx4 a[208:211], v169, s[64:67], s14 offen sc1
 buffer_load_dwordx4 a[212:215], v169, s[64:67], s14 offen offset:1024 sc1
 s_add_u32 s14, s13, 45056
 buffer_load_dwordx4 a[216:219], v169, s[64:67], s14 offen sc1
 buffer_load_dwordx4 a[220:223], v169, s[64:67], s14 offen offset:1024 sc1
 s_add_u32 s14, s13, 61440
 buffer_load_dwordx4 a[224:227], v169, s[64:67], s14 offen sc1
 buffer_load_dwordx4 a[228:231], v169, s[64:67], s14 offen offset:1024 sc1
 s_add_u32 s14, s13, 63488
 buffer_load_dwordx4 a[232:235], v169, s[64:67], s14 offen sc1
 buffer_load_dwordx4 a[236:239], v169, s[64:67], s14 offen offset:1024 sc1
 s_add_u32 s14, s13, 65536
 buffer_load_dwordx4 a[240:243], v169, s[64:67], s14 offen sc1
 buffer_load_dwordx4 a[244:247], v169, s[64:67], s14 offen offset:1024 sc1
 s_add_u32 s14, s13, 67584
 buffer_load_dwordx4 a[248:251], v169, s[64:67], s14 offen sc1
 buffer_load_dwordx4 a[252:255], v169, s[64:67], s14 offen offset:1024 sc1
 s_add_u32 s14, s13, 69632
 buffer_load_dwordx4 v[176:179], v169, s[64:67], s14 offen sc1
 buffer_load_dwordx4 v[180:183], v169, s[64:67], s14 offen offset:1024 sc1
 s_add_u32 s14, s13, 57344
 buffer_load_dwordx4 v[184:187], v169, s[64:67], s14 offen sc1
 buffer_load_dwordx4 v[188:191], v169, s[64:67], s14 offen offset:1024 sc1
 s_add_u32 s14, s13, 59392
 buffer_load_dwordx4 v[192:195], v169, s[64:67], s14 offen sc1
 buffer_load_dwordx4 v[196:199], v169, s[64:67], s14 offen offset:1024 sc1
 s_add_u32 s14, s13, 75776
 buffer_load_dwordx4 v[200:203], v169, s[64:67], s14 offen sc1
 buffer_load_dwordx4 v[204:207], v169, s[64:67], s14 offen offset:1024 sc1
 s_add_u32 s14, s13, 77824
 buffer_load_dwordx4 v[208:211], v169, s[64:67], s14 offen sc1
 buffer_load_dwordx4 v[212:215], v169, s[64:67], s14 offen offset:1024 sc1
 s_add_u32 s14, s13, 79872
 buffer_load_dwordx4 v[216:219], v169, s[64:67], s14 offen sc1
 buffer_load_dwordx4 v[220:223], v169, s[64:67], s14 offen offset:1024 sc1
 s_add_u32 s14, s13, 81920
 buffer_load_dwordx4 v[224:227], v169, s[64:67], s14 offen sc1
 buffer_load_dwordx4 v[228:231], v169, s[64:67], s14 offen offset:1024 sc1
 s_add_u32 s14, s13, 83968
 buffer_load_dwordx4 v[232:235], v169, s[64:67], s14 offen sc1
 buffer_load_dwordx4 v[236:239], v169, s[64:67], s14 offen offset:1024 sc1
 s_add_u32 s14, s13, 71680
 buffer_load_dwordx4 v[240:243], v169, s[64:67], s14 offen sc1
 buffer_load_dwordx4 v[244:247], v169, s[64:67], s14 offen offset:1024 sc1
 s_add_u32 s14, s13, 73728
 buffer_load_dwordx4 v[248:251], v169, s[64:67], s14 offen sc1
 buffer_load_dwordx4 v[252:255], v169, s[64:67], s14 offen offset:1024 sc1
 s_add_u32 m0, s15, 0
 s_add_u32 s14, s13, 86016
 buffer_load_dwordx4 v169, s[64:67], s14 offen sc1 lds
 buffer_load_dwordx4 v169, s[64:67], s14 offen offset:1024 sc1 lds
 buffer_load_dwordx4 v169, s[64:67], s14 offen offset:2048 sc1 lds
 buffer_load_dwordx4 v169, s[64:67], s14 offen offset:3072 sc1 lds
 s_add_u32 m0, s15, 4096
 s_add_u32 s14, s13, 90112
 buffer_load_dwordx4 v169, s[64:67], s14 offen sc1 lds
 buffer_load_dwordx4 v169, s[64:67], s14 offen offset:1024 sc1 lds
 buffer_load_dwordx4 v169, s[64:67], s14 offen offset:2048 sc1 lds
 buffer_load_dwordx4 v169, s[64:67], s14 offen offset:3072 sc1 lds
 s_add_u32 m0, s15, 8192
 s_add_u32 s14, s13, 94208
 buffer_load_dwordx4 v169, s[64:67], s14 offen sc1 lds
 buffer_load_dwordx4 v169, s[64:67], s14 offen offset:1024 sc1 lds
 buffer_load_dwordx4 v169, s[64:67], s14 offen offset:2048 sc1 lds
 buffer_load_dwordx4 v169, s[64:67], s14 offen offset:3072 sc1 lds
 s_add_u32 m0, s15, 12288
 s_add_u32 s14, s13, 98304
 buffer_load_dwordx4 v169, s[64:67], s14 offen sc1 lds
 buffer_load_dwordx4 v169, s[64:67], s14 offen offset:1024 sc1 lds
 buffer_load_dwordx4 v169, s[64:67], s14 offen offset:2048 sc1 lds
 buffer_load_dwordx4 v169, s[64:67], s14 offen offset:3072 sc1 lds
 s_add_u32 m0, s15, 16384
 s_add_u32 s14, s13, 102400
 buffer_load_dwordx4 v169, s[64:67], s14 offen sc1 lds
 buffer_load_dwordx4 v169, s[64:67], s14 offen offset:1024 sc1 lds
 buffer_load_dwordx4 v169, s[64:67], s14 offen offset:2048 sc1 lds
 buffer_load_dwordx4 v169, s[64:67], s14 offen offset:3072 sc1 lds
 s_add_u32 m0, s15, 20480
 s_add_u32 s14, s13, 106496
 buffer_load_dwordx4 v169, s[64:67], s14 offen sc1 lds
 buffer_load_dwordx4 v169, s[64:67], s14 offen offset:1024 sc1 lds
 buffer_load_dwordx4 v169, s[64:67], s14 offen offset:2048 sc1 lds
 buffer_load_dwordx4 v169, s[64:67], s14 offen offset:3072 sc1 lds
 s_add_u32 m0, s15, 24576
 s_add_u32 s14, s13, 110592
 buffer_load_dwordx4 v169, s[64:67], s14 offen sc1 lds
 buffer_load_dwordx4 v169, s[64:67], s14 offen offset:1024 sc1 lds
 buffer_load_dwordx4 v169, s[64:67], s14 offen offset:2048 sc1 lds
 buffer_load_dwordx4 v169, s[64:67], s14 offen offset:3072 sc1 lds
 v_add_u32 v175, 40960, v169
 v_bfe_u32 v5, v0, 1, 1
 v_mov_b32 v6, 0x4444
 v_mov_b32 v7, 0xeeee
 v_cmp_eq_u32 vcc, 1, v5
 s_nop 1
 v_cndmask_b32 v168, v6, v7, vcc
 v_lshrrev_b32 v1, 4, v0
 v_and_b32 v2, 15, v0
 v_lshrrev_b32 v4, 2, v2
 v_lshlrev_b32 v4, 8, v4
 v_add_u32 v4, 4096, v4
 v_and_b32 v6, 3, v0
 v_lshl_add_u32 v171, v6, 3, v4
 v_lshl_add_u32 v171, v1, 10, v171
 v_add_u32 v171, 128, v171
 v_lshl_add_u32 v4, v6, 4, v4
 v_lshrrev_b32 v6, 1, v1
 v_lshl_add_u32 v4, v6, 10, v4
 v_and_b32 v6, 1, v1
 v_lshl_add_u32 v170, v6, 6, v4
 v_mul_u32_u24 v4, 320, v1
 v_lshlrev_b32 v6, 2, v2
 v_add_u32 v4, v4, v6
 v_add_u32 v172, 8448, v4
 v_lshlrev_b32 v4, 1, v1
 v_bfe_u32 v6, v0, 2, 1
 v_add_u32 v4, v4, v6
 v_mul_u32_u24 v4, 160, v4
 v_bfe_u32 v6, v0, 3, 1
 v_lshlrev_b32 v6, 5, v6
 v_and_b32 v7, 3, v0
 v_lshlrev_b32 v7, 3, v7
 v_add3_u32 v4, v4, v6, v7
 v_add_u32 v173, 7232, v4
 v_lshlrev_b32 v174, 2, v0
 v_add_u32 v174, 256, v174
 v_lshlrev_b32 v171, 3, v0
 v_add_u32 v171, 8704, v171
 v_lshrrev_b32 v4, 2, v2
 v_lshlrev_b32 v4, 7, v4
 v_add_u32 v4, 2048, v4
 v_and_b32 v6, 3, v0
 v_lshl_add_u32 v4, v6, 4, v4
 v_lshrrev_b32 v6, 1, v1
 v_lshl_add_u32 v4, v6, 9, v4
 v_and_b32 v6, 1, v1
 v_lshl_add_u32 v170, v6, 6, v4
 s_mov_b32 s34, 0xfffffffe
 v_mov_b32 v4, 0
 v_mov_b32 v5, 0
 s_mov_b32 s25, 50331648
 s_mov_b32 s26, 53485568
 s_mov_b32 s27, 50855936
 s_mul_i32 s13, s11, 32768
 s_add_u32 s24, s13, 12853248
 s_lshl_b32 s13, s11, 9
 s_add_u32 s28, s13, 50339840
 s_mov_b32 s29, 0x7ffffff0
 s_lshl_b32 s13, s11, 6
 s_add_u32 s33, s13, 52166660
 v_mov_b32 v36, 0
 v_mov_b32 v37, 0
 v_mov_b32 v38, 0
 v_mov_b32 v39, 0
 v_mov_b32 v40, 0
 v_mov_b32 v41, 0
 v_mov_b32 v42, 0
 v_mov_b32 v43, 0
 v_mov_b32 v44, 0
 v_mov_b32 v45, 0
 v_mov_b32 v46, 0
 v_mov_b32 v47, 0
 v_mov_b32 v48, 0
 v_mov_b32 v49, 0
 v_mov_b32 v50, 0
 v_mov_b32 v51, 0
 v_mov_b32 v52, 0
 v_mov_b32 v53, 0
 v_mov_b32 v54, 0
 v_mov_b32 v55, 0
 v_mov_b32 v56, 0
 v_mov_b32 v57, 0
 v_mov_b32 v58, 0
 v_mov_b32 v59, 0
 v_mov_b32 v60, 0
 v_mov_b32 v61, 0
 v_mov_b32 v62, 0
 v_mov_b32 v63, 0
 v_mov_b32 v64, 0
 v_mov_b32 v65, 0
 v_mov_b32 v66, 0
 v_mov_b32 v67, 0
 v_mov_b32 v128, 0
 v_mov_b32 v129, 0
 v_mov_b32 v130, 0
 v_mov_b32 v131, 0
 v_mov_b32 v132, 0
 v_mov_b32 v133, 0
 v_mov_b32 v134, 0
 v_mov_b32 v135, 0
 s_cmp_lg_u32 s12, 0
 s_cbranch_scc1 L_wg_38_done
 v_lshlrev_b32 v1, 7, v0
 s_mov_b32 s31, 0
 s_mov_b32 s3, 53501952
 s_mov_b32 exec_lo, 262143
 s_mov_b32 exec_hi, 1
L_wg_38:
 buffer_load_dword v2, v1, s[64:67], s3 offen sc1
 s_add_u32 s31, s31, 1
 s_cmp_gt_u32 s31, 524288
 s_cbranch_scc1 L_exit
 s_waitcnt vmcnt(0)
 v_cmp_eq_u32 vcc, 0, v2
 s_cbranch_vccz L_wg_38_ok
 s_sleep 4
 s_branch L_wg_38
L_wg_38_ok:
 s_mov_b64 exec, -1
L_wg_38_done:
 s_barrier
 s_mov_b32 s31, 0
 s_branch L_sp_39_go
L_sp_39:
 s_sleep 2
 s_add_u32 s31, s31, 1
 s_cmp_gt_u32 s31, 524288
 s_cbranch_scc1 L_exit
L_sp_39_go:
 buffer_load_dword v7, v4, s[64:67], s33 offen sc1
 s_waitcnt vmcnt(0)
 v_cmp_eq_u32 vcc, -1, v7
 s_cbranch_vccnz L_sp_39
 s_mov_b32 s30, 0
 s_waitcnt vmcnt(0) lgkmcnt(0)
 s_barrier
L_Bloop_40:
 s_add_u32 s20, s25, 2048
 s_add_u32 s21, s25, 3072
 s_mov_b32 s22, s27
 ds_read_b128 v[136:139], v175 offset:4096
 ds_read_b128 v[140:143], v175 offset:5120
 ds_read_b128 v[144:147], v175 offset:18432
 ds_read_b128 v[148:151], v175 offset:19456
 ds_read_b128 v[152:155], v175 offset:6144
 ds_read_b128 v[156:159], v175 offset:7168
 ds_read_b128 v[160:163], v175 offset:20480
 ds_read_b128 v[164:167], v175 offset:21504
 s_sleep 2
 s_mov_b32 s31, 0
 buffer_load_dwordx4 v[8:11], v169, s[64:67], s20 offen sc1
 buffer_load_dwordx4 v[12:15], v169, s[64:67], s21 offen sc1
 buffer_load_dword v7, v4, s[64:67], s33 offen sc1
L_fp_41_w:
 s_waitcnt vmcnt(0)
 v_max3_u32 v6, v8, v9, v10
 v_max3_u32 v6, v6, v11, v12
 v_max3_u32 v6, v6, v13, v14
 v_max3_u32 v6, v6, v15, v7
 v_cmp_eq_u32 vcc, -1, v6
 s_cbranch_vccnz L_fp_41
 s_waitcnt lgkmcnt(0)
 ds_write_b128 v169, v[8:11] offset:2048
 ds_write_b128 v169, v[12:15] offset:3072
 v_smfmac_f32_16x16x64_bf16 v[60:63], v[8:11], v[136:143], v168
 v_smfmac_f32_16x16x64_bf16 v[64:67], v[8:11], v[144:151], v168
 buffer_load_dwordx4 v[84:87], v169, s[64:67], s24 offen sc1
 v_smfmac_f32_16x16x64_bf16 v[36:39], v[8:11], a[0:7], v168
 v_smfmac_f32_16x16x64_bf16 v[40:43], v[8:11], a[56:63], v168
 buffer_load_dwordx4 v[88:91], v169, s[64:67], s24 offen offset:1024 sc1
 v_smfmac_f32_16x16x64_bf16 v[44:47], v[8:11], a[112:119], v168
 v_smfmac_f32_16x16x64_bf16 v[48:51], v[8:11], a[168:175], v168
 buffer_load_dwordx4 v[92:95], v169, s[64:67], s24 offen offset:2048 sc1
 v_smfmac_f32_16x16x64_bf16 v[52:55], v[8:11], a[224:231], v168
 v_smfmac_f32_16x16x64_bf16 v[56:59], v[8:11], v[200:207], v168
 buffer_load_dwordx4 v[96:99], v169, s[64:67], s24 offen offset:3072 sc1
 s_add_u32 s24, s24, 4096
 buffer_store_dword v5, v174, s[64:67], s29 offen sc1
 s_waitcnt lgkmcnt(0)
 s_barrier
 ds_read_b128 v[16:19], v169 offset:4096
 ds_read_b128 v[20:23], v169 offset:5120
 ds_read_b128 v[24:27], v169 offset:6144
 ds_read_b128 v[28:31], v169
 ds_read_b128 v[32:35], v169 offset:1024
 ds_read_b128 v[136:139], v175 offset:8192
 ds_read_b128 v[140:143], v175 offset:9216
 ds_read_b128 v[144:147], v175 offset:22528
 ds_read_b128 v[148:151], v175 offset:23552
 v_smfmac_f32_16x16x64_bf16 v[60:63], v[12:15], v[152:159], v168
 v_smfmac_f32_16x16x64_bf16 v[64:67], v[12:15], v[160:167], v168
 buffer_load_dwordx4 v[100:103], v169, s[64:67], s24 offen sc1
 v_smfmac_f32_16x16x64_bf16 v[36:39], v[12:15], a[8:15], v168
 ds_read_b128 v[152:155], v175 offset:10240
 v_smfmac_f32_16x16x64_bf16 v[40:43], v[12:15], a[64:71], v168
 ds_read_b128 v[156:159], v175 offset:11264
 buffer_load_dwordx4 v[104:107], v169, s[64:67], s24 offen offset:1024 sc1
 v_smfmac_f32_16x16x64_bf16 v[44:47], v[12:15], a[120:127], v168
 ds_read_b128 v[160:163], v175 offset:24576
 v_smfmac_f32_16x16x64_bf16 v[48:51], v[12:15], a[176:183], v168
 ds_read_b128 v[164:167], v175 offset:25600
 buffer_load_dwordx4 v[108:111], v169, s[64:67], s24 offen offset:2048 sc1
 v_smfmac_f32_16x16x64_bf16 v[52:55], v[12:15], a[232:239], v168
 v_smfmac_f32_16x16x64_bf16 v[56:59], v[12:15], v[208:215], v168
 buffer_load_dwordx4 v[112:115], v169, s[64:67], s24 offen offset:3072 sc1
 s_add_u32 s24, s24, 454656
 s_waitcnt lgkmcnt(4)
 v_smfmac_f32_16x16x64_bf16 v[60:63], v[16:19], v[136:143], v168
 v_smfmac_f32_16x16x64_bf16 v[64:67], v[16:19], v[144:151], v168
 v_smfmac_f32_16x16x64_bf16 v[36:39], v[16:19], a[16:23], v168
 ds_read_b128 v[136:139], v175 offset:12288
 v_smfmac_f32_16x16x64_bf16 v[40:43], v[16:19], a[72:79], v168
 ds_read_b128 v[140:143], v175 offset:13312
 v_smfmac_f32_16x16x64_bf16 v[44:47], v[16:19], a[128:135], v168
 ds_read_b128 v[144:147], v175 offset:26624
 v_smfmac_f32_16x16x64_bf16 v[48:51], v[16:19], a[184:191], v168
 ds_read_b128 v[148:151], v175 offset:27648
 v_smfmac_f32_16x16x64_bf16 v[52:55], v[16:19], a[240:247], v168
 v_smfmac_f32_16x16x64_bf16 v[56:59], v[16:19], v[216:223], v168
 s_waitcnt lgkmcnt(4)
 v_smfmac_f32_16x16x64_bf16 v[60:63], v[20:23], v[152:159], v168
 v_smfmac_f32_16x16x64_bf16 v[64:67], v[20:23], v[160:167], v168
 v_smfmac_f32_16x16x64_bf16 v[36:39], v[20:23], a[24:31], v168
 ds_read_b128 v[152:155], v175
 v_smfmac_f32_16x16x64_bf16 v[40:43], v[20:23], a[80:87], v168
 ds_read_b128 v[156:159], v175 offset:1024
 v_smfmac_f32_16x16x64_bf16 v[44:47], v[20:23], a[136:143], v168
 ds_read_b128 v[160:163], v175 offset:14336
 v_smfmac_f32_16x16x64_bf16 v[48:51], v[20:23], a[192:199], v168
 ds_read_b128 v[164:167], v175 offset:15360
 v_smfmac_f32_16x16x64_bf16 v[52:55], v[20:23], a[248:255], v168
 v_smfmac_f32_16x16x64_bf16 v[56:59], v[20:23], v[224:231], v168
 s_waitcnt lgkmcnt(4)
 v_smfmac_f32_16x16x64_bf16 v[60:63], v[24:27], v[136:143], v168
 v_smfmac_f32_16x16x64_bf16 v[64:67], v[24:27], v[144:151], v168
 v_smfmac_f32_16x16x64_bf16 v[36:39], v[24:27], a[32:39], v168
 ds_read_b128 v[136:139], v175 offset:2048
 v_smfmac_f32_16x16x64_bf16 v[40:43], v[24:27], a[88:95], v168
 ds_read_b128 v[140:143], v175 offset:3072
 v_smfmac_f32_16x16x64_bf16 v[44:47], v[24:27], a[144:151], v168
 ds_read_b128 v[144:147], v175 offset:16384
 v_smfmac_f32_16x16x64_bf16 v[48:51], v[24:27], a[200:207], v168
 ds_read_b128 v[148:151], v175 offset:17408
 v_smfmac_f32_16x16x64_bf16 v[52:55], v[24:27], v[176:183], v168
 v_smfmac_f32_16x16x64_bf16 v[56:59], v[24:27], v[232:239], v168
 s_waitcnt lgkmcnt(4)
 v_smfmac_f32_16x16x64_bf16 v[60:63], v[28:31], v[152:159], v168
 v_smfmac_f32_16x16x64_bf16 v[64:67], v[28:31], v[160:167], v168
 v_smfmac_f32_16x16x64_bf16 v[36:39], v[28:31], a[40:47], v168
 v_smfmac_f32_16x16x64_bf16 v[40:43], v[28:31], a[96:103], v168
 v_smfmac_f32_16x16x64_bf16 v[44:47], v[28:31], a[152:159], v168
 v_smfmac_f32_16x16x64_bf16 v[48:51], v[28:31], a[208:215], v168
 v_smfmac_f32_16x16x64_bf16 v[52:55], v[28:31], v[184:191], v168
 v_smfmac_f32_16x16x64_bf16 v[56:59], v[28:31], v[240:247], v168
 s_waitcnt lgkmcnt(0)
 v_smfmac_f32_16x16x64_bf16 v[60:63], v[32:35], v[136:143], v168
 v_smfmac_f32_16x16x64_bf16 v[64:67], v[32:35], v[144:151], v168
 v_smfmac_f32_16x16x64_bf16 v[36:39], v[32:35], a[48:55], v168
 v_smfmac_f32_16x16x64_bf16 v[40:43], v[32:35], a[104:111], v168
 v_smfmac_f32_16x16x64_bf16 v[44:47], v[32:35], a[160:167], v168
 v_smfmac_f32_16x16x64_bf16 v[48:51], v[32:35], a[216:223], v168
 v_smfmac_f32_16x16x64_bf16 v[52:55], v[32:35], v[192:199], v168
 v_smfmac_f32_16x16x64_bf16 v[56:59], v[32:35], v[248:255], v168
 s_nop 0
 v_pk_add_f32 v[60:61], v[60:61], v[62:63]
 v_pk_add_f32 v[64:65], v[64:65], v[66:67]
 v_pk_add_f32 v[36:37], v[36:37], v[38:39]
 v_pk_add_f32 v[40:41], v[40:41], v[42:43]
 v_pk_add_f32 v[44:45], v[44:45], v[46:47]
 v_pk_add_f32 v[48:49], v[48:49], v[50:51]
 v_pk_add_f32 v[52:53], v[52:53], v[54:55]
 v_pk_add_f32 v[56:57], v[56:57], v[58:59]
 v_cvt_pk_bf16_f32 v71, v60, v61
 v_cvt_pk_bf16_f32 v75, v64, v65
 v_cvt_pk_bf16_f32 v68, v36, v37
 v_cvt_pk_bf16_f32 v72, v40, v41
 v_cvt_pk_bf16_f32 v70, v44, v45
 v_cvt_pk_bf16_f32 v74, v48, v49
 v_cvt_pk_bf16_f32 v69, v52, v53
 v_cvt_pk_bf16_f32 v73, v56, v57
 s_nop 0
 v_permlane32_swap_b32 v68, v69
 v_permlane32_swap_b32 v70, v71
 v_permlane32_swap_b32 v72, v73
 v_permlane32_swap_b32 v74, v75
 v_permlane16_swap_b32 v68, v70
 v_permlane16_swap_b32 v69, v71
 v_permlane16_swap_b32 v72, v74
 v_permlane16_swap_b32 v73, v75
 s_sleep 2
 s_mov_b32 s31, 0
 buffer_load_dwordx4 v[116:119], v170, s[64:67], s22 offen sc1
 buffer_load_dwordx4 v[120:123], v170, s[64:67], s22 offen offset:1024 sc1
 buffer_load_dwordx2 v[124:125], v171, s[64:67], s22 offen sc1
 s_nop 15
 s_nop 15
 buffer_load_dwordx4 v[116:119], v170, s[64:67], s22 offen sc1
 buffer_load_dwordx4 v[120:123], v170, s[64:67], s22 offen offset:1024 sc1
 buffer_load_dwordx2 v[124:125], v171, s[64:67], s22 offen sc1
L_q2_42_w:
 s_waitcnt vmcnt(3)
 v_max3_u32 v6, v119, v123, v124
 v_max_u32 v6, v6, v125
 v_cmp_eq_u32 vcc, -1, v6
 v_smfmac_f32_16x16x32_bf16 v[128:131], v[124:125], v[68:71], v168
 v_smfmac_f32_16x16x32_bf16 v[132:135], v[124:125], v[72:75], v168
 s_cbranch_vccnz L_q2_42
 s_nop 3
 v_smfmac_f32_16x16x64_bf16 v[128:131], v[116:119], v[84:91], v168
 v_smfmac_f32_16x16x64_bf16 v[128:131], v[120:123], v[100:107], v168
 v_smfmac_f32_16x16x64_bf16 v[132:135], v[116:119], v[92:99], v168
 v_smfmac_f32_16x16x64_bf16 v[132:135], v[120:123], v[108:115], v168
 s_nop 5
 v_pk_add_f32 v[128:129], v[128:129], v[130:131]
 ds_write2_b32 v172, v128, v129 offset0:0 offset1:40
 v_pk_add_f32 v[132:133], v[132:133], v[134:135]
 ds_write2_b32 v172, v132, v133 offset0:16 offset1:56
 s_waitcnt lgkmcnt(0)
 s_barrier
 ds_read_b64 v[36:37], v173
 ds_read_b64 v[38:39], v173 offset:1280
 ds_read_b64 v[40:41], v173 offset:2560
 ds_read_b64 v[42:43], v173 offset:3840
 s_waitcnt lgkmcnt(2)
 v_pk_add_f32 v[36:37], v[36:37], v[38:39]
 s_waitcnt lgkmcnt(0)
 v_pk_add_f32 v[40:41], v[40:41], v[42:43]
 v_pk_add_f32 v[36:37], v[36:37], v[40:41]
 v_cvt_pk_bf16_f32 v5, v36, v37
 v_min_u32 v5, s34, v5
 buffer_store_dword v5, v174, s[64:67], s28 offen
 s_add_u32 s29, s28, 2098176
 s_add_u32 s28, s28, 8192
 s_cmp_eq_u32 s30, 62
 s_cbranch_scc1 L_Bloop_40_x
 v_mov_b32 v36, 0
 v_mov_b32 v37, 0
 v_mov_b32 v38, 0
 v_mov_b32 v39, 0
 v_mov_b32 v40, 0
 v_mov_b32 v41, 0
 v_mov_b32 v42, 0
 v_mov_b32 v43, 0
 v_mov_b32 v44, 0
 v_mov_b32 v45, 0
 v_mov_b32 v46, 0
 v_mov_b32 v47, 0
 v_mov_b32 v48, 0
 v_mov_b32 v49, 0
 v_mov_b32 v50, 0
 v_mov_b32 v51, 0
 v_mov_b32 v52, 0
 v_mov_b32 v53, 0
 v_mov_b32 v54, 0
 v_mov_b32 v55, 0
 v_mov_b32 v56, 0
 v_mov_b32 v57, 0
 v_mov_b32 v58, 0
 v_mov_b32 v59, 0
 v_mov_b32 v60, 0
 v_mov_b32 v61, 0
 v_mov_b32 v62, 0
 v_mov_b32 v63, 0
 v_mov_b32 v64, 0
 v_mov_b32 v65, 0
 v_mov_b32 v66, 0
 v_mov_b32 v67, 0
 v_mov_b32 v128, 0
 v_mov_b32 v129, 0
 v_mov_b32 v130, 0
 v_mov_b32 v131, 0
 v_mov_b32 v132, 0
 v_mov_b32 v133, 0
 v_mov_b32 v134, 0
 v_mov_b32 v135, 0
 s_add_u32 s25, s25, 8192
 s_add_u32 s26, s25, 2098176
 s_add_u32 s27, s27, 10240
 s_add_u32 s33, s33, 1024
 s_add_u32 s30, s30, 1
 s_cmp_lt_u32 s30, 63
 s_cbranch_scc1 L_Bloop_40
L_Bloop_40_x:
 buffer_store_dword v5, v174, s[64:67], s29 offen sc1
 s_branch L_exit
L_fp_41:
 s_add_u32 s31, s31, 1
 s_cmp_ge_u32 s31, 48
 s_cbranch_scc1 L_fp_41_sw
L_fp_41_r:
 buffer_load_dwordx4 v[8:11], v169, s[64:67], s20 offen sc1
 buffer_load_dwordx4 v[12:15], v169, s[64:67], s21 offen sc1
 buffer_load_dword v7, v4, s[64:67], s33 offen sc1
 s_branch L_fp_41_w
L_fp_41_sw:
 s_cmp_gt_u32 s31, 524288
 s_cbranch_scc1 L_exit
 s_cmp_lg_u32 s31, 48
 s_cbranch_scc1 L_fp_41_r
 s_waitcnt vmcnt(0)
 buffer_store_dword v5, v174, s[64:67], s29 offen sc1
 s_add_u32 s20, s26, 2048
 s_add_u32 s21, s26, 3072
 s_branch L_fp_41_r
L_q2_42:
 buffer_load_dwordx4 v[116:119], v170, s[64:67], s22 offen sc1
 buffer_load_dwordx4 v[120:123], v170, s[64:67], s22 offen offset:1024 sc1
 buffer_load_dwordx2 v[124:125], v171, s[64:67], s22 offen sc1
 s_nop 2
 v_mov_b32 v128, 0
 v_mov_b32 v129, 0
 v_mov_b32 v130, 0
 v_mov_b32 v131, 0
 v_mov_b32 v132, 0
 v_mov_b32 v133, 0
 v_mov_b32 v134, 0
 v_mov_b32 v135, 0
 s_add_u32 s31, s31, 1
 s_cmp_lt_u32 s31, 64
 s_cbranch_scc1 L_q2_42_w
 s_cmp_gt_u32 s31, 524288
 s_cbranch_scc1 L_exit
 s_cmp_lg_u32 s31, 64
 s_cbranch_scc1 L_q2_42_w
 s_waitcnt vmcnt(0)
 s_add_u32 s22, s27, 655360
 buffer_load_dwordx4 v[116:119], v170, s[64:67], s22 offen sc1
 buffer_load_dwordx4 v[120:123], v170, s[64:67], s22 offen offset:1024 sc1
 buffer_load_dwordx2 v[124:125], v171, s[64:67], s22 offen sc1
 buffer_load_dwordx4 v[116:119], v170, s[64:67], s22 offen sc1
 buffer_load_dwordx4 v[120:123], v170, s[64:67], s22 offen offset:1024 sc1
 buffer_load_dwordx2 v[124:125], v171, s[64:67], s22 offen sc1
 s_branch L_q2_42_w
L_pad8:
 s_setpc_b64 s[94:95]
L_B2:
 v_lshlrev_b32 v169, 4, v0
 s_mul_i32 s13, s11, 458752
 s_add_u32 s13, s13, 6651904
 s_mov_b32 s15, 69632
 s_add_u32 s14, s13, 8192
 buffer_load_dwordx4 a[0:3], v169, s[64:67], s14 offen sc1
 buffer_load_dwordx4 a[4:7], v169, s[64:67], s14 offen offset:1024 sc1
 s_add_u32 s14, s13, 10240
 buffer_load_dwordx4 a[8:11], v169, s[64:67], s14 offen sc1
 buffer_load_dwordx4 a[12:15], v169, s[64:67], s14 offen offset:1024 sc1
 s_add_u32 s14, s13, 12288
 buffer_load_dwordx4 a[16:19], v169, s[64:67], s14 offen sc1
 buffer_load_dwordx4 a[20:23], v169, s[64:67], s14 offen offset:1024 sc1
 s_add_u32 s14, s13, 0
 buffer_load_dwordx4 a[24:27], v169, s[64:67], s14 offen sc1
 buffer_load_dwordx4 a[28:31], v169, s[64:67], s14 offen offset:1024 sc1
 s_add_u32 s14, s13, 2048
 buffer_load_dwordx4 a[32:35], v169, s[64:67], s14 offen sc1
 buffer_load_dwordx4 a[36:39], v169, s[64:67], s14 offen offset:1024 sc1
 s_add_u32 s14, s13, 4096
 buffer_load_dwordx4 a[40:43], v169, s[64:67], s14 offen sc1
 buffer_load_dwordx4 a[44:47], v169, s[64:67], s14 offen offset:1024 sc1
 s_add_u32 s14, s13, 6144
 buffer_load_dwordx4 a[48:51], v169, s[64:67], s14 offen sc1
 buffer_load_dwordx4 a[52:55], v169, s[64:67], s14 offen offset:1024 sc1
 s_add_u32 s14, s13, 22528
 buffer_load_dwordx4 a[56:59], v169, s[64:67], s14 offen sc1
 buffer_load_dwordx4 a[60:63], v169, s[64:67], s14 offen offset:1024 sc1
 s_add_u32 s14, s13, 24576
 buffer_load_dwordx4 a[64:67], v169, s[64:67], s14 offen sc1
 buffer_load_dwordx4 a[68:71], v169, s[64:67], s14 offen offset:1024 sc1
 s_add_u32 s14, s13, 26624
 buffer_load_dwordx4 a[72:75], v169, s[64:67], s14 offen sc1
 buffer_load_dwordx4 a[76:79], v169, s[64:67], s14 offen offset:1024 sc1
 s_add_u32 s14, s13, 14336
 buffer_load_dwordx4 a[80:83], v169, s[64:67], s14 offen sc1
 buffer_load_dwordx4 a[84:87], v169, s[64:67], s14 offen offset:1024 sc1
 s_add_u32 s14, s13, 16384
 buffer_load_dwordx4 a[88:91], v169, s[64:67], s14 offen sc1
 buffer_load_dwordx4 a[92:95], v169, s[64:67], s14 offen offset:1024 sc1
 s_add_u32 s14, s13, 18432
 buffer_load_dwordx4 a[96:99], v169, s[64:67], s14 offen sc1
 buffer_load_dwordx4 a[100:103], v169, s[64:67], s14 offen offset:1024 sc1
 s_add_u32 s14, s13, 20480
 buffer_load_dwordx4 a[104:107], v169, s[64:67], s14 offen sc1
 buffer_load_dwordx4 a[108:111], v169, s[64:67], s14 offen offset:1024 sc1
 s_add_u32 s14, s13, 36864
 buffer_load_dwordx4 a[112:115], v169, s[64:67], s14 offen sc1
 buffer_load_dwordx4 a[116:119], v169, s[64:67], s14 offen offset:1024 sc1
 s_add_u32 s14, s13, 38912
 buffer_load_dwordx4 a[120:123], v169, s[64:67], s14 offen sc1
 buffer_load_dwordx4 a[124:127], v169, s[64:67], s14 offen offset:1024 sc1
 s_add_u32 s14, s13, 40960
 buffer_load_dwordx4 a[128:131], v169, s[64:67], s14 offen sc1
 buffer_load_dwordx4 a[132:135], v169, s[64:67], s14 offen offset:1024 sc1
 s_add_u32 s14, s13, 28672
 buffer_load_dwordx4 a[136:139], v169, s[64:67], s14 offen sc1
 buffer_load_dwordx4 a[140:143], v169, s[64:67], s14 offen offset:1024 sc1
 s_add_u32 s14, s13, 30720
 buffer_load_dwordx4 a[144:147], v169, s[64:67], s14 offen sc1
 buffer_load_dwordx4 a[148:151], v169, s[64:67], s14 offen offset:1024 sc1
 s_add_u32 s14, s13, 32768
 buffer_load_dwordx4 a[152:155], v169, s[64:67], s14 offen sc1
 buffer_load_dwordx4 a[156:159], v169, s[64:67], s14 offen offset:1024 sc1
 s_add_u32 s14, s13, 34816
 buffer_load_dwordx4 a[160:163], v169, s[64:67], s14 offen sc1
 buffer_load_dwordx4 a[164:167], v169, s[64:67], s14 offen offset:1024 sc1
 s_add_u32 s14, s13, 51200
 buffer_load_dwordx4 a[168:171], v169, s[64:67], s14 offen sc1
 buffer_load_dwordx4 a[172:175], v169, s[64:67], s14 offen offset:1024 sc1
 s_add_u32 s14, s13, 53248
 buffer_load_dwordx4 a[176:179], v169, s[64:67], s14 offen sc1
 buffer_load_dwordx4 a[180:183], v169, s[64:67], s14 offen offset:1024 sc1
 s_add_u32 s14, s13, 55296
 buffer_load_dwordx4 a[184:187], v169, s[64:67], s14 offen sc1
 buffer_load_dwordx4 a[188:191], v169, s[64:67], s14 offen offset:1024 sc1
 s_add_u32 s14, s13, 43008
 buffer_load_dwordx4 a[192:195], v169, s[64:67], s14 offen sc1
 buffer_load_dwordx4 a[196:199], v169, s[64:67], s14 offen offset:1024 sc1
 s_add_u32 s14, s13, 45056
 buffer_load_dwordx4 a[200:203], v169, s[64:67], s14 offen sc1
 buffer_load_dwordx4 a[204:207], v169, s[64:67], s14 offen offset:1024 sc1
 s_add_u32 s14, s13, 47104
 buffer_load_dwordx4 a[208:211], v169, s[64:67], s14 offen sc1
 buffer_load_dwordx4 a[212:215], v169, s[64:67], s14 offen offset:1024 sc1
 s_add_u32 s14, s13, 49152
 buffer_load_dwordx4 a[216:219], v169, s[64:67], s14 offen sc1
 buffer_load_dwordx4 a[220:223], v169, s[64:67], s14 offen offset:1024 sc1
 s_add_u32 s14, s13, 65536
 buffer_load_dwordx4 a[224:227], v169, s[64:67], s14 offen sc1
 buffer_load_dwordx4 a[228:231], v169, s[64:67], s14 offen offset:1024 sc1
 s_add_u32 s14, s13, 67584
 buffer_load_dwordx4 a[232:235], v169, s[64:67], s14 offen sc1
 buffer_load_dwordx4 a[236:239], v169, s[64:67], s14 offen offset:1024 sc1
 s_add_u32 s14, s13, 69632
 buffer_load_dwordx4 a[240:243], v169, s[64:67], s14 offen sc1
 buffer_load_dwordx4 a[244:247], v169, s[64:67], s14 offen offset:1024 sc1
 s_add_u32 s14, s13, 57344
 buffer_load_dwordx4 a[248:251], v169, s[64:67], s14 offen sc1
 buffer_load_dwordx4 a[252:255], v169, s[64:67], s14 offen offset:1024 sc1
 s_add_u32 s14, s13, 59392
 buffer_load_dwordx4 v[176:179], v169, s[64:67], s14 offen sc1
 buffer_load_dwordx4 v[180:183], v169, s[64:67], s14 offen offset:1024 sc1
 s_add_u32 s14, s13, 61440
 buffer_load_dwordx4 v[184:187], v169, s[64:67], s14 offen sc1
 buffer_load_dwordx4 v[188:191], v169, s[64:67], s14 offen offset:1024 sc1
 s_add_u32 s14, s13, 63488
 buffer_load_dwordx4 v[192:195], v169, s[64:67], s14 offen sc1
 buffer_load_dwordx4 v[196:199], v169, s[64:67], s14 offen offset:1024 sc1
 s_add_u32 s14, s13, 79872
 buffer_load_dwordx4 v[200:203], v169, s[64:67], s14 offen sc1
 buffer_load_dwordx4 v[204:207], v169, s[64:67], s14 offen offset:1024 sc1
 s_add_u32 s14, s13, 81920
 buffer_load_dwordx4 v[208:211], v169, s[64:67], s14 offen sc1
 buffer_load_dwordx4 v[212:215], v169, s[64:67], s14 offen offset:1024 sc1
 s_add_u32 s14, s13, 83968
 buffer_load_dwordx4 v[216:219], v169, s[64:67], s14 offen sc1
 buffer_load_dwordx4 v[220:223], v169, s[64:67], s14 offen offset:1024 sc1
 s_add_u32 s14, s13, 71680
 buffer_load_dwordx4 v[224:227], v169, s[64:67], s14 offen sc1
 buffer_load_dwordx4 v[228:231], v169, s[64:67], s14 offen offset:1024 sc1
 s_add_u32 s14, s13, 73728
 buffer_load_dwordx4 v[232:235], v169, s[64:67], s14 offen sc1
 buffer_load_dwordx4 v[236:239], v169, s[64:67], s14 offen offset:1024 sc1
 s_add_u32 s14, s13, 75776
 buffer_load_dwordx4 v[240:243], v169, s[64:67], s14 offen sc1
 buffer_load_dwordx4 v[244:247], v169, s[64:67], s14 offen offset:1024 sc1
 s_add_u32 s14, s13, 77824
 buffer_load_dwordx4 v[248:251], v169, s[64:67], s14 offen sc1
 buffer_load_dwordx4 v[252:255], v169, s[64:67], s14 offen offset:1024 sc1
 s_add_u32 m0, s15, 0
 s_add_u32 s14, s13, 86016
 buffer_load_dwordx4 v169, s[64:67], s14 offen sc1 lds
 buffer_load_dwordx4 v169, s[64:67], s14 offen offset:1024 sc1 lds
 buffer_load_dwordx4 v169, s[64:67], s14 offen offset:2048 sc1 lds
 buffer_load_dwordx4 v169, s[64:67], s14 offen offset:3072 sc1 lds
 s_add_u32 m0, s15, 4096
 s_add_u32 s14, s13, 90112
 buffer_load_dwordx4 v169, s[64:67], s14 offen sc1 lds
 buffer_load_dwordx4 v169, s[64:67], s14 offen offset:1024 sc1 lds
 buffer_load_dwordx4 v169, s[64:67], s14 offen offset:2048 sc1 lds
 buffer_load_dwordx4 v169, s[64:67], s14 offen offset:3072 sc1 lds
 s_add_u32 m0, s15, 8192
 s_add_u32 s14, s13, 94208
 buffer_load_dwordx4 v169, s[64:67], s14 offen sc1 lds
 buffer_load_dwordx4 v169, s[64:67], s14 offen offset:1024 sc1 lds
 buffer_load_dwordx4 v169, s[64:67], s14 offen offset:2048 sc1 lds
 buffer_load_dwordx4 v169, s[64:67], s14 offen offset:3072 sc1 lds
 s_add_u32 m0, s15, 12288
 s_add_u32 s14, s13, 98304
 buffer_load_dwordx4 v169, s[64:67], s14 offen sc1 lds
 buffer_load_dwordx4 v169, s[64:67], s14 offen offset:1024 sc1 lds
 buffer_load_dwordx4 v169, s[64:67], s14 offen offset:2048 sc1 lds
 buffer_load_dwordx4 v169, s[64:67], s14 offen offset:3072 sc1 lds
 s_add_u32 m0, s15, 16384
 s_add_u32 s14, s13, 102400
 buffer_load_dwordx4 v169, s[64:67], s14 offen sc1 lds
 buffer_load_dwordx4 v169, s[64:67], s14 offen offset:1024 sc1 lds
 buffer_load_dwordx4 v169, s[64:67], s14 offen offset:2048 sc1 lds
 buffer_load_dwordx4 v169, s[64:67], s14 offen offset:3072 sc1 lds
 s_add_u32 m0, s15, 20480
 s_add_u32 s14, s13, 106496
 buffer_load_dwordx4 v169, s[64:67], s14 offen sc1 lds
 buffer_load_dwordx4 v169, s[64:67], s14 offen offset:1024 sc1 lds
 buffer_load_dwordx4 v169, s[64:67], s14 offen offset:2048 sc1 lds
 buffer_load_dwordx4 v169, s[64:67], s14 offen offset:3072 sc1 lds
 s_add_u32 m0, s15, 24576
 s_add_u32 s14, s13, 110592
 buffer_load_dwordx4 v169, s[64:67], s14 offen sc1 lds
 buffer_load_dwordx4 v169, s[64:67], s14 offen offset:1024 sc1 lds
 buffer_load_dwordx4 v169, s[64:67], s14 offen offset:2048 sc1 lds
 buffer_load_dwordx4 v169, s[64:67], s14 offen offset:3072 sc1 lds
 v_add_u32 v175, 69632, v169
 v_bfe_u32 v5, v0, 1, 1
 v_mov_b32 v6, 0x4444
 v_mov_b32 v7, 0xeeee
 v_cmp_eq_u32 vcc, 1, v5
 s_nop 1
 v_cndmask_b32 v168, v6, v7, vcc
 v_lshrrev_b32 v1, 4, v0
 v_and_b32 v2, 15, v0
 v_lshrrev_b32 v4, 2, v2
 v_lshlrev_b32 v4, 8, v4
 v_add_u32 v4, 8192, v4
 v_and_b32 v6, 3, v0
 v_lshl_add_u32 v171, v6, 3, v4
 v_lshl_add_u32 v171, v1, 10, v171
 v_add_u32 v171, 128, v171
 v_lshl_add_u32 v4, v6, 4, v4
 v_lshrrev_b32 v6, 1, v1
 v_lshl_add_u32 v4, v6, 10, v4
 v_and_b32 v6, 1, v1
 v_lshl_add_u32 v170, v6, 6, v4
 v_mul_u32_u24 v4, 320, v1
 v_lshlrev_b32 v6, 2, v2
 v_add_u32 v4, v4, v6
 v_add_u32 v172, 9728, v4
 v_lshlrev_b32 v4, 1, v1
 v_bfe_u32 v6, v0, 2, 1
 v_add_u32 v4, v4, v6
 v_mul_u32_u24 v4, 160, v4
 v_bfe_u32 v6, v0, 3, 1
 v_lshlrev_b32 v6, 5, v6
 v_and_b32 v7, 3, v0
 v_lshlrev_b32 v7, 3, v7
 v_add3_u32 v4, v4, v6, v7
 v_add_u32 v173, 7168, v4
 v_lshlrev_b32 v174, 2, v0
 v_add_u32 v174, 0, v174
 v_lshlrev_b32 v171, 3, v0
 v_add_u32 v171, 9216, v171
 v_lshrrev_b32 v4, 2, v2
 v_lshlrev_b32 v4, 7, v4
 v_add_u32 v4, 4096, v4
 v_and_b32 v6, 3, v0
 v_lshl_add_u32 v4, v6, 4, v4
 v_lshrrev_b32 v6, 1, v1
 v_lshl_add_u32 v4, v6, 9, v4
 v_and_b32 v6, 1, v1
 v_lshl_add_u32 v170, v6, 6, v4
 s_mov_b32 s34, 0xfffffffe
 v_mov_b32 v4, 0
 v_mov_b32 v5, 0
 s_mov_b32 s25, 50331648
 s_mov_b32 s26, 53485568
 s_mov_b32 s27, 50855936
 s_mul_i32 s13, s11, 32768
 s_add_u32 s24, s13, 12861440
 s_lshl_b32 s13, s11, 9
 s_add_u32 s28, s13, 50339840
 s_mov_b32 s29, 0x7ffffff0
 s_lshl_b32 s13, s11, 6
 s_add_u32 s33, s13, 52166664
 v_mov_b32 v36, 0
 v_mov_b32 v37, 0
 v_mov_b32 v38, 0
 v_mov_b32 v39, 0
 v_mov_b32 v40, 0
 v_mov_b32 v41, 0
 v_mov_b32 v42, 0
 v_mov_b32 v43, 0
 v_mov_b32 v44, 0
 v_mov_b32 v45, 0
 v_mov_b32 v46, 0
 v_mov_b32 v47, 0
 v_mov_b32 v48, 0
 v_mov_b32 v49, 0
 v_mov_b32 v50, 0
 v_mov_b32 v51, 0
 v_mov_b32 v52, 0
 v_mov_b32 v53, 0
 v_mov_b32 v54, 0
 v_mov_b32 v55, 0
 v_mov_b32 v56, 0
 v_mov_b32 v57, 0
 v_mov_b32 v58, 0
 v_mov_b32 v59, 0
 v_mov_b32 v60, 0
 v_mov_b32 v61, 0
 v_mov_b32 v62, 0
 v_mov_b32 v63, 0
 v_mov_b32 v64, 0
 v_mov_b32 v65, 0
 v_mov_b32 v66, 0
 v_mov_b32 v67, 0
 v_mov_b32 v128, 0
 v_mov_b32 v129, 0
 v_mov_b32 v130, 0
 v_mov_b32 v131, 0
 v_mov_b32 v132, 0
 v_mov_b32 v133, 0
 v_mov_b32 v134, 0
 v_mov_b32 v135, 0
 s_cmp_lg_u32 s12, 0
 s_cbranch_scc1 L_wg_43_done
 v_lshlrev_b32 v1, 7, v0
 s_mov_b32 s31, 0
 s_mov_b32 s3, 53501952
 s_mov_b32 exec_lo, 262143
 s_mov_b32 exec_hi, 1
L_wg_43:
 buffer_load_dword v2, v1, s[64:67], s3 offen sc1
 s_add_u32 s31, s31, 1
 s_cmp_gt_u32 s31, 524288
 s_cbranch_scc1 L_exit
 s_waitcnt vmcnt(0)
 v_cmp_eq_u32 vcc, 0, v2
 s_cbranch_vccz L_wg_43_ok
 s_sleep 4
 s_branch L_wg_43
L_wg_43_ok:
 s_mov_b64 exec, -1
L_wg_43_done:
 s_barrier
 s_mov_b32 s31, 0
 s_branch L_sp_44_go
L_sp_44:
 s_sleep 2
 s_add_u32 s31, s31, 1
 s_cmp_gt_u32 s31, 524288
 s_cbranch_scc1 L_exit
L_sp_44_go:
 buffer_load_dword v7, v4, s[64:67], s33 offen sc1
 s_waitcnt vmcnt(0)
 v_cmp_eq_u32 vcc, -1, v7
 s_cbranch_vccnz L_sp_44
 s_mov_b32 s30, 0
 s_waitcnt vmcnt(0) lgkmcnt(0)
 s_barrier
L_Bloop_45:
 s_add_u32 s20, s25, 4096
 s_add_u32 s21, s25, 5120
 s_mov_b32 s22, s27
 ds_read_b128 v[136:139], v175 offset:8192
 ds_read_b128 v[140:143], v175 offset:9216
 ds_read_b128 v[144:147], v175 offset:22528
 ds_read_b128 v[148:151], v175 offset:23552
 ds_read_b128 v[152:155], v175 offset:10240
 ds_read_b128 v[156:159], v175 offset:11264
 ds_read_b128 v[160:163], v175 offset:24576
 ds_read_b128 v[164:167], v175 offset:25600
 s_sleep 2
 s_mov_b32 s31, 0
 buffer_load_dwordx4 v[8:11], v169, s[64:67], s20 offen sc1
 buffer_load_dwordx4 v[12:15], v169, s[64:67], s21 offen sc1
 buffer_load_dword v7, v4, s[64:67], s33 offen sc1
L_fp_46_w:
 s_waitcnt vmcnt(0)
 v_max3_u32 v6, v8, v9, v10
 v_max3_u32 v6, v6, v11, v12
 v_max3_u32 v6, v6, v13, v14
 v_max3_u32 v6, v6, v15, v7
 v_cmp_eq_u32 vcc, -1, v6
 s_cbranch_vccnz L_fp_46
 s_waitcnt lgkmcnt(0)
 ds_write_b128 v169, v[8:11] offset:4096
 ds_write_b128 v169, v[12:15] offset:5120
 v_smfmac_f32_16x16x64_bf16 v[60:63], v[8:11], v[136:143], v168
 v_smfmac_f32_16x16x64_bf16 v[64:67], v[8:11], v[144:151], v168
 buffer_load_dwordx4 v[84:87], v169, s[64:67], s24 offen sc1
 v_smfmac_f32_16x16x64_bf16 v[36:39], v[8:11], a[0:7], v168
 v_smfmac_f32_16x16x64_bf16 v[40:43], v[8:11], a[56:63], v168
 buffer_load_dwordx4 v[88:91], v169, s[64:67], s24 offen offset:1024 sc1
 v_smfmac_f32_16x16x64_bf16 v[44:47], v[8:11], a[112:119], v168
 v_smfmac_f32_16x16x64_bf16 v[48:51], v[8:11], a[168:175], v168
 buffer_load_dwordx4 v[92:95], v169, s[64:67], s24 offen offset:2048 sc1
 v_smfmac_f32_16x16x64_bf16 v[52:55], v[8:11], a[224:231], v168
 v_smfmac_f32_16x16x64_bf16 v[56:59], v[8:11], v[200:207], v168
 buffer_load_dwordx4 v[96:99], v169, s[64:67], s24 offen offset:3072 sc1
 s_add_u32 s24, s24, 4096
 s_waitcnt lgkmcnt(0)
 s_barrier
 ds_read_b128 v[16:19], v169 offset:6144
 ds_read_b128 v[20:23], v169
 ds_read_b128 v[24:27], v169 offset:1024
 ds_read_b128 v[28:31], v169 offset:2048
 ds_read_b128 v[32:35], v169 offset:3072
 ds_read_b128 v[136:139], v175 offset:12288
 ds_read_b128 v[140:143], v175 offset:13312
 ds_read_b128 v[144:147], v175 offset:26624
 ds_read_b128 v[148:151], v175 offset:27648
 v_smfmac_f32_16x16x64_bf16 v[60:63], v[12:15], v[152:159], v168
 v_smfmac_f32_16x16x64_bf16 v[64:67], v[12:15], v[160:167], v168
 buffer_load_dwordx4 v[100:103], v169, s[64:67], s24 offen sc1
 v_smfmac_f32_16x16x64_bf16 v[36:39], v[12:15], a[8:15], v168
 ds_read_b128 v[152:155], v175
 v_smfmac_f32_16x16x64_bf16 v[40:43], v[12:15], a[64:71], v168
 ds_read_b128 v[156:159], v175 offset:1024
 buffer_load_dwordx4 v[104:107], v169, s[64:67], s24 offen offset:1024 sc1
 v_smfmac_f32_16x16x64_bf16 v[44:47], v[12:15], a[120:127], v168
 ds_read_b128 v[160:163], v175 offset:14336
 v_smfmac_f32_16x16x64_bf16 v[48:51], v[12:15], a[176:183], v168
 ds_read_b128 v[164:167], v175 offset:15360
 buffer_load_dwordx4 v[108:111], v169, s[64:67], s24 offen offset:2048 sc1
 v_smfmac_f32_16x16x64_bf16 v[52:55], v[12:15], a[232:239], v168
 v_smfmac_f32_16x16x64_bf16 v[56:59], v[12:15], v[208:215], v168
 buffer_load_dwordx4 v[112:115], v169, s[64:67], s24 offen offset:3072 sc1
 s_add_u32 s24, s24, 454656
 s_waitcnt lgkmcnt(4)
 v_smfmac_f32_16x16x64_bf16 v[60:63], v[16:19], v[136:143], v168
 v_smfmac_f32_16x16x64_bf16 v[64:67], v[16:19], v[144:151], v168
 v_smfmac_f32_16x16x64_bf16 v[36:39], v[16:19], a[16:23], v168
 ds_read_b128 v[136:139], v175 offset:2048
 v_smfmac_f32_16x16x64_bf16 v[40:43], v[16:19], a[72:79], v168
 ds_read_b128 v[140:143], v175 offset:3072
 v_smfmac_f32_16x16x64_bf16 v[44:47], v[16:19], a[128:135], v168
 ds_read_b128 v[144:147], v175 offset:16384
 v_smfmac_f32_16x16x64_bf16 v[48:51], v[16:19], a[184:191], v168
 ds_read_b128 v[148:151], v175 offset:17408
 v_smfmac_f32_16x16x64_bf16 v[52:55], v[16:19], a[240:247], v168
 v_smfmac_f32_16x16x64_bf16 v[56:59], v[16:19], v[216:223], v168
 s_waitcnt lgkmcnt(4)
 v_smfmac_f32_16x16x64_bf16 v[60:63], v[20:23], v[152:159], v168
 v_smfmac_f32_16x16x64_bf16 v[64:67], v[20:23], v[160:167], v168
 v_smfmac_f32_16x16x64_bf16 v[36:39], v[20:23], a[24:31], v168
 ds_read_b128 v[152:155], v175 offset:4096
 v_smfmac_f32_16x16x64_bf16 v[40:43], v[20:23], a[80:87], v168
 ds_read_b128 v[156:159], v175 offset:5120
 v_smfmac_f32_16x16x64_bf16 v[44:47], v[20:23], a[136:143], v168
 ds_read_b128 v[160:163], v175 offset:18432
 v_smfmac_f32_16x16x64_bf16 v[48:51], v[20:23], a[192:199], v168
 ds_read_b128 v[164:167], v175 offset:19456
 v_smfmac_f32_16x16x64_bf16 v[52:55], v[20:23], a[248:255], v168
 v_smfmac_f32_16x16x64_bf16 v[56:59], v[20:23], v[224:231], v168
 s_waitcnt lgkmcnt(4)
 v_smfmac_f32_16x16x64_bf16 v[60:63], v[24:27], v[136:143], v168
 v_smfmac_f32_16x16x64_bf16 v[64:67], v[24:27], v[144:151], v168
 v_smfmac_f32_16x16x64_bf16 v[36:39], v[24:27], a[32:39], v168
 ds_read_b128 v[136:139], v175 offset:6144
 v_smfmac_f32_16x16x64_bf16 v[40:43], v[24:27], a[88:95], v168
 ds_read_b128 v[140:143], v175 offset:7168
 v_smfmac_f32_16x16x64_bf16 v[44:47], v[24:27], a[144:151], v168
 ds_read_b128 v[144:147], v175 offset:20480
 v_smfmac_f32_16x16x64_bf16 v[48:51], v[24:27], a[200:207], v168
 ds_read_b128 v[148:151], v175 offset:21504
 v_smfmac_f32_16x16x64_bf16 v[52:55], v[24:27], v[176:183], v168
 v_smfmac_f32_16x16x64_bf16 v[56:59], v[24:27], v[232:239], v168
 s_waitcnt lgkmcnt(4)
 v_smfmac_f32_16x16x64_bf16 v[60:63], v[28:31], v[152:159], v168
 v_smfmac_f32_16x16x64_bf16 v[64:67], v[28:31], v[160:167], v168
 v_smfmac_f32_16x16x64_bf16 v[36:39], v[28:31], a[40:47], v168
 v_smfmac_f32_16x16x64_bf16 v[40:43], v[28:31], a[96:103], v168
 v_smfmac_f32_16x16x64_bf16 v[44:47], v[28:31], a[152:159], v168
 v_smfmac_f32_16x16x64_bf16 v[48:51], v[28:31], a[208:215], v168
 v_smfmac_f32_16x16x64_bf16 v[52:55], v[28:31], v[184:191], v168
 v_smfmac_f32_16x16x64_bf16 v[56:59], v[28:31], v[240:247], v168
 s_waitcnt lgkmcnt(0)
 v_smfmac_f32_16x16x64_bf16 v[60:63], v[32:35], v[136:143], v168
 v_smfmac_f32_16x16x64_bf16 v[64:67], v[32:35], v[144:151], v168
 v_smfmac_f32_16x16x64_bf16 v[36:39], v[32:35], a[48:55], v168
 v_smfmac_f32_16x16x64_bf16 v[40:43], v[32:35], a[104:111], v168
 v_smfmac_f32_16x16x64_bf16 v[44:47], v[32:35], a[160:167], v168
 v_smfmac_f32_16x16x64_bf16 v[48:51], v[32:35], a[216:223], v168
 v_smfmac_f32_16x16x64_bf16 v[52:55], v[32:35], v[192:199], v168
 v_smfmac_f32_16x16x64_bf16 v[56:59], v[32:35], v[248:255], v168
 s_nop 0
 v_pk_add_f32 v[60:61], v[60:61], v[62:63]
 v_pk_add_f32 v[64:65], v[64:65], v[66:67]
 v_pk_add_f32 v[36:37], v[36:37], v[38:39]
 v_pk_add_f32 v[40:41], v[40:41], v[42:43]
 v_pk_add_f32 v[44:45], v[44:45], v[46:47]
 v_pk_add_f32 v[48:49], v[48:49], v[50:51]
 v_pk_add_f32 v[52:53], v[52:53], v[54:55]
 v_pk_add_f32 v[56:57], v[56:57], v[58:59]
 v_cvt_pk_bf16_f32 v71, v60, v61
 v_cvt_pk_bf16_f32 v75, v64, v65
 v_cvt_pk_bf16_f32 v68, v36, v37
 v_cvt_pk_bf16_f32 v72, v40, v41
 v_cvt_pk_bf16_f32 v70, v44, v45
 v_cvt_pk_bf16_f32 v74, v48, v49
 v_cvt_pk_bf16_f32 v69, v52, v53
 v_cvt_pk_bf16_f32 v73, v56, v57
 s_nop 0
 v_permlane32_swap_b32 v68, v69
 v_permlane32_swap_b32 v70, v71
 v_permlane32_swap_b32 v72, v73
 v_permlane32_swap_b32 v74, v75
 v_permlane16_swap_b32 v68, v70
 v_permlane16_swap_b32 v69, v71
 v_permlane16_swap_b32 v72, v74
 v_permlane16_swap_b32 v73, v75
 s_sleep 2
 s_mov_b32 s31, 0
 buffer_load_dwordx4 v[116:119], v170, s[64:67], s22 offen sc1
 buffer_load_dwordx4 v[120:123], v170, s[64:67], s22 offen offset:1024 sc1
 buffer_load_dwordx2 v[124:125], v171, s[64:67], s22 offen sc1
 s_nop 15
 s_nop 15
 buffer_load_dwordx4 v[116:119], v170, s[64:67], s22 offen sc1
 buffer_load_dwordx4 v[120:123], v170, s[64:67], s22 offen offset:1024 sc1
 buffer_load_dwordx2 v[124:125], v171, s[64:67], s22 offen sc1
L_q2_47_w:
 s_waitcnt vmcnt(3)
 v_max3_u32 v6, v119, v123, v124
 v_max_u32 v6, v6, v125
 v_cmp_eq_u32 vcc, -1, v6
 v_smfmac_f32_16x16x32_bf16 v[128:131], v[124:125], v[68:71], v168
 v_smfmac_f32_16x16x32_bf16 v[132:135], v[124:125], v[72:75], v168
 s_cbranch_vccnz L_q2_47
 s_nop 3
 v_smfmac_f32_16x16x64_bf16 v[128:131], v[116:119], v[84:91], v168
 v_smfmac_f32_16x16x64_bf16 v[128:131], v[120:123], v[100:107], v168
 v_smfmac_f32_16x16x64_bf16 v[132:135], v[116:119], v[92:99], v168
 v_smfmac_f32_16x16x64_bf16 v[132:135], v[120:123], v[108:115], v168
 s_nop 5
 v_pk_add_f32 v[128:129], v[128:129], v[130:131]
 ds_write2_b32 v172, v128, v129 offset0:0 offset1:40
 v_pk_add_f32 v[132:133], v[132:133], v[134:135]
 ds_write2_b32 v172, v132, v133 offset0:16 offset1:56
 s_waitcnt lgkmcnt(0)
 s_barrier
 s_add_u32 s29, s28, 2098176
 s_add_u32 s28, s28, 8192
 s_cmp_eq_u32 s30, 62
 s_cbranch_scc1 L_Bloop_45_x
 v_mov_b32 v36, 0
 v_mov_b32 v37, 0
 v_mov_b32 v38, 0
 v_mov_b32 v39, 0
 v_mov_b32 v40, 0
 v_mov_b32 v41, 0
 v_mov_b32 v42, 0
 v_mov_b32 v43, 0
 v_mov_b32 v44, 0
 v_mov_b32 v45, 0
 v_mov_b32 v46, 0
 v_mov_b32 v47, 0
 v_mov_b32 v48, 0
 v_mov_b32 v49, 0
 v_mov_b32 v50, 0
 v_mov_b32 v51, 0
 v_mov_b32 v52, 0
 v_mov_b32 v53, 0
 v_mov_b32 v54, 0
 v_mov_b32 v55, 0
 v_mov_b32 v56, 0
 v_mov_b32 v57, 0
 v_mov_b32 v58, 0
 v_mov_b32 v59, 0
 v_mov_b32 v60, 0
 v_mov_b32 v61, 0
 v_mov_b32 v62, 0
 v_mov_b32 v63, 0
 v_mov_b32 v64, 0
 v_mov_b32 v65, 0
 v_mov_b32 v66, 0
 v_mov_b32 v67, 0
 v_mov_b32 v128, 0
 v_mov_b32 v129, 0
 v_mov_b32 v130, 0
 v_mov_b32 v131, 0
 v_mov_b32 v132, 0
 v_mov_b32 v133, 0
 v_mov_b32 v134, 0
 v_mov_b32 v135, 0
 s_add_u32 s25, s25, 8192
 s_add_u32 s26, s25, 2098176
 s_add_u32 s27, s27, 10240
 s_add_u32 s33, s33, 1024
 s_add_u32 s30, s30, 1
 s_cmp_lt_u32 s30, 63
 s_cbranch_scc1 L_Bloop_45
L_Bloop_45_x:
 s_branch L_exit
L_fp_46:
 s_add_u32 s31, s31, 1
 s_cmp_ge_u32 s31, 48
 s_cbranch_scc1 L_fp_46_sw
L_fp_46_r:
 buffer_load_dwordx4 v[8:11], v169, s[64:67], s20 offen sc1
 buffer_load_dwordx4 v[12:15], v169, s[64:67], s21 offen sc1
 buffer_load_dword v7, v4, s[64:67], s33 offen sc1
 s_branch L_fp_46_w
L_fp_46_sw:
 s_cmp_gt_u32 s31, 524288
 s_cbranch_scc1 L_exit
 s_cmp_lg_u32 s31, 48
 s_cbranch_scc1 L_fp_46_r
 s_waitcnt vmcnt(0)
 s_add_u32 s20, s26, 4096
 s_add_u32 s21, s26, 5120
 s_branch L_fp_46_r
L_q2_47:
 buffer_load_dwordx4 v[116:119], v170, s[64:67], s22 offen sc1
 buffer_load_dwordx4 v[120:123], v170, s[64:67], s22 offen offset:1024 sc1
 buffer_load_dwordx2 v[124:125], v171, s[64:67], s22 offen sc1
 s_nop 2
 v_mov_b32 v128, 0
 v_mov_b32 v129, 0
 v_mov_b32 v130, 0
 v_mov_b32 v131, 0
 v_mov_b32 v132, 0
 v_mov_b32 v133, 0
 v_mov_b32 v134, 0
 v_mov_b32 v135, 0
 s_add_u32 s31, s31, 1
 s_cmp_lt_u32 s31, 64
 s_cbranch_scc1 L_q2_47_w
 s_cmp_gt_u32 s31, 524288
 s_cbranch_scc1 L_exit
 s_cmp_lg_u32 s31, 64
 s_cbranch_scc1 L_q2_47_w
 s_waitcnt vmcnt(0)
 s_add_u32 s22, s27, 655360
 buffer_load_dwordx4 v[116:119], v170, s[64:67], s22 offen sc1
 buffer_load_dwordx4 v[120:123], v170, s[64:67], s22 offen offset:1024 sc1
 buffer_load_dwordx2 v[124:125], v171, s[64:67], s22 offen sc1
 buffer_load_dwordx4 v[116:119], v170, s[64:67], s22 offen sc1
 buffer_load_dwordx4 v[120:123], v170, s[64:67], s22 offen offset:1024 sc1
 buffer_load_dwordx2 v[124:125], v171, s[64:67], s22 offen sc1
 s_branch L_q2_47_w
L_pad9:
 s_setpc_b64 s[94:95]
L_B3:
 v_lshlrev_b32 v169, 4, v0
 s_mul_i32 s13, s11, 458752
 s_add_u32 s13, s13, 6766592
 s_mov_b32 s15, 98304
 s_add_u32 s14, s13, 12288
 buffer_load_dwordx4 a[0:3], v169, s[64:67], s14 offen sc1
 buffer_load_dwordx4 a[4:7], v169, s[64:67], s14 offen offset:1024 sc1
 s_add_u32 s14, s13, 0
 buffer_load_dwordx4 a[8:11], v169, s[64:67], s14 offen sc1
 buffer_load_dwordx4 a[12:15], v169, s[64:67], s14 offen offset:1024 sc1
 s_add_u32 s14, s13, 2048
 buffer_load_dwordx4 a[16:19], v169, s[64:67], s14 offen sc1
 buffer_load_dwordx4 a[20:23], v169, s[64:67], s14 offen offset:1024 sc1
 s_add_u32 s14, s13, 4096
 buffer_load_dwordx4 a[24:27], v169, s[64:67], s14 offen sc1
 buffer_load_dwordx4 a[28:31], v169, s[64:67], s14 offen offset:1024 sc1
 s_add_u32 s14, s13, 6144
 buffer_load_dwordx4 a[32:35], v169, s[64:67], s14 offen sc1
 buffer_load_dwordx4 a[36:39], v169, s[64:67], s14 offen offset:1024 sc1
 s_add_u32 s14, s13, 8192
 buffer_load_dwordx4 a[40:43], v169, s[64:67], s14 offen sc1
 buffer_load_dwordx4 a[44:47], v169, s[64:67], s14 offen offset:1024 sc1
 s_add_u32 s14, s13, 10240
 buffer_load_dwordx4 a[48:51], v169, s[64:67], s14 offen sc1
 buffer_load_dwordx4 a[52:55], v169, s[64:67], s14 offen offset:1024 sc1
 s_add_u32 s14, s13, 26624
 buffer_load_dwordx4 a[56:59], v169, s[64:67], s14 offen sc1
 buffer_load_dwordx4 a[60:63], v169, s[64:67], s14 offen offset:1024 sc1
 s_add_u32 s14, s13, 14336
 buffer_load_dwordx4 a[64:67], v169, s[64:67], s14 offen sc1
 buffer_load_dwordx4 a[68:71], v169, s[64:67], s14 offen offset:1024 sc1
 s_add_u32 s14, s13, 16384
 buffer_load_dwordx4 a[72:75], v169, s[64:67], s14 offen sc1
 buffer_load_dwordx4 a[76:79], v169, s[64:67], s14 offen offset:1024 sc1
 s_add_u32 s14, s13, 18432
 buffer_load_dwordx4 a[80:83], v169, s[64:67], s14 offen sc1
 buffer_load_dwordx4 a[84:87], v169, s[64:67], s14 offen offset:1024 sc1
 s_add_u32 s14, s13, 20480
 buffer_load_dwordx4 a[88:91], v169, s[64:67], s14 offen sc1
 buffer_load_dwordx4 a[92:95], v169, s[64:67], s14 offen offset:1024 sc1
 s_add_u32 s14, s13, 22528
 buffer_load_dwordx4 a[96:99], v169, s[64:67], s14 offen sc1
 buffer_load_dwordx4 a[100:103], v169, s[64:67], s14 offen offset:1024 sc1
 s_add_u32 s14, s13, 24576
 buffer_load_dwordx4 a[104:107], v169, s[64:67], s14 offen sc1
 buffer_load_dwordx4 a[108:111], v169, s[64:67], s14 offen offset:1024 sc1
 s_add_u32 s14, s13, 40960
 buffer_load_dwordx4 a[112:115], v169, s[64:67], s14 offen sc1
 buffer_load_dwordx4 a[116:119], v169, s[64:67], s14 offen offset:1024 sc1
 s_add_u32 s14, s13, 28672
 buffer_load_dwordx4 a[120:123], v169, s[64:67], s14 offen sc1
 buffer_load_dwordx4 a[124:127], v169, s[64:67], s14 offen offset:1024 sc1
 s_add_u32 s14, s13, 30720
 buffer_load_dwordx4 a[128:131], v169, s[64:67], s14 offen sc1
 buffer_load_dwordx4 a[132:135], v169, s[64:67], s14 offen offset:1024 sc1
 s_add_u32 s14, s13, 32768
 buffer_load_dwordx4 a[136:139], v169, s[64:67], s14 offen sc1
 buffer_load_dwordx4 a[140:143], v169, s[64:67], s14 offen offset:1024 sc1
 s_add_u32 s14, s13, 34816
 buffer_load_dwordx4 a[144:147], v169, s[64:67], s14 offen sc1
 buffer_load_dwordx4 a[148:151], v169, s[64:67], s14 offen offset:1024 sc1
 s_add_u32 s14, s13, 36864
 buffer_load_dwordx4 a[152:155], v169, s[64:67], s14 offen sc1
 buffer_load_dwordx4 a[156:159], v169, s[64:67], s14 offen offset:1024 sc1
 s_add_u32 s14, s13, 38912
 buffer_load_dwordx4 a[160:163], v169, s[64:67], s14 offen sc1
 buffer_load_dwordx4 a[164:167], v169, s[64:67], s14 offen offset:1024 sc1
 s_add_u32 s14, s13, 55296
 buffer_load_dwordx4 a[168:171], v169, s[64:67], s14 offen sc1
 buffer_load_dwordx4 a[172:175], v169, s[64:67], s14 offen offset:1024 sc1
 s_add_u32 s14, s13, 43008
 buffer_load_dwordx4 a[176:179], v169, s[64:67], s14 offen sc1
 buffer_load_dwordx4 a[180:183], v169, s[64:67], s14 offen offset:1024 sc1
 s_add_u32 s14, s13, 45056
 buffer_load_dwordx4 a[184:187], v169, s[64:67], s14 offen sc1
 buffer_load_dwordx4 a[188:191], v169, s[64:67], s14 offen offset:1024 sc1
 s_add_u32 s14, s13, 47104
 buffer_load_dwordx4 a[192:195], v169, s[64:67], s14 offen sc1
 buffer_load_dwordx4 a[196:199], v169, s[64:67], s14 offen offset:1024 sc1
 s_add_u32 s14, s13, 49152
 buffer_load_dwordx4 a[200:203], v169, s[64:67], s14 offen sc1
 buffer_load_dwordx4 a[204:207], v169, s[64:67], s14 offen offset:1024 sc1
 s_add_u32 s14, s13, 51200
 buffer_load_dwordx4 a[208:211], v169, s[64:67], s14 offen sc1
 buffer_load_dwordx4 a[212:215], v169, s[64:67], s14 offen offset:1024 sc1
 s_add_u32 s14, s13, 53248
 buffer_load_dwordx4 a[216:219], v169, s[64:67], s14 offen sc1
 buffer_load_dwordx4 a[220:223], v169, s[64:67], s14 offen offset:1024 sc1
 s_add_u32 s14, s13, 69632
 buffer_load_dwordx4 a[224:227], v169, s[64:67], s14 offen sc1
 buffer_load_dwordx4 a[228:231], v169, s[64:67], s14 offen offset:1024 sc1
 s_add_u32 s14, s13, 57344
 buffer_load_dwordx4 a[232:235], v169, s[64:67], s14 offen sc1
 buffer_load_dwordx4 a[236:239], v169, s[64:67], s14 offen offset:1024 sc1
 s_add_u32 s14, s13, 59392
 buffer_load_dwordx4 a[240:243], v169, s[64:67], s14 offen sc1
 buffer_load_dwordx4 a[244:247], v169, s[64:67], s14 offen offset:1024 sc1
 s_add_u32 s14, s13, 61440
 buffer_load_dwordx4 a[248:251], v169, s[64:67], s14 offen sc1
 buffer_load_dwordx4 a[252:255], v169, s[64:67], s14 offen offset:1024 sc1
 s_add_u32 s14, s13, 63488
 buffer_load_dwordx4 v[176:179], v169, s[64:67], s14 offen sc1
 buffer_load_dwordx4 v[180:183], v169, s[64:67], s14 offen offset:1024 sc1
 s_add_u32 s14, s13, 65536
 buffer_load_dwordx4 v[184:187], v169, s[64:67], s14 offen sc1
 buffer_load_dwordx4 v[188:191], v169, s[64:67], s14 offen offset:1024 sc1
 s_add_u32 s14, s13, 67584
 buffer_load_dwordx4 v[192:195], v169, s[64:67], s14 offen sc1
 buffer_load_dwordx4 v[196:199], v169, s[64:67], s14 offen offset:1024 sc1
 s_add_u32 s14, s13, 83968
 buffer_load_dwordx4 v[200:203], v169, s[64:67], s14 offen sc1
 buffer_load_dwordx4 v[204:207], v169, s[64:67], s14 offen offset:1024 sc1
 s_add_u32 s14, s13, 71680
 buffer_load_dwordx4 v[208:211], v169, s[64:67], s14 offen sc1
 buffer_load_dwordx4 v[212:215], v169, s[64:67], s14 offen offset:1024 sc1
 s_add_u32 s14, s13, 73728
 buffer_load_dwordx4 v[216:219], v169, s[64:67], s14 offen sc1
 buffer_load_dwordx4 v[220:223], v169, s[64:67], s14 offen offset:1024 sc1
 s_add_u32 s14, s13, 75776
 buffer_load_dwordx4 v[224:227], v169, s[64:67], s14 offen sc1
 buffer_load_dwordx4 v[228:231], v169, s[64:67], s14 offen offset:1024 sc1
 s_add_u32 s14, s13, 77824
 buffer_load_dwordx4 v[232:235], v169, s[64:67], s14 offen sc1
 buffer_load_dwordx4 v[236:239], v169, s[64:67], s14 offen offset:1024 sc1
 s_add_u32 s14, s13, 79872
 buffer_load_dwordx4 v[240:243], v169, s[64:67], s14 offen sc1
 buffer_load_dwordx4 v[244:247], v169, s[64:67], s14 offen offset:1024 sc1
 s_add_u32 s14, s13, 81920
 buffer_load_dwordx4 v[248:251], v169, s[64:67], s14 offen sc1
 buffer_load_dwordx4 v[252:255], v169, s[64:67], s14 offen offset:1024 sc1
 s_add_u32 m0, s15, 0
 s_add_u32 s14, s13, 86016
 buffer_load_dwordx4 v169, s[64:67], s14 offen sc1 lds
 buffer_load_dwordx4 v169, s[64:67], s14 offen offset:1024 sc1 lds
 buffer_load_dwordx4 v169, s[64:67], s14 offen offset:2048 sc1 lds
 buffer_load_dwordx4 v169, s[64:67], s14 offen offset:3072 sc1 lds
 s_add_u32 m0, s15, 4096
 s_add_u32 s14, s13, 90112
 buffer_load_dwordx4 v169, s[64:67], s14 offen sc1 lds
 buffer_load_dwordx4 v169, s[64:67], s14 offen offset:1024 sc1 lds
 buffer_load_dwordx4 v169, s[64:67], s14 offen offset:2048 sc1 lds
 buffer_load_dwordx4 v169, s[64:67], s14 offen offset:3072 sc1 lds
 s_add_u32 m0, s15, 8192
 s_add_u32 s14, s13, 94208
 buffer_load_dwordx4 v169, s[64:67], s14 offen sc1 lds
 buffer_load_dwordx4 v169, s[64:67], s14 offen offset:1024 sc1 lds
 buffer_load_dwordx4 v169, s[64:67], s14 offen offset:2048 sc1 lds
 buffer_load_dwordx4 v169, s[64:67], s14 offen offset:3072 sc1 lds
 s_add_u32 m0, s15, 12288
 s_add_u32 s14, s13, 98304
 buffer_load_dwordx4 v169, s[64:67], s14 offen sc1 lds
 buffer_load_dwordx4 v169, s[64:67], s14 offen offset:1024 sc1 lds
 buffer_load_dwordx4 v169, s[64:67], s14 offen offset:2048 sc1 lds
 buffer_load_dwordx4 v169, s[64:67], s14 offen offset:3072 sc1 lds
 s_add_u32 m0, s15, 16384
 s_add_u32 s14, s13, 102400
 buffer_load_dwordx4 v169, s[64:67], s14 offen sc1 lds
 buffer_load_dwordx4 v169, s[64:67], s14 offen offset:1024 sc1 lds
 buffer_load_dwordx4 v169, s[64:67], s14 offen offset:2048 sc1 lds
 buffer_load_dwordx4 v169, s[64:67], s14 offen offset:3072 sc1 lds
 s_add_u32 m0, s15, 20480
 s_add_u32 s14, s13, 106496
 buffer_load_dwordx4 v169, s[64:67], s14 offen sc1 lds
 buffer_load_dwordx4 v169, s[64:67], s14 offen offset:1024 sc1 lds
 buffer_load_dwordx4 v169, s[64:67], s14 offen offset:2048 sc1 lds
 buffer_load_dwordx4 v169, s[64:67], s14 offen offset:3072 sc1 lds
 s_add_u32 m0, s15, 24576
 s_add_u32 s14, s13, 110592
 buffer_load_dwordx4 v169, s[64:67], s14 offen sc1 lds
 buffer_load_dwordx4 v169, s[64:67], s14 offen offset:1024 sc1 lds
 buffer_load_dwordx4 v169, s[64:67], s14 offen offset:2048 sc1 lds
 buffer_load_dwordx4 v169, s[64:67], s14 offen offset:3072 sc1 lds
 v_add_u32 v175, 98304, v169
 v_bfe_u32 v5, v0, 1, 1
 v_mov_b32 v6, 0x4444
 v_mov_b32 v7, 0xeeee
 v_cmp_eq_u32 vcc, 1, v5
 s_nop 1
 v_cndmask_b32 v168, v6, v7, vcc
 v_lshrrev_b32 v1, 4, v0
 v_and_b32 v2, 15, v0
 v_lshrrev_b32 v4, 2, v2
 v_lshlrev_b32 v4, 8, v4
 v_add_u32 v4, 12288, v4
 v_and_b32 v6, 3, v0
 v_lshl_add_u32 v171, v6, 3, v4
 v_lshl_add_u32 v171, v1, 10, v171
 v_add_u32 v171, 128, v171
 v_lshl_add_u32 v4, v6, 4, v4
 v_lshrrev_b32 v6, 1, v1
 v_lshl_add_u32 v4, v6, 10, v4
 v_and_b32 v6, 1, v1
 v_lshl_add_u32 v170, v6, 6, v4
 v_mul_u32_u24 v4, 320, v1
 v_lshlrev_b32 v6, 2, v2
 v_add_u32 v4, v4, v6
 v_add_u32 v172, 11008, v4
 v_lshlrev_b32 v4, 1, v1
 v_bfe_u32 v6, v0, 2, 1
 v_add_u32 v4, v4, v6
 v_mul_u32_u24 v4, 160, v4
 v_bfe_u32 v6, v0, 3, 1
 v_lshlrev_b32 v6, 5, v6
 v_and_b32 v7, 3, v0
 v_lshlrev_b32 v7, 3, v7
 v_add3_u32 v4, v4, v6, v7
 v_add_u32 v173, 7232, v4
 v_lshlrev_b32 v174, 2, v0
 v_add_u32 v174, 256, v174
 v_lshlrev_b32 v171, 3, v0
 v_add_u32 v171, 9728, v171
 v_lshrrev_b32 v4, 2, v2
 v_lshlrev_b32 v4, 7, v4
 v_add_u32 v4, 6144, v4
 v_and_b32 v6, 3, v0
 v_lshl_add_u32 v4, v6, 4, v4
 v_lshrrev_b32 v6, 1, v1
 v_lshl_add_u32 v4, v6, 9, v4
 v_and_b32 v6, 1, v1
 v_lshl_add_u32 v170, v6, 6, v4
 s_mov_b32 s34, 0xfffffffe
 v_mov_b32 v4, 0
 v_mov_b32 v5, 0
 s_mov_b32 s25, 50331648
 s_mov_b32 s26, 53485568
 s_mov_b32 s27, 50855936
 s_mul_i32 s13, s11, 32768
 s_add_u32 s24, s13, 12869632
 s_lshl_b32 s13, s11, 9
 s_add_u32 s28, s13, 50339840
 s_mov_b32 s29, 0x7ffffff0
 s_lshl_b32 s13, s11, 6
 s_add_u32 s33, s13, 52166668
 v_mov_b32 v36, 0
 v_mov_b32 v37, 0
 v_mov_b32 v38, 0
 v_mov_b32 v39, 0
 v_mov_b32 v40, 0
 v_mov_b32 v41, 0
 v_mov_b32 v42, 0
 v_mov_b32 v43, 0
 v_mov_b32 v44, 0
 v_mov_b32 v45, 0
 v_mov_b32 v46, 0
 v_mov_b32 v47, 0
 v_mov_b32 v48, 0
 v_mov_b32 v49, 0
 v_mov_b32 v50, 0
 v_mov_b32 v51, 0
 v_mov_b32 v52, 0
 v_mov_b32 v53, 0
 v_mov_b32 v54, 0
 v_mov_b32 v55, 0
 v_mov_b32 v56, 0
 v_mov_b32 v57, 0
 v_mov_b32 v58, 0
 v_mov_b32 v59, 0
 v_mov_b32 v60, 0
 v_mov_b32 v61, 0
 v_mov_b32 v62, 0
 v_mov_b32 v63, 0
 v_mov_b32 v64, 0
 v_mov_b32 v65, 0
 v_mov_b32 v66, 0
 v_mov_b32 v67, 0
 v_mov_b32 v128, 0
 v_mov_b32 v129, 0
 v_mov_b32 v130, 0
 v_mov_b32 v131, 0
 v_mov_b32 v132, 0
 v_mov_b32 v133, 0
 v_mov_b32 v134, 0
 v_mov_b32 v135, 0
 s_cmp_lg_u32 s12, 0
 s_cbranch_scc1 L_wg_48_done
 v_lshlrev_b32 v1, 7, v0
 s_mov_b32 s31, 0
 s_mov_b32 s3, 53501952
 s_mov_b32 exec_lo, 262143
 s_mov_b32 exec_hi, 1
L_wg_48:
 buffer_load_dword v2, v1, s[64:67], s3 offen sc1
 s_add_u32 s31, s31, 1
 s_cmp_gt_u32 s31, 524288
 s_cbranch_scc1 L_exit
 s_waitcnt vmcnt(0)
 v_cmp_eq_u32 vcc, 0, v2
 s_cbranch_vccz L_wg_48_ok
 s_sleep 4
 s_branch L_wg_48
L_wg_48_ok:
 s_mov_b64 exec, -1
L_wg_48_done:
 s_barrier
 s_mov_b32 s31, 0
 s_branch L_sp_49_go
L_sp_49:
 s_sleep 2
 s_add_u32 s31, s31, 1
 s_cmp_gt_u32 s31, 524288
 s_cbranch_scc1 L_exit
L_sp_49_go:
 buffer_load_dword v7, v4, s[64:67], s33 offen sc1
 s_waitcnt vmcnt(0)
 v_cmp_eq_u32 vcc, -1, v7
 s_cbranch_vccnz L_sp_49
 s_mov_b32 s30, 0
 s_waitcnt vmcnt(0) lgkmcnt(0)
 s_barrier
L_Bloop_50:
 s_add_u32 s20, s25, 6144
 s_add_u32 s21, s25, 0
 s_mov_b32 s22, s27
 ds_read_b128 v[136:139], v175 offset:12288
 ds_read_b128 v[140:143], v175 offset:13312
 ds_read_b128 v[144:147], v175 offset:26624
 ds_read_b128 v[148:151], v175 offset:27648
 ds_read_b128 v[152:155], v175
 ds_read_b128 v[156:159], v175 offset:1024
 ds_read_b128 v[160:163], v175 offset:14336
 ds_read_b128 v[164:167], v175 offset:15360
 s_sleep 2
 s_mov_b32 s31, 0
 buffer_load_dwordx4 v[8:11], v169, s[64:67], s20 offen sc1
 buffer_load_dwordx4 v[12:15], v169, s[64:67], s21 offen sc1
 buffer_load_dword v7, v4, s[64:67], s33 offen sc1
L_fp_51_w:
 s_waitcnt vmcnt(0)
 v_max3_u32 v6, v8, v9, v10
 v_max3_u32 v6, v6, v11, v12
 v_max3_u32 v6, v6, v13, v14
 v_max3_u32 v6, v6, v15, v7
 v_cmp_eq_u32 vcc, -1, v6
 s_cbranch_vccnz L_fp_51
 s_waitcnt lgkmcnt(0)
 ds_write_b128 v169, v[8:11] offset:6144
 v_smfmac_f32_16x16x64_bf16 v[60:63], v[8:11], v[136:143], v168
 v_smfmac_f32_16x16x64_bf16 v[64:67], v[8:11], v[144:151], v168
 buffer_load_dwordx4 v[84:87], v169, s[64:67], s24 offen sc1
 v_smfmac_f32_16x16x64_bf16 v[36:39], v[8:11], a[0:7], v168
 v_smfmac_f32_16x16x64_bf16 v[40:43], v[8:11], a[56:63], v168
 buffer_load_dwordx4 v[88:91], v169, s[64:67], s24 offen offset:1024 sc1
 v_smfmac_f32_16x16x64_bf16 v[44:47], v[8:11], a[112:119], v168
 v_smfmac_f32_16x16x64_bf16 v[48:51], v[8:11], a[168:175], v168
 buffer_load_dwordx4 v[92:95], v169, s[64:67], s24 offen offset:2048 sc1
 v_smfmac_f32_16x16x64_bf16 v[52:55], v[8:11], a[224:231], v168
 v_smfmac_f32_16x16x64_bf16 v[56:59], v[8:11], v[200:207], v168
 buffer_load_dwordx4 v[96:99], v169, s[64:67], s24 offen offset:3072 sc1
 s_add_u32 s24, s24, 4096
 s_waitcnt lgkmcnt(0)
 s_barrier
 ds_read_b128 v[16:19], v169 offset:1024
 ds_read_b128 v[20:23], v169 offset:2048
 ds_read_b128 v[24:27], v169 offset:3072
 ds_read_b128 v[28:31], v169 offset:4096
 ds_read_b128 v[32:35], v169 offset:5120
 ds_read_b128 v[136:139], v175 offset:2048
 ds_read_b128 v[140:143], v175 offset:3072
 ds_read_b128 v[144:147], v175 offset:16384
 ds_read_b128 v[148:151], v175 offset:17408
 v_smfmac_f32_16x16x64_bf16 v[60:63], v[12:15], v[152:159], v168
 v_smfmac_f32_16x16x64_bf16 v[64:67], v[12:15], v[160:167], v168
 buffer_load_dwordx4 v[100:103], v169, s[64:67], s24 offen sc1
 v_smfmac_f32_16x16x64_bf16 v[36:39], v[12:15], a[8:15], v168
 ds_read_b128 v[152:155], v175 offset:4096
 v_smfmac_f32_16x16x64_bf16 v[40:43], v[12:15], a[64:71], v168
 ds_read_b128 v[156:159], v175 offset:5120
 buffer_load_dwordx4 v[104:107], v169, s[64:67], s24 offen offset:1024 sc1
 v_smfmac_f32_16x16x64_bf16 v[44:47], v[12:15], a[120:127], v168
 ds_read_b128 v[160:163], v175 offset:18432
 v_smfmac_f32_16x16x64_bf16 v[48:51], v[12:15], a[176:183], v168
 ds_read_b128 v[164:167], v175 offset:19456
 buffer_load_dwordx4 v[108:111], v169, s[64:67], s24 offen offset:2048 sc1
 v_smfmac_f32_16x16x64_bf16 v[52:55], v[12:15], a[232:239], v168
 v_smfmac_f32_16x16x64_bf16 v[56:59], v[12:15], v[208:215], v168
 buffer_load_dwordx4 v[112:115], v169, s[64:67], s24 offen offset:3072 sc1
 s_add_u32 s24, s24, 454656
 s_waitcnt lgkmcnt(4)
 v_smfmac_f32_16x16x64_bf16 v[60:63], v[16:19], v[136:143], v168
 v_smfmac_f32_16x16x64_bf16 v[64:67], v[16:19], v[144:151], v168
 v_smfmac_f32_16x16x64_bf16 v[36:39], v[16:19], a[16:23], v168
 ds_read_b128 v[136:139], v175 offset:6144
 v_smfmac_f32_16x16x64_bf16 v[40:43], v[16:19], a[72:79], v168
 ds_read_b128 v[140:143], v175 offset:7168
 v_smfmac_f32_16x16x64_bf16 v[44:47], v[16:19], a[128:135], v168
 ds_read_b128 v[144:147], v175 offset:20480
 v_smfmac_f32_16x16x64_bf16 v[48:51], v[16:19], a[184:191], v168
 ds_read_b128 v[148:151], v175 offset:21504
 v_smfmac_f32_16x16x64_bf16 v[52:55], v[16:19], a[240:247], v168
 v_smfmac_f32_16x16x64_bf16 v[56:59], v[16:19], v[216:223], v168
 s_waitcnt lgkmcnt(4)
 v_smfmac_f32_16x16x64_bf16 v[60:63], v[20:23], v[152:159], v168
 v_smfmac_f32_16x16x64_bf16 v[64:67], v[20:23], v[160:167], v168
 v_smfmac_f32_16x16x64_bf16 v[36:39], v[20:23], a[24:31], v168
 ds_read_b128 v[152:155], v175 offset:8192
 v_smfmac_f32_16x16x64_bf16 v[40:43], v[20:23], a[80:87], v168
 ds_read_b128 v[156:159], v175 offset:9216
 v_smfmac_f32_16x16x64_bf16 v[44:47], v[20:23], a[136:143], v168
 ds_read_b128 v[160:163], v175 offset:22528
 v_smfmac_f32_16x16x64_bf16 v[48:51], v[20:23], a[192:199], v168
 ds_read_b128 v[164:167], v175 offset:23552
 v_smfmac_f32_16x16x64_bf16 v[52:55], v[20:23], a[248:255], v168
 v_smfmac_f32_16x16x64_bf16 v[56:59], v[20:23], v[224:231], v168
 s_waitcnt lgkmcnt(4)
 v_smfmac_f32_16x16x64_bf16 v[60:63], v[24:27], v[136:143], v168
 v_smfmac_f32_16x16x64_bf16 v[64:67], v[24:27], v[144:151], v168
 v_smfmac_f32_16x16x64_bf16 v[36:39], v[24:27], a[32:39], v168
 ds_read_b128 v[136:139], v175 offset:10240
 v_smfmac_f32_16x16x64_bf16 v[40:43], v[24:27], a[88:95], v168
 ds_read_b128 v[140:143], v175 offset:11264
 v_smfmac_f32_16x16x64_bf16 v[44:47], v[24:27], a[144:151], v168
 ds_read_b128 v[144:147], v175 offset:24576
 v_smfmac_f32_16x16x64_bf16 v[48:51], v[24:27], a[200:207], v168
 ds_read_b128 v[148:151], v175 offset:25600
 v_smfmac_f32_16x16x64_bf16 v[52:55], v[24:27], v[176:183], v168
 v_smfmac_f32_16x16x64_bf16 v[56:59], v[24:27], v[232:239], v168
 s_waitcnt lgkmcnt(4)
 v_smfmac_f32_16x16x64_bf16 v[60:63], v[28:31], v[152:159], v168
 v_smfmac_f32_16x16x64_bf16 v[64:67], v[28:31], v[160:167], v168
 v_smfmac_f32_16x16x64_bf16 v[36:39], v[28:31], a[40:47], v168
 v_smfmac_f32_16x16x64_bf16 v[40:43], v[28:31], a[96:103], v168
 v_smfmac_f32_16x16x64_bf16 v[44:47], v[28:31], a[152:159], v168
 v_smfmac_f32_16x16x64_bf16 v[48:51], v[28:31], a[208:215], v168
 v_smfmac_f32_16x16x64_bf16 v[52:55], v[28:31], v[184:191], v168
 v_smfmac_f32_16x16x64_bf16 v[56:59], v[28:31], v[240:247], v168
 s_waitcnt lgkmcnt(0)
 v_smfmac_f32_16x16x64_bf16 v[60:63], v[32:35], v[136:143], v168
 v_smfmac_f32_16x16x64_bf16 v[64:67], v[32:35], v[144:151], v168
 v_smfmac_f32_16x16x64_bf16 v[36:39], v[32:35], a[48:55], v168
 v_smfmac_f32_16x16x64_bf16 v[40:43], v[32:35], a[104:111], v168
 v_smfmac_f32_16x16x64_bf16 v[44:47], v[32:35], a[160:167], v168
 v_smfmac_f32_16x16x64_bf16 v[48:51], v[32:35], a[216:223], v168
 v_smfmac_f32_16x16x64_bf16 v[52:55], v[32:35], v[192:199], v168
 v_smfmac_f32_16x16x64_bf16 v[56:59], v[32:35], v[248:255], v168
 s_nop 0
 v_pk_add_f32 v[60:61], v[60:61], v[62:63]
 v_pk_add_f32 v[64:65], v[64:65], v[66:67]
 v_pk_add_f32 v[36:37], v[36:37], v[38:39]
 v_pk_add_f32 v[40:41], v[40:41], v[42:43]
 v_pk_add_f32 v[44:45], v[44:45], v[46:47]
 v_pk_add_f32 v[48:49], v[48:49], v[50:51]
 v_pk_add_f32 v[52:53], v[52:53], v[54:55]
 v_pk_add_f32 v[56:57], v[56:57], v[58:59]
 v_cvt_pk_bf16_f32 v71, v60, v61
 v_cvt_pk_bf16_f32 v75, v64, v65
 v_cvt_pk_bf16_f32 v68, v36, v37
 v_cvt_pk_bf16_f32 v72, v40, v41
 v_cvt_pk_bf16_f32 v70, v44, v45
 v_cvt_pk_bf16_f32 v74, v48, v49
 v_cvt_pk_bf16_f32 v69, v52, v53
 v_cvt_pk_bf16_f32 v73, v56, v57
 s_nop 0
 v_permlane32_swap_b32 v68, v69
 v_permlane32_swap_b32 v70, v71
 v_permlane32_swap_b32 v72, v73
 v_permlane32_swap_b32 v74, v75
 v_permlane16_swap_b32 v68, v70
 v_permlane16_swap_b32 v69, v71
 v_permlane16_swap_b32 v72, v74
 v_permlane16_swap_b32 v73, v75
 s_sleep 2
 s_mov_b32 s31, 0
 buffer_load_dwordx4 v[116:119], v170, s[64:67], s22 offen sc1
 buffer_load_dwordx4 v[120:123], v170, s[64:67], s22 offen offset:1024 sc1
 buffer_load_dwordx2 v[124:125], v171, s[64:67], s22 offen sc1
 s_nop 15
 s_nop 15
 buffer_load_dwordx4 v[116:119], v170, s[64:67], s22 offen sc1
 buffer_load_dwordx4 v[120:123], v170, s[64:67], s22 offen offset:1024 sc1
 buffer_load_dwordx2 v[124:125], v171, s[64:67], s22 offen sc1
L_q2_52_w:
 s_waitcnt vmcnt(3)
 v_max3_u32 v6, v119, v123, v124
 v_max_u32 v6, v6, v125
 v_cmp_eq_u32 vcc, -1, v6
 v_smfmac_f32_16x16x32_bf16 v[128:131], v[124:125], v[68:71], v168
 v_smfmac_f32_16x16x32_bf16 v[132:135], v[124:125], v[72:75], v168
 s_cbranch_vccnz L_q2_52
 s_nop 3
 v_smfmac_f32_16x16x64_bf16 v[128:131], v[116:119], v[84:91], v168
 v_smfmac_f32_16x16x64_bf16 v[128:131], v[120:123], v[100:107], v168
 v_smfmac_f32_16x16x64_bf16 v[132:135], v[116:119], v[92:99], v168
 v_smfmac_f32_16x16x64_bf16 v[132:135], v[120:123], v[108:115], v168
 s_nop 5
 v_pk_add_f32 v[128:129], v[128:129], v[130:131]
 ds_write2_b32 v172, v128, v129 offset0:0 offset1:40
 v_pk_add_f32 v[132:133], v[132:133], v[134:135]
 ds_write2_b32 v172, v132, v133 offset0:16 offset1:56
 s_waitcnt lgkmcnt(0)
 s_barrier
 s_add_u32 s29, s28, 2098176
 s_add_u32 s28, s28, 8192
 s_cmp_eq_u32 s30, 62
 s_cbranch_scc1 L_Bloop_50_x
 v_mov_b32 v36, 0
 v_mov_b32 v37, 0
 v_mov_b32 v38, 0
 v_mov_b32 v39, 0
 v_mov_b32 v40, 0
 v_mov_b32 v41, 0
 v_mov_b32 v42, 0
 v_mov_b32 v43, 0
 v_mov_b32 v44, 0
 v_mov_b32 v45, 0
 v_mov_b32 v46, 0
 v_mov_b32 v47, 0
 v_mov_b32 v48, 0
 v_mov_b32 v49, 0
 v_mov_b32 v50, 0
 v_mov_b32 v51, 0
 v_mov_b32 v52, 0
 v_mov_b32 v53, 0
 v_mov_b32 v54, 0
 v_mov_b32 v55, 0
 v_mov_b32 v56, 0
 v_mov_b32 v57, 0
 v_mov_b32 v58, 0
 v_mov_b32 v59, 0
 v_mov_b32 v60, 0
 v_mov_b32 v61, 0
 v_mov_b32 v62, 0
 v_mov_b32 v63, 0
 v_mov_b32 v64, 0
 v_mov_b32 v65, 0
 v_mov_b32 v66, 0
 v_mov_b32 v67, 0
 v_mov_b32 v128, 0
 v_mov_b32 v129, 0
 v_mov_b32 v130, 0
 v_mov_b32 v131, 0
 v_mov_b32 v132, 0
 v_mov_b32 v133, 0
 v_mov_b32 v134, 0
 v_mov_b32 v135, 0
 s_add_u32 s25, s25, 8192
 s_add_u32 s26, s25, 2098176
 s_add_u32 s27, s27, 10240
 s_add_u32 s33, s33, 1024
 s_add_u32 s30, s30, 1
 s_cmp_lt_u32 s30, 63
 s_cbranch_scc1 L_Bloop_50
L_Bloop_50_x:
 s_branch L_exit
L_fp_51:
 s_add_u32 s31, s31, 1
 s_cmp_ge_u32 s31, 48
 s_cbranch_scc1 L_fp_51_sw
L_fp_51_r:
 buffer_load_dwordx4 v[8:11], v169, s[64:67], s20 offen sc1
 buffer_load_dwordx4 v[12:15], v169, s[64:67], s21 offen sc1
 buffer_load_dword v7, v4, s[64:67], s33 offen sc1
 s_branch L_fp_51_w
L_fp_51_sw:
 s_cmp_gt_u32 s31, 524288
 s_cbranch_scc1 L_exit
 s_cmp_lg_u32 s31, 48
 s_cbranch_scc1 L_fp_51_r
 s_waitcnt vmcnt(0)
 s_add_u32 s20, s26, 6144
 s_add_u32 s21, s26, 0
 s_branch L_fp_51_r
L_q2_52:
 buffer_load_dwordx4 v[116:119], v170, s[64:67], s22 offen sc1
 buffer_load_dwordx4 v[120:123], v170, s[64:67], s22 offen offset:1024 sc1
 buffer_load_dwordx2 v[124:125], v171, s[64:67], s22 offen sc1
 s_nop 2
 v_mov_b32 v128, 0
 v_mov_b32 v129, 0
 v_mov_b32 v130, 0
 v_mov_b32 v131, 0
 v_mov_b32 v132, 0
 v_mov_b32 v133, 0
 v_mov_b32 v134, 0
 v_mov_b32 v135, 0
 s_add_u32 s31, s31, 1
 s_cmp_lt_u32 s31, 64
 s_cbranch_scc1 L_q2_52_w
 s_cmp_gt_u32 s31, 524288
 s_cbranch_scc1 L_exit
 s_cmp_lg_u32 s31, 64
 s_cbranch_scc1 L_q2_52_w
 s_waitcnt vmcnt(0)
 s_add_u32 s22, s27, 655360
 buffer_load_dwordx4 v[116:119], v170, s[64:67], s22 offen sc1
 buffer_load_dwordx4 v[120:123], v170, s[64:67], s22 offen offset:1024 sc1
 buffer_load_dwordx2 v[124:125], v171, s[64:67], s22 offen sc1
 buffer_load_dwordx4 v[116:119], v170, s[64:67], s22 offen sc1
 buffer_load_dwordx4 v[120:123], v170, s[64:67], s22 offen offset:1024 sc1
 buffer_load_dwordx2 v[124:125], v171, s[64:67], s22 offen sc1
 s_branch L_q2_52_w
L_pad10:
 s_setpc_b64 s[94:95]
L_TB:
 v_lshlrev_b32 v169, 4, v0
 v_mov_b32 v172, 0
 s_lshl_b32 s26, s12, 12
 s_mul_i32 s27, s12, 3072
 s_add_u32 s27, s27, 16384
 s_mov_b32 s30, s37
 s_lshl_b32 s13, s11, 2
 s_add_u32 s13, s13, s12
 s_mul_i32 s13, s13, 114688
 s_add_u32 s13, s13, 6422528
 s_mul_i32 s15, s12, 28672
 s_mov_b32 s36, s13
 s_cmp_lg_u32 s12, 0
 s_cbranch_scc1 L_wg_53_done
 v_lshlrev_b32 v1, 7, v0
 s_mov_b32 s31, 0
 s_mov_b32 s3, 53501952
 s_mov_b32 exec_lo, 262143
 s_mov_b32 exec_hi, 1
L_wg_53:
 buffer_load_dword v2, v1, s[64:67], s3 offen sc1
 s_add_u32 s31, s31, 1
 s_cmp_gt_u32 s31, 524288
 s_cbranch_scc1 L_exit
 s_waitcnt vmcnt(0)
 v_cmp_eq_u32 vcc, 0, v2
 s_cbranch_vccz L_wg_53_ok
 s_sleep 2
 s_branch L_wg_53
L_wg_53_ok:
 s_mov_b64 exec, -1
L_wg_53_done:
 s_barrier
 s_mul_i32 s13, s30, 28672
 s_add_u32 s13, s13, s26
 s_add_u32 s24, s13, 44040192
 s_add_u32 m0, s26, 114688
 s_nop 0
 buffer_load_dwordx4 v169, s[64:67], s24 offen sc1 lds
 buffer_load_dwordx4 v169, s[64:67], s24 offen offset:1024 sc1 lds
 buffer_load_dwordx4 v169, s[64:67], s24 offen offset:2048 sc1 lds
 buffer_load_dwordx4 v169, s[64:67], s24 offen offset:3072 sc1 lds
 s_mul_i32 s13, s30, 28672
 s_add_u32 s13, s13, s27
 s_add_u32 s24, s13, 44040192
 s_add_u32 m0, s27, 114688
 s_nop 0
 buffer_load_dwordx4 v169, s[64:67], s24 offen sc1 lds
 buffer_load_dwordx4 v169, s[64:67], s24 offen offset:1024 sc1 lds
 buffer_load_dwordx4 v169, s[64:67], s24 offen offset:2048 sc1 lds
 s_add_u32 m0, s15, 0
 s_add_u32 s14, s36, 86016
 buffer_load_dwordx4 v169, s[64:67], s14 offen sc1 lds
 buffer_load_dwordx4 v169, s[64:67], s14 offen offset:1024 sc1 lds
 s_add_u32 m0, s15, 14336
 s_add_u32 s14, s36, 100352
 buffer_load_dwordx4 v169, s[64:67], s14 offen sc1 lds
 buffer_load_dwordx4 v169, s[64:67], s14 offen offset:1024 sc1 lds
 s_add_u32 s14, s36, 0
 buffer_load_dwordx4 a[0:3], v169, s[64:67], s14 offen sc1
 buffer_load_dwordx4 a[4:7], v169, s[64:67], s14 offen offset:1024 sc1
 s_add_u32 s14, s36, 14336
 buffer_load_dwordx4 a[56:59], v169, s[64:67], s14 offen sc1
 buffer_load_dwordx4 a[60:63], v169, s[64:67], s14 offen offset:1024 sc1
 s_add_u32 s14, s36, 28672
 buffer_load_dwordx4 a[112:115], v169, s[64:67], s14 offen sc1
 buffer_load_dwordx4 a[116:119], v169, s[64:67], s14 offen offset:1024 sc1
 s_add_u32 s14, s36, 43008
 buffer_load_dwordx4 a[168:171], v169, s[64:67], s14 offen sc1
 buffer_load_dwordx4 a[172:175], v169, s[64:67], s14 offen offset:1024 sc1
 s_add_u32 s14, s36, 57344
 buffer_load_dwordx4 a[224:227], v169, s[64:67], s14 offen sc1
 buffer_load_dwordx4 a[228:231], v169, s[64:67], s14 offen offset:1024 sc1
 s_add_u32 s14, s36, 71680
 buffer_load_dwordx4 v[200:203], v169, s[64:67], s14 offen sc1
 buffer_load_dwordx4 v[204:207], v169, s[64:67], s14 offen offset:1024 sc1
 s_add_u32 m0, s15, 2048
 s_add_u32 s14, s36, 88064
 buffer_load_dwordx4 v169, s[64:67], s14 offen sc1 lds
 buffer_load_dwordx4 v169, s[64:67], s14 offen offset:1024 sc1 lds
 s_add_u32 m0, s15, 16384
 s_add_u32 s14, s36, 102400
 buffer_load_dwordx4 v169, s[64:67], s14 offen sc1 lds
 buffer_load_dwordx4 v169, s[64:67], s14 offen offset:1024 sc1 lds
 s_add_u32 s14, s36, 2048
 buffer_load_dwordx4 a[8:11], v169, s[64:67], s14 offen sc1
 buffer_load_dwordx4 a[12:15], v169, s[64:67], s14 offen offset:1024 sc1
 s_add_u32 s14, s36, 16384
 buffer_load_dwordx4 a[64:67], v169, s[64:67], s14 offen sc1
 buffer_load_dwordx4 a[68:71], v169, s[64:67], s14 offen offset:1024 sc1
 s_add_u32 s14, s36, 30720
 buffer_load_dwordx4 a[120:123], v169, s[64:67], s14 offen sc1
 buffer_load_dwordx4 a[124:127], v169, s[64:67], s14 offen offset:1024 sc1
 s_add_u32 s14, s36, 45056
 buffer_load_dwordx4 a[176:179], v169, s[64:67], s14 offen sc1
 buffer_load_dwordx4 a[180:183], v169, s[64:67], s14 offen offset:1024 sc1
 s_add_u32 s14, s36, 59392
 buffer_load_dwordx4 a[232:235], v169, s[64:67], s14 offen sc1
 buffer_load_dwordx4 a[236:239], v169, s[64:67], s14 offen offset:1024 sc1
 s_add_u32 s14, s36, 73728
 buffer_load_dwordx4 v[208:211], v169, s[64:67], s14 offen sc1
 buffer_load_dwordx4 v[212:215], v169, s[64:67], s14 offen offset:1024 sc1
 v_add_u32 v170, s15, v169
 v_add_u32 v171, 114688, v169
 v_bfe_u32 v5, v0, 1, 1
 v_mov_b32 v6, 0x4444
 v_mov_b32 v7, 0xeeee
 v_cmp_eq_u32 vcc, 1, v5
 s_nop 1
 v_cndmask_b32 v168, v6, v7, vcc
 s_lshl_b32 s13, s11, 15
 s_lshl_b32 s14, s12, 13
 s_add_u32 s13, s13, s14
 s_add_u32 s28, s13, 12845056
 s_lshl_b32 s13, s11, 6
 s_lshl_b32 s14, s12, 2
 s_add_u32 s13, s13, s14
 s_add_u32 s29, s13, 52166656
 s_mov_b32 s33, 0x7ffffff0
 s_waitcnt vmcnt(28)
 s_barrier
 ds_read_b128 v[72:75], v171
 ds_read_b128 v[76:79], v171 offset:1024
 ds_read_b128 v[88:91], v170
 ds_read_b128 v[92:95], v170 offset:14336
 s_add_u32 s32, s30, 4
 s_min_u32 s38, s32, 63
 s_waitcnt lgkmcnt(0)
 s_waitcnt vmcnt(16)
 v_mfma_f32_16x16x32_bf16 v[8:11], v[72:75], a[0:3], 0
 ds_read_b128 v[80:83], v171 offset:2048
 s_add_u32 m0, s15, 4096
 s_add_u32 s14, s36, 90112
 buffer_load_dwordx4 v169, s[64:67], s14 offen sc1 lds
 v_mfma_f32_16x16x32_bf16 v[12:15], v[76:79], a[0:3], 0
 ds_read_b128 v[84:87], v171 offset:3072
 buffer_load_dwordx4 v169, s[64:67], s14 offen offset:1024 sc1 lds
 v_mfma_f32_16x16x32_bf16 v[16:19], v[72:75], a[56:59], 0
 ds_read_b128 v[96:99], v170 offset:1024
 s_add_u32 m0, s15, 18432
 s_add_u32 s14, s36, 104448
 buffer_load_dwordx4 v169, s[64:67], s14 offen sc1 lds
 v_mfma_f32_16x16x32_bf16 v[20:23], v[76:79], a[56:59], 0
 ds_read_b128 v[100:103], v170 offset:15360
 buffer_load_dwordx4 v169, s[64:67], s14 offen offset:1024 sc1 lds
 v_mfma_f32_16x16x32_bf16 v[24:27], v[72:75], a[112:115], 0
 s_add_u32 s14, s36, 4096
 buffer_load_dwordx4 a[16:19], v169, s[64:67], s14 offen sc1
 v_mfma_f32_16x16x32_bf16 v[28:31], v[76:79], a[112:115], 0
 buffer_load_dwordx4 a[20:23], v169, s[64:67], s14 offen offset:1024 sc1
 v_mfma_f32_16x16x32_bf16 v[32:35], v[72:75], a[168:171], 0
 s_add_u32 s14, s36, 18432
 buffer_load_dwordx4 a[72:75], v169, s[64:67], s14 offen sc1
 v_mfma_f32_16x16x32_bf16 v[36:39], v[76:79], a[168:171], 0
 buffer_load_dwordx4 a[76:79], v169, s[64:67], s14 offen offset:1024 sc1
 v_mfma_f32_16x16x32_bf16 v[40:43], v[72:75], a[224:227], 0
 s_add_u32 s14, s36, 32768
 buffer_load_dwordx4 a[128:131], v169, s[64:67], s14 offen sc1
 v_mfma_f32_16x16x32_bf16 v[44:47], v[76:79], a[224:227], 0
 buffer_load_dwordx4 a[132:135], v169, s[64:67], s14 offen offset:1024 sc1
 v_mfma_f32_16x16x32_bf16 v[48:51], v[72:75], v[200:203], 0
 s_add_u32 s14, s36, 47104
 buffer_load_dwordx4 a[184:187], v169, s[64:67], s14 offen sc1
 v_mfma_f32_16x16x32_bf16 v[52:55], v[76:79], v[200:203], 0
 buffer_load_dwordx4 a[188:191], v169, s[64:67], s14 offen offset:1024 sc1
 v_mfma_f32_16x16x32_bf16 v[56:59], v[72:75], v[88:91], 0
 s_add_u32 s14, s36, 61440
 buffer_load_dwordx4 a[240:243], v169, s[64:67], s14 offen sc1
 v_mfma_f32_16x16x32_bf16 v[60:63], v[76:79], v[88:91], 0
 buffer_load_dwordx4 a[244:247], v169, s[64:67], s14 offen offset:1024 sc1
 v_mfma_f32_16x16x32_bf16 v[64:67], v[72:75], v[92:95], 0
 s_add_u32 s14, s36, 75776
 buffer_load_dwordx4 v[216:219], v169, s[64:67], s14 offen sc1
 v_mfma_f32_16x16x32_bf16 v[68:71], v[76:79], v[92:95], 0
 buffer_load_dwordx4 v[220:223], v169, s[64:67], s14 offen offset:1024 sc1
 s_waitcnt lgkmcnt(0)
 s_waitcnt vmcnt(28)
 v_mfma_f32_16x16x32_bf16 v[8:11], v[80:83], a[4:7], v[8:11]
 ds_read_b128 v[72:75], v171 offset:4096
 v_mfma_f32_16x16x32_bf16 v[12:15], v[84:87], a[4:7], v[12:15]
 ds_read_b128 v[76:79], v171 offset:5120
 v_mfma_f32_16x16x32_bf16 v[16:19], v[80:83], a[60:63], v[16:19]
 ds_read_b128 v[88:91], v170 offset:2048
 v_mfma_f32_16x16x32_bf16 v[20:23], v[84:87], a[60:63], v[20:23]
 ds_read_b128 v[92:95], v170 offset:16384
 v_mfma_f32_16x16x32_bf16 v[24:27], v[80:83], a[116:119], v[24:27]
 v_mfma_f32_16x16x32_bf16 v[28:31], v[84:87], a[116:119], v[28:31]
 v_mfma_f32_16x16x32_bf16 v[32:35], v[80:83], a[172:175], v[32:35]
 v_mfma_f32_16x16x32_bf16 v[36:39], v[84:87], a[172:175], v[36:39]
 v_mfma_f32_16x16x32_bf16 v[40:43], v[80:83], a[228:231], v[40:43]
 v_mfma_f32_16x16x32_bf16 v[44:47], v[84:87], a[228:231], v[44:47]
 v_mfma_f32_16x16x32_bf16 v[48:51], v[80:83], v[204:207], v[48:51]
 v_mfma_f32_16x16x32_bf16 v[52:55], v[84:87], v[204:207], v[52:55]
 v_mfma_f32_16x16x32_bf16 v[56:59], v[80:83], v[96:99], v[56:59]
 v_mfma_f32_16x16x32_bf16 v[60:63], v[84:87], v[96:99], v[60:63]
 v_mfma_f32_16x16x32_bf16 v[64:67], v[80:83], v[100:103], v[64:67]
 v_mfma_f32_16x16x32_bf16 v[68:71], v[84:87], v[100:103], v[68:71]
 s_waitcnt lgkmcnt(0)
 s_waitcnt vmcnt(16)
 v_mfma_f32_16x16x32_bf16 v[8:11], v[72:75], a[8:11], v[8:11]
 ds_read_b128 v[80:83], v171 offset:6144
 s_add_u32 m0, s15, 6144
 s_add_u32 s14, s36, 92160
 buffer_load_dwordx4 v169, s[64:67], s14 offen sc1 lds
 v_mfma_f32_16x16x32_bf16 v[12:15], v[76:79], a[8:11], v[12:15]
 ds_read_b128 v[84:87], v171 offset:7168
 buffer_load_dwordx4 v169, s[64:67], s14 offen offset:1024 sc1 lds
 v_mfma_f32_16x16x32_bf16 v[16:19], v[72:75], a[64:67], v[16:19]
 ds_read_b128 v[96:99], v170 offset:3072
 s_add_u32 m0, s15, 20480
 s_add_u32 s14, s36, 106496
 buffer_load_dwordx4 v169, s[64:67], s14 offen sc1 lds
 v_mfma_f32_16x16x32_bf16 v[20:23], v[76:79], a[64:67], v[20:23]
 ds_read_b128 v[100:103], v170 offset:17408
 buffer_load_dwordx4 v169, s[64:67], s14 offen offset:1024 sc1 lds
 v_mfma_f32_16x16x32_bf16 v[24:27], v[72:75], a[120:123], v[24:27]
 s_add_u32 s14, s36, 6144
 buffer_load_dwordx4 a[24:27], v169, s[64:67], s14 offen sc1
 v_mfma_f32_16x16x32_bf16 v[28:31], v[76:79], a[120:123], v[28:31]
 buffer_load_dwordx4 a[28:31], v169, s[64:67], s14 offen offset:1024 sc1
 v_mfma_f32_16x16x32_bf16 v[32:35], v[72:75], a[176:179], v[32:35]
 s_add_u32 s14, s36, 20480
 buffer_load_dwordx4 a[80:83], v169, s[64:67], s14 offen sc1
 v_mfma_f32_16x16x32_bf16 v[36:39], v[76:79], a[176:179], v[36:39]
 buffer_load_dwordx4 a[84:87], v169, s[64:67], s14 offen offset:1024 sc1
 v_mfma_f32_16x16x32_bf16 v[40:43], v[72:75], a[232:235], v[40:43]
 s_add_u32 s14, s36, 34816
 buffer_load_dwordx4 a[136:139], v169, s[64:67], s14 offen sc1
 v_mfma_f32_16x16x32_bf16 v[44:47], v[76:79], a[232:235], v[44:47]
 buffer_load_dwordx4 a[140:143], v169, s[64:67], s14 offen offset:1024 sc1
 v_mfma_f32_16x16x32_bf16 v[48:51], v[72:75], v[208:211], v[48:51]
 s_add_u32 s14, s36, 49152
 buffer_load_dwordx4 a[192:195], v169, s[64:67], s14 offen sc1
 v_mfma_f32_16x16x32_bf16 v[52:55], v[76:79], v[208:211], v[52:55]
 buffer_load_dwordx4 a[196:199], v169, s[64:67], s14 offen offset:1024 sc1
 v_mfma_f32_16x16x32_bf16 v[56:59], v[72:75], v[88:91], v[56:59]
 s_add_u32 s14, s36, 63488
 buffer_load_dwordx4 a[248:251], v169, s[64:67], s14 offen sc1
 v_mfma_f32_16x16x32_bf16 v[60:63], v[76:79], v[88:91], v[60:63]
 buffer_load_dwordx4 a[252:255], v169, s[64:67], s14 offen offset:1024 sc1
 v_mfma_f32_16x16x32_bf16 v[64:67], v[72:75], v[92:95], v[64:67]
 s_add_u32 s14, s36, 77824
 buffer_load_dwordx4 v[224:227], v169, s[64:67], s14 offen sc1
 v_mfma_f32_16x16x32_bf16 v[68:71], v[76:79], v[92:95], v[68:71]
 buffer_load_dwordx4 v[228:231], v169, s[64:67], s14 offen offset:1024 sc1
 s_waitcnt lgkmcnt(0)
 s_waitcnt vmcnt(28)
 v_mfma_f32_16x16x32_bf16 v[8:11], v[80:83], a[12:15], v[8:11]
 ds_read_b128 v[72:75], v171 offset:8192
 v_mfma_f32_16x16x32_bf16 v[12:15], v[84:87], a[12:15], v[12:15]
 ds_read_b128 v[76:79], v171 offset:9216
 v_mfma_f32_16x16x32_bf16 v[16:19], v[80:83], a[68:71], v[16:19]
 ds_read_b128 v[88:91], v170 offset:4096
 v_mfma_f32_16x16x32_bf16 v[20:23], v[84:87], a[68:71], v[20:23]
 ds_read_b128 v[92:95], v170 offset:18432
 v_mfma_f32_16x16x32_bf16 v[24:27], v[80:83], a[124:127], v[24:27]
 v_mfma_f32_16x16x32_bf16 v[28:31], v[84:87], a[124:127], v[28:31]
 v_mfma_f32_16x16x32_bf16 v[32:35], v[80:83], a[180:183], v[32:35]
 v_mfma_f32_16x16x32_bf16 v[36:39], v[84:87], a[180:183], v[36:39]
 v_mfma_f32_16x16x32_bf16 v[40:43], v[80:83], a[236:239], v[40:43]
 v_mfma_f32_16x16x32_bf16 v[44:47], v[84:87], a[236:239], v[44:47]
 v_mfma_f32_16x16x32_bf16 v[48:51], v[80:83], v[212:215], v[48:51]
 v_mfma_f32_16x16x32_bf16 v[52:55], v[84:87], v[212:215], v[52:55]
 v_mfma_f32_16x16x32_bf16 v[56:59], v[80:83], v[96:99], v[56:59]
 v_mfma_f32_16x16x32_bf16 v[60:63], v[84:87], v[96:99], v[60:63]
 v_mfma_f32_16x16x32_bf16 v[64:67], v[80:83], v[100:103], v[64:67]
 v_mfma_f32_16x16x32_bf16 v[68:71], v[84:87], v[100:103], v[68:71]
 s_waitcnt lgkmcnt(0)
 s_waitcnt vmcnt(16)
 v_mfma_f32_16x16x32_bf16 v[8:11], v[72:75], a[16:19], v[8:11]
 ds_read_b128 v[80:83], v171 offset:10240
 s_add_u32 m0, s15, 8192
 s_add_u32 s14, s36, 94208
 buffer_load_dwordx4 v169, s[64:67], s14 offen sc1 lds
 v_mfma_f32_16x16x32_bf16 v[12:15], v[76:79], a[16:19], v[12:15]
 ds_read_b128 v[84:87], v171 offset:11264
 buffer_load_dwordx4 v169, s[64:67], s14 offen offset:1024 sc1 lds
 v_mfma_f32_16x16x32_bf16 v[16:19], v[72:75], a[72:75], v[16:19]
 ds_read_b128 v[96:99], v170 offset:5120
 s_add_u32 m0, s15, 22528
 s_add_u32 s14, s36, 108544
 buffer_load_dwordx4 v169, s[64:67], s14 offen sc1 lds
 v_mfma_f32_16x16x32_bf16 v[20:23], v[76:79], a[72:75], v[20:23]
 ds_read_b128 v[100:103], v170 offset:19456
 buffer_load_dwordx4 v169, s[64:67], s14 offen offset:1024 sc1 lds
 v_mfma_f32_16x16x32_bf16 v[24:27], v[72:75], a[128:131], v[24:27]
 s_add_u32 s14, s36, 8192
 buffer_load_dwordx4 a[32:35], v169, s[64:67], s14 offen sc1
 v_mfma_f32_16x16x32_bf16 v[28:31], v[76:79], a[128:131], v[28:31]
 buffer_load_dwordx4 a[36:39], v169, s[64:67], s14 offen offset:1024 sc1
 v_mfma_f32_16x16x32_bf16 v[32:35], v[72:75], a[184:187], v[32:35]
 s_add_u32 s14, s36, 22528
 buffer_load_dwordx4 a[88:91], v169, s[64:67], s14 offen sc1
 v_mfma_f32_16x16x32_bf16 v[36:39], v[76:79], a[184:187], v[36:39]
 buffer_load_dwordx4 a[92:95], v169, s[64:67], s14 offen offset:1024 sc1
 v_mfma_f32_16x16x32_bf16 v[40:43], v[72:75], a[240:243], v[40:43]
 s_add_u32 s14, s36, 36864
 buffer_load_dwordx4 a[144:147], v169, s[64:67], s14 offen sc1
 v_mfma_f32_16x16x32_bf16 v[44:47], v[76:79], a[240:243], v[44:47]
 buffer_load_dwordx4 a[148:151], v169, s[64:67], s14 offen offset:1024 sc1
 v_mfma_f32_16x16x32_bf16 v[48:51], v[72:75], v[216:219], v[48:51]
 s_add_u32 s14, s36, 51200
 buffer_load_dwordx4 a[200:203], v169, s[64:67], s14 offen sc1
 v_mfma_f32_16x16x32_bf16 v[52:55], v[76:79], v[216:219], v[52:55]
 buffer_load_dwordx4 a[204:207], v169, s[64:67], s14 offen offset:1024 sc1
 v_mfma_f32_16x16x32_bf16 v[56:59], v[72:75], v[88:91], v[56:59]
 s_add_u32 s14, s36, 65536
 buffer_load_dwordx4 v[176:179], v169, s[64:67], s14 offen sc1
 v_mfma_f32_16x16x32_bf16 v[60:63], v[76:79], v[88:91], v[60:63]
 buffer_load_dwordx4 v[180:183], v169, s[64:67], s14 offen offset:1024 sc1
 v_mfma_f32_16x16x32_bf16 v[64:67], v[72:75], v[92:95], v[64:67]
 s_add_u32 s14, s36, 79872
 buffer_load_dwordx4 v[232:235], v169, s[64:67], s14 offen sc1
 v_mfma_f32_16x16x32_bf16 v[68:71], v[76:79], v[92:95], v[68:71]
 buffer_load_dwordx4 v[236:239], v169, s[64:67], s14 offen offset:1024 sc1
 s_waitcnt lgkmcnt(0)
 s_waitcnt vmcnt(28)
 v_mfma_f32_16x16x32_bf16 v[8:11], v[80:83], a[20:23], v[8:11]
 ds_read_b128 v[72:75], v171 offset:12288
 v_mfma_f32_16x16x32_bf16 v[12:15], v[84:87], a[20:23], v[12:15]
 ds_read_b128 v[76:79], v171 offset:13312
 v_mfma_f32_16x16x32_bf16 v[16:19], v[80:83], a[76:79], v[16:19]
 ds_read_b128 v[88:91], v170 offset:6144
 v_mfma_f32_16x16x32_bf16 v[20:23], v[84:87], a[76:79], v[20:23]
 ds_read_b128 v[92:95], v170 offset:20480
 v_mfma_f32_16x16x32_bf16 v[24:27], v[80:83], a[132:135], v[24:27]
 v_mfma_f32_16x16x32_bf16 v[28:31], v[84:87], a[132:135], v[28:31]
 v_mfma_f32_16x16x32_bf16 v[32:35], v[80:83], a[188:191], v[32:35]
 v_mfma_f32_16x16x32_bf16 v[36:39], v[84:87], a[188:191], v[36:39]
 v_mfma_f32_16x16x32_bf16 v[40:43], v[80:83], a[244:247], v[40:43]
 v_mfma_f32_16x16x32_bf16 v[44:47], v[84:87], a[244:247], v[44:47]
 v_mfma_f32_16x16x32_bf16 v[48:51], v[80:83], v[220:223], v[48:51]
 v_mfma_f32_16x16x32_bf16 v[52:55], v[84:87], v[220:223], v[52:55]
 v_mfma_f32_16x16x32_bf16 v[56:59], v[80:83], v[96:99], v[56:59]
 v_mfma_f32_16x16x32_bf16 v[60:63], v[84:87], v[96:99], v[60:63]
 v_mfma_f32_16x16x32_bf16 v[64:67], v[80:83], v[100:103], v[64:67]
 v_mfma_f32_16x16x32_bf16 v[68:71], v[84:87], v[100:103], v[68:71]
 s_waitcnt lgkmcnt(0)
 s_waitcnt vmcnt(16)
 v_mfma_f32_16x16x32_bf16 v[8:11], v[72:75], a[24:27], v[8:11]
 ds_read_b128 v[80:83], v171 offset:14336
 s_add_u32 m0, s15, 10240
 s_add_u32 s14, s36, 96256
 buffer_load_dwordx4 v169, s[64:67], s14 offen sc1 lds
 v_mfma_f32_16x16x32_bf16 v[12:15], v[76:79], a[24:27], v[12:15]
 ds_read_b128 v[84:87], v171 offset:15360
 buffer_load_dwordx4 v169, s[64:67], s14 offen offset:1024 sc1 lds
 v_mfma_f32_16x16x32_bf16 v[16:19], v[72:75], a[80:83], v[16:19]
 ds_read_b128 v[96:99], v170 offset:7168
 s_add_u32 m0, s15, 24576
 s_add_u32 s14, s36, 110592
 buffer_load_dwordx4 v169, s[64:67], s14 offen sc1 lds
 v_mfma_f32_16x16x32_bf16 v[20:23], v[76:79], a[80:83], v[20:23]
 ds_read_b128 v[100:103], v170 offset:21504
 buffer_load_dwordx4 v169, s[64:67], s14 offen offset:1024 sc1 lds
 v_mfma_f32_16x16x32_bf16 v[24:27], v[72:75], a[136:139], v[24:27]
 s_add_u32 s14, s36, 10240
 buffer_load_dwordx4 a[40:43], v169, s[64:67], s14 offen sc1
 v_mfma_f32_16x16x32_bf16 v[28:31], v[76:79], a[136:139], v[28:31]
 buffer_load_dwordx4 a[44:47], v169, s[64:67], s14 offen offset:1024 sc1
 v_mfma_f32_16x16x32_bf16 v[32:35], v[72:75], a[192:195], v[32:35]
 s_add_u32 s14, s36, 24576
 buffer_load_dwordx4 a[96:99], v169, s[64:67], s14 offen sc1
 v_mfma_f32_16x16x32_bf16 v[36:39], v[76:79], a[192:195], v[36:39]
 buffer_load_dwordx4 a[100:103], v169, s[64:67], s14 offen offset:1024 sc1
 v_mfma_f32_16x16x32_bf16 v[40:43], v[72:75], a[248:251], v[40:43]
 s_add_u32 s14, s36, 38912
 buffer_load_dwordx4 a[152:155], v169, s[64:67], s14 offen sc1
 v_mfma_f32_16x16x32_bf16 v[44:47], v[76:79], a[248:251], v[44:47]
 buffer_load_dwordx4 a[156:159], v169, s[64:67], s14 offen offset:1024 sc1
 v_mfma_f32_16x16x32_bf16 v[48:51], v[72:75], v[224:227], v[48:51]
 s_add_u32 s14, s36, 53248
 buffer_load_dwordx4 a[208:211], v169, s[64:67], s14 offen sc1
 v_mfma_f32_16x16x32_bf16 v[52:55], v[76:79], v[224:227], v[52:55]
 buffer_load_dwordx4 a[212:215], v169, s[64:67], s14 offen offset:1024 sc1
 v_mfma_f32_16x16x32_bf16 v[56:59], v[72:75], v[88:91], v[56:59]
 s_add_u32 s14, s36, 67584
 buffer_load_dwordx4 v[184:187], v169, s[64:67], s14 offen sc1
 v_mfma_f32_16x16x32_bf16 v[60:63], v[76:79], v[88:91], v[60:63]
 buffer_load_dwordx4 v[188:191], v169, s[64:67], s14 offen offset:1024 sc1
 v_mfma_f32_16x16x32_bf16 v[64:67], v[72:75], v[92:95], v[64:67]
 s_add_u32 s14, s36, 81920
 buffer_load_dwordx4 v[240:243], v169, s[64:67], s14 offen sc1
 v_mfma_f32_16x16x32_bf16 v[68:71], v[76:79], v[92:95], v[68:71]
 buffer_load_dwordx4 v[244:247], v169, s[64:67], s14 offen offset:1024 sc1
 s_waitcnt lgkmcnt(0)
 s_waitcnt vmcnt(28)
 s_barrier
 v_mfma_f32_16x16x32_bf16 v[8:11], v[80:83], a[28:31], v[8:11]
 ds_read_b128 v[72:75], v171 offset:16384
 s_mul_i32 s13, s38, 28672
 s_add_u32 s13, s13, s26
 s_add_u32 s24, s13, 44040192
 s_add_u32 m0, s26, 114688
 s_nop 0
 buffer_load_dwordx4 v169, s[64:67], s24 offen sc1 lds
 v_mfma_f32_16x16x32_bf16 v[12:15], v[84:87], a[28:31], v[12:15]
 ds_read_b128 v[76:79], v171 offset:17408
 buffer_load_dwordx4 v169, s[64:67], s24 offen offset:1024 sc1 lds
 v_mfma_f32_16x16x32_bf16 v[16:19], v[80:83], a[84:87], v[16:19]
 ds_read_b128 v[88:91], v170 offset:8192
 buffer_load_dwordx4 v169, s[64:67], s24 offen offset:2048 sc1 lds
 v_mfma_f32_16x16x32_bf16 v[20:23], v[84:87], a[84:87], v[20:23]
 ds_read_b128 v[92:95], v170 offset:22528
 buffer_load_dwordx4 v169, s[64:67], s24 offen offset:3072 sc1 lds
 v_mfma_f32_16x16x32_bf16 v[24:27], v[80:83], a[140:143], v[24:27]
 v_mfma_f32_16x16x32_bf16 v[28:31], v[84:87], a[140:143], v[28:31]
 v_mfma_f32_16x16x32_bf16 v[32:35], v[80:83], a[196:199], v[32:35]
 v_mfma_f32_16x16x32_bf16 v[36:39], v[84:87], a[196:199], v[36:39]
 v_mfma_f32_16x16x32_bf16 v[40:43], v[80:83], a[252:255], v[40:43]
 v_mfma_f32_16x16x32_bf16 v[44:47], v[84:87], a[252:255], v[44:47]
 v_mfma_f32_16x16x32_bf16 v[48:51], v[80:83], v[228:231], v[48:51]
 v_mfma_f32_16x16x32_bf16 v[52:55], v[84:87], v[228:231], v[52:55]
 v_mfma_f32_16x16x32_bf16 v[56:59], v[80:83], v[96:99], v[56:59]
 v_mfma_f32_16x16x32_bf16 v[60:63], v[84:87], v[96:99], v[60:63]
 v_mfma_f32_16x16x32_bf16 v[64:67], v[80:83], v[100:103], v[64:67]
 v_mfma_f32_16x16x32_bf16 v[68:71], v[84:87], v[100:103], v[68:71]
 s_waitcnt lgkmcnt(0)
 s_waitcnt vmcnt(20)
 v_mfma_f32_16x16x32_bf16 v[8:11], v[72:75], a[32:35], v[8:11]
 ds_read_b128 v[80:83], v171 offset:18432
 s_add_u32 m0, s15, 12288
 s_add_u32 s14, s36, 98304
 buffer_load_dwordx4 v169, s[64:67], s14 offen sc1 lds
 v_mfma_f32_16x16x32_bf16 v[12:15], v[76:79], a[32:35], v[12:15]
 ds_read_b128 v[84:87], v171 offset:19456
 buffer_load_dwordx4 v169, s[64:67], s14 offen offset:1024 sc1 lds
 v_mfma_f32_16x16x32_bf16 v[16:19], v[72:75], a[88:91], v[16:19]
 ds_read_b128 v[96:99], v170 offset:9216
 s_add_u32 m0, s15, 26624
 s_add_u32 s14, s36, 112640
 buffer_load_dwordx4 v169, s[64:67], s14 offen sc1 lds
 v_mfma_f32_16x16x32_bf16 v[20:23], v[76:79], a[88:91], v[20:23]
 ds_read_b128 v[100:103], v170 offset:23552
 buffer_load_dwordx4 v169, s[64:67], s14 offen offset:1024 sc1 lds
 v_mfma_f32_16x16x32_bf16 v[24:27], v[72:75], a[144:147], v[24:27]
 s_add_u32 s14, s36, 12288
 buffer_load_dwordx4 a[48:51], v169, s[64:67], s14 offen sc1
 v_mfma_f32_16x16x32_bf16 v[28:31], v[76:79], a[144:147], v[28:31]
 buffer_load_dwordx4 a[52:55], v169, s[64:67], s14 offen offset:1024 sc1
 v_mfma_f32_16x16x32_bf16 v[32:35], v[72:75], a[200:203], v[32:35]
 s_add_u32 s14, s36, 26624
 buffer_load_dwordx4 a[104:107], v169, s[64:67], s14 offen sc1
 v_mfma_f32_16x16x32_bf16 v[36:39], v[76:79], a[200:203], v[36:39]
 buffer_load_dwordx4 a[108:111], v169, s[64:67], s14 offen offset:1024 sc1
 v_mfma_f32_16x16x32_bf16 v[40:43], v[72:75], v[176:179], v[40:43]
 s_add_u32 s14, s36, 40960
 buffer_load_dwordx4 a[160:163], v169, s[64:67], s14 offen sc1
 v_mfma_f32_16x16x32_bf16 v[44:47], v[76:79], v[176:179], v[44:47]
 buffer_load_dwordx4 a[164:167], v169, s[64:67], s14 offen offset:1024 sc1
 v_mfma_f32_16x16x32_bf16 v[48:51], v[72:75], v[232:235], v[48:51]
 s_add_u32 s14, s36, 55296
 buffer_load_dwordx4 a[216:219], v169, s[64:67], s14 offen sc1
 v_mfma_f32_16x16x32_bf16 v[52:55], v[76:79], v[232:235], v[52:55]
 buffer_load_dwordx4 a[220:223], v169, s[64:67], s14 offen offset:1024 sc1
 v_mfma_f32_16x16x32_bf16 v[56:59], v[72:75], v[88:91], v[56:59]
 s_add_u32 s14, s36, 69632
 buffer_load_dwordx4 v[192:195], v169, s[64:67], s14 offen sc1
 v_mfma_f32_16x16x32_bf16 v[60:63], v[76:79], v[88:91], v[60:63]
 buffer_load_dwordx4 v[196:199], v169, s[64:67], s14 offen offset:1024 sc1
 v_mfma_f32_16x16x32_bf16 v[64:67], v[72:75], v[92:95], v[64:67]
 s_add_u32 s14, s36, 83968
 buffer_load_dwordx4 v[248:251], v169, s[64:67], s14 offen sc1
 v_mfma_f32_16x16x32_bf16 v[68:71], v[76:79], v[92:95], v[68:71]
 buffer_load_dwordx4 v[252:255], v169, s[64:67], s14 offen offset:1024 sc1
 s_waitcnt lgkmcnt(0)
 s_waitcnt vmcnt(32)
 v_mfma_f32_16x16x32_bf16 v[8:11], v[80:83], a[36:39], v[8:11]
 ds_read_b128 v[72:75], v171 offset:20480
 v_mfma_f32_16x16x32_bf16 v[12:15], v[84:87], a[36:39], v[12:15]
 ds_read_b128 v[76:79], v171 offset:21504
 v_mfma_f32_16x16x32_bf16 v[16:19], v[80:83], a[92:95], v[16:19]
 ds_read_b128 v[88:91], v170 offset:10240
 v_mfma_f32_16x16x32_bf16 v[20:23], v[84:87], a[92:95], v[20:23]
 ds_read_b128 v[92:95], v170 offset:24576
 v_mfma_f32_16x16x32_bf16 v[24:27], v[80:83], a[148:151], v[24:27]
 v_mfma_f32_16x16x32_bf16 v[28:31], v[84:87], a[148:151], v[28:31]
 v_mfma_f32_16x16x32_bf16 v[32:35], v[80:83], a[204:207], v[32:35]
 v_mfma_f32_16x16x32_bf16 v[36:39], v[84:87], a[204:207], v[36:39]
 v_mfma_f32_16x16x32_bf16 v[40:43], v[80:83], v[180:183], v[40:43]
 v_mfma_f32_16x16x32_bf16 v[44:47], v[84:87], v[180:183], v[44:47]
 v_mfma_f32_16x16x32_bf16 v[48:51], v[80:83], v[236:239], v[48:51]
 v_mfma_f32_16x16x32_bf16 v[52:55], v[84:87], v[236:239], v[52:55]
 v_mfma_f32_16x16x32_bf16 v[56:59], v[80:83], v[96:99], v[56:59]
 v_mfma_f32_16x16x32_bf16 v[60:63], v[84:87], v[96:99], v[60:63]
 v_mfma_f32_16x16x32_bf16 v[64:67], v[80:83], v[100:103], v[64:67]
 v_mfma_f32_16x16x32_bf16 v[68:71], v[84:87], v[100:103], v[68:71]
 s_waitcnt lgkmcnt(0)
 s_waitcnt vmcnt(20)
 v_mfma_f32_16x16x32_bf16 v[8:11], v[72:75], a[40:43], v[8:11]
 ds_read_b128 v[80:83], v171 offset:22528
 v_mfma_f32_16x16x32_bf16 v[12:15], v[76:79], a[40:43], v[12:15]
 ds_read_b128 v[84:87], v171 offset:23552
 v_mfma_f32_16x16x32_bf16 v[16:19], v[72:75], a[96:99], v[16:19]
 ds_read_b128 v[96:99], v170 offset:11264
 v_mfma_f32_16x16x32_bf16 v[20:23], v[76:79], a[96:99], v[20:23]
 ds_read_b128 v[100:103], v170 offset:25600
 v_mfma_f32_16x16x32_bf16 v[24:27], v[72:75], a[152:155], v[24:27]
 v_mfma_f32_16x16x32_bf16 v[28:31], v[76:79], a[152:155], v[28:31]
 v_mfma_f32_16x16x32_bf16 v[32:35], v[72:75], a[208:211], v[32:35]
 v_mfma_f32_16x16x32_bf16 v[36:39], v[76:79], a[208:211], v[36:39]
 v_mfma_f32_16x16x32_bf16 v[40:43], v[72:75], v[184:187], v[40:43]
 v_mfma_f32_16x16x32_bf16 v[44:47], v[76:79], v[184:187], v[44:47]
 v_mfma_f32_16x16x32_bf16 v[48:51], v[72:75], v[240:243], v[48:51]
 v_mfma_f32_16x16x32_bf16 v[52:55], v[76:79], v[240:243], v[52:55]
 v_mfma_f32_16x16x32_bf16 v[56:59], v[72:75], v[88:91], v[56:59]
 v_mfma_f32_16x16x32_bf16 v[60:63], v[76:79], v[88:91], v[60:63]
 v_mfma_f32_16x16x32_bf16 v[64:67], v[72:75], v[92:95], v[64:67]
 v_mfma_f32_16x16x32_bf16 v[68:71], v[76:79], v[92:95], v[68:71]
 s_waitcnt lgkmcnt(0)
 s_waitcnt vmcnt(12)
 v_mfma_f32_16x16x32_bf16 v[8:11], v[80:83], a[44:47], v[8:11]
 ds_read_b128 v[72:75], v171 offset:24576
 v_mfma_f32_16x16x32_bf16 v[12:15], v[84:87], a[44:47], v[12:15]
 ds_read_b128 v[76:79], v171 offset:25600
 v_mfma_f32_16x16x32_bf16 v[16:19], v[80:83], a[100:103], v[16:19]
 ds_read_b128 v[88:91], v170 offset:12288
 v_mfma_f32_16x16x32_bf16 v[20:23], v[84:87], a[100:103], v[20:23]
 ds_read_b128 v[92:95], v170 offset:26624
 v_mfma_f32_16x16x32_bf16 v[24:27], v[80:83], a[156:159], v[24:27]
 v_mfma_f32_16x16x32_bf16 v[28:31], v[84:87], a[156:159], v[28:31]
 v_mfma_f32_16x16x32_bf16 v[32:35], v[80:83], a[212:215], v[32:35]
 v_mfma_f32_16x16x32_bf16 v[36:39], v[84:87], a[212:215], v[36:39]
 v_mfma_f32_16x16x32_bf16 v[40:43], v[80:83], v[188:191], v[40:43]
 v_mfma_f32_16x16x32_bf16 v[44:47], v[84:87], v[188:191], v[44:47]
 v_mfma_f32_16x16x32_bf16 v[48:51], v[80:83], v[244:247], v[48:51]
 v_mfma_f32_16x16x32_bf16 v[52:55], v[84:87], v[244:247], v[52:55]
 v_mfma_f32_16x16x32_bf16 v[56:59], v[80:83], v[96:99], v[56:59]
 v_mfma_f32_16x16x32_bf16 v[60:63], v[84:87], v[96:99], v[60:63]
 v_mfma_f32_16x16x32_bf16 v[64:67], v[80:83], v[100:103], v[64:67]
 v_mfma_f32_16x16x32_bf16 v[68:71], v[84:87], v[100:103], v[68:71]
 s_waitcnt lgkmcnt(0)
 s_waitcnt vmcnt(0)
 v_mfma_f32_16x16x32_bf16 v[8:11], v[72:75], a[48:51], v[8:11]
 ds_read_b128 v[80:83], v171 offset:26624
 v_mfma_f32_16x16x32_bf16 v[12:15], v[76:79], a[48:51], v[12:15]
 ds_read_b128 v[84:87], v171 offset:27648
 v_mfma_f32_16x16x32_bf16 v[16:19], v[72:75], a[104:107], v[16:19]
 ds_read_b128 v[96:99], v170 offset:13312
 v_mfma_f32_16x16x32_bf16 v[20:23], v[76:79], a[104:107], v[20:23]
 ds_read_b128 v[100:103], v170 offset:27648
 v_mfma_f32_16x16x32_bf16 v[24:27], v[72:75], a[160:163], v[24:27]
 v_mfma_f32_16x16x32_bf16 v[28:31], v[76:79], a[160:163], v[28:31]
 v_mfma_f32_16x16x32_bf16 v[32:35], v[72:75], a[216:219], v[32:35]
 v_mfma_f32_16x16x32_bf16 v[36:39], v[76:79], a[216:219], v[36:39]
 v_mfma_f32_16x16x32_bf16 v[40:43], v[72:75], v[192:195], v[40:43]
 v_mfma_f32_16x16x32_bf16 v[44:47], v[76:79], v[192:195], v[44:47]
 v_mfma_f32_16x16x32_bf16 v[48:51], v[72:75], v[248:251], v[48:51]
 v_mfma_f32_16x16x32_bf16 v[52:55], v[76:79], v[248:251], v[52:55]
 v_mfma_f32_16x16x32_bf16 v[56:59], v[72:75], v[88:91], v[56:59]
 v_mfma_f32_16x16x32_bf16 v[60:63], v[76:79], v[88:91], v[60:63]
 v_mfma_f32_16x16x32_bf16 v[64:67], v[72:75], v[92:95], v[64:67]
 v_mfma_f32_16x16x32_bf16 v[68:71], v[76:79], v[92:95], v[68:71]
 s_waitcnt lgkmcnt(0)
 v_mfma_f32_16x16x32_bf16 v[8:11], v[80:83], a[52:55], v[8:11]
 v_mfma_f32_16x16x32_bf16 v[12:15], v[84:87], a[52:55], v[12:15]
 v_mfma_f32_16x16x32_bf16 v[16:19], v[80:83], a[108:111], v[16:19]
 v_mfma_f32_16x16x32_bf16 v[20:23], v[84:87], a[108:111], v[20:23]
 v_mfma_f32_16x16x32_bf16 v[24:27], v[80:83], a[164:167], v[24:27]
 v_mfma_f32_16x16x32_bf16 v[28:31], v[84:87], a[164:167], v[28:31]
 v_mfma_f32_16x16x32_bf16 v[32:35], v[80:83], a[220:223], v[32:35]
 v_mfma_f32_16x16x32_bf16 v[36:39], v[84:87], a[220:223], v[36:39]
 v_mfma_f32_16x16x32_bf16 v[40:43], v[80:83], v[196:199], v[40:43]
 v_mfma_f32_16x16x32_bf16 v[44:47], v[84:87], v[196:199], v[44:47]
 v_mfma_f32_16x16x32_bf16 v[48:51], v[80:83], v[252:255], v[48:51]
 v_mfma_f32_16x16x32_bf16 v[52:55], v[84:87], v[252:255], v[52:55]
 v_mfma_f32_16x16x32_bf16 v[56:59], v[80:83], v[96:99], v[56:59]
 v_mfma_f32_16x16x32_bf16 v[60:63], v[84:87], v[96:99], v[60:63]
 v_mfma_f32_16x16x32_bf16 v[64:67], v[80:83], v[100:103], v[64:67]
 v_mfma_f32_16x16x32_bf16 v[68:71], v[84:87], v[100:103], v[68:71]
 s_branch L_TB1_54_e
L_TB1_54:
 s_barrier
 ds_read_b128 v[72:75], v171
 ds_read_b128 v[76:79], v171 offset:1024
 ds_read_b128 v[88:91], v170
 ds_read_b128 v[92:95], v170 offset:14336
 s_add_u32 s32, s30, 4
 s_min_u32 s38, s32, 63
 s_waitcnt lgkmcnt(0)
 v_mfma_f32_16x16x32_bf16 v[8:11], v[72:75], a[0:3], 0
 ds_read_b128 v[80:83], v171 offset:2048
 v_mfma_f32_16x16x32_bf16 v[12:15], v[76:79], a[0:3], 0
 ds_read_b128 v[84:87], v171 offset:3072
 v_mfma_f32_16x16x32_bf16 v[16:19], v[72:75], a[56:59], 0
 ds_read_b128 v[96:99], v170 offset:1024
 v_mfma_f32_16x16x32_bf16 v[20:23], v[76:79], a[56:59], 0
 ds_read_b128 v[100:103], v170 offset:15360
 v_mfma_f32_16x16x32_bf16 v[24:27], v[72:75], a[112:115], 0
 v_mfma_f32_16x16x32_bf16 v[28:31], v[76:79], a[112:115], 0
 v_mfma_f32_16x16x32_bf16 v[32:35], v[72:75], a[168:171], 0
 v_mfma_f32_16x16x32_bf16 v[36:39], v[76:79], a[168:171], 0
 v_mfma_f32_16x16x32_bf16 v[40:43], v[72:75], a[224:227], 0
 v_mfma_f32_16x16x32_bf16 v[44:47], v[76:79], a[224:227], 0
 v_mfma_f32_16x16x32_bf16 v[48:51], v[72:75], v[200:203], 0
 v_mfma_f32_16x16x32_bf16 v[52:55], v[76:79], v[200:203], 0
 v_mfma_f32_16x16x32_bf16 v[56:59], v[72:75], v[88:91], 0
 v_mfma_f32_16x16x32_bf16 v[60:63], v[76:79], v[88:91], 0
 v_mfma_f32_16x16x32_bf16 v[64:67], v[72:75], v[92:95], 0
 v_mfma_f32_16x16x32_bf16 v[68:71], v[76:79], v[92:95], 0
 s_waitcnt lgkmcnt(0)
 v_mfma_f32_16x16x32_bf16 v[8:11], v[80:83], a[4:7], v[8:11]
 ds_read_b128 v[72:75], v171 offset:4096
 v_mfma_f32_16x16x32_bf16 v[12:15], v[84:87], a[4:7], v[12:15]
 ds_read_b128 v[76:79], v171 offset:5120
 v_mfma_f32_16x16x32_bf16 v[16:19], v[80:83], a[60:63], v[16:19]
 ds_read_b128 v[88:91], v170 offset:2048
 v_mfma_f32_16x16x32_bf16 v[20:23], v[84:87], a[60:63], v[20:23]
 ds_read_b128 v[92:95], v170 offset:16384
 v_mfma_f32_16x16x32_bf16 v[24:27], v[80:83], a[116:119], v[24:27]
 v_mfma_f32_16x16x32_bf16 v[28:31], v[84:87], a[116:119], v[28:31]
 v_mfma_f32_16x16x32_bf16 v[32:35], v[80:83], a[172:175], v[32:35]
 v_mfma_f32_16x16x32_bf16 v[36:39], v[84:87], a[172:175], v[36:39]
 v_mfma_f32_16x16x32_bf16 v[40:43], v[80:83], a[228:231], v[40:43]
 v_mfma_f32_16x16x32_bf16 v[44:47], v[84:87], a[228:231], v[44:47]
 v_mfma_f32_16x16x32_bf16 v[48:51], v[80:83], v[204:207], v[48:51]
 v_mfma_f32_16x16x32_bf16 v[52:55], v[84:87], v[204:207], v[52:55]
 v_mfma_f32_16x16x32_bf16 v[56:59], v[80:83], v[96:99], v[56:59]
 v_mfma_f32_16x16x32_bf16 v[60:63], v[84:87], v[96:99], v[60:63]
 v_mfma_f32_16x16x32_bf16 v[64:67], v[80:83], v[100:103], v[64:67]
 v_mfma_f32_16x16x32_bf16 v[68:71], v[84:87], v[100:103], v[68:71]
 s_waitcnt lgkmcnt(0)
 v_mfma_f32_16x16x32_bf16 v[8:11], v[72:75], a[8:11], v[8:11]
 ds_read_b128 v[80:83], v171 offset:6144
 v_mfma_f32_16x16x32_bf16 v[12:15], v[76:79], a[8:11], v[12:15]
 ds_read_b128 v[84:87], v171 offset:7168
 v_mfma_f32_16x16x32_bf16 v[16:19], v[72:75], a[64:67], v[16:19]
 ds_read_b128 v[96:99], v170 offset:3072
 v_mfma_f32_16x16x32_bf16 v[20:23], v[76:79], a[64:67], v[20:23]
 ds_read_b128 v[100:103], v170 offset:17408
 v_mfma_f32_16x16x32_bf16 v[24:27], v[72:75], a[120:123], v[24:27]
 v_mfma_f32_16x16x32_bf16 v[28:31], v[76:79], a[120:123], v[28:31]
 v_mfma_f32_16x16x32_bf16 v[32:35], v[72:75], a[176:179], v[32:35]
 v_mfma_f32_16x16x32_bf16 v[36:39], v[76:79], a[176:179], v[36:39]
 v_mfma_f32_16x16x32_bf16 v[40:43], v[72:75], a[232:235], v[40:43]
 v_mfma_f32_16x16x32_bf16 v[44:47], v[76:79], a[232:235], v[44:47]
 v_mfma_f32_16x16x32_bf16 v[48:51], v[72:75], v[208:211], v[48:51]
 v_mfma_f32_16x16x32_bf16 v[52:55], v[76:79], v[208:211], v[52:55]
 v_mfma_f32_16x16x32_bf16 v[56:59], v[72:75], v[88:91], v[56:59]
 v_mfma_f32_16x16x32_bf16 v[60:63], v[76:79], v[88:91], v[60:63]
 v_mfma_f32_16x16x32_bf16 v[64:67], v[72:75], v[92:95], v[64:67]
 v_mfma_f32_16x16x32_bf16 v[68:71], v[76:79], v[92:95], v[68:71]
 s_waitcnt lgkmcnt(0)
 v_mfma_f32_16x16x32_bf16 v[8:11], v[80:83], a[12:15], v[8:11]
 ds_read_b128 v[72:75], v171 offset:8192
 v_mfma_f32_16x16x32_bf16 v[12:15], v[84:87], a[12:15], v[12:15]
 ds_read_b128 v[76:79], v171 offset:9216
 v_mfma_f32_16x16x32_bf16 v[16:19], v[80:83], a[68:71], v[16:19]
 ds_read_b128 v[88:91], v170 offset:4096
 v_mfma_f32_16x16x32_bf16 v[20:23], v[84:87], a[68:71], v[20:23]
 ds_read_b128 v[92:95], v170 offset:18432
 v_mfma_f32_16x16x32_bf16 v[24:27], v[80:83], a[124:127], v[24:27]
 v_mfma_f32_16x16x32_bf16 v[28:31], v[84:87], a[124:127], v[28:31]
 v_mfma_f32_16x16x32_bf16 v[32:35], v[80:83], a[180:183], v[32:35]
 v_mfma_f32_16x16x32_bf16 v[36:39], v[84:87], a[180:183], v[36:39]
 v_mfma_f32_16x16x32_bf16 v[40:43], v[80:83], a[236:239], v[40:43]
 v_mfma_f32_16x16x32_bf16 v[44:47], v[84:87], a[236:239], v[44:47]
 v_mfma_f32_16x16x32_bf16 v[48:51], v[80:83], v[212:215], v[48:51]
 v_mfma_f32_16x16x32_bf16 v[52:55], v[84:87], v[212:215], v[52:55]
 v_mfma_f32_16x16x32_bf16 v[56:59], v[80:83], v[96:99], v[56:59]
 v_mfma_f32_16x16x32_bf16 v[60:63], v[84:87], v[96:99], v[60:63]
 v_mfma_f32_16x16x32_bf16 v[64:67], v[80:83], v[100:103], v[64:67]
 v_mfma_f32_16x16x32_bf16 v[68:71], v[84:87], v[100:103], v[68:71]
 s_waitcnt lgkmcnt(0)
 v_mfma_f32_16x16x32_bf16 v[8:11], v[72:75], a[16:19], v[8:11]
 ds_read_b128 v[80:83], v171 offset:10240
 v_mfma_f32_16x16x32_bf16 v[12:15], v[76:79], a[16:19], v[12:15]
 ds_read_b128 v[84:87], v171 offset:11264
 v_mfma_f32_16x16x32_bf16 v[16:19], v[72:75], a[72:75], v[16:19]
 ds_read_b128 v[96:99], v170 offset:5120
 v_mfma_f32_16x16x32_bf16 v[20:23], v[76:79], a[72:75], v[20:23]
 ds_read_b128 v[100:103], v170 offset:19456
 v_mfma_f32_16x16x32_bf16 v[24:27], v[72:75], a[128:131], v[24:27]
 v_mfma_f32_16x16x32_bf16 v[28:31], v[76:79], a[128:131], v[28:31]
 v_mfma_f32_16x16x32_bf16 v[32:35], v[72:75], a[184:187], v[32:35]
 v_mfma_f32_16x16x32_bf16 v[36:39], v[76:79], a[184:187], v[36:39]
 v_mfma_f32_16x16x32_bf16 v[40:43], v[72:75], a[240:243], v[40:43]
 v_mfma_f32_16x16x32_bf16 v[44:47], v[76:79], a[240:243], v[44:47]
 v_mfma_f32_16x16x32_bf16 v[48:51], v[72:75], v[216:219], v[48:51]
 v_mfma_f32_16x16x32_bf16 v[52:55], v[76:79], v[216:219], v[52:55]
 v_mfma_f32_16x16x32_bf16 v[56:59], v[72:75], v[88:91], v[56:59]
 v_mfma_f32_16x16x32_bf16 v[60:63], v[76:79], v[88:91], v[60:63]
 v_mfma_f32_16x16x32_bf16 v[64:67], v[72:75], v[92:95], v[64:67]
 v_mfma_f32_16x16x32_bf16 v[68:71], v[76:79], v[92:95], v[68:71]
 s_waitcnt lgkmcnt(0)
 v_mfma_f32_16x16x32_bf16 v[8:11], v[80:83], a[20:23], v[8:11]
 ds_read_b128 v[72:75], v171 offset:12288
 v_mfma_f32_16x16x32_bf16 v[12:15], v[84:87], a[20:23], v[12:15]
 ds_read_b128 v[76:79], v171 offset:13312
 v_mfma_f32_16x16x32_bf16 v[16:19], v[80:83], a[76:79], v[16:19]
 ds_read_b128 v[88:91], v170 offset:6144
 v_mfma_f32_16x16x32_bf16 v[20:23], v[84:87], a[76:79], v[20:23]
 ds_read_b128 v[92:95], v170 offset:20480
 v_mfma_f32_16x16x32_bf16 v[24:27], v[80:83], a[132:135], v[24:27]
 v_mfma_f32_16x16x32_bf16 v[28:31], v[84:87], a[132:135], v[28:31]
 v_mfma_f32_16x16x32_bf16 v[32:35], v[80:83], a[188:191], v[32:35]
 v_mfma_f32_16x16x32_bf16 v[36:39], v[84:87], a[188:191], v[36:39]
 v_mfma_f32_16x16x32_bf16 v[40:43], v[80:83], a[244:247], v[40:43]
 v_mfma_f32_16x16x32_bf16 v[44:47], v[84:87], a[244:247], v[44:47]
 v_mfma_f32_16x16x32_bf16 v[48:51], v[80:83], v[220:223], v[48:51]
 v_mfma_f32_16x16x32_bf16 v[52:55], v[84:87], v[220:223], v[52:55]
 v_mfma_f32_16x16x32_bf16 v[56:59], v[80:83], v[96:99], v[56:59]
 v_mfma_f32_16x16x32_bf16 v[60:63], v[84:87], v[96:99], v[60:63]
 v_mfma_f32_16x16x32_bf16 v[64:67], v[80:83], v[100:103], v[64:67]
 v_mfma_f32_16x16x32_bf16 v[68:71], v[84:87], v[100:103], v[68:71]
 s_waitcnt lgkmcnt(0)
 v_mfma_f32_16x16x32_bf16 v[8:11], v[72:75], a[24:27], v[8:11]
 ds_read_b128 v[80:83], v171 offset:14336
 v_mfma_f32_16x16x32_bf16 v[12:15], v[76:79], a[24:27], v[12:15]
 ds_read_b128 v[84:87], v171 offset:15360
 v_mfma_f32_16x16x32_bf16 v[16:19], v[72:75], a[80:83], v[16:19]
 ds_read_b128 v[96:99], v170 offset:7168
 v_mfma_f32_16x16x32_bf16 v[20:23], v[76:79], a[80:83], v[20:23]
 ds_read_b128 v[100:103], v170 offset:21504
 v_mfma_f32_16x16x32_bf16 v[24:27], v[72:75], a[136:139], v[24:27]
 v_mfma_f32_16x16x32_bf16 v[28:31], v[76:79], a[136:139], v[28:31]
 v_mfma_f32_16x16x32_bf16 v[32:35], v[72:75], a[192:195], v[32:35]
 v_mfma_f32_16x16x32_bf16 v[36:39], v[76:79], a[192:195], v[36:39]
 v_mfma_f32_16x16x32_bf16 v[40:43], v[72:75], a[248:251], v[40:43]
 v_mfma_f32_16x16x32_bf16 v[44:47], v[76:79], a[248:251], v[44:47]
 v_mfma_f32_16x16x32_bf16 v[48:51], v[72:75], v[224:227], v[48:51]
 v_mfma_f32_16x16x32_bf16 v[52:55], v[76:79], v[224:227], v[52:55]
 v_mfma_f32_16x16x32_bf16 v[56:59], v[72:75], v[88:91], v[56:59]
 v_mfma_f32_16x16x32_bf16 v[60:63], v[76:79], v[88:91], v[60:63]
 v_mfma_f32_16x16x32_bf16 v[64:67], v[72:75], v[92:95], v[64:67]
 v_mfma_f32_16x16x32_bf16 v[68:71], v[76:79], v[92:95], v[68:71]
 s_waitcnt lgkmcnt(0)
 s_waitcnt vmcnt(8)
 s_barrier
 v_mfma_f32_16x16x32_bf16 v[8:11], v[80:83], a[28:31], v[8:11]
 ds_read_b128 v[72:75], v171 offset:16384
 v_mfma_f32_16x16x32_bf16 v[12:15], v[84:87], a[28:31], v[12:15]
 ds_read_b128 v[76:79], v171 offset:17408
 v_mfma_f32_16x16x32_bf16 v[16:19], v[80:83], a[84:87], v[16:19]
 ds_read_b128 v[88:91], v170 offset:8192
 v_mfma_f32_16x16x32_bf16 v[20:23], v[84:87], a[84:87], v[20:23]
 ds_read_b128 v[92:95], v170 offset:22528
 v_mfma_f32_16x16x32_bf16 v[24:27], v[80:83], a[140:143], v[24:27]
 s_mul_i32 s13, s38, 28672
 s_add_u32 s13, s13, s26
 s_add_u32 s24, s13, 44040192
 s_add_u32 m0, s26, 114688
 v_mfma_f32_16x16x32_bf16 v[28:31], v[84:87], a[140:143], v[28:31]
 buffer_load_dwordx4 v169, s[64:67], s24 offen sc1 lds
 v_mfma_f32_16x16x32_bf16 v[32:35], v[80:83], a[196:199], v[32:35]
 buffer_load_dwordx4 v169, s[64:67], s24 offen offset:1024 sc1 lds
 v_mfma_f32_16x16x32_bf16 v[36:39], v[84:87], a[196:199], v[36:39]
 buffer_load_dwordx4 v169, s[64:67], s24 offen offset:2048 sc1 lds
 v_mfma_f32_16x16x32_bf16 v[40:43], v[80:83], a[252:255], v[40:43]
 buffer_load_dwordx4 v169, s[64:67], s24 offen offset:3072 sc1 lds
 v_mfma_f32_16x16x32_bf16 v[44:47], v[84:87], a[252:255], v[44:47]
 v_mfma_f32_16x16x32_bf16 v[48:51], v[80:83], v[228:231], v[48:51]
 v_mfma_f32_16x16x32_bf16 v[52:55], v[84:87], v[228:231], v[52:55]
 v_mfma_f32_16x16x32_bf16 v[56:59], v[80:83], v[96:99], v[56:59]
 v_mfma_f32_16x16x32_bf16 v[60:63], v[84:87], v[96:99], v[60:63]
 v_mfma_f32_16x16x32_bf16 v[64:67], v[80:83], v[100:103], v[64:67]
 v_mfma_f32_16x16x32_bf16 v[68:71], v[84:87], v[100:103], v[68:71]
 s_waitcnt lgkmcnt(0)
 v_mfma_f32_16x16x32_bf16 v[8:11], v[72:75], a[32:35], v[8:11]
 ds_read_b128 v[80:83], v171 offset:18432
 v_mfma_f32_16x16x32_bf16 v[12:15], v[76:79], a[32:35], v[12:15]
 ds_read_b128 v[84:87], v171 offset:19456
 v_mfma_f32_16x16x32_bf16 v[16:19], v[72:75], a[88:91], v[16:19]
 ds_read_b128 v[96:99], v170 offset:9216
 v_mfma_f32_16x16x32_bf16 v[20:23], v[76:79], a[88:91], v[20:23]
 ds_read_b128 v[100:103], v170 offset:23552
 v_mfma_f32_16x16x32_bf16 v[24:27], v[72:75], a[144:147], v[24:27]
 v_mfma_f32_16x16x32_bf16 v[28:31], v[76:79], a[144:147], v[28:31]
 v_mfma_f32_16x16x32_bf16 v[32:35], v[72:75], a[200:203], v[32:35]
 v_mfma_f32_16x16x32_bf16 v[36:39], v[76:79], a[200:203], v[36:39]
 v_mfma_f32_16x16x32_bf16 v[40:43], v[72:75], v[176:179], v[40:43]
 v_mfma_f32_16x16x32_bf16 v[44:47], v[76:79], v[176:179], v[44:47]
 v_mfma_f32_16x16x32_bf16 v[48:51], v[72:75], v[232:235], v[48:51]
 v_mfma_f32_16x16x32_bf16 v[52:55], v[76:79], v[232:235], v[52:55]
 v_mfma_f32_16x16x32_bf16 v[56:59], v[72:75], v[88:91], v[56:59]
 v_mfma_f32_16x16x32_bf16 v[60:63], v[76:79], v[88:91], v[60:63]
 v_mfma_f32_16x16x32_bf16 v[64:67], v[72:75], v[92:95], v[64:67]
 v_mfma_f32_16x16x32_bf16 v[68:71], v[76:79], v[92:95], v[68:71]
 s_waitcnt lgkmcnt(0)
 v_mfma_f32_16x16x32_bf16 v[8:11], v[80:83], a[36:39], v[8:11]
 ds_read_b128 v[72:75], v171 offset:20480
 v_mfma_f32_16x16x32_bf16 v[12:15], v[84:87], a[36:39], v[12:15]
 ds_read_b128 v[76:79], v171 offset:21504
 v_mfma_f32_16x16x32_bf16 v[16:19], v[80:83], a[92:95], v[16:19]
 ds_read_b128 v[88:91], v170 offset:10240
 v_mfma_f32_16x16x32_bf16 v[20:23], v[84:87], a[92:95], v[20:23]
 ds_read_b128 v[92:95], v170 offset:24576
 v_mfma_f32_16x16x32_bf16 v[24:27], v[80:83], a[148:151], v[24:27]
 v_mfma_f32_16x16x32_bf16 v[28:31], v[84:87], a[148:151], v[28:31]
 v_mfma_f32_16x16x32_bf16 v[32:35], v[80:83], a[204:207], v[32:35]
 v_mfma_f32_16x16x32_bf16 v[36:39], v[84:87], a[204:207], v[36:39]
 v_mfma_f32_16x16x32_bf16 v[40:43], v[80:83], v[180:183], v[40:43]
 v_mfma_f32_16x16x32_bf16 v[44:47], v[84:87], v[180:183], v[44:47]
 v_mfma_f32_16x16x32_bf16 v[48:51], v[80:83], v[236:239], v[48:51]
 v_mfma_f32_16x16x32_bf16 v[52:55], v[84:87], v[236:239], v[52:55]
 v_mfma_f32_16x16x32_bf16 v[56:59], v[80:83], v[96:99], v[56:59]
 v_mfma_f32_16x16x32_bf16 v[60:63], v[84:87], v[96:99], v[60:63]
 v_mfma_f32_16x16x32_bf16 v[64:67], v[80:83], v[100:103], v[64:67]
 v_mfma_f32_16x16x32_bf16 v[68:71], v[84:87], v[100:103], v[68:71]
 s_waitcnt lgkmcnt(0)
 v_mfma_f32_16x16x32_bf16 v[8:11], v[72:75], a[40:43], v[8:11]
 ds_read_b128 v[80:83], v171 offset:22528
 v_mfma_f32_16x16x32_bf16 v[12:15], v[76:79], a[40:43], v[12:15]
 ds_read_b128 v[84:87], v171 offset:23552
 v_mfma_f32_16x16x32_bf16 v[16:19], v[72:75], a[96:99], v[16:19]
 ds_read_b128 v[96:99], v170 offset:11264
 v_mfma_f32_16x16x32_bf16 v[20:23], v[76:79], a[96:99], v[20:23]
 ds_read_b128 v[100:103], v170 offset:25600
 v_mfma_f32_16x16x32_bf16 v[24:27], v[72:75], a[152:155], v[24:27]
 v_mfma_f32_16x16x32_bf16 v[28:31], v[76:79], a[152:155], v[28:31]
 v_mfma_f32_16x16x32_bf16 v[32:35], v[72:75], a[208:211], v[32:35]
 v_mfma_f32_16x16x32_bf16 v[36:39], v[76:79], a[208:211], v[36:39]
 v_mfma_f32_16x16x32_bf16 v[40:43], v[72:75], v[184:187], v[40:43]
 v_mfma_f32_16x16x32_bf16 v[44:47], v[76:79], v[184:187], v[44:47]
 v_mfma_f32_16x16x32_bf16 v[48:51], v[72:75], v[240:243], v[48:51]
 v_mfma_f32_16x16x32_bf16 v[52:55], v[76:79], v[240:243], v[52:55]
 v_mfma_f32_16x16x32_bf16 v[56:59], v[72:75], v[88:91], v[56:59]
 v_mfma_f32_16x16x32_bf16 v[60:63], v[76:79], v[88:91], v[60:63]
 v_mfma_f32_16x16x32_bf16 v[64:67], v[72:75], v[92:95], v[64:67]
 v_mfma_f32_16x16x32_bf16 v[68:71], v[76:79], v[92:95], v[68:71]
 s_waitcnt lgkmcnt(0)
 v_mfma_f32_16x16x32_bf16 v[8:11], v[80:83], a[44:47], v[8:11]
 ds_read_b128 v[72:75], v171 offset:24576
 v_mfma_f32_16x16x32_bf16 v[12:15], v[84:87], a[44:47], v[12:15]
 ds_read_b128 v[76:79], v171 offset:25600
 v_mfma_f32_16x16x32_bf16 v[16:19], v[80:83], a[100:103], v[16:19]
 ds_read_b128 v[88:91], v170 offset:12288
 v_mfma_f32_16x16x32_bf16 v[20:23], v[84:87], a[100:103], v[20:23]
 ds_read_b128 v[92:95], v170 offset:26624
 v_mfma_f32_16x16x32_bf16 v[24:27], v[80:83], a[156:159], v[24:27]
 v_mfma_f32_16x16x32_bf16 v[28:31], v[84:87], a[156:159], v[28:31]
 v_mfma_f32_16x16x32_bf16 v[32:35], v[80:83], a[212:215], v[32:35]
 v_mfma_f32_16x16x32_bf16 v[36:39], v[84:87], a[212:215], v[36:39]
 v_mfma_f32_16x16x32_bf16 v[40:43], v[80:83], v[188:191], v[40:43]
 v_mfma_f32_16x16x32_bf16 v[44:47], v[84:87], v[188:191], v[44:47]
 v_mfma_f32_16x16x32_bf16 v[48:51], v[80:83], v[244:247], v[48:51]
 v_mfma_f32_16x16x32_bf16 v[52:55], v[84:87], v[244:247], v[52:55]
 v_mfma_f32_16x16x32_bf16 v[56:59], v[80:83], v[96:99], v[56:59]
 v_mfma_f32_16x16x32_bf16 v[60:63], v[84:87], v[96:99], v[60:63]
 v_mfma_f32_16x16x32_bf16 v[64:67], v[80:83], v[100:103], v[64:67]
 v_mfma_f32_16x16x32_bf16 v[68:71], v[84:87], v[100:103], v[68:71]
 s_waitcnt lgkmcnt(0)
 v_mfma_f32_16x16x32_bf16 v[8:11], v[72:75], a[48:51], v[8:11]
 ds_read_b128 v[80:83], v171 offset:26624
 v_mfma_f32_16x16x32_bf16 v[12:15], v[76:79], a[48:51], v[12:15]
 ds_read_b128 v[84:87], v171 offset:27648
 v_mfma_f32_16x16x32_bf16 v[16:19], v[72:75], a[104:107], v[16:19]
 ds_read_b128 v[96:99], v170 offset:13312
 v_mfma_f32_16x16x32_bf16 v[20:23], v[76:79], a[104:107], v[20:23]
 ds_read_b128 v[100:103], v170 offset:27648
 v_mfma_f32_16x16x32_bf16 v[24:27], v[72:75], a[160:163], v[24:27]
 v_mfma_f32_16x16x32_bf16 v[28:31], v[76:79], a[160:163], v[28:31]
 v_mfma_f32_16x16x32_bf16 v[32:35], v[72:75], a[216:219], v[32:35]
 v_mfma_f32_16x16x32_bf16 v[36:39], v[76:79], a[216:219], v[36:39]
 v_mfma_f32_16x16x32_bf16 v[40:43], v[72:75], v[192:195], v[40:43]
 v_mfma_f32_16x16x32_bf16 v[44:47], v[76:79], v[192:195], v[44:47]
 v_mfma_f32_16x16x32_bf16 v[48:51], v[72:75], v[248:251], v[48:51]
 v_mfma_f32_16x16x32_bf16 v[52:55], v[76:79], v[248:251], v[52:55]
 v_mfma_f32_16x16x32_bf16 v[56:59], v[72:75], v[88:91], v[56:59]
 v_mfma_f32_16x16x32_bf16 v[60:63], v[76:79], v[88:91], v[60:63]
 v_mfma_f32_16x16x32_bf16 v[64:67], v[72:75], v[92:95], v[64:67]
 v_mfma_f32_16x16x32_bf16 v[68:71], v[76:79], v[92:95], v[68:71]
 s_waitcnt lgkmcnt(0)
 v_mfma_f32_16x16x32_bf16 v[8:11], v[80:83], a[52:55], v[8:11]
 v_mfma_f32_16x16x32_bf16 v[12:15], v[84:87], a[52:55], v[12:15]
 v_mfma_f32_16x16x32_bf16 v[16:19], v[80:83], a[108:111], v[16:19]
 v_mfma_f32_16x16x32_bf16 v[20:23], v[84:87], a[108:111], v[20:23]
 v_mfma_f32_16x16x32_bf16 v[24:27], v[80:83], a[164:167], v[24:27]
 v_mfma_f32_16x16x32_bf16 v[28:31], v[84:87], a[164:167], v[28:31]
 v_mfma_f32_16x16x32_bf16 v[32:35], v[80:83], a[220:223], v[32:35]
 v_mfma_f32_16x16x32_bf16 v[36:39], v[84:87], a[220:223], v[36:39]
 v_mfma_f32_16x16x32_bf16 v[40:43], v[80:83], v[196:199], v[40:43]
 v_mfma_f32_16x16x32_bf16 v[44:47], v[84:87], v[196:199], v[44:47]
 v_mfma_f32_16x16x32_bf16 v[48:51], v[80:83], v[252:255], v[48:51]
 v_mfma_f32_16x16x32_bf16 v[52:55], v[84:87], v[252:255], v[52:55]
 v_mfma_f32_16x16x32_bf16 v[56:59], v[80:83], v[96:99], v[56:59]
 v_mfma_f32_16x16x32_bf16 v[60:63], v[84:87], v[96:99], v[60:63]
 v_mfma_f32_16x16x32_bf16 v[64:67], v[80:83], v[100:103], v[64:67]
 v_mfma_f32_16x16x32_bf16 v[68:71], v[84:87], v[100:103], v[68:71]
L_TB1_54_e:
 s_barrier
 s_waitcnt vmcnt(4)
 s_mov_b64 exec, 1
 buffer_store_dword v172, v172, s[64:67], s33 offen sc1
 s_mov_b64 exec, -1
 s_mul_i32 s13, s38, 28672
 s_add_u32 s13, s13, s27
 s_add_u32 s24, s13, 44040192
 s_add_u32 m0, s27, 114688
 s_nop 0
 buffer_load_dwordx4 v169, s[64:67], s24 offen sc1 lds
 buffer_load_dwordx4 v169, s[64:67], s24 offen offset:1024 sc1 lds
 buffer_load_dwordx4 v169, s[64:67], s24 offen offset:2048 sc1 lds
 v_cvt_pk_bf16_f32 v104, v8, v9
 v_cvt_pk_bf16_f32 v105, v10, v11
 v_cvt_pk_bf16_f32 v106, v12, v13
 v_cvt_pk_bf16_f32 v107, v14, v15
 v_cvt_pk_bf16_f32 v112, v16, v17
 v_cvt_pk_bf16_f32 v113, v18, v19
 v_cvt_pk_bf16_f32 v114, v20, v21
 v_cvt_pk_bf16_f32 v115, v22, v23
 v_cvt_pk_bf16_f32 v108, v24, v25
 v_cvt_pk_bf16_f32 v109, v26, v27
 v_cvt_pk_bf16_f32 v110, v28, v29
 v_cvt_pk_bf16_f32 v111, v30, v31
 v_cvt_pk_bf16_f32 v116, v32, v33
 v_cvt_pk_bf16_f32 v117, v34, v35
 v_cvt_pk_bf16_f32 v118, v36, v37
 v_cvt_pk_bf16_f32 v119, v38, v39
 v_cvt_pk_bf16_f32 v120, v40, v41
 v_cvt_pk_bf16_f32 v121, v42, v43
 v_cvt_pk_bf16_f32 v122, v44, v45
 v_cvt_pk_bf16_f32 v123, v46, v47
 v_cvt_pk_bf16_f32 v128, v48, v49
 v_cvt_pk_bf16_f32 v129, v50, v51
 v_cvt_pk_bf16_f32 v130, v52, v53
 v_cvt_pk_bf16_f32 v131, v54, v55
 v_cvt_pk_bf16_f32 v124, v56, v57
 v_cvt_pk_bf16_f32 v125, v58, v59
 v_cvt_pk_bf16_f32 v126, v60, v61
 v_cvt_pk_bf16_f32 v127, v62, v63
 v_cvt_pk_bf16_f32 v132, v64, v65
 v_cvt_pk_bf16_f32 v133, v66, v67
 v_cvt_pk_bf16_f32 v134, v68, v69
 v_cvt_pk_bf16_f32 v135, v70, v71
 s_mul_i32 s13, s30, 458752
 s_add_u32 s13, s13, s28
 buffer_store_dwordx4 v[104:107], v169, s[64:67], s13 offen sc1
 buffer_store_dwordx4 v[108:111], v169, s[64:67], s13 offen offset:1024 sc1
 buffer_store_dwordx4 v[112:115], v169, s[64:67], s13 offen offset:2048 sc1
 buffer_store_dwordx4 v[116:119], v169, s[64:67], s13 offen offset:3072 sc1
 s_add_u32 s13, s13, 4096
 buffer_store_dwordx4 v[120:123], v169, s[64:67], s13 offen sc1
 buffer_store_dwordx4 v[124:127], v169, s[64:67], s13 offen offset:1024 sc1
 buffer_store_dwordx4 v[128:131], v169, s[64:67], s13 offen offset:2048 sc1
 buffer_store_dwordx4 v[132:135], v169, s[64:67], s13 offen offset:3072 sc1
 s_lshl_b32 s13, s30, 10
 s_add_u32 s33, s13, s29
 s_cmp_ge_u32 s30, 8
 s_cbranch_scc1 L_TBf_55
 s_waitcnt vmcnt(0)
 s_mov_b64 exec, 1
 buffer_store_dword v172, v172, s[64:67], s33 offen sc1
 s_mov_b64 exec, -1
 s_mov_b32 s33, 0x7ffffff0
L_TBf_55:
 s_waitcnt vmcnt(12)
 s_mov_b32 s30, s32
 s_cmp_lt_u32 s30, 64
 s_cbranch_scc1 L_TB1_54
 s_waitcnt vmcnt(0)
 s_mov_b64 exec, 1
 buffer_store_dword v172, v172, s[64:67], s33 offen sc1
 s_mov_b64 exec, -1
 s_barrier
 v_lshrrev_b32 v1, 4, v0
 v_and_b32 v2, 15, v0
 v_lshlrev_b32 v174, 2, v0
 s_mul_i32 s13, s12, 4608
 s_add_u32 s13, s13, 114688
 v_mul_u32_u24 v3, 144, v2
 v_lshlrev_b32 v4, 4, v1
 v_add3_u32 v175, v3, v4, s13
 s_lshl_b32 s13, s12, 3
 v_lshrrev_b32 v3, 3, v0
 v_add_u32 v3, s13, v3
 v_and_b32 v4, 7, v0
 v_mul_u32_u24 v5, 144, v3
 v_lshlrev_b32 v6, 4, v4
 v_add_u32 v5, v5, v6
 v_add_u32 v100, 114688, v5
 s_lshl_b32 s13, s11, 6
 v_mul_u32_u24 v5, 896, v3
 v_lshlrev_b32 v6, 3, v4
 v_add3_u32 v101, v5, v6, s13
 v_lshrrev_b32 v5, 2, v4
 v_lshlrev_b32 v5, 10, v5
 v_and_b32 v6, 3, v4
 v_lshl_add_u32 v5, v6, 7, v5
 v_lshrrev_b32 v6, 4, v3
 v_lshl_add_u32 v5, v6, 9, v5
 v_and_b32 v6, 15, v3
 v_lshl_add_u32 v5, v6, 3, v5
 s_lshl_b32 s13, s11, 11
 v_add_u32 v76, s13, v5
 s_lshl_b32 s13, s12, 7
 v_and_b32 v3, 7, v0
 v_lshlrev_b32 v3, 2, v3
 v_add_u32 v102, s13, v3
 v_min_u32 v3, 27, v0
 v_lshlrev_b32 v103, 8, v3
 s_mov_b32 s30, s37
 s_mov_b32 s34, 0xffff0000
 s_lshl_b32 s20, s30, 13
 s_add_u32 s20, s20, 52429824
 s_cmp_eq_u32 s30, 0
 s_cselect_b32 s20, 53485568, s20
 s_add_u32 s22, s20, 4096
 s_lshl_b32 s21, s30, 7
 s_add_u32 s21, s21, 52264960
 buffer_load_dwordx4 v[8:11], v169, s[64:67], s20 offen sc1
 buffer_load_dwordx4 v[12:15], v169, s[64:67], s20 offen offset:1024 sc1
 buffer_load_dwordx4 v[16:19], v169, s[64:67], s20 offen offset:2048 sc1
 buffer_load_dwordx4 v[20:23], v169, s[64:67], s20 offen offset:3072 sc1
 buffer_load_dwordx4 v[24:27], v169, s[64:67], s22 offen sc1
 buffer_load_dwordx4 v[28:31], v169, s[64:67], s22 offen offset:1024 sc1
 buffer_load_dwordx4 v[32:35], v169, s[64:67], s22 offen offset:2048 sc1
 buffer_load_dword v77, v172, s[64:67], s21 offen sc1
 s_mul_i32 s13, s30, 458752
 s_add_u32 s13, s13, s28
 buffer_load_dwordx4 v[104:107], v169, s[64:67], s13 offen sc1
 buffer_load_dwordx4 v[108:111], v169, s[64:67], s13 offen offset:1024 sc1
 buffer_load_dwordx4 v[112:115], v169, s[64:67], s13 offen offset:2048 sc1
 buffer_load_dwordx4 v[116:119], v169, s[64:67], s13 offen offset:3072 sc1
 s_add_u32 s13, s13, 4096
 buffer_load_dwordx4 v[120:123], v169, s[64:67], s13 offen sc1
 buffer_load_dwordx4 v[124:127], v169, s[64:67], s13 offen offset:1024 sc1
 buffer_load_dwordx4 v[128:131], v169, s[64:67], s13 offen offset:2048 sc1
 buffer_load_dwordx4 v[132:135], v169, s[64:67], s13 offen offset:3072 sc1
 s_waitcnt vmcnt(8)
L_TB2_56:
 ds_read_b128 v[136:139], v170
 ds_read_b128 v[140:143], v170 offset:1024
 ds_read_b128 v[144:147], v170 offset:14336
 ds_read_b128 v[148:151], v170 offset:15360
 ds_read_b128 v[152:155], v170 offset:2048
 ds_read_b128 v[156:159], v170 offset:3072
 ds_read_b128 v[160:163], v170 offset:16384
 ds_read_b128 v[164:167], v170 offset:17408
 v_mov_b32 v36, 0
 v_mov_b32 v37, 0
 v_mov_b32 v38, 0
 v_mov_b32 v39, 0
 v_mov_b32 v40, 0
 v_mov_b32 v41, 0
 v_mov_b32 v42, 0
 v_mov_b32 v43, 0
 v_mov_b32 v44, 0
 v_mov_b32 v45, 0
 v_mov_b32 v46, 0
 v_mov_b32 v47, 0
 v_mov_b32 v48, 0
 v_mov_b32 v49, 0
 v_mov_b32 v50, 0
 v_mov_b32 v51, 0
 v_mov_b32 v52, 0
 v_mov_b32 v53, 0
 v_mov_b32 v54, 0
 v_mov_b32 v55, 0
 v_mov_b32 v56, 0
 v_mov_b32 v57, 0
 v_mov_b32 v58, 0
 v_mov_b32 v59, 0
 v_mov_b32 v60, 0
 v_mov_b32 v61, 0
 v_mov_b32 v62, 0
 v_mov_b32 v63, 0
 v_mov_b32 v64, 0
 v_mov_b32 v65, 0
 v_mov_b32 v66, 0
 v_mov_b32 v67, 0
 s_waitcnt vmcnt(9)
 v_max3_u32 v173, v8, v9, v10
 v_max3_u32 v173, v173, v11, v12
 v_max3_u32 v173, v173, v13, v14
 v_max3_u32 v173, v173, v15, v16
 v_max3_u32 v173, v173, v17, v18
 v_max3_u32 v173, v173, v19, v20
 v_max3_u32 v173, v173, v21, v22
 v_max3_u32 v173, v173, v23, v24
 v_max3_u32 v173, v173, v25, v26
 v_max3_u32 v173, v173, v27, v28
 v_max3_u32 v173, v173, v29, v30
 v_max3_u32 v173, v173, v31, v32
 v_max3_u32 v173, v173, v33, v34
 v_max3_u32 v173, v173, v35, v77
 v_cmp_eq_u32 vcc, -1, v173
 s_cbranch_vccz L_mok_57
 s_cmp_ge_u32 s30, 60
 s_cbranch_scc1 L_mlate_58
 s_mov_b32 s31, 0
 s_branch L_sp_59_go
L_sp_59:
 s_sleep 2
 s_add_u32 s31, s31, 1
 s_cmp_gt_u32 s31, 524288
 s_cbranch_scc1 L_exit
L_sp_59_go:
 buffer_load_dword v1, v103, s[64:67], s20 offen sc1
 s_waitcnt vmcnt(0)
 v_cmp_eq_u32 vcc, -1, v1
 s_cbranch_vccnz L_sp_59
L_mlate_58:
 s_mov_b32 s31, 0
 s_branch L_sp_60_go
L_sp_60:
 s_sleep 2
 s_add_u32 s31, s31, 1
 s_cmp_gt_u32 s31, 524288
 s_cbranch_scc1 L_exit
L_sp_60_go:
 buffer_load_dwordx4 v[8:11], v169, s[64:67], s20 offen sc1
 buffer_load_dwordx4 v[12:15], v169, s[64:67], s20 offen offset:1024 sc1
 buffer_load_dwordx4 v[16:19], v169, s[64:67], s20 offen offset:2048 sc1
 buffer_load_dwordx4 v[20:23], v169, s[64:67], s20 offen offset:3072 sc1
 buffer_load_dwordx4 v[24:27], v169, s[64:67], s22 offen sc1
 buffer_load_dwordx4 v[28:31], v169, s[64:67], s22 offen offset:1024 sc1
 buffer_load_dwordx4 v[32:35], v169, s[64:67], s22 offen offset:2048 sc1
 buffer_load_dword v77, v172, s[64:67], s21 offen sc1
 s_waitcnt vmcnt(0)
 v_max3_u32 v173, v8, v9, v10
 v_max3_u32 v173, v173, v11, v12
 v_max3_u32 v173, v173, v13, v14
 v_max3_u32 v173, v173, v15, v16
 v_max3_u32 v173, v173, v17, v18
 v_max3_u32 v173, v173, v19, v20
 v_max3_u32 v173, v173, v21, v22
 v_max3_u32 v173, v173, v23, v24
 v_max3_u32 v173, v173, v25, v26
 v_max3_u32 v173, v173, v27, v28
 v_max3_u32 v173, v173, v29, v30
 v_max3_u32 v173, v173, v31, v32
 v_max3_u32 v173, v173, v33, v34
 v_max3_u32 v173, v173, v35, v77
 v_cmp_eq_u32 vcc, -1, v173
 s_cbranch_vccnz L_sp_60
L_mok_57:
 s_mul_i32 s23, s30, 28672
 s_add_u32 s25, s23, 48496640
 s_lshl_b32 s21, s30, 9
 s_add_u32 s21, s21, 52232192
 buffer_load_dwordx2 v[2:3], v101, s[76:79], s23 offen
 buffer_load_dwordx2 v[4:5], v76, s[64:67], s25 offen sc1
 buffer_load_dword v1, v102, s[64:67], s21 offen sc1
 s_waitcnt lgkmcnt(0)
 v_smfmac_f32_16x16x64_bf16 v[60:63], v[8:11], v[136:143], v168
 v_smfmac_f32_16x16x64_bf16 v[64:67], v[8:11], v[144:151], v168
 v_smfmac_f32_16x16x64_bf16 v[36:39], v[8:11], a[0:7], v168
 ds_read_b128 v[136:139], v170 offset:4096
 v_smfmac_f32_16x16x64_bf16 v[40:43], v[8:11], a[56:63], v168
 ds_read_b128 v[140:143], v170 offset:5120
 v_smfmac_f32_16x16x64_bf16 v[44:47], v[8:11], a[112:119], v168
 ds_read_b128 v[144:147], v170 offset:18432
 v_smfmac_f32_16x16x64_bf16 v[48:51], v[8:11], a[168:175], v168
 ds_read_b128 v[148:151], v170 offset:19456
 v_smfmac_f32_16x16x64_bf16 v[52:55], v[8:11], a[224:231], v168
 v_smfmac_f32_16x16x64_bf16 v[56:59], v[8:11], v[200:207], v168
 v_smfmac_f32_16x16x64_bf16 v[60:63], v[12:15], v[152:159], v168
 v_smfmac_f32_16x16x64_bf16 v[64:67], v[12:15], v[160:167], v168
 v_smfmac_f32_16x16x64_bf16 v[36:39], v[12:15], a[8:15], v168
 ds_read_b128 v[152:155], v170 offset:6144
 v_smfmac_f32_16x16x64_bf16 v[40:43], v[12:15], a[64:71], v168
 ds_read_b128 v[156:159], v170 offset:7168
 v_smfmac_f32_16x16x64_bf16 v[44:47], v[12:15], a[120:127], v168
 ds_read_b128 v[160:163], v170 offset:20480
 v_smfmac_f32_16x16x64_bf16 v[48:51], v[12:15], a[176:183], v168
 ds_read_b128 v[164:167], v170 offset:21504
 v_smfmac_f32_16x16x64_bf16 v[52:55], v[12:15], a[232:239], v168
 v_smfmac_f32_16x16x64_bf16 v[56:59], v[12:15], v[208:215], v168
 s_waitcnt lgkmcnt(4)
 v_smfmac_f32_16x16x64_bf16 v[60:63], v[16:19], v[136:143], v168
 v_smfmac_f32_16x16x64_bf16 v[64:67], v[16:19], v[144:151], v168
 v_smfmac_f32_16x16x64_bf16 v[36:39], v[16:19], a[16:23], v168
 ds_read_b128 v[136:139], v170 offset:8192
 v_smfmac_f32_16x16x64_bf16 v[40:43], v[16:19], a[72:79], v168
 ds_read_b128 v[140:143], v170 offset:9216
 v_smfmac_f32_16x16x64_bf16 v[44:47], v[16:19], a[128:135], v168
 ds_read_b128 v[144:147], v170 offset:22528
 v_smfmac_f32_16x16x64_bf16 v[48:51], v[16:19], a[184:191], v168
 ds_read_b128 v[148:151], v170 offset:23552
 v_smfmac_f32_16x16x64_bf16 v[52:55], v[16:19], a[240:247], v168
 v_smfmac_f32_16x16x64_bf16 v[56:59], v[16:19], v[216:223], v168
 s_waitcnt lgkmcnt(4)
 v_smfmac_f32_16x16x64_bf16 v[60:63], v[20:23], v[152:159], v168
 v_smfmac_f32_16x16x64_bf16 v[64:67], v[20:23], v[160:167], v168
 v_smfmac_f32_16x16x64_bf16 v[36:39], v[20:23], a[24:31], v168
 ds_read_b128 v[152:155], v170 offset:10240
 v_smfmac_f32_16x16x64_bf16 v[40:43], v[20:23], a[80:87], v168
 ds_read_b128 v[156:159], v170 offset:11264
 v_smfmac_f32_16x16x64_bf16 v[44:47], v[20:23], a[136:143], v168
 ds_read_b128 v[160:163], v170 offset:24576
 v_smfmac_f32_16x16x64_bf16 v[48:51], v[20:23], a[192:199], v168
 ds_read_b128 v[164:167], v170 offset:25600
 v_smfmac_f32_16x16x64_bf16 v[52:55], v[20:23], a[248:255], v168
 v_smfmac_f32_16x16x64_bf16 v[56:59], v[20:23], v[224:231], v168
 s_waitcnt lgkmcnt(4)
 v_smfmac_f32_16x16x64_bf16 v[60:63], v[24:27], v[136:143], v168
 v_smfmac_f32_16x16x64_bf16 v[64:67], v[24:27], v[144:151], v168
 v_smfmac_f32_16x16x64_bf16 v[36:39], v[24:27], a[32:39], v168
 ds_read_b128 v[136:139], v170 offset:12288
 v_smfmac_f32_16x16x64_bf16 v[40:43], v[24:27], a[88:95], v168
 ds_read_b128 v[140:143], v170 offset:13312
 v_smfmac_f32_16x16x64_bf16 v[44:47], v[24:27], a[144:151], v168
 ds_read_b128 v[144:147], v170 offset:26624
 v_smfmac_f32_16x16x64_bf16 v[48:51], v[24:27], a[200:207], v168
 ds_read_b128 v[148:151], v170 offset:27648
 v_smfmac_f32_16x16x64_bf16 v[52:55], v[24:27], v[176:183], v168
 v_smfmac_f32_16x16x64_bf16 v[56:59], v[24:27], v[232:239], v168
 s_waitcnt lgkmcnt(4)
 v_smfmac_f32_16x16x64_bf16 v[60:63], v[28:31], v[152:159], v168
 v_smfmac_f32_16x16x64_bf16 v[64:67], v[28:31], v[160:167], v168
 v_smfmac_f32_16x16x64_bf16 v[36:39], v[28:31], a[40:47], v168
 v_smfmac_f32_16x16x64_bf16 v[40:43], v[28:31], a[96:103], v168
 v_smfmac_f32_16x16x64_bf16 v[44:47], v[28:31], a[152:159], v168
 v_smfmac_f32_16x16x64_bf16 v[48:51], v[28:31], a[208:215], v168
 v_smfmac_f32_16x16x64_bf16 v[52:55], v[28:31], v[184:191], v168
 v_smfmac_f32_16x16x64_bf16 v[56:59], v[28:31], v[240:247], v168
 s_waitcnt lgkmcnt(0)
 v_smfmac_f32_16x16x64_bf16 v[60:63], v[32:35], v[136:143], v168
 v_smfmac_f32_16x16x64_bf16 v[64:67], v[32:35], v[144:151], v168
 v_smfmac_f32_16x16x64_bf16 v[36:39], v[32:35], a[48:55], v168
 v_smfmac_f32_16x16x64_bf16 v[40:43], v[32:35], a[104:111], v168
 v_smfmac_f32_16x16x64_bf16 v[44:47], v[32:35], a[160:167], v168
 v_smfmac_f32_16x16x64_bf16 v[48:51], v[32:35], a[216:223], v168
 v_smfmac_f32_16x16x64_bf16 v[52:55], v[32:35], v[192:199], v168
 v_smfmac_f32_16x16x64_bf16 v[56:59], v[32:35], v[248:255], v168
 s_nop 0
 v_pk_add_f32 v[60:61], v[60:61], v[62:63]
 v_pk_add_f32 v[64:65], v[64:65], v[66:67]
 v_pk_add_f32 v[36:37], v[36:37], v[38:39]
 v_pk_add_f32 v[40:41], v[40:41], v[42:43]
 v_pk_add_f32 v[44:45], v[44:45], v[46:47]
 v_pk_add_f32 v[48:49], v[48:49], v[50:51]
 v_pk_add_f32 v[52:53], v[52:53], v[54:55]
 v_pk_add_f32 v[56:57], v[56:57], v[58:59]
 v_cvt_pk_bf16_f32 v71, v60, v61
 v_cvt_pk_bf16_f32 v75, v64, v65
 v_cvt_pk_bf16_f32 v68, v36, v37
 v_cvt_pk_bf16_f32 v72, v40, v41
 v_cvt_pk_bf16_f32 v69, v44, v45
 v_cvt_pk_bf16_f32 v73, v48, v49
 v_cvt_pk_bf16_f32 v70, v52, v53
 v_cvt_pk_bf16_f32 v74, v56, v57
 s_cmp_lt_u32 s30, 60
 s_cbranch_scc1 L_late_61_f
 s_mul_i32 s21, s30, 40960
 s_add_u32 s21, s21, 49816576
 s_add_u32 s22, s21, 32768
 s_lshl_b32 s14, s12, 13
 s_add_u32 s21, s21, s14
 s_add_u32 s24, s21, 4096
 s_lshl_b32 s14, s12, 11
 s_add_u32 s22, s22, s14
 s_mov_b32 s31, 0
L_late_61_q:
 buffer_load_dwordx4 v[8:11], v169, s[64:67], s21 offen sc1
 buffer_load_dwordx4 v[12:15], v169, s[64:67], s21 offen offset:1024 sc1
 buffer_load_dwordx4 v[16:19], v169, s[64:67], s21 offen offset:2048 sc1
 buffer_load_dwordx4 v[20:23], v169, s[64:67], s21 offen offset:3072 sc1
 buffer_load_dwordx4 v[24:27], v169, s[64:67], s24 offen sc1
 buffer_load_dwordx4 v[28:31], v169, s[64:67], s24 offen offset:1024 sc1
 buffer_load_dwordx4 v[32:35], v169, s[64:67], s24 offen offset:2048 sc1
 buffer_load_dwordx4 v[36:39], v169, s[64:67], s24 offen offset:3072 sc1
 buffer_load_dword v40, v174, s[64:67], s22 offen sc1
 buffer_load_dword v44, v174, s[64:67], s22 offen offset:256 sc1
 buffer_load_dword v41, v174, s[64:67], s22 offen offset:512 sc1
 buffer_load_dword v45, v174, s[64:67], s22 offen offset:768 sc1
 buffer_load_dword v42, v174, s[64:67], s22 offen offset:1024 sc1
 buffer_load_dword v46, v174, s[64:67], s22 offen offset:1280 sc1
 buffer_load_dword v43, v174, s[64:67], s22 offen offset:1536 sc1
 buffer_load_dword v47, v174, s[64:67], s22 offen offset:1792 sc1
 s_waitcnt vmcnt(0)
 v_max3_u32 v173, v11, v15, v19
 v_max3_u32 v173, v173, v23, v27
 v_max3_u32 v173, v173, v31, v35
 v_max3_u32 v173, v173, v39, v40
 v_max3_u32 v173, v173, v41, v42
 v_max3_u32 v173, v173, v43, v44
 v_max3_u32 v173, v173, v45, v46
 v_max_u32 v173, v173, v47
 v_cmp_eq_u32 vcc, -1, v173
 s_cbranch_vccz L_late_61_d
 s_add_u32 s31, s31, 1
 s_cmp_lt_u32 s31, 24
 s_cbranch_scc1 L_late_61_q
L_late_61_f:
 s_waitcnt vmcnt(0)
 v_cmp_eq_u32 vcc, -1, v1
 s_cbranch_vccz L_late_61
 s_lshl_b32 s21, s30, 9
 s_add_u32 s21, s21, 52232192
 s_mov_b32 s31, 0
 s_branch L_sp_62_go
L_sp_62:
 s_sleep 2
 s_add_u32 s31, s31, 1
 s_cmp_gt_u32 s31, 524288
 s_cbranch_scc1 L_exit
L_sp_62_go:
 buffer_load_dword v1, v102, s[64:67], s21 offen sc1
 s_waitcnt vmcnt(0)
 v_cmp_eq_u32 vcc, -1, v1
 s_cbranch_vccnz L_sp_62
L_late_61:
 s_lshl_b32 s21, s30, 15
 s_add_u32 s21, s21, 45875200
 s_lshl_b32 s22, s30, 13
 s_add_u32 s22, s22, 47972352
 s_lshl_b32 s14, s12, 13
 s_add_u32 s21, s21, s14
 s_add_u32 s24, s21, 4096
 s_lshl_b32 s14, s12, 11
 s_add_u32 s22, s22, s14
 buffer_load_dwordx4 v[8:11], v169, s[64:67], s21 offen sc1
 buffer_load_dwordx4 v[12:15], v169, s[64:67], s21 offen offset:1024 sc1
 buffer_load_dwordx4 v[16:19], v169, s[64:67], s21 offen offset:2048 sc1
 buffer_load_dwordx4 v[20:23], v169, s[64:67], s21 offen offset:3072 sc1
 buffer_load_dwordx4 v[24:27], v169, s[64:67], s24 offen sc1
 buffer_load_dwordx4 v[28:31], v169, s[64:67], s24 offen offset:1024 sc1
 buffer_load_dwordx4 v[32:35], v169, s[64:67], s24 offen offset:2048 sc1
 buffer_load_dwordx4 v[36:39], v169, s[64:67], s24 offen offset:3072 sc1
 buffer_load_dword v40, v174, s[64:67], s22 offen sc1
 buffer_load_dword v44, v174, s[64:67], s22 offen offset:256 sc1
 buffer_load_dword v41, v174, s[64:67], s22 offen offset:512 sc1
 buffer_load_dword v45, v174, s[64:67], s22 offen offset:768 sc1
 buffer_load_dword v42, v174, s[64:67], s22 offen offset:1024 sc1
 buffer_load_dword v46, v174, s[64:67], s22 offen offset:1280 sc1
 buffer_load_dword v43, v174, s[64:67], s22 offen offset:1536 sc1
 buffer_load_dword v47, v174, s[64:67], s22 offen offset:1792 sc1
 s_waitcnt vmcnt(0)
L_late_61_d:
 v_mfma_f32_16x16x32_bf16 v[84:87], v[104:107], v[8:11], 0
 v_mfma_f32_16x16x32_bf16 v[88:91], v[112:115], v[8:11], 0
 v_mfma_f32_16x16x32_bf16 v[92:95], v[104:107], v[12:15], 0
 v_mfma_f32_16x16x32_bf16 v[96:99], v[112:115], v[12:15], 0
 v_mfma_f32_16x16x32_bf16 v[84:87], v[108:111], v[16:19], v[84:87]
 v_mfma_f32_16x16x32_bf16 v[88:91], v[116:119], v[16:19], v[88:91]
 v_mfma_f32_16x16x32_bf16 v[92:95], v[108:111], v[20:23], v[92:95]
 v_mfma_f32_16x16x32_bf16 v[96:99], v[116:119], v[20:23], v[96:99]
 v_mfma_f32_16x16x32_bf16 v[84:87], v[120:123], v[24:27], v[84:87]
 v_mfma_f32_16x16x32_bf16 v[88:91], v[128:131], v[24:27], v[88:91]
 v_mfma_f32_16x16x32_bf16 v[92:95], v[120:123], v[28:31], v[92:95]
 v_mfma_f32_16x16x32_bf16 v[96:99], v[128:131], v[28:31], v[96:99]
 v_mfma_f32_16x16x32_bf16 v[84:87], v[124:127], v[32:35], v[84:87]
 v_mfma_f32_16x16x32_bf16 v[88:91], v[132:135], v[32:35], v[88:91]
 v_mfma_f32_16x16x32_bf16 v[92:95], v[124:127], v[36:39], v[92:95]
 v_mfma_f32_16x16x32_bf16 v[96:99], v[132:135], v[36:39], v[96:99]
 v_mfma_f32_16x16x32_bf16 v[84:87], v[68:71], v[40:43], v[84:87]
 v_mfma_f32_16x16x32_bf16 v[88:91], v[72:75], v[40:43], v[88:91]
 v_mfma_f32_16x16x32_bf16 v[92:95], v[68:71], v[44:47], v[92:95]
 v_mfma_f32_16x16x32_bf16 v[96:99], v[72:75], v[44:47], v[96:99]
 s_barrier
 s_nop 3
 ds_write_b128 v175, v[84:87]
 ds_write_b128 v175, v[88:91] offset:64
 ds_write_b128 v175, v[92:95] offset:2304
 ds_write_b128 v175, v[96:99] offset:2368
 s_add_u32 s32, s30, 4
 s_cmp_ge_u32 s32, 64
 s_cbranch_scc1 L_na_63
 s_lshl_b32 s20, s32, 13
 s_add_u32 s20, s20, 52429824
 s_cmp_eq_u32 s32, 0
 s_cselect_b32 s20, 53485568, s20
 s_add_u32 s22, s20, 4096
 s_lshl_b32 s21, s32, 7
 s_add_u32 s21, s21, 52264960
 buffer_load_dwordx4 v[8:11], v169, s[64:67], s20 offen sc1
 buffer_load_dwordx4 v[12:15], v169, s[64:67], s20 offen offset:1024 sc1
 buffer_load_dwordx4 v[16:19], v169, s[64:67], s20 offen offset:2048 sc1
 buffer_load_dwordx4 v[20:23], v169, s[64:67], s20 offen offset:3072 sc1
 buffer_load_dwordx4 v[24:27], v169, s[64:67], s22 offen sc1
 buffer_load_dwordx4 v[28:31], v169, s[64:67], s22 offen offset:1024 sc1
 buffer_load_dwordx4 v[32:35], v169, s[64:67], s22 offen offset:2048 sc1
 buffer_load_dword v77, v172, s[64:67], s21 offen sc1
 s_mul_i32 s13, s32, 458752
 s_add_u32 s13, s13, s28
 buffer_load_dwordx4 v[104:107], v169, s[64:67], s13 offen sc1
 buffer_load_dwordx4 v[108:111], v169, s[64:67], s13 offen offset:1024 sc1
 buffer_load_dwordx4 v[112:115], v169, s[64:67], s13 offen offset:2048 sc1
 buffer_load_dwordx4 v[116:119], v169, s[64:67], s13 offen offset:3072 sc1
 s_add_u32 s13, s13, 4096
 buffer_load_dwordx4 v[120:123], v169, s[64:67], s13 offen sc1
 buffer_load_dwordx4 v[124:127], v169, s[64:67], s13 offen offset:1024 sc1
 buffer_load_dwordx4 v[128:131], v169, s[64:67], s13 offen offset:2048 sc1
 buffer_load_dwordx4 v[132:135], v169, s[64:67], s13 offen offset:3072 sc1
L_na_63:
 s_waitcnt lgkmcnt(0)
 s_barrier
 ds_read_b128 v[40:43], v100
 ds_read_b128 v[44:47], v100 offset:4608
 ds_read_b128 v[48:51], v100 offset:9216
 ds_read_b128 v[52:55], v100 offset:13824
 v_lshlrev_b32 v56, 16, v2
 v_and_b32 v57, s34, v2
 v_lshlrev_b32 v58, 16, v3
 v_and_b32 v59, s34, v3
 v_lshlrev_b32 v60, 16, v4
 v_and_b32 v61, s34, v4
 v_lshlrev_b32 v62, 16, v5
 v_and_b32 v63, s34, v5
 s_waitcnt lgkmcnt(0)
 v_pk_add_f32 v[40:41], v[40:41], v[44:45]
 v_pk_add_f32 v[42:43], v[42:43], v[46:47]
 v_pk_add_f32 v[48:49], v[48:49], v[52:53]
 v_pk_add_f32 v[50:51], v[50:51], v[54:55]
 v_pk_add_f32 v[40:41], v[40:41], v[48:49]
 v_pk_add_f32 v[42:43], v[42:43], v[50:51]
 v_cvt_pk_bf16_f32 v44, v40, v41
 v_cvt_pk_bf16_f32 v45, v42, v43
 v_lshlrev_b32 v40, 16, v44
 v_and_b32 v41, s34, v44
 v_lshlrev_b32 v42, 16, v45
 v_and_b32 v43, s34, v45
 v_pk_mul_f32 v[40:41], v[40:41], v[60:61]
 v_pk_mul_f32 v[42:43], v[42:43], v[62:63]
 v_cvt_pk_bf16_f32 v44, v40, v41
 v_cvt_pk_bf16_f32 v45, v42, v43
 v_lshlrev_b32 v40, 16, v44
 v_and_b32 v41, s34, v44
 v_lshlrev_b32 v42, 16, v45
 v_and_b32 v43, s34, v45
 v_pk_add_f32 v[40:41], v[40:41], v[56:57]
 v_pk_add_f32 v[42:43], v[42:43], v[58:59]
 v_cvt_pk_bf16_f32 v6, v40, v41
 v_cvt_pk_bf16_f32 v7, v42, v43
 buffer_store_dwordx2 v[6:7], v101, s[68:71], s23 offen
 s_mov_b32 s30, s32
 s_cmp_lt_u32 s30, 64
 s_cbranch_scc1 L_TB2_56
 s_branch L_exit
L_pad11:
 s_setpc_b64 s[94:95]
L_TA:
 v_lshlrev_b32 v108, 4, v0
 v_mov_b32 v116, 0
 s_cmp_lg_u32 s12, 0
 s_cbranch_scc1 L_wd_64_done
 v_mov_b32 v1, 52273152
 s_mov_b32 s31, 0
 s_mov_b64 exec, 1
L_wd_64:
 buffer_load_dword v2, v1, s[64:67], 0 offen sc1
 s_add_u32 s31, s31, 1
 s_cmp_gt_u32 s31, 524288
 s_cbranch_scc1 L_exit
 s_waitcnt vmcnt(0)
 v_cmp_eq_u32 vcc, -1, v2
 s_cbranch_vccz L_wd_64_ok
 s_sleep 32
 s_branch L_wd_64
L_wd_64_ok:
 s_mov_b64 exec, -1
L_wd_64_done:
 s_barrier
 s_lshl_b32 s13, s11, 2
 s_add_u32 s13, s13, s12
 s_mul_i32 s13, s13, 100352
 s_add_u32 s13, s13, 0
 s_add_u32 s14, s13, 0
 buffer_load_dwordx4 a[0:3], v108, s[64:67], s14 offen sc1
 buffer_load_dwordx4 a[4:7], v108, s[64:67], s14 offen offset:1024 sc1
 s_add_u32 s14, s13, 2048
 buffer_load_dwordx4 a[8:11], v108, s[64:67], s14 offen sc1
 buffer_load_dwordx4 a[12:15], v108, s[64:67], s14 offen offset:1024 sc1
 s_add_u32 s14, s13, 4096
 buffer_load_dwordx4 a[16:19], v108, s[64:67], s14 offen sc1
 buffer_load_dwordx4 a[20:23], v108, s[64:67], s14 offen offset:1024 sc1
 s_add_u32 s14, s13, 6144
 buffer_load_dwordx4 a[24:27], v108, s[64:67], s14 offen sc1
 buffer_load_dwordx4 a[28:31], v108, s[64:67], s14 offen offset:1024 sc1
 s_add_u32 s14, s13, 8192
 buffer_load_dwordx4 a[32:35], v108, s[64:67], s14 offen sc1
 buffer_load_dwordx4 a[36:39], v108, s[64:67], s14 offen offset:1024 sc1
 s_add_u32 s14, s13, 10240
 buffer_load_dwordx4 a[40:43], v108, s[64:67], s14 offen sc1
 buffer_load_dwordx4 a[44:47], v108, s[64:67], s14 offen offset:1024 sc1
 s_add_u32 s14, s13, 12288
 buffer_load_dwordx4 a[48:51], v108, s[64:67], s14 offen sc1
 buffer_load_dwordx4 a[52:55], v108, s[64:67], s14 offen offset:1024 sc1
 s_add_u32 s14, s13, 14336
 buffer_load_dwordx4 a[56:59], v108, s[64:67], s14 offen sc1
 buffer_load_dwordx4 a[60:63], v108, s[64:67], s14 offen offset:1024 sc1
 s_add_u32 s14, s13, 16384
 buffer_load_dwordx4 a[64:67], v108, s[64:67], s14 offen sc1
 buffer_load_dwordx4 a[68:71], v108, s[64:67], s14 offen offset:1024 sc1
 s_add_u32 s14, s13, 18432
 buffer_load_dwordx4 a[72:75], v108, s[64:67], s14 offen sc1
 buffer_load_dwordx4 a[76:79], v108, s[64:67], s14 offen offset:1024 sc1
 s_add_u32 s14, s13, 20480
 buffer_load_dwordx4 a[80:83], v108, s[64:67], s14 offen sc1
 buffer_load_dwordx4 a[84:87], v108, s[64:67], s14 offen offset:1024 sc1
 s_add_u32 s14, s13, 22528
 buffer_load_dwordx4 a[88:91], v108, s[64:67], s14 offen sc1
 buffer_load_dwordx4 a[92:95], v108, s[64:67], s14 offen offset:1024 sc1
 s_add_u32 s14, s13, 24576
 buffer_load_dwordx4 a[96:99], v108, s[64:67], s14 offen sc1
 buffer_load_dwordx4 a[100:103], v108, s[64:67], s14 offen offset:1024 sc1
 s_add_u32 s14, s13, 26624
 buffer_load_dwordx4 a[104:107], v108, s[64:67], s14 offen sc1
 buffer_load_dwordx4 a[108:111], v108, s[64:67], s14 offen offset:1024 sc1
 s_add_u32 s14, s13, 28672
 buffer_load_dwordx4 a[112:115], v108, s[64:67], s14 offen sc1
 buffer_load_dwordx4 a[116:119], v108, s[64:67], s14 offen offset:1024 sc1
 s_add_u32 s14, s13, 30720
 buffer_load_dwordx4 a[120:123], v108, s[64:67], s14 offen sc1
 buffer_load_dwordx4 a[124:127], v108, s[64:67], s14 offen offset:1024 sc1
 s_add_u32 s14, s13, 32768
 buffer_load_dwordx4 a[128:131], v108, s[64:67], s14 offen sc1
 buffer_load_dwordx4 a[132:135], v108, s[64:67], s14 offen offset:1024 sc1
 s_add_u32 s14, s13, 34816
 buffer_load_dwordx4 a[136:139], v108, s[64:67], s14 offen sc1
 buffer_load_dwordx4 a[140:143], v108, s[64:67], s14 offen offset:1024 sc1
 s_add_u32 s14, s13, 36864
 buffer_load_dwordx4 a[144:147], v108, s[64:67], s14 offen sc1
 buffer_load_dwordx4 a[148:151], v108, s[64:67], s14 offen offset:1024 sc1
 s_add_u32 s14, s13, 38912
 buffer_load_dwordx4 a[152:155], v108, s[64:67], s14 offen sc1
 buffer_load_dwordx4 a[156:159], v108, s[64:67], s14 offen offset:1024 sc1
 s_add_u32 s14, s13, 40960
 buffer_load_dwordx4 a[160:163], v108, s[64:67], s14 offen sc1
 buffer_load_dwordx4 a[164:167], v108, s[64:67], s14 offen offset:1024 sc1
 s_add_u32 s14, s13, 43008
 buffer_load_dwordx4 a[168:171], v108, s[64:67], s14 offen sc1
 buffer_load_dwordx4 a[172:175], v108, s[64:67], s14 offen offset:1024 sc1
 s_add_u32 s14, s13, 45056
 buffer_load_dwordx4 a[176:179], v108, s[64:67], s14 offen sc1
 buffer_load_dwordx4 a[180:183], v108, s[64:67], s14 offen offset:1024 sc1
 s_add_u32 s14, s13, 47104
 buffer_load_dwordx4 a[184:187], v108, s[64:67], s14 offen sc1
 buffer_load_dwordx4 a[188:191], v108, s[64:67], s14 offen offset:1024 sc1
 s_add_u32 s14, s13, 49152
 buffer_load_dwordx4 a[192:195], v108, s[64:67], s14 offen sc1
 buffer_load_dwordx4 a[196:199], v108, s[64:67], s14 offen offset:1024 sc1
 s_add_u32 s14, s13, 51200
 buffer_load_dwordx4 a[200:203], v108, s[64:67], s14 offen sc1
 buffer_load_dwordx4 a[204:207], v108, s[64:67], s14 offen offset:1024 sc1
 s_add_u32 s14, s13, 53248
 buffer_load_dwordx4 a[208:211], v108, s[64:67], s14 offen sc1
 buffer_load_dwordx4 a[212:215], v108, s[64:67], s14 offen offset:1024 sc1
 s_add_u32 s14, s13, 55296
 buffer_load_dwordx4 a[216:219], v108, s[64:67], s14 offen sc1
 buffer_load_dwordx4 a[220:223], v108, s[64:67], s14 offen offset:1024 sc1
 s_add_u32 s14, s13, 57344
 buffer_load_dwordx4 a[224:227], v108, s[64:67], s14 offen sc1
 buffer_load_dwordx4 a[228:231], v108, s[64:67], s14 offen offset:1024 sc1
 s_add_u32 s14, s13, 59392
 buffer_load_dwordx4 a[232:235], v108, s[64:67], s14 offen sc1
 buffer_load_dwordx4 a[236:239], v108, s[64:67], s14 offen offset:1024 sc1
 s_add_u32 s14, s13, 61440
 buffer_load_dwordx4 a[240:243], v108, s[64:67], s14 offen sc1
 buffer_load_dwordx4 a[244:247], v108, s[64:67], s14 offen offset:1024 sc1
 s_add_u32 s14, s13, 63488
 buffer_load_dwordx4 a[248:251], v108, s[64:67], s14 offen sc1
 buffer_load_dwordx4 a[252:255], v108, s[64:67], s14 offen offset:1024 sc1
 s_add_u32 s14, s13, 65536
 buffer_load_dwordx4 v[120:123], v108, s[64:67], s14 offen sc1
 buffer_load_dwordx4 v[124:127], v108, s[64:67], s14 offen offset:1024 sc1
 s_add_u32 s14, s13, 67584
 buffer_load_dwordx4 v[128:131], v108, s[64:67], s14 offen sc1
 buffer_load_dwordx4 v[132:135], v108, s[64:67], s14 offen offset:1024 sc1
 s_add_u32 s14, s13, 69632
 buffer_load_dwordx4 v[136:139], v108, s[64:67], s14 offen sc1
 buffer_load_dwordx4 v[140:143], v108, s[64:67], s14 offen offset:1024 sc1
 s_add_u32 s14, s13, 71680
 buffer_load_dwordx4 v[144:147], v108, s[64:67], s14 offen sc1
 buffer_load_dwordx4 v[148:151], v108, s[64:67], s14 offen offset:1024 sc1
 s_add_u32 s14, s13, 73728
 buffer_load_dwordx4 v[152:155], v108, s[64:67], s14 offen sc1
 buffer_load_dwordx4 v[156:159], v108, s[64:67], s14 offen offset:1024 sc1
 s_add_u32 s14, s13, 75776
 buffer_load_dwordx4 v[160:163], v108, s[64:67], s14 offen sc1
 buffer_load_dwordx4 v[164:167], v108, s[64:67], s14 offen offset:1024 sc1
 s_add_u32 s14, s13, 77824
 buffer_load_dwordx4 v[168:171], v108, s[64:67], s14 offen sc1
 buffer_load_dwordx4 v[172:175], v108, s[64:67], s14 offen offset:1024 sc1
 s_add_u32 s14, s13, 79872
 buffer_load_dwordx4 v[176:179], v108, s[64:67], s14 offen sc1
 buffer_load_dwordx4 v[180:183], v108, s[64:67], s14 offen offset:1024 sc1
 s_add_u32 s14, s13, 81920
 buffer_load_dwordx4 v[184:187], v108, s[64:67], s14 offen sc1
 buffer_load_dwordx4 v[188:191], v108, s[64:67], s14 offen offset:1024 sc1
 s_add_u32 s14, s13, 83968
 buffer_load_dwordx4 v[192:195], v108, s[64:67], s14 offen sc1
 buffer_load_dwordx4 v[196:199], v108, s[64:67], s14 offen offset:1024 sc1
 s_add_u32 s14, s13, 86016
 buffer_load_dwordx4 v[200:203], v108, s[64:67], s14 offen sc1
 buffer_load_dwordx4 v[204:207], v108, s[64:67], s14 offen offset:1024 sc1
 s_add_u32 s14, s13, 88064
 buffer_load_dwordx4 v[208:211], v108, s[64:67], s14 offen sc1
 buffer_load_dwordx4 v[212:215], v108, s[64:67], s14 offen offset:1024 sc1
 s_add_u32 s14, s13, 90112
 buffer_load_dwordx4 v[216:219], v108, s[64:67], s14 offen sc1
 buffer_load_dwordx4 v[220:223], v108, s[64:67], s14 offen offset:1024 sc1
 s_add_u32 s14, s13, 92160
 buffer_load_dwordx4 v[224:227], v108, s[64:67], s14 offen sc1
 buffer_load_dwordx4 v[228:231], v108, s[64:67], s14 offen offset:1024 sc1
 s_add_u32 s14, s13, 94208
 buffer_load_dwordx4 v[232:235], v108, s[64:67], s14 offen sc1
 buffer_load_dwordx4 v[236:239], v108, s[64:67], s14 offen offset:1024 sc1
 s_add_u32 s14, s13, 96256
 buffer_load_dwordx4 v[240:243], v108, s[64:67], s14 offen sc1
 buffer_load_dwordx4 v[244:247], v108, s[64:67], s14 offen offset:1024 sc1
 s_add_u32 s14, s13, 98304
 buffer_load_dwordx4 v[248:251], v108, s[64:67], s14 offen sc1
 buffer_load_dwordx4 v[252:255], v108, s[64:67], s14 offen offset:1024 sc1
 v_lshrrev_b32 v1, 4, v0
 v_and_b32 v2, 15, v0
 v_and_b32 v4, 1, v2
 v_lshlrev_b32 v3, 4, v4
 v_and_b32 v4, 8, v2
 v_or_b32 v3, v3, v4
 v_and_b32 v4, 2, v2
 v_lshlrev_b32 v4, 1, v4
 v_and_b32 v5, 4, v2
 v_lshrrev_b32 v5, 1, v5
 v_or_b32 v4, v4, v5
 v_lshrrev_b32 v5, 4, v2
 v_or3_b32 v3, v3, v4, v5
 s_lshr_b32 s13, s12, 1
 s_mul_i32 s13, s13, 28
 s_and_b32 s14, s12, 1
 s_lshl_b32 s15, s14, 3
 s_add_u32 s15, s15, s13
 v_lshlrev_b32 v4, 1, v1
 v_add_u32 v4, s15, v4
 s_lshl_b32 s15, s14, 2
 s_add_u32 s15, s15, s13
 s_add_u32 s15, s15, 16
 v_add_u32 v5, s15, v1
 s_add_u32 s15, s13, 24
 v_add_u32 v6, s15, v1
 v_lshlrev_b32 v3, 4, v3
 v_add_u32 v3, 28672, v3
 v_lshrrev_b32 v7, 2, v2
 v_lshlrev_b32 v7, 1, v7
 v_and_b32 v8, 1, v0
 v_add_u32 v7, v7, v8
 v_lshl_add_u32 v109, v4, 9, v3
 v_lshrrev_b32 v8, 1, v4
 v_lshlrev_b32 v8, 8, v8
 v_and_b32 v9, 1, v4
 v_lshl_add_u32 v8, v9, 5, v8
 v_lshrrev_b32 v9, 1, v7
 v_lshl_add_u32 v8, v9, 6, v8
 v_and_b32 v9, 1, v7
 v_lshl_add_u32 v112, v9, 4, v8
 v_lshl_add_u32 v110, v5, 9, v3
 v_lshrrev_b32 v8, 1, v5
 v_lshlrev_b32 v8, 8, v8
 v_and_b32 v9, 1, v5
 v_lshl_add_u32 v8, v9, 5, v8
 v_lshrrev_b32 v9, 1, v7
 v_lshl_add_u32 v8, v9, 6, v8
 v_and_b32 v9, 1, v7
 v_lshl_add_u32 v113, v9, 4, v8
 v_lshl_add_u32 v111, v6, 9, v3
 v_lshrrev_b32 v8, 1, v6
 v_lshlrev_b32 v8, 8, v8
 v_and_b32 v9, 1, v6
 v_lshl_add_u32 v8, v9, 5, v8
 v_lshrrev_b32 v9, 1, v7
 v_lshl_add_u32 v8, v9, 6, v8
 v_and_b32 v9, 1, v7
 v_lshl_add_u32 v114, v9, 4, v8
 s_cmp_eq_u32 s14, 0
 s_cselect_b64 s[16:17], -1, 0
 v_lshlrev_b32 v4, 2, v1
 v_sub_u32 v118, v2, v4
 v_lshlrev_b32 v117, 2, v0
 s_mul_i32 s26, s12, 7168
 s_mov_b32 s30, s37
 s_add_u32 s27, s26, 28672
 s_mov_b32 s35, 0xff800000
 s_mul_i32 s13, s30, 28672
 s_add_u32 s13, s13, s26
 s_add_u32 s24, s13, 44040192
 s_add_u32 s25, s13, 42205184
 s_add_u32 m0, s26, 0
 s_nop 0
 buffer_load_dwordx4 v108, s[64:67], s24 offen sc1 lds
 buffer_load_dwordx4 v108, s[64:67], s24 offen offset:1024 sc1 lds
 buffer_load_dwordx4 v108, s[64:67], s24 offen offset:2048 sc1 lds
 buffer_load_dwordx4 v108, s[64:67], s24 offen offset:3072 sc1 lds
 s_add_u32 s24, s24, 4096
 s_add_u32 m0, s26, 4096
 s_nop 0
 buffer_load_dwordx4 v108, s[64:67], s24 offen sc1 lds
 buffer_load_dwordx4 v108, s[64:67], s24 offen offset:1024 sc1 lds
 buffer_load_dwordx4 v108, s[64:67], s24 offen offset:2048 sc1 lds
 s_add_u32 m0, s27, 0
 s_nop 0
 buffer_load_dwordx4 v108, s[64:67], s25 offen sc1 lds
 buffer_load_dwordx4 v108, s[64:67], s25 offen offset:1024 sc1 lds
 buffer_load_dwordx4 v108, s[64:67], s25 offen offset:2048 sc1 lds
 buffer_load_dwordx4 v108, s[64:67], s25 offen offset:3072 sc1 lds
 s_add_u32 s25, s25, 4096
 s_add_u32 m0, s27, 4096
 s_nop 0
 buffer_load_dwordx4 v108, s[64:67], s25 offen sc1 lds
 buffer_load_dwordx4 v108, s[64:67], s25 offen offset:1024 sc1 lds
 buffer_load_dwordx4 v108, s[64:67], s25 offen offset:2048 sc1 lds
 s_mov_b32 s28, 0x7ffffff0
L_TA_65:
 s_waitcnt vmcnt(0)
 s_mov_b64 exec, 1
 buffer_store_dword v116, v116, s[64:67], s28 offen sc1
 s_mov_b64 exec, -1
 s_barrier
 ds_read_b128 v[68:71], v108
 ds_read_b128 v[72:75], v108 offset:2048
 s_waitcnt lgkmcnt(1)
 v_mfma_f32_16x16x32_bf16 v[8:11], a[0:3], v[68:71], 0
 v_mfma_f32_16x16x32_bf16 v[12:15], a[56:59], v[68:71], 0
 v_mfma_f32_16x16x32_bf16 v[16:19], a[112:115], v[68:71], 0
 v_mfma_f32_16x16x32_bf16 v[20:23], a[168:171], v[68:71], 0
 v_mfma_f32_16x16x32_bf16 v[24:27], a[224:227], v[68:71], 0
 v_mfma_f32_16x16x32_bf16 v[28:31], v[144:147], v[68:71], 0
 v_mfma_f32_16x16x32_bf16 v[32:35], v[200:203], v[68:71], 0
 ds_read_b128 v[68:71], v108 offset:4096
 s_waitcnt lgkmcnt(1)
 v_mfma_f32_16x16x32_bf16 v[8:11], a[4:7], v[72:75], v[8:11]
 v_mfma_f32_16x16x32_bf16 v[12:15], a[60:63], v[72:75], v[12:15]
 v_mfma_f32_16x16x32_bf16 v[16:19], a[116:119], v[72:75], v[16:19]
 v_mfma_f32_16x16x32_bf16 v[20:23], a[172:175], v[72:75], v[20:23]
 v_mfma_f32_16x16x32_bf16 v[24:27], a[228:231], v[72:75], v[24:27]
 v_mfma_f32_16x16x32_bf16 v[28:31], v[148:151], v[72:75], v[28:31]
 v_mfma_f32_16x16x32_bf16 v[32:35], v[204:207], v[72:75], v[32:35]
 ds_read_b128 v[72:75], v108 offset:6144
 s_waitcnt lgkmcnt(1)
 v_mfma_f32_16x16x32_bf16 v[8:11], a[8:11], v[68:71], v[8:11]
 v_mfma_f32_16x16x32_bf16 v[12:15], a[64:67], v[68:71], v[12:15]
 v_mfma_f32_16x16x32_bf16 v[16:19], a[120:123], v[68:71], v[16:19]
 v_mfma_f32_16x16x32_bf16 v[20:23], a[176:179], v[68:71], v[20:23]
 v_mfma_f32_16x16x32_bf16 v[24:27], a[232:235], v[68:71], v[24:27]
 v_mfma_f32_16x16x32_bf16 v[28:31], v[152:155], v[68:71], v[28:31]
 v_mfma_f32_16x16x32_bf16 v[32:35], v[208:211], v[68:71], v[32:35]
 ds_read_b128 v[68:71], v108 offset:8192
 s_waitcnt lgkmcnt(1)
 v_mfma_f32_16x16x32_bf16 v[8:11], a[12:15], v[72:75], v[8:11]
 v_mfma_f32_16x16x32_bf16 v[12:15], a[68:71], v[72:75], v[12:15]
 v_mfma_f32_16x16x32_bf16 v[16:19], a[124:127], v[72:75], v[16:19]
 v_mfma_f32_16x16x32_bf16 v[20:23], a[180:183], v[72:75], v[20:23]
 v_mfma_f32_16x16x32_bf16 v[24:27], a[236:239], v[72:75], v[24:27]
 v_mfma_f32_16x16x32_bf16 v[28:31], v[156:159], v[72:75], v[28:31]
 v_mfma_f32_16x16x32_bf16 v[32:35], v[212:215], v[72:75], v[32:35]
 ds_read_b128 v[72:75], v108 offset:10240
 s_waitcnt lgkmcnt(1)
 v_mfma_f32_16x16x32_bf16 v[8:11], a[16:19], v[68:71], v[8:11]
 v_mfma_f32_16x16x32_bf16 v[12:15], a[72:75], v[68:71], v[12:15]
 v_mfma_f32_16x16x32_bf16 v[16:19], a[128:131], v[68:71], v[16:19]
 v_mfma_f32_16x16x32_bf16 v[20:23], a[184:187], v[68:71], v[20:23]
 v_mfma_f32_16x16x32_bf16 v[24:27], a[240:243], v[68:71], v[24:27]
 v_mfma_f32_16x16x32_bf16 v[28:31], v[160:163], v[68:71], v[28:31]
 v_mfma_f32_16x16x32_bf16 v[32:35], v[216:219], v[68:71], v[32:35]
 ds_read_b128 v[68:71], v108 offset:12288
 s_waitcnt lgkmcnt(1)
 v_mfma_f32_16x16x32_bf16 v[8:11], a[20:23], v[72:75], v[8:11]
 v_mfma_f32_16x16x32_bf16 v[12:15], a[76:79], v[72:75], v[12:15]
 v_mfma_f32_16x16x32_bf16 v[16:19], a[132:135], v[72:75], v[16:19]
 v_mfma_f32_16x16x32_bf16 v[20:23], a[188:191], v[72:75], v[20:23]
 v_mfma_f32_16x16x32_bf16 v[24:27], a[244:247], v[72:75], v[24:27]
 v_mfma_f32_16x16x32_bf16 v[28:31], v[164:167], v[72:75], v[28:31]
 v_mfma_f32_16x16x32_bf16 v[32:35], v[220:223], v[72:75], v[32:35]
 ds_read_b128 v[72:75], v108 offset:14336
 s_waitcnt lgkmcnt(1)
 v_mfma_f32_16x16x32_bf16 v[8:11], a[24:27], v[68:71], v[8:11]
 v_mfma_f32_16x16x32_bf16 v[12:15], a[80:83], v[68:71], v[12:15]
 v_mfma_f32_16x16x32_bf16 v[16:19], a[136:139], v[68:71], v[16:19]
 v_mfma_f32_16x16x32_bf16 v[20:23], a[192:195], v[68:71], v[20:23]
 v_mfma_f32_16x16x32_bf16 v[24:27], a[248:251], v[68:71], v[24:27]
 v_mfma_f32_16x16x32_bf16 v[28:31], v[168:171], v[68:71], v[28:31]
 v_mfma_f32_16x16x32_bf16 v[32:35], v[224:227], v[68:71], v[32:35]
 ds_read_b128 v[68:71], v108 offset:16384
 s_waitcnt lgkmcnt(1)
 v_mfma_f32_16x16x32_bf16 v[8:11], a[28:31], v[72:75], v[8:11]
 v_mfma_f32_16x16x32_bf16 v[12:15], a[84:87], v[72:75], v[12:15]
 v_mfma_f32_16x16x32_bf16 v[16:19], a[140:143], v[72:75], v[16:19]
 v_mfma_f32_16x16x32_bf16 v[20:23], a[196:199], v[72:75], v[20:23]
 v_mfma_f32_16x16x32_bf16 v[24:27], a[252:255], v[72:75], v[24:27]
 v_mfma_f32_16x16x32_bf16 v[28:31], v[172:175], v[72:75], v[28:31]
 v_mfma_f32_16x16x32_bf16 v[32:35], v[228:231], v[72:75], v[32:35]
 ds_read_b128 v[72:75], v108 offset:18432
 s_waitcnt lgkmcnt(1)
 v_mfma_f32_16x16x32_bf16 v[8:11], a[32:35], v[68:71], v[8:11]
 v_mfma_f32_16x16x32_bf16 v[12:15], a[88:91], v[68:71], v[12:15]
 v_mfma_f32_16x16x32_bf16 v[16:19], a[144:147], v[68:71], v[16:19]
 v_mfma_f32_16x16x32_bf16 v[20:23], a[200:203], v[68:71], v[20:23]
 v_mfma_f32_16x16x32_bf16 v[24:27], v[120:123], v[68:71], v[24:27]
 v_mfma_f32_16x16x32_bf16 v[28:31], v[176:179], v[68:71], v[28:31]
 v_mfma_f32_16x16x32_bf16 v[32:35], v[232:235], v[68:71], v[32:35]
 ds_read_b128 v[68:71], v108 offset:20480
 s_waitcnt lgkmcnt(1)
 v_mfma_f32_16x16x32_bf16 v[8:11], a[36:39], v[72:75], v[8:11]
 v_mfma_f32_16x16x32_bf16 v[12:15], a[92:95], v[72:75], v[12:15]
 v_mfma_f32_16x16x32_bf16 v[16:19], a[148:151], v[72:75], v[16:19]
 v_mfma_f32_16x16x32_bf16 v[20:23], a[204:207], v[72:75], v[20:23]
 v_mfma_f32_16x16x32_bf16 v[24:27], v[124:127], v[72:75], v[24:27]
 v_mfma_f32_16x16x32_bf16 v[28:31], v[180:183], v[72:75], v[28:31]
 v_mfma_f32_16x16x32_bf16 v[32:35], v[236:239], v[72:75], v[32:35]
 ds_read_b128 v[72:75], v108 offset:22528
 s_waitcnt lgkmcnt(1)
 v_mfma_f32_16x16x32_bf16 v[8:11], a[40:43], v[68:71], v[8:11]
 v_mfma_f32_16x16x32_bf16 v[12:15], a[96:99], v[68:71], v[12:15]
 v_mfma_f32_16x16x32_bf16 v[16:19], a[152:155], v[68:71], v[16:19]
 v_mfma_f32_16x16x32_bf16 v[20:23], a[208:211], v[68:71], v[20:23]
 v_mfma_f32_16x16x32_bf16 v[24:27], v[128:131], v[68:71], v[24:27]
 v_mfma_f32_16x16x32_bf16 v[28:31], v[184:187], v[68:71], v[28:31]
 v_mfma_f32_16x16x32_bf16 v[32:35], v[240:243], v[68:71], v[32:35]
 ds_read_b128 v[68:71], v108 offset:24576
 s_waitcnt lgkmcnt(1)
 v_mfma_f32_16x16x32_bf16 v[8:11], a[44:47], v[72:75], v[8:11]
 v_mfma_f32_16x16x32_bf16 v[12:15], a[100:103], v[72:75], v[12:15]
 v_mfma_f32_16x16x32_bf16 v[16:19], a[156:159], v[72:75], v[16:19]
 v_mfma_f32_16x16x32_bf16 v[20:23], a[212:215], v[72:75], v[20:23]
 v_mfma_f32_16x16x32_bf16 v[24:27], v[132:135], v[72:75], v[24:27]
 v_mfma_f32_16x16x32_bf16 v[28:31], v[188:191], v[72:75], v[28:31]
 v_mfma_f32_16x16x32_bf16 v[32:35], v[244:247], v[72:75], v[32:35]
 ds_read_b128 v[72:75], v108 offset:26624
 s_waitcnt lgkmcnt(1)
 v_mfma_f32_16x16x32_bf16 v[8:11], a[48:51], v[68:71], v[8:11]
 v_mfma_f32_16x16x32_bf16 v[12:15], a[104:107], v[68:71], v[12:15]
 v_mfma_f32_16x16x32_bf16 v[16:19], a[160:163], v[68:71], v[16:19]
 v_mfma_f32_16x16x32_bf16 v[20:23], a[216:219], v[68:71], v[20:23]
 v_mfma_f32_16x16x32_bf16 v[24:27], v[136:139], v[68:71], v[24:27]
 v_mfma_f32_16x16x32_bf16 v[28:31], v[192:195], v[68:71], v[28:31]
 v_mfma_f32_16x16x32_bf16 v[32:35], v[248:251], v[68:71], v[32:35]
 s_waitcnt lgkmcnt(0)
 v_mfma_f32_16x16x32_bf16 v[8:11], a[52:55], v[72:75], v[8:11]
 v_mfma_f32_16x16x32_bf16 v[12:15], a[108:111], v[72:75], v[12:15]
 v_mfma_f32_16x16x32_bf16 v[16:19], a[164:167], v[72:75], v[16:19]
 v_mfma_f32_16x16x32_bf16 v[20:23], a[220:223], v[72:75], v[20:23]
 v_mfma_f32_16x16x32_bf16 v[24:27], v[140:143], v[72:75], v[24:27]
 v_mfma_f32_16x16x32_bf16 v[28:31], v[196:199], v[72:75], v[28:31]
 v_mfma_f32_16x16x32_bf16 v[32:35], v[252:255], v[72:75], v[32:35]
 s_nop 1
 v_cvt_pk_bf16_f32 v36, v8, v9
 v_cvt_pk_bf16_f32 v37, v12, v13
 v_cvt_pk_bf16_f32 v38, v10, v11
 v_cvt_pk_bf16_f32 v39, v14, v15
 v_cvt_pk_bf16_f32 v40, v16, v17
 v_cvt_pk_bf16_f32 v41, v20, v21
 v_cvt_pk_bf16_f32 v42, v18, v19
 v_cvt_pk_bf16_f32 v43, v22, v23
 v_cvt_pk_bf16_f32 v44, v24, v25
 v_cvt_pk_bf16_f32 v45, v28, v29
 v_cvt_pk_bf16_f32 v46, v26, v27
 v_cvt_pk_bf16_f32 v47, v30, v31
 v_cvt_pk_bf16_f32 v115, v32, v33
 v_cndmask_b32 v48, 0, v115, s[16:17]
 v_cndmask_b32 v49, v115, 0, s[16:17]
 v_cvt_pk_bf16_f32 v115, v34, v35
 v_cndmask_b32 v50, 0, v115, s[16:17]
 v_cndmask_b32 v51, v115, 0, s[16:17]
 ds_read_b128 v[68:71], v108 offset:1024
 ds_read_b128 v[72:75], v108 offset:3072
 s_waitcnt lgkmcnt(1)
 v_mfma_f32_16x16x32_bf16 v[8:11], a[0:3], v[68:71], 0
 v_mfma_f32_16x16x32_bf16 v[12:15], a[56:59], v[68:71], 0
 v_mfma_f32_16x16x32_bf16 v[16:19], a[112:115], v[68:71], 0
 v_mfma_f32_16x16x32_bf16 v[20:23], a[168:171], v[68:71], 0
 v_mfma_f32_16x16x32_bf16 v[24:27], a[224:227], v[68:71], 0
 v_mfma_f32_16x16x32_bf16 v[28:31], v[144:147], v[68:71], 0
 v_mfma_f32_16x16x32_bf16 v[32:35], v[200:203], v[68:71], 0
 ds_read_b128 v[68:71], v108 offset:5120
 s_waitcnt lgkmcnt(1)
 v_mfma_f32_16x16x32_bf16 v[8:11], a[4:7], v[72:75], v[8:11]
 v_mfma_f32_16x16x32_bf16 v[12:15], a[60:63], v[72:75], v[12:15]
 v_mfma_f32_16x16x32_bf16 v[16:19], a[116:119], v[72:75], v[16:19]
 v_mfma_f32_16x16x32_bf16 v[20:23], a[172:175], v[72:75], v[20:23]
 v_mfma_f32_16x16x32_bf16 v[24:27], a[228:231], v[72:75], v[24:27]
 v_mfma_f32_16x16x32_bf16 v[28:31], v[148:151], v[72:75], v[28:31]
 v_mfma_f32_16x16x32_bf16 v[32:35], v[204:207], v[72:75], v[32:35]
 ds_read_b128 v[72:75], v108 offset:7168
 s_waitcnt lgkmcnt(1)
 v_mfma_f32_16x16x32_bf16 v[8:11], a[8:11], v[68:71], v[8:11]
 v_mfma_f32_16x16x32_bf16 v[12:15], a[64:67], v[68:71], v[12:15]
 v_mfma_f32_16x16x32_bf16 v[16:19], a[120:123], v[68:71], v[16:19]
 v_mfma_f32_16x16x32_bf16 v[20:23], a[176:179], v[68:71], v[20:23]
 v_mfma_f32_16x16x32_bf16 v[24:27], a[232:235], v[68:71], v[24:27]
 v_mfma_f32_16x16x32_bf16 v[28:31], v[152:155], v[68:71], v[28:31]
 v_mfma_f32_16x16x32_bf16 v[32:35], v[208:211], v[68:71], v[32:35]
 ds_read_b128 v[68:71], v108 offset:9216
 s_waitcnt lgkmcnt(1)
 v_mfma_f32_16x16x32_bf16 v[8:11], a[12:15], v[72:75], v[8:11]
 v_mfma_f32_16x16x32_bf16 v[12:15], a[68:71], v[72:75], v[12:15]
 v_mfma_f32_16x16x32_bf16 v[16:19], a[124:127], v[72:75], v[16:19]
 v_mfma_f32_16x16x32_bf16 v[20:23], a[180:183], v[72:75], v[20:23]
 v_mfma_f32_16x16x32_bf16 v[24:27], a[236:239], v[72:75], v[24:27]
 v_mfma_f32_16x16x32_bf16 v[28:31], v[156:159], v[72:75], v[28:31]
 v_mfma_f32_16x16x32_bf16 v[32:35], v[212:215], v[72:75], v[32:35]
 ds_read_b128 v[72:75], v108 offset:11264
 s_waitcnt lgkmcnt(1)
 v_mfma_f32_16x16x32_bf16 v[8:11], a[16:19], v[68:71], v[8:11]
 v_mfma_f32_16x16x32_bf16 v[12:15], a[72:75], v[68:71], v[12:15]
 v_mfma_f32_16x16x32_bf16 v[16:19], a[128:131], v[68:71], v[16:19]
 v_mfma_f32_16x16x32_bf16 v[20:23], a[184:187], v[68:71], v[20:23]
 v_mfma_f32_16x16x32_bf16 v[24:27], a[240:243], v[68:71], v[24:27]
 v_mfma_f32_16x16x32_bf16 v[28:31], v[160:163], v[68:71], v[28:31]
 v_mfma_f32_16x16x32_bf16 v[32:35], v[216:219], v[68:71], v[32:35]
 ds_read_b128 v[68:71], v108 offset:13312
 s_waitcnt lgkmcnt(1)
 v_mfma_f32_16x16x32_bf16 v[8:11], a[20:23], v[72:75], v[8:11]
 v_mfma_f32_16x16x32_bf16 v[12:15], a[76:79], v[72:75], v[12:15]
 v_mfma_f32_16x16x32_bf16 v[16:19], a[132:135], v[72:75], v[16:19]
 v_mfma_f32_16x16x32_bf16 v[20:23], a[188:191], v[72:75], v[20:23]
 v_mfma_f32_16x16x32_bf16 v[24:27], a[244:247], v[72:75], v[24:27]
 v_mfma_f32_16x16x32_bf16 v[28:31], v[164:167], v[72:75], v[28:31]
 v_mfma_f32_16x16x32_bf16 v[32:35], v[220:223], v[72:75], v[32:35]
 ds_read_b128 v[72:75], v108 offset:15360
 s_waitcnt lgkmcnt(1)
 v_mfma_f32_16x16x32_bf16 v[8:11], a[24:27], v[68:71], v[8:11]
 v_mfma_f32_16x16x32_bf16 v[12:15], a[80:83], v[68:71], v[12:15]
 v_mfma_f32_16x16x32_bf16 v[16:19], a[136:139], v[68:71], v[16:19]
 v_mfma_f32_16x16x32_bf16 v[20:23], a[192:195], v[68:71], v[20:23]
 v_mfma_f32_16x16x32_bf16 v[24:27], a[248:251], v[68:71], v[24:27]
 v_mfma_f32_16x16x32_bf16 v[28:31], v[168:171], v[68:71], v[28:31]
 v_mfma_f32_16x16x32_bf16 v[32:35], v[224:227], v[68:71], v[32:35]
 ds_read_b128 v[68:71], v108 offset:17408
 s_waitcnt lgkmcnt(1)
 v_mfma_f32_16x16x32_bf16 v[8:11], a[28:31], v[72:75], v[8:11]
 v_mfma_f32_16x16x32_bf16 v[12:15], a[84:87], v[72:75], v[12:15]
 v_mfma_f32_16x16x32_bf16 v[16:19], a[140:143], v[72:75], v[16:19]
 v_mfma_f32_16x16x32_bf16 v[20:23], a[196:199], v[72:75], v[20:23]
 v_mfma_f32_16x16x32_bf16 v[24:27], a[252:255], v[72:75], v[24:27]
 v_mfma_f32_16x16x32_bf16 v[28:31], v[172:175], v[72:75], v[28:31]
 v_mfma_f32_16x16x32_bf16 v[32:35], v[228:231], v[72:75], v[32:35]
 ds_read_b128 v[72:75], v108 offset:19456
 s_waitcnt lgkmcnt(1)
 v_mfma_f32_16x16x32_bf16 v[8:11], a[32:35], v[68:71], v[8:11]
 v_mfma_f32_16x16x32_bf16 v[12:15], a[88:91], v[68:71], v[12:15]
 v_mfma_f32_16x16x32_bf16 v[16:19], a[144:147], v[68:71], v[16:19]
 v_mfma_f32_16x16x32_bf16 v[20:23], a[200:203], v[68:71], v[20:23]
 v_mfma_f32_16x16x32_bf16 v[24:27], v[120:123], v[68:71], v[24:27]
 v_mfma_f32_16x16x32_bf16 v[28:31], v[176:179], v[68:71], v[28:31]
 v_mfma_f32_16x16x32_bf16 v[32:35], v[232:235], v[68:71], v[32:35]
 ds_read_b128 v[68:71], v108 offset:21504
 s_waitcnt lgkmcnt(1)
 v_mfma_f32_16x16x32_bf16 v[8:11], a[36:39], v[72:75], v[8:11]
 v_mfma_f32_16x16x32_bf16 v[12:15], a[92:95], v[72:75], v[12:15]
 v_mfma_f32_16x16x32_bf16 v[16:19], a[148:151], v[72:75], v[16:19]
 v_mfma_f32_16x16x32_bf16 v[20:23], a[204:207], v[72:75], v[20:23]
 v_mfma_f32_16x16x32_bf16 v[24:27], v[124:127], v[72:75], v[24:27]
 v_mfma_f32_16x16x32_bf16 v[28:31], v[180:183], v[72:75], v[28:31]
 v_mfma_f32_16x16x32_bf16 v[32:35], v[236:239], v[72:75], v[32:35]
 ds_read_b128 v[72:75], v108 offset:23552
 s_waitcnt lgkmcnt(1)
 v_mfma_f32_16x16x32_bf16 v[8:11], a[40:43], v[68:71], v[8:11]
 v_mfma_f32_16x16x32_bf16 v[12:15], a[96:99], v[68:71], v[12:15]
 v_mfma_f32_16x16x32_bf16 v[16:19], a[152:155], v[68:71], v[16:19]
 v_mfma_f32_16x16x32_bf16 v[20:23], a[208:211], v[68:71], v[20:23]
 v_mfma_f32_16x16x32_bf16 v[24:27], v[128:131], v[68:71], v[24:27]
 v_mfma_f32_16x16x32_bf16 v[28:31], v[184:187], v[68:71], v[28:31]
 v_mfma_f32_16x16x32_bf16 v[32:35], v[240:243], v[68:71], v[32:35]
 ds_read_b128 v[68:71], v108 offset:25600
 s_waitcnt lgkmcnt(1)
 v_mfma_f32_16x16x32_bf16 v[8:11], a[44:47], v[72:75], v[8:11]
 v_mfma_f32_16x16x32_bf16 v[12:15], a[100:103], v[72:75], v[12:15]
 v_mfma_f32_16x16x32_bf16 v[16:19], a[156:159], v[72:75], v[16:19]
 v_mfma_f32_16x16x32_bf16 v[20:23], a[212:215], v[72:75], v[20:23]
 v_mfma_f32_16x16x32_bf16 v[24:27], v[132:135], v[72:75], v[24:27]
 v_mfma_f32_16x16x32_bf16 v[28:31], v[188:191], v[72:75], v[28:31]
 v_mfma_f32_16x16x32_bf16 v[32:35], v[244:247], v[72:75], v[32:35]
 ds_read_b128 v[72:75], v108 offset:27648
 s_waitcnt lgkmcnt(1)
 v_mfma_f32_16x16x32_bf16 v[8:11], a[48:51], v[68:71], v[8:11]
 v_mfma_f32_16x16x32_bf16 v[12:15], a[104:107], v[68:71], v[12:15]
 v_mfma_f32_16x16x32_bf16 v[16:19], a[160:163], v[68:71], v[16:19]
 v_mfma_f32_16x16x32_bf16 v[20:23], a[216:219], v[68:71], v[20:23]
 v_mfma_f32_16x16x32_bf16 v[24:27], v[136:139], v[68:71], v[24:27]
 v_mfma_f32_16x16x32_bf16 v[28:31], v[192:195], v[68:71], v[28:31]
 v_mfma_f32_16x16x32_bf16 v[32:35], v[248:251], v[68:71], v[32:35]
 s_waitcnt lgkmcnt(0)
 v_mfma_f32_16x16x32_bf16 v[8:11], a[52:55], v[72:75], v[8:11]
 v_mfma_f32_16x16x32_bf16 v[12:15], a[108:111], v[72:75], v[12:15]
 v_mfma_f32_16x16x32_bf16 v[16:19], a[164:167], v[72:75], v[16:19]
 v_mfma_f32_16x16x32_bf16 v[20:23], a[220:223], v[72:75], v[20:23]
 v_mfma_f32_16x16x32_bf16 v[24:27], v[140:143], v[72:75], v[24:27]
 v_mfma_f32_16x16x32_bf16 v[28:31], v[196:199], v[72:75], v[28:31]
 v_mfma_f32_16x16x32_bf16 v[32:35], v[252:255], v[72:75], v[32:35]
 s_nop 1
 v_cvt_pk_bf16_f32 v52, v8, v9
 v_cvt_pk_bf16_f32 v53, v12, v13
 v_cvt_pk_bf16_f32 v54, v10, v11
 v_cvt_pk_bf16_f32 v55, v14, v15
 v_cvt_pk_bf16_f32 v56, v16, v17
 v_cvt_pk_bf16_f32 v57, v20, v21
 v_cvt_pk_bf16_f32 v58, v18, v19
 v_cvt_pk_bf16_f32 v59, v22, v23
 v_cvt_pk_bf16_f32 v60, v24, v25
 v_cvt_pk_bf16_f32 v61, v28, v29
 v_cvt_pk_bf16_f32 v62, v26, v27
 v_cvt_pk_bf16_f32 v63, v30, v31
 v_cvt_pk_bf16_f32 v115, v32, v33
 v_cndmask_b32 v64, 0, v115, s[16:17]
 v_cndmask_b32 v65, v115, 0, s[16:17]
 v_cvt_pk_bf16_f32 v115, v34, v35
 v_cndmask_b32 v66, 0, v115, s[16:17]
 v_cndmask_b32 v67, v115, 0, s[16:17]
 ds_read_b128 v[96:99], v109
 ds_read_b128 v[100:103], v109 offset:16
 s_waitcnt lgkmcnt(1)
 v_mfma_f32_16x16x32_bf16 v[84:87], v[96:99], v[36:39], 0
 v_mfma_f32_16x16x32_bf16 v[88:91], v[96:99], v[52:55], 0
 s_waitcnt lgkmcnt(0)
 v_mfma_f32_16x16x32_bf16 v[92:95], v[100:103], v[52:55], 0
 ds_read_b128 v[96:99], v109 offset:512
 ds_read_b128 v[100:103], v109 offset:528
 s_waitcnt lgkmcnt(1)
 v_mfma_f32_16x16x32_bf16 v[84:87], v[96:99], v[40:43], v[84:87]
 v_mfma_f32_16x16x32_bf16 v[88:91], v[96:99], v[56:59], v[88:91]
 s_waitcnt lgkmcnt(0)
 v_mfma_f32_16x16x32_bf16 v[92:95], v[100:103], v[56:59], v[92:95]
 ds_read_b128 v[96:99], v110
 ds_read_b128 v[100:103], v110 offset:16
 s_waitcnt lgkmcnt(1)
 v_mfma_f32_16x16x32_bf16 v[84:87], v[96:99], v[44:47], v[84:87]
 v_mfma_f32_16x16x32_bf16 v[88:91], v[96:99], v[60:63], v[88:91]
 s_waitcnt lgkmcnt(0)
 v_mfma_f32_16x16x32_bf16 v[92:95], v[100:103], v[60:63], v[92:95]
 ds_read_b128 v[96:99], v111
 ds_read_b128 v[100:103], v111 offset:16
 s_waitcnt lgkmcnt(1)
 v_mfma_f32_16x16x32_bf16 v[84:87], v[96:99], v[48:51], v[84:87]
 v_mfma_f32_16x16x32_bf16 v[88:91], v[96:99], v[64:67], v[88:91]
 s_waitcnt lgkmcnt(0)
 v_mfma_f32_16x16x32_bf16 v[92:95], v[100:103], v[64:67], v[92:95]
 s_barrier
 s_add_u32 s29, s30, 4
 s_cmp_lt_u32 s29, 64
 s_cbranch_scc0 L_TAx_66
 s_mul_i32 s13, s29, 28672
 s_add_u32 s13, s13, s26
 s_add_u32 s24, s13, 44040192
 s_add_u32 s25, s13, 42205184
 s_add_u32 m0, s26, 0
 s_nop 0
 buffer_load_dwordx4 v108, s[64:67], s24 offen sc1 lds
 buffer_load_dwordx4 v108, s[64:67], s24 offen offset:1024 sc1 lds
 buffer_load_dwordx4 v108, s[64:67], s24 offen offset:2048 sc1 lds
 buffer_load_dwordx4 v108, s[64:67], s24 offen offset:3072 sc1 lds
 s_add_u32 s24, s24, 4096
 s_add_u32 m0, s26, 4096
 s_nop 0
 buffer_load_dwordx4 v108, s[64:67], s24 offen sc1 lds
 buffer_load_dwordx4 v108, s[64:67], s24 offen offset:1024 sc1 lds
 buffer_load_dwordx4 v108, s[64:67], s24 offen offset:2048 sc1 lds
 s_add_u32 m0, s27, 0
 s_nop 0
 buffer_load_dwordx4 v108, s[64:67], s25 offen sc1 lds
 buffer_load_dwordx4 v108, s[64:67], s25 offen offset:1024 sc1 lds
 buffer_load_dwordx4 v108, s[64:67], s25 offen offset:2048 sc1 lds
 buffer_load_dwordx4 v108, s[64:67], s25 offen offset:3072 sc1 lds
 s_add_u32 s25, s25, 4096
 s_add_u32 m0, s27, 4096
 s_nop 0
 buffer_load_dwordx4 v108, s[64:67], s25 offen sc1 lds
 buffer_load_dwordx4 v108, s[64:67], s25 offen offset:1024 sc1 lds
 buffer_load_dwordx4 v108, s[64:67], s25 offen offset:2048 sc1 lds
L_TAx_66:
 s_lshl_b32 s20, s30, 13
 s_add_u32 s20, s20, 52429824
 s_cmp_eq_u32 s30, 0
 s_cselect_b32 s20, 53485568, s20
 s_mov_b32 s31, 0
 s_branch L_sp_67_go
L_sp_67:
 s_sleep 2
 s_add_u32 s31, s31, 1
 s_cmp_gt_u32 s31, 524288
 s_cbranch_scc1 L_exit
L_sp_67_go:
 buffer_load_dwordx4 v[8:11], v112, s[64:67], s20 offen sc1
 buffer_load_dwordx4 v[12:15], v112, s[64:67], s20 offen offset:32 sc1
 buffer_load_dwordx4 v[16:19], v113, s[64:67], s20 offen sc1
 buffer_load_dwordx4 v[20:23], v114, s[64:67], s20 offen sc1
 s_waitcnt vmcnt(0)
 v_max3_u32 v115, v8, v9, v10
 v_max3_u32 v115, v115, v11, v12
 v_max3_u32 v115, v115, v13, v14
 v_max3_u32 v115, v115, v15, v16
 v_max3_u32 v115, v115, v17, v18
 v_max3_u32 v115, v115, v19, v20
 v_max3_u32 v115, v115, v21, v22
 v_max_u32 v115, v115, v23
 v_cmp_eq_u32 vcc, -1, v115
 s_cbranch_vccnz L_sp_67
 v_mfma_f32_16x16x32_bf16 v[76:79], v[8:11], v[36:39], 0
 v_mfma_f32_16x16x32_bf16 v[80:83], v[8:11], v[52:55], 0
 v_mfma_f32_16x16x32_bf16 v[76:79], v[12:15], v[40:43], v[76:79]
 v_mfma_f32_16x16x32_bf16 v[80:83], v[12:15], v[56:59], v[80:83]
 v_mfma_f32_16x16x32_bf16 v[76:79], v[16:19], v[44:47], v[76:79]
 v_mfma_f32_16x16x32_bf16 v[80:83], v[16:19], v[60:63], v[80:83]
 v_mfma_f32_16x16x32_bf16 v[76:79], v[20:23], v[48:51], v[76:79]
 v_mfma_f32_16x16x32_bf16 v[80:83], v[20:23], v[64:67], v[80:83]
 s_mul_i32 s13, s12, 5120
 s_add_u32 s13, s13, 57344
 v_add_u32 v1, s13, v108
 ds_write_b128 v1, v[84:87]
 ds_write_b128 v1, v[88:91] offset:1024
 ds_write_b128 v1, v[92:95] offset:2048
 s_nop 0
 ds_write_b128 v1, v[76:79] offset:3072
 ds_write_b128 v1, v[80:83] offset:4096
 s_waitcnt lgkmcnt(0)
 s_barrier
 s_cmp_gt_u32 s12, 1
 s_cbranch_scc1 L_TAs_68
 s_lshl_b32 s13, s12, 10
 s_add_u32 s13, s13, 57344
 v_add_u32 v1, s13, v108
 v_add_u32 v2, 57344, v108
 ds_read_b128 v[8:11], v1 offset:3072
 ds_read_b128 v[12:15], v1
 ds_read_b128 v[16:19], v2 offset:2048
 ds_read_b128 v[20:23], v1 offset:8192
 ds_read_b128 v[24:27], v1 offset:5120
 ds_read_b128 v[28:31], v2 offset:7168
 ds_read_b128 v[32:35], v1 offset:13312
 ds_read_b128 v[36:39], v1 offset:10240
 ds_read_b128 v[40:43], v2 offset:12288
 ds_read_b128 v[44:47], v1 offset:18432
 ds_read_b128 v[48:51], v1 offset:15360
 ds_read_b128 v[52:55], v2 offset:17408
 s_waitcnt lgkmcnt(0)
 v_pk_add_f32 v[8:9], v[8:9], v[20:21]
 v_pk_add_f32 v[32:33], v[32:33], v[44:45]
 v_pk_add_f32 v[10:11], v[10:11], v[22:23]
 v_pk_add_f32 v[34:35], v[34:35], v[46:47]
 v_pk_add_f32 v[12:13], v[12:13], v[24:25]
 v_pk_add_f32 v[36:37], v[36:37], v[48:49]
 v_pk_add_f32 v[14:15], v[14:15], v[26:27]
 v_pk_add_f32 v[38:39], v[38:39], v[50:51]
 v_pk_add_f32 v[16:17], v[16:17], v[28:29]
 v_pk_add_f32 v[40:41], v[40:41], v[52:53]
 v_pk_add_f32 v[18:19], v[18:19], v[30:31]
 v_pk_add_f32 v[42:43], v[42:43], v[54:55]
 v_pk_add_f32 v[8:9], v[8:9], v[32:33]
 v_pk_add_f32 v[10:11], v[10:11], v[34:35]
 v_pk_add_f32 v[12:13], v[12:13], v[36:37]
 v_pk_add_f32 v[14:15], v[14:15], v[38:39]
 v_pk_add_f32 v[16:17], v[16:17], v[40:41]
 v_pk_add_f32 v[18:19], v[18:19], v[42:43]
 v_mov_b32 v3, s35
 v_mov_b32 v10, v8
 v_mov_b32 v11, v9
 s_lshl_b32 s13, s12, 4
 v_add_u32 v4, s13, v118
 v_subrev_u32 v5, 16, v4
 v_cmp_le_i32 vcc, 0, v4
 s_nop 1
 v_cndmask_b32 v12, v3, v12, vcc
 v_cmp_le_i32 vcc, 0, v5
 s_nop 1
 v_cndmask_b32 v16, v3, v16, vcc
 v_cmp_le_i32 vcc, 1, v4
 s_nop 1
 v_cndmask_b32 v13, v3, v13, vcc
 v_cmp_le_i32 vcc, 1, v5
 s_nop 1
 v_cndmask_b32 v17, v3, v17, vcc
 v_cmp_le_i32 vcc, 2, v4
 s_nop 1
 v_cndmask_b32 v14, v3, v14, vcc
 v_cmp_le_i32 vcc, 2, v5
 s_nop 1
 v_cndmask_b32 v18, v3, v18, vcc
 v_cmp_le_i32 vcc, 3, v4
 s_nop 1
 v_cndmask_b32 v15, v3, v15, vcc
 v_cmp_le_i32 vcc, 3, v5
 s_nop 1
 v_cndmask_b32 v19, v3, v19, vcc
 v_max_f32 v6, v10, v11
 v_max3_f32 v6, v6, v12, v13
 v_max3_f32 v6, v6, v14, v15
 v_max3_f32 v6, v6, v16, v17
 v_max3_f32 v6, v6, v18, v19
 v_mov_b32 v7, v6
 s_nop 1
 v_permlane16_swap_b32 v6, v7
 v_max_f32 v6, v6, v7
 v_mov_b32 v7, v6
 s_nop 1
 v_permlane32_swap_b32 v6, v7
 v_max_f32 v6, v6, v7
 v_sub_f32 v10, v10, v6
 v_sub_f32 v11, v11, v6
 v_sub_f32 v12, v12, v6
 v_sub_f32 v13, v13, v6
 v_sub_f32 v14, v14, v6
 v_sub_f32 v15, v15, v6
 v_sub_f32 v16, v16, v6
 v_sub_f32 v17, v17, v6
 v_sub_f32 v18, v18, v6
 v_sub_f32 v19, v19, v6
 v_exp_f32 v10, v10
 v_exp_f32 v11, v11
 v_exp_f32 v12, v12
 v_exp_f32 v13, v13
 v_exp_f32 v14, v14
 v_exp_f32 v15, v15
 v_exp_f32 v16, v16
 v_exp_f32 v17, v17
 v_exp_f32 v18, v18
 v_exp_f32 v19, v19
 v_add_f32 v6, v10, v11
 v_add_f32 v6, v6, v12
 v_add_f32 v6, v6, v13
 v_add_f32 v6, v6, v14
 v_add_f32 v6, v6, v15
 v_add_f32 v6, v6, v16
 v_add_f32 v6, v6, v17
 v_add_f32 v6, v6, v18
 v_add_f32 v6, v6, v19
 v_mov_b32 v7, v6
 s_nop 1
 v_permlane16_swap_b32 v6, v7
 v_add_f32 v6, v6, v7
 v_mov_b32 v7, v6
 s_nop 1
 v_permlane32_swap_b32 v6, v7
 v_add_f32 v6, v6, v7
 v_rcp_f32 v6, v6
 s_nop 0
 v_mul_f32 v10, v10, v6
 v_mul_f32 v11, v11, v6
 v_mul_f32 v12, v12, v6
 v_mul_f32 v13, v13, v6
 v_mul_f32 v14, v14, v6
 v_mul_f32 v15, v15, v6
 v_mul_f32 v16, v16, v6
 v_mul_f32 v17, v17, v6
 v_mul_f32 v18, v18, v6
 v_mul_f32 v19, v19, v6
 v_cvt_pk_bf16_f32 v24, v10, v11
 v_cvt_pk_bf16_f32 v20, v12, v13
 v_cvt_pk_bf16_f32 v21, v14, v15
 v_cvt_pk_bf16_f32 v22, v16, v17
 v_cvt_pk_bf16_f32 v23, v18, v19
 s_mov_b32 s15, 0xfffffffe
 v_min_u32 v20, s15, v20
 v_min_u32 v21, s15, v21
 v_min_u32 v22, s15, v22
 v_min_u32 v23, s15, v23
 v_min_u32 v24, s15, v24
 s_lshl_b32 s13, s11, 1
 s_add_u32 s13, s13, s12
 s_cmp_lt_u32 s30, 60
 s_cbranch_scc1 L_nl_69
 s_mul_i32 s21, s30, 40960
 s_add_u32 s21, s21, 49816576
 s_add_u32 s22, s21, 32768
 s_lshl_b32 s14, s13, 10
 s_add_u32 s14, s14, s21
 buffer_store_dwordx4 v[20:23], v108, s[64:67], s14 offen
 s_lshl_b32 s14, s13, 8
 s_add_u32 s14, s14, s22
 buffer_store_dword v24, v117, s[64:67], s14 offen
L_nl_69:
 s_lshl_b32 s21, s30, 15
 s_add_u32 s21, s21, 45875200
 s_lshl_b32 s22, s30, 13
 s_add_u32 s22, s22, 47972352
 s_lshl_b32 s14, s13, 10
 s_add_u32 s14, s14, s21
 buffer_store_dwordx4 v[20:23], v108, s[64:67], s14 offen sc1
 s_lshl_b32 s14, s13, 8
 s_add_u32 s14, s14, s22
 buffer_store_dword v24, v117, s[64:67], s14 offen sc1
 s_lshl_b32 s14, s30, 5
 s_add_u32 s13, s13, s14
 s_lshr_b32 s14, s13, 3
 s_lshl_b32 s14, s14, 7
 s_and_b32 s13, s13, 7
 s_lshl_b32 s13, s13, 2
 s_add_u32 s13, s13, s14
 s_add_u32 s28, s13, 52232192
L_TAs_68:
 s_add_u32 s30, s30, 4
 s_cmp_lt_u32 s30, 64
 s_cbranch_scc1 L_TA_65
 s_waitcnt vmcnt(0)
 s_mov_b64 exec, 1
 buffer_store_dword v116, v116, s[64:67], s28 offen sc1
 s_mov_b64 exec, -1
 s_branch L_exit
L_pad12:
 s_setpc_b64 s[94:95]
L_FFN:
 s_lshl_b32 s13, s13, 5
 s_add_u32 s11, s11, s13
 s_cmp_lg_u32 s12, 0
 s_cbranch_scc1 L_wg_70_done
 v_lshlrev_b32 v1, 7, v0
 s_mov_b32 s31, 0
 s_mov_b32 s3, 53501952
 s_mov_b32 exec_lo, 262143
 s_mov_b32 exec_hi, 1
L_wg_70:
 buffer_load_dword v2, v1, s[64:67], s3 offen sc1
 s_add_u32 s31, s31, 1
 s_cmp_gt_u32 s31, 524288
 s_cbranch_scc1 L_exit
 s_waitcnt vmcnt(0)
 v_cmp_eq_u32 vcc, 0, v2
 s_cbranch_vccz L_wg_70_ok
 s_sleep 48
 s_branch L_wg_70
L_wg_70_ok:
 s_mov_b64 exec, -1
L_wg_70_done:
 s_barrier
 s_mov_b32 s80, s56
 s_mov_b32 s81, s57
 s_mov_b32 s82, 1605632
 s_mov_b32 s83, 0x20000
 s_mov_b32 s84, s60
 s_mov_b32 s85, s61
 s_mov_b32 s86, 1605632
 s_mov_b32 s87, 0x20000
 s_mov_b32 s88, s58
 s_mov_b32 s89, s59
 s_mov_b32 s90, 3584
 s_mov_b32 s91, 0x20000
 s_mov_b32 s92, s62
 s_mov_b32 s93, s63
 s_mov_b32 s94, 896
 s_mov_b32 s95, 0x20000
 v_lshlrev_b32 v88, 4, v0
 v_mov_b32 v93, 0
 s_lshl_b32 s13, s12, 10
 s_add_u32 m0, s13, 131072
 s_nop 0
 buffer_load_dwordx4 v88, s[88:91], s13 offen lds
 s_mov_b32 m0, 135168
 s_nop 0
 buffer_load_dwordx4 v88, s[92:95], 0 offen lds
 v_lshrrev_b32 v1, 4, v0
 v_and_b32 v2, 15, v0
 v_and_b32 v4, 1, v2
 v_lshlrev_b32 v3, 4, v4
 v_and_b32 v4, 8, v2
 v_or_b32 v3, v3, v4
 v_and_b32 v4, 2, v2
 v_lshlrev_b32 v4, 1, v4
 v_and_b32 v5, 4, v2
 v_lshrrev_b32 v5, 1, v5
 v_or_b32 v4, v4, v5
 v_lshrrev_b32 v5, 4, v2
 v_or3_b32 v3, v3, v4, v5
 v_lshlrev_b32 v3, 4, v3
 v_lshl_add_u32 v3, v1, 9, v3
 s_mul_i32 s13, s11, 28672
 s_add_u32 s13, s13, 42205184
 buffer_load_dwordx4 v[128:131], v3, s[64:67], s13 offen sc1
 buffer_load_dwordx4 v[132:135], v3, s[64:67], s13 offen offset:16 sc1
 buffer_load_dwordx4 v[136:139], v3, s[64:67], s13 offen offset:2048 sc1
 buffer_load_dwordx4 v[140:143], v3, s[64:67], s13 offen offset:2064 sc1
 s_add_u32 s13, s13, 4096
 buffer_load_dwordx4 v[144:147], v3, s[64:67], s13 offen sc1
 buffer_load_dwordx4 v[148:151], v3, s[64:67], s13 offen offset:16 sc1
 buffer_load_dwordx4 v[152:155], v3, s[64:67], s13 offen offset:2048 sc1
 buffer_load_dwordx4 v[156:159], v3, s[64:67], s13 offen offset:2064 sc1
 s_add_u32 s13, s13, 4096
 buffer_load_dwordx4 v[160:163], v3, s[64:67], s13 offen sc1
 buffer_load_dwordx4 v[164:167], v3, s[64:67], s13 offen offset:16 sc1
 buffer_load_dwordx4 v[168:171], v3, s[64:67], s13 offen offset:2048 sc1
 buffer_load_dwordx4 v[172:175], v3, s[64:67], s13 offen offset:2064 sc1
 s_add_u32 s13, s13, 4096
 buffer_load_dwordx4 v[176:179], v3, s[64:67], s13 offen sc1
 buffer_load_dwordx4 v[180:183], v3, s[64:67], s13 offen offset:16 sc1
 buffer_load_dwordx4 v[184:187], v3, s[64:67], s13 offen offset:2048 sc1
 buffer_load_dwordx4 v[188:191], v3, s[64:67], s13 offen offset:2064 sc1
 s_add_u32 s13, s13, 4096
 buffer_load_dwordx4 v[192:195], v3, s[64:67], s13 offen sc1
 buffer_load_dwordx4 v[196:199], v3, s[64:67], s13 offen offset:16 sc1
 buffer_load_dwordx4 v[200:203], v3, s[64:67], s13 offen offset:2048 sc1
 buffer_load_dwordx4 v[204:207], v3, s[64:67], s13 offen offset:2064 sc1
 s_add_u32 s13, s13, 4096
 buffer_load_dwordx4 v[208:211], v3, s[64:67], s13 offen sc1
 buffer_load_dwordx4 v[212:215], v3, s[64:67], s13 offen offset:16 sc1
 buffer_load_dwordx4 v[216:219], v3, s[64:67], s13 offen offset:2048 sc1
 buffer_load_dwordx4 v[220:223], v3, s[64:67], s13 offen offset:2064 sc1
 s_add_u32 s13, s13, 4096
 buffer_load_dwordx4 v[224:227], v3, s[64:67], s13 offen sc1
 buffer_load_dwordx4 v[228:231], v3, s[64:67], s13 offen offset:16 sc1
 buffer_load_dwordx4 v[232:235], v3, s[64:67], s13 offen offset:2048 sc1
 buffer_load_dwordx4 v[236:239], v3, s[64:67], s13 offen offset:2064 sc1
 s_add_u32 s13, s13, 4096
 v_accvgpr_write_b32 a0, 0
 v_accvgpr_write_b32 a1, 0
 v_accvgpr_write_b32 a2, 0
 v_accvgpr_write_b32 a3, 0
 v_accvgpr_write_b32 a4, 0
 v_accvgpr_write_b32 a5, 0
 v_accvgpr_write_b32 a6, 0
 v_accvgpr_write_b32 a7, 0
 v_accvgpr_write_b32 a8, 0
 v_accvgpr_write_b32 a9, 0
 v_accvgpr_write_b32 a10, 0
 v_accvgpr_write_b32 a11, 0
 v_accvgpr_write_b32 a12, 0
 v_accvgpr_write_b32 a13, 0
 v_accvgpr_write_b32 a14, 0
 v_accvgpr_write_b32 a15, 0
 v_accvgpr_write_b32 a16, 0
 v_accvgpr_write_b32 a17, 0
 v_accvgpr_write_b32 a18, 0
 v_accvgpr_write_b32 a19, 0
 v_accvgpr_write_b32 a20, 0
 v_accvgpr_write_b32 a21, 0
 v_accvgpr_write_b32 a22, 0
 v_accvgpr_write_b32 a23, 0
 v_accvgpr_write_b32 a24, 0
 v_accvgpr_write_b32 a25, 0
 v_accvgpr_write_b32 a26, 0
 v_accvgpr_write_b32 a27, 0
 v_accvgpr_write_b32 a28, 0
 v_accvgpr_write_b32 a29, 0
 v_accvgpr_write_b32 a30, 0
 v_accvgpr_write_b32 a31, 0
 v_accvgpr_write_b32 a32, 0
 v_accvgpr_write_b32 a33, 0
 v_accvgpr_write_b32 a34, 0
 v_accvgpr_write_b32 a35, 0
 v_accvgpr_write_b32 a36, 0
 v_accvgpr_write_b32 a37, 0
 v_accvgpr_write_b32 a38, 0
 v_accvgpr_write_b32 a39, 0
 v_accvgpr_write_b32 a40, 0
 v_accvgpr_write_b32 a41, 0
 v_accvgpr_write_b32 a42, 0
 v_accvgpr_write_b32 a43, 0
 v_accvgpr_write_b32 a44, 0
 v_accvgpr_write_b32 a45, 0
 v_accvgpr_write_b32 a46, 0
 v_accvgpr_write_b32 a47, 0
 v_accvgpr_write_b32 a48, 0
 v_accvgpr_write_b32 a49, 0
 v_accvgpr_write_b32 a50, 0
 v_accvgpr_write_b32 a51, 0
 v_accvgpr_write_b32 a52, 0
 v_accvgpr_write_b32 a53, 0
 v_accvgpr_write_b32 a54, 0
 v_accvgpr_write_b32 a55, 0
 v_accvgpr_write_b32 a56, 0
 v_accvgpr_write_b32 a57, 0
 v_accvgpr_write_b32 a58, 0
 v_accvgpr_write_b32 a59, 0
 v_accvgpr_write_b32 a60, 0
 v_accvgpr_write_b32 a61, 0
 v_accvgpr_write_b32 a62, 0
 v_accvgpr_write_b32 a63, 0
 v_accvgpr_write_b32 a64, 0
 v_accvgpr_write_b32 a65, 0
 v_accvgpr_write_b32 a66, 0
 v_accvgpr_write_b32 a67, 0
 v_accvgpr_write_b32 a68, 0
 v_accvgpr_write_b32 a69, 0
 v_accvgpr_write_b32 a70, 0
 v_accvgpr_write_b32 a71, 0
 v_accvgpr_write_b32 a72, 0
 v_accvgpr_write_b32 a73, 0
 v_accvgpr_write_b32 a74, 0
 v_accvgpr_write_b32 a75, 0
 v_accvgpr_write_b32 a76, 0
 v_accvgpr_write_b32 a77, 0
 v_accvgpr_write_b32 a78, 0
 v_accvgpr_write_b32 a79, 0
 v_accvgpr_write_b32 a80, 0
 v_accvgpr_write_b32 a81, 0
 v_accvgpr_write_b32 a82, 0
 v_accvgpr_write_b32 a83, 0
 v_accvgpr_write_b32 a84, 0
 v_accvgpr_write_b32 a85, 0
 v_accvgpr_write_b32 a86, 0
 v_accvgpr_write_b32 a87, 0
 v_accvgpr_write_b32 a88, 0
 v_accvgpr_write_b32 a89, 0
 v_accvgpr_write_b32 a90, 0
 v_accvgpr_write_b32 a91, 0
 v_accvgpr_write_b32 a92, 0
 v_accvgpr_write_b32 a93, 0
 v_accvgpr_write_b32 a94, 0
 v_accvgpr_write_b32 a95, 0
 v_accvgpr_write_b32 a96, 0
 v_accvgpr_write_b32 a97, 0
 v_accvgpr_write_b32 a98, 0
 v_accvgpr_write_b32 a99, 0
 v_accvgpr_write_b32 a100, 0
 v_accvgpr_write_b32 a101, 0
 v_accvgpr_write_b32 a102, 0
 v_accvgpr_write_b32 a103, 0
 v_accvgpr_write_b32 a104, 0
 v_accvgpr_write_b32 a105, 0
 v_accvgpr_write_b32 a106, 0
 v_accvgpr_write_b32 a107, 0
 v_accvgpr_write_b32 a108, 0
 v_accvgpr_write_b32 a109, 0
 v_accvgpr_write_b32 a110, 0
 v_accvgpr_write_b32 a111, 0
 v_accvgpr_write_b32 a112, 0
 v_accvgpr_write_b32 a113, 0
 v_accvgpr_write_b32 a114, 0
 v_accvgpr_write_b32 a115, 0
 v_accvgpr_write_b32 a116, 0
 v_accvgpr_write_b32 a117, 0
 v_accvgpr_write_b32 a118, 0
 v_accvgpr_write_b32 a119, 0
 v_accvgpr_write_b32 a120, 0
 v_accvgpr_write_b32 a121, 0
 v_accvgpr_write_b32 a122, 0
 v_accvgpr_write_b32 a123, 0
 v_accvgpr_write_b32 a124, 0
 v_accvgpr_write_b32 a125, 0
 v_accvgpr_write_b32 a126, 0
 v_accvgpr_write_b32 a127, 0
 v_accvgpr_write_b32 a128, 0
 v_accvgpr_write_b32 a129, 0
 v_accvgpr_write_b32 a130, 0
 v_accvgpr_write_b32 a131, 0
 v_accvgpr_write_b32 a132, 0
 v_accvgpr_write_b32 a133, 0
 v_accvgpr_write_b32 a134, 0
 v_accvgpr_write_b32 a135, 0
 v_accvgpr_write_b32 a136, 0
 v_accvgpr_write_b32 a137, 0
 v_accvgpr_write_b32 a138, 0
 v_accvgpr_write_b32 a139, 0
 v_accvgpr_write_b32 a140, 0
 v_accvgpr_write_b32 a141, 0
 v_accvgpr_write_b32 a142, 0
 v_accvgpr_write_b32 a143, 0
 v_accvgpr_write_b32 a144, 0
 v_accvgpr_write_b32 a145, 0
 v_accvgpr_write_b32 a146, 0
 v_accvgpr_write_b32 a147, 0
 v_accvgpr_write_b32 a148, 0
 v_accvgpr_write_b32 a149, 0
 v_accvgpr_write_b32 a150, 0
 v_accvgpr_write_b32 a151, 0
 v_accvgpr_write_b32 a152, 0
 v_accvgpr_write_b32 a153, 0
 v_accvgpr_write_b32 a154, 0
 v_accvgpr_write_b32 a155, 0
 v_accvgpr_write_b32 a156, 0
 v_accvgpr_write_b32 a157, 0
 v_accvgpr_write_b32 a158, 0
 v_accvgpr_write_b32 a159, 0
 v_accvgpr_write_b32 a160, 0
 v_accvgpr_write_b32 a161, 0
 v_accvgpr_write_b32 a162, 0
 v_accvgpr_write_b32 a163, 0
 v_accvgpr_write_b32 a164, 0
 v_accvgpr_write_b32 a165, 0
 v_accvgpr_write_b32 a166, 0
 v_accvgpr_write_b32 a167, 0
 v_accvgpr_write_b32 a168, 0
 v_accvgpr_write_b32 a169, 0
 v_accvgpr_write_b32 a170, 0
 v_accvgpr_write_b32 a171, 0
 v_accvgpr_write_b32 a172, 0
 v_accvgpr_write_b32 a173, 0
 v_accvgpr_write_b32 a174, 0
 v_accvgpr_write_b32 a175, 0
 v_accvgpr_write_b32 a176, 0
 v_accvgpr_write_b32 a177, 0
 v_accvgpr_write_b32 a178, 0
 v_accvgpr_write_b32 a179, 0
 v_accvgpr_write_b32 a180, 0
 v_accvgpr_write_b32 a181, 0
 v_accvgpr_write_b32 a182, 0
 v_accvgpr_write_b32 a183, 0
 v_accvgpr_write_b32 a184, 0
 v_accvgpr_write_b32 a185, 0
 v_accvgpr_write_b32 a186, 0
 v_accvgpr_write_b32 a187, 0
 v_accvgpr_write_b32 a188, 0
 v_accvgpr_write_b32 a189, 0
 v_accvgpr_write_b32 a190, 0
 v_accvgpr_write_b32 a191, 0
 v_accvgpr_write_b32 a192, 0
 v_accvgpr_write_b32 a193, 0
 v_accvgpr_write_b32 a194, 0
 v_accvgpr_write_b32 a195, 0
 v_accvgpr_write_b32 a196, 0
 v_accvgpr_write_b32 a197, 0
 v_accvgpr_write_b32 a198, 0
 v_accvgpr_write_b32 a199, 0
 v_accvgpr_write_b32 a200, 0
 v_accvgpr_write_b32 a201, 0
 v_accvgpr_write_b32 a202, 0
 v_accvgpr_write_b32 a203, 0
 v_accvgpr_write_b32 a204, 0
 v_accvgpr_write_b32 a205, 0
 v_accvgpr_write_b32 a206, 0
 v_accvgpr_write_b32 a207, 0
 v_accvgpr_write_b32 a208, 0
 v_accvgpr_write_b32 a209, 0
 v_accvgpr_write_b32 a210, 0
 v_accvgpr_write_b32 a211, 0
 v_accvgpr_write_b32 a212, 0
 v_accvgpr_write_b32 a213, 0
 v_accvgpr_write_b32 a214, 0
 v_accvgpr_write_b32 a215, 0
 v_accvgpr_write_b32 a216, 0
 v_accvgpr_write_b32 a217, 0
 v_accvgpr_write_b32 a218, 0
 v_accvgpr_write_b32 a219, 0
 v_accvgpr_write_b32 a220, 0
 v_accvgpr_write_b32 a221, 0
 v_accvgpr_write_b32 a222, 0
 v_accvgpr_write_b32 a223, 0
 v_lshrrev_b32 v4, 3, v0
 v_and_b32 v5, 7, v0
 v_and_b32 v6, 2, v4
 v_xor_b32 v6, v6, v5
 v_lshlrev_b32 v6, 4, v6
 v_mul_u32_u24 v7, 3584, v4
 v_add_u32 v89, v6, v7
 v_xor_b32 v90, 64, v89
 v_and_b32 v6, 6, v4
 v_xor_b32 v6, v6, v5
 v_lshlrev_b32 v6, 4, v6
 v_mul_u32_u24 v7, 896, v4
 v_add_u32 v91, v6, v7
 s_lshl_b32 s26, s12, 15
 v_lshrrev_b32 v4, 2, v2
 v_and_b32 v5, 3, v0
 v_lshlrev_b32 v5, 3, v5
 v_add_u32 v5, s26, v5
 v_lshrrev_b32 v6, 1, v4
 v_and_b32 v7, 1, v1
 v_lshl_add_u32 v6, v7, 1, v6
 v_lshl_add_u32 v7, v1, 3, v4
 v_lshl_add_u32 v8, v7, 7, v5
 v_lshl_add_u32 v7, v1, 2, v4
 v_lshl_add_u32 v9, v7, 7, v5
 v_xor_b32 v7, 0, v6
 v_lshl_add_u32 v96, v7, 5, v8
 v_lshl_add_u32 v100, v7, 5, v9
 v_xor_b32 v7, 1, v6
 v_lshl_add_u32 v97, v7, 5, v8
 v_lshl_add_u32 v101, v7, 5, v9
 v_xor_b32 v7, 2, v6
 v_lshl_add_u32 v98, v7, 5, v8
 v_lshl_add_u32 v102, v7, 5, v9
 v_xor_b32 v7, 3, v6
 v_lshl_add_u32 v99, v7, 5, v8
 v_lshl_add_u32 v103, v7, 5, v9
 s_mul_i32 s13, s12, 896
 s_add_u32 s13, s13, 131072
 v_lshlrev_b32 v7, 3, v1
 v_add_u32 v92, s13, v7
 s_mul_i32 s13, s11, 147
 s_lshr_b32 s13, s13, 10
 s_mul_i32 s13, s13, 7
 s_sub_u32 s27, s11, s13
 s_lshl_b32 s13, s27, 7
 v_add_u32 v92, s13, v92
 s_mul_i32 s22, s12, 896
 s_mul_i32 s23, s12, 401408
 s_lshl_b32 s13, s27, 7
 s_add_u32 s20, s22, s13
 s_mul_i32 s13, s27, 57344
 s_add_u32 s21, s23, s13
 s_add_u32 s27, s27, 1
 s_mov_b32 s29, 128
 s_cmp_eq_u32 s27, 7
 s_cselect_b32 s27, 0, s27
 s_cselect_b32 s29, -768, s29
 s_lshl_b32 s13, s27, 7
 s_add_u32 s28, s22, s13
 s_mov_b32 s34, 0xffff0000
 s_add_u32 m0, s26, 0
 s_add_u32 s13, s20, 0
 buffer_load_dwordx4 v89, s[80:83], s13 offen lds
 s_add_u32 m0, s26, 1024
 s_add_u32 s13, s20, 28672
 buffer_load_dwordx4 v90, s[80:83], s13 offen lds
 s_add_u32 m0, s26, 2048
 s_add_u32 s13, s20, 57344
 buffer_load_dwordx4 v89, s[80:83], s13 offen lds
 s_add_u32 m0, s26, 3072
 s_add_u32 s13, s20, 86016
 buffer_load_dwordx4 v90, s[80:83], s13 offen lds
 s_add_u32 m0, s26, 4096
 s_add_u32 s13, s20, 114688
 buffer_load_dwordx4 v89, s[80:83], s13 offen lds
 s_add_u32 m0, s26, 5120
 s_add_u32 s13, s20, 143360
 buffer_load_dwordx4 v90, s[80:83], s13 offen lds
 s_add_u32 m0, s26, 6144
 s_add_u32 s13, s20, 172032
 buffer_load_dwordx4 v89, s[80:83], s13 offen lds
 s_add_u32 m0, s26, 7168
 s_add_u32 s13, s20, 200704
 buffer_load_dwordx4 v90, s[80:83], s13 offen lds
 s_add_u32 m0, s26, 8192
 s_add_u32 s13, s20, 229376
 buffer_load_dwordx4 v89, s[80:83], s13 offen lds
 s_add_u32 m0, s26, 9216
 s_add_u32 s13, s20, 258048
 buffer_load_dwordx4 v90, s[80:83], s13 offen lds
 s_add_u32 m0, s26, 10240
 s_add_u32 s13, s20, 286720
 buffer_load_dwordx4 v89, s[80:83], s13 offen lds
 s_add_u32 m0, s26, 11264
 s_add_u32 s13, s20, 315392
 buffer_load_dwordx4 v90, s[80:83], s13 offen lds
 s_add_u32 m0, s26, 12288
 s_add_u32 s13, s20, 344064
 buffer_load_dwordx4 v89, s[80:83], s13 offen lds
 s_add_u32 m0, s26, 13312
 s_add_u32 s13, s20, 372736
 buffer_load_dwordx4 v90, s[80:83], s13 offen lds
 s_add_u32 m0, s26, 14336
 s_add_u32 s13, s20, 401408
 buffer_load_dwordx4 v89, s[80:83], s13 offen lds
 s_add_u32 m0, s26, 15360
 s_add_u32 s13, s20, 430080
 buffer_load_dwordx4 v90, s[80:83], s13 offen lds
 s_add_u32 m0, s26, 16384
 s_add_u32 s13, s20, 458752
 buffer_load_dwordx4 v89, s[80:83], s13 offen lds
 s_add_u32 m0, s26, 17408
 s_add_u32 s13, s20, 487424
 buffer_load_dwordx4 v90, s[80:83], s13 offen lds
 s_add_u32 m0, s26, 18432
 s_add_u32 s13, s20, 516096
 buffer_load_dwordx4 v89, s[80:83], s13 offen lds
 s_add_u32 m0, s26, 19456
 s_add_u32 s13, s20, 544768
 buffer_load_dwordx4 v90, s[80:83], s13 offen lds
 s_add_u32 m0, s26, 20480
 s_add_u32 s13, s20, 573440
 buffer_load_dwordx4 v89, s[80:83], s13 offen lds
 s_add_u32 m0, s26, 21504
 s_add_u32 s13, s20, 602112
 buffer_load_dwordx4 v90, s[80:83], s13 offen lds
 s_add_u32 m0, s26, 22528
 s_add_u32 s13, s20, 630784
 buffer_load_dwordx4 v89, s[80:83], s13 offen lds
 s_add_u32 m0, s26, 23552
 s_add_u32 s13, s20, 659456
 buffer_load_dwordx4 v90, s[80:83], s13 offen lds
 s_waitcnt vmcnt(24)
 s_barrier
 s_mov_b32 s30, 0
L_ffn_71:
 s_waitcnt vmcnt(16)
 ds_read_b64_tr_b16 v[56:57], v96
 ds_read_b64_tr_b16 v[58:59], v96 offset:512
 ds_read_b64_tr_b16 v[60:61], v97
 ds_read_b64_tr_b16 v[62:63], v97 offset:512
 ds_read_b64_tr_b16 v[64:65], v98
 ds_read_b64_tr_b16 v[66:67], v98 offset:512
 ds_read_b64_tr_b16 v[68:69], v99
 ds_read_b64_tr_b16 v[70:71], v99 offset:512
 s_add_u32 m0, s26, 24576
 s_add_u32 s13, s20, 688128
 buffer_load_dwordx4 v89, s[80:83], s13 offen lds
 s_add_u32 m0, s26, 25600
 s_add_u32 s13, s20, 716800
 buffer_load_dwordx4 v90, s[80:83], s13 offen lds
 s_add_u32 m0, s26, 26624
 s_add_u32 s13, s20, 745472
 buffer_load_dwordx4 v89, s[80:83], s13 offen lds
 s_add_u32 m0, s26, 27648
 s_add_u32 s13, s20, 774144
 buffer_load_dwordx4 v90, s[80:83], s13 offen lds
 s_add_u32 m0, s26, 28672
 s_add_u32 s13, s20, 802816
 buffer_load_dwordx4 v89, s[80:83], s13 offen lds
 s_add_u32 m0, s26, 29696
 s_add_u32 s13, s20, 831488
 buffer_load_dwordx4 v90, s[80:83], s13 offen lds
 s_add_u32 m0, s26, 30720
 s_add_u32 s13, s20, 860160
 buffer_load_dwordx4 v89, s[80:83], s13 offen lds
 s_add_u32 m0, s26, 31744
 s_add_u32 s13, s20, 888832
 buffer_load_dwordx4 v90, s[80:83], s13 offen lds
 s_waitcnt lgkmcnt(0)
 v_mfma_f32_16x16x32_bf16 v[8:11], v[56:59], v[128:131], 0
 ds_read_b64_tr_b16 v[72:73], v96 offset:4096
 v_mfma_f32_16x16x32_bf16 v[12:15], v[56:59], v[132:135], 0
 ds_read_b64_tr_b16 v[74:75], v96 offset:4608
 v_mfma_f32_16x16x32_bf16 v[16:19], v[60:63], v[128:131], 0
 ds_read_b64_tr_b16 v[76:77], v97 offset:4096
 v_mfma_f32_16x16x32_bf16 v[20:23], v[60:63], v[132:135], 0
 ds_read_b64_tr_b16 v[78:79], v97 offset:4608
 v_mfma_f32_16x16x32_bf16 v[24:27], v[64:67], v[128:131], 0
 ds_read_b64_tr_b16 v[80:81], v98 offset:4096
 v_mfma_f32_16x16x32_bf16 v[28:31], v[64:67], v[132:135], 0
 ds_read_b64_tr_b16 v[82:83], v98 offset:4608
 v_mfma_f32_16x16x32_bf16 v[32:35], v[68:71], v[128:131], 0
 ds_read_b64_tr_b16 v[84:85], v99 offset:4096
 v_mfma_f32_16x16x32_bf16 v[36:39], v[68:71], v[132:135], 0
 ds_read_b64_tr_b16 v[86:87], v99 offset:4608
 s_waitcnt lgkmcnt(0)
 v_mfma_f32_16x16x32_bf16 v[8:11], v[72:75], v[136:139], v[8:11]
 v_mfma_f32_16x16x32_bf16 v[12:15], v[72:75], v[140:143], v[12:15]
 v_mfma_f32_16x16x32_bf16 v[16:19], v[76:79], v[136:139], v[16:19]
 v_mfma_f32_16x16x32_bf16 v[20:23], v[76:79], v[140:143], v[20:23]
 v_mfma_f32_16x16x32_bf16 v[24:27], v[80:83], v[136:139], v[24:27]
 v_mfma_f32_16x16x32_bf16 v[28:31], v[80:83], v[140:143], v[28:31]
 v_mfma_f32_16x16x32_bf16 v[32:35], v[84:87], v[136:139], v[32:35]
 v_mfma_f32_16x16x32_bf16 v[36:39], v[84:87], v[140:143], v[36:39]
 s_waitcnt vmcnt(16)
 ds_read_b64_tr_b16 v[56:57], v96 offset:8192
 ds_read_b64_tr_b16 v[58:59], v96 offset:8704
 ds_read_b64_tr_b16 v[60:61], v97 offset:8192
 ds_read_b64_tr_b16 v[62:63], v97 offset:8704
 ds_read_b64_tr_b16 v[64:65], v98 offset:8192
 ds_read_b64_tr_b16 v[66:67], v98 offset:8704
 ds_read_b64_tr_b16 v[68:69], v99 offset:8192
 ds_read_b64_tr_b16 v[70:71], v99 offset:8704
 s_add_u32 m0, s26, 0
 s_add_u32 s13, s20, 917504
 buffer_load_dwordx4 v89, s[80:83], s13 offen lds
 s_add_u32 m0, s26, 1024
 s_add_u32 s13, s20, 946176
 buffer_load_dwordx4 v90, s[80:83], s13 offen lds
 s_add_u32 m0, s26, 2048
 s_add_u32 s13, s20, 974848
 buffer_load_dwordx4 v89, s[80:83], s13 offen lds
 s_add_u32 m0, s26, 3072
 s_add_u32 s13, s20, 1003520
 buffer_load_dwordx4 v90, s[80:83], s13 offen lds
 s_add_u32 m0, s26, 4096
 s_add_u32 s13, s20, 1032192
 buffer_load_dwordx4 v89, s[80:83], s13 offen lds
 s_add_u32 m0, s26, 5120
 s_add_u32 s13, s20, 1060864
 buffer_load_dwordx4 v90, s[80:83], s13 offen lds
 s_add_u32 m0, s26, 6144
 s_add_u32 s13, s20, 1089536
 buffer_load_dwordx4 v89, s[80:83], s13 offen lds
 s_add_u32 m0, s26, 7168
 s_add_u32 s13, s20, 1118208
 buffer_load_dwordx4 v90, s[80:83], s13 offen lds
 s_waitcnt lgkmcnt(0)
 v_mfma_f32_16x16x32_bf16 v[8:11], v[56:59], v[144:147], v[8:11]
 ds_read_b64_tr_b16 v[72:73], v96 offset:12288
 v_mfma_f32_16x16x32_bf16 v[12:15], v[56:59], v[148:151], v[12:15]
 ds_read_b64_tr_b16 v[74:75], v96 offset:12800
 v_mfma_f32_16x16x32_bf16 v[16:19], v[60:63], v[144:147], v[16:19]
 ds_read_b64_tr_b16 v[76:77], v97 offset:12288
 v_mfma_f32_16x16x32_bf16 v[20:23], v[60:63], v[148:151], v[20:23]
 ds_read_b64_tr_b16 v[78:79], v97 offset:12800
 v_mfma_f32_16x16x32_bf16 v[24:27], v[64:67], v[144:147], v[24:27]
 ds_read_b64_tr_b16 v[80:81], v98 offset:12288
 v_mfma_f32_16x16x32_bf16 v[28:31], v[64:67], v[148:151], v[28:31]
 ds_read_b64_tr_b16 v[82:83], v98 offset:12800
 v_mfma_f32_16x16x32_bf16 v[32:35], v[68:71], v[144:147], v[32:35]
 ds_read_b64_tr_b16 v[84:85], v99 offset:12288
 v_mfma_f32_16x16x32_bf16 v[36:39], v[68:71], v[148:151], v[36:39]
 ds_read_b64_tr_b16 v[86:87], v99 offset:12800
 s_waitcnt lgkmcnt(0)
 v_mfma_f32_16x16x32_bf16 v[8:11], v[72:75], v[152:155], v[8:11]
 v_mfma_f32_16x16x32_bf16 v[12:15], v[72:75], v[156:159], v[12:15]
 v_mfma_f32_16x16x32_bf16 v[16:19], v[76:79], v[152:155], v[16:19]
 v_mfma_f32_16x16x32_bf16 v[20:23], v[76:79], v[156:159], v[20:23]
 v_mfma_f32_16x16x32_bf16 v[24:27], v[80:83], v[152:155], v[24:27]
 v_mfma_f32_16x16x32_bf16 v[28:31], v[80:83], v[156:159], v[28:31]
 v_mfma_f32_16x16x32_bf16 v[32:35], v[84:87], v[152:155], v[32:35]
 v_mfma_f32_16x16x32_bf16 v[36:39], v[84:87], v[156:159], v[36:39]
 s_waitcnt vmcnt(16)
 ds_read_b64_tr_b16 v[56:57], v96 offset:16384
 ds_read_b64_tr_b16 v[58:59], v96 offset:16896
 ds_read_b64_tr_b16 v[60:61], v97 offset:16384
 ds_read_b64_tr_b16 v[62:63], v97 offset:16896
 ds_read_b64_tr_b16 v[64:65], v98 offset:16384
 ds_read_b64_tr_b16 v[66:67], v98 offset:16896
 ds_read_b64_tr_b16 v[68:69], v99 offset:16384
 ds_read_b64_tr_b16 v[70:71], v99 offset:16896
 s_add_u32 m0, s26, 8192
 s_add_u32 s13, s20, 1146880
 buffer_load_dwordx4 v89, s[80:83], s13 offen lds
 s_add_u32 m0, s26, 9216
 s_add_u32 s13, s20, 1175552
 buffer_load_dwordx4 v90, s[80:83], s13 offen lds
 s_add_u32 m0, s26, 10240
 s_add_u32 s13, s20, 1204224
 buffer_load_dwordx4 v89, s[80:83], s13 offen lds
 s_add_u32 m0, s26, 11264
 s_add_u32 s13, s20, 1232896
 buffer_load_dwordx4 v90, s[80:83], s13 offen lds
 s_add_u32 m0, s26, 12288
 s_add_u32 s13, s20, 1261568
 buffer_load_dwordx4 v89, s[80:83], s13 offen lds
 s_add_u32 m0, s26, 13312
 s_add_u32 s13, s20, 1290240
 buffer_load_dwordx4 v90, s[80:83], s13 offen lds
 s_add_u32 m0, s26, 14336
 s_add_u32 s13, s20, 1318912
 buffer_load_dwordx4 v89, s[80:83], s13 offen lds
 s_add_u32 m0, s26, 15360
 s_add_u32 s13, s20, 1347584
 buffer_load_dwordx4 v90, s[80:83], s13 offen lds
 s_waitcnt lgkmcnt(0)
 v_mfma_f32_16x16x32_bf16 v[8:11], v[56:59], v[160:163], v[8:11]
 ds_read_b64_tr_b16 v[72:73], v96 offset:20480
 v_mfma_f32_16x16x32_bf16 v[12:15], v[56:59], v[164:167], v[12:15]
 ds_read_b64_tr_b16 v[74:75], v96 offset:20992
 v_mfma_f32_16x16x32_bf16 v[16:19], v[60:63], v[160:163], v[16:19]
 ds_read_b64_tr_b16 v[76:77], v97 offset:20480
 v_mfma_f32_16x16x32_bf16 v[20:23], v[60:63], v[164:167], v[20:23]
 ds_read_b64_tr_b16 v[78:79], v97 offset:20992
 v_mfma_f32_16x16x32_bf16 v[24:27], v[64:67], v[160:163], v[24:27]
 ds_read_b64_tr_b16 v[80:81], v98 offset:20480
 v_mfma_f32_16x16x32_bf16 v[28:31], v[64:67], v[164:167], v[28:31]
 ds_read_b64_tr_b16 v[82:83], v98 offset:20992
 v_mfma_f32_16x16x32_bf16 v[32:35], v[68:71], v[160:163], v[32:35]
 ds_read_b64_tr_b16 v[84:85], v99 offset:20480
 v_mfma_f32_16x16x32_bf16 v[36:39], v[68:71], v[164:167], v[36:39]
 ds_read_b64_tr_b16 v[86:87], v99 offset:20992
 s_waitcnt lgkmcnt(0)
 v_mfma_f32_16x16x32_bf16 v[8:11], v[72:75], v[168:171], v[8:11]
 v_mfma_f32_16x16x32_bf16 v[12:15], v[72:75], v[172:175], v[12:15]
 v_mfma_f32_16x16x32_bf16 v[16:19], v[76:79], v[168:171], v[16:19]
 v_mfma_f32_16x16x32_bf16 v[20:23], v[76:79], v[172:175], v[20:23]
 v_mfma_f32_16x16x32_bf16 v[24:27], v[80:83], v[168:171], v[24:27]
 v_mfma_f32_16x16x32_bf16 v[28:31], v[80:83], v[172:175], v[28:31]
 v_mfma_f32_16x16x32_bf16 v[32:35], v[84:87], v[168:171], v[32:35]
 v_mfma_f32_16x16x32_bf16 v[36:39], v[84:87], v[172:175], v[36:39]
 s_waitcnt vmcnt(16)
 ds_read_b64_tr_b16 v[56:57], v96 offset:24576
 ds_read_b64_tr_b16 v[58:59], v96 offset:25088
 ds_read_b64_tr_b16 v[60:61], v97 offset:24576
 ds_read_b64_tr_b16 v[62:63], v97 offset:25088
 ds_read_b64_tr_b16 v[64:65], v98 offset:24576
 ds_read_b64_tr_b16 v[66:67], v98 offset:25088
 ds_read_b64_tr_b16 v[68:69], v99 offset:24576
 ds_read_b64_tr_b16 v[70:71], v99 offset:25088
 s_add_u32 m0, s26, 16384
 s_add_u32 s13, s20, 1376256
 buffer_load_dwordx4 v89, s[80:83], s13 offen lds
 s_add_u32 m0, s26, 17408
 s_add_u32 s13, s20, 1404928
 buffer_load_dwordx4 v90, s[80:83], s13 offen lds
 s_add_u32 m0, s26, 18432
 s_add_u32 s13, s20, 1433600
 buffer_load_dwordx4 v89, s[80:83], s13 offen lds
 s_add_u32 m0, s26, 19456
 s_add_u32 s13, s20, 1462272
 buffer_load_dwordx4 v90, s[80:83], s13 offen lds
 s_add_u32 m0, s26, 20480
 s_add_u32 s13, s20, 1490944
 buffer_load_dwordx4 v89, s[80:83], s13 offen lds
 s_add_u32 m0, s26, 21504
 s_add_u32 s13, s20, 1519616
 buffer_load_dwordx4 v90, s[80:83], s13 offen lds
 s_add_u32 m0, s26, 22528
 s_add_u32 s13, s20, 1548288
 buffer_load_dwordx4 v89, s[80:83], s13 offen lds
 s_add_u32 m0, s26, 23552
 s_add_u32 s13, s20, 1576960
 buffer_load_dwordx4 v90, s[80:83], s13 offen lds
 s_waitcnt lgkmcnt(0)
 v_mfma_f32_16x16x32_bf16 v[8:11], v[56:59], v[176:179], v[8:11]
 ds_read_b64_tr_b16 v[72:73], v96 offset:28672
 v_mfma_f32_16x16x32_bf16 v[12:15], v[56:59], v[180:183], v[12:15]
 ds_read_b64_tr_b16 v[74:75], v96 offset:29184
 v_mfma_f32_16x16x32_bf16 v[16:19], v[60:63], v[176:179], v[16:19]
 ds_read_b64_tr_b16 v[76:77], v97 offset:28672
 v_mfma_f32_16x16x32_bf16 v[20:23], v[60:63], v[180:183], v[20:23]
 ds_read_b64_tr_b16 v[78:79], v97 offset:29184
 v_mfma_f32_16x16x32_bf16 v[24:27], v[64:67], v[176:179], v[24:27]
 ds_read_b64_tr_b16 v[80:81], v98 offset:28672
 v_mfma_f32_16x16x32_bf16 v[28:31], v[64:67], v[180:183], v[28:31]
 ds_read_b64_tr_b16 v[82:83], v98 offset:29184
 v_mfma_f32_16x16x32_bf16 v[32:35], v[68:71], v[176:179], v[32:35]
 ds_read_b64_tr_b16 v[84:85], v99 offset:28672
 v_mfma_f32_16x16x32_bf16 v[36:39], v[68:71], v[180:183], v[36:39]
 ds_read_b64_tr_b16 v[86:87], v99 offset:29184
 s_waitcnt lgkmcnt(0)
 v_mfma_f32_16x16x32_bf16 v[8:11], v[72:75], v[184:187], v[8:11]
 v_mfma_f32_16x16x32_bf16 v[12:15], v[72:75], v[188:191], v[12:15]
 v_mfma_f32_16x16x32_bf16 v[16:19], v[76:79], v[184:187], v[16:19]
 v_mfma_f32_16x16x32_bf16 v[20:23], v[76:79], v[188:191], v[20:23]
 v_mfma_f32_16x16x32_bf16 v[24:27], v[80:83], v[184:187], v[24:27]
 v_mfma_f32_16x16x32_bf16 v[28:31], v[80:83], v[188:191], v[28:31]
 v_mfma_f32_16x16x32_bf16 v[32:35], v[84:87], v[184:187], v[32:35]
 v_mfma_f32_16x16x32_bf16 v[36:39], v[84:87], v[188:191], v[36:39]
 s_waitcnt vmcnt(16)
 ds_read_b64_tr_b16 v[56:57], v96
 ds_read_b64_tr_b16 v[58:59], v96 offset:512
 ds_read_b64_tr_b16 v[60:61], v97
 ds_read_b64_tr_b16 v[62:63], v97 offset:512
 ds_read_b64_tr_b16 v[64:65], v98
 ds_read_b64_tr_b16 v[66:67], v98 offset:512
 ds_read_b64_tr_b16 v[68:69], v99
 ds_read_b64_tr_b16 v[70:71], v99 offset:512
 s_add_u32 m0, s26, 24576
 s_add_u32 s13, s21, 0
 buffer_load_dwordx4 v91, s[84:87], s13 offen lds
 s_add_u32 m0, s26, 25600
 s_add_u32 s13, s21, 7168
 buffer_load_dwordx4 v91, s[84:87], s13 offen lds
 s_add_u32 m0, s26, 26624
 s_add_u32 s13, s21, 14336
 buffer_load_dwordx4 v91, s[84:87], s13 offen lds
 s_add_u32 m0, s26, 27648
 s_add_u32 s13, s21, 21504
 buffer_load_dwordx4 v91, s[84:87], s13 offen lds
 s_add_u32 m0, s26, 28672
 s_add_u32 s13, s21, 28672
 buffer_load_dwordx4 v91, s[84:87], s13 offen lds
 s_add_u32 m0, s26, 29696
 s_add_u32 s13, s21, 35840
 buffer_load_dwordx4 v91, s[84:87], s13 offen lds
 s_add_u32 m0, s26, 30720
 s_add_u32 s13, s21, 43008
 buffer_load_dwordx4 v91, s[84:87], s13 offen lds
 s_add_u32 m0, s26, 31744
 s_add_u32 s13, s21, 50176
 buffer_load_dwordx4 v91, s[84:87], s13 offen lds
 s_waitcnt lgkmcnt(0)
 v_mfma_f32_16x16x32_bf16 v[8:11], v[56:59], v[192:195], v[8:11]
 ds_read_b64_tr_b16 v[72:73], v96 offset:4096
 v_mfma_f32_16x16x32_bf16 v[12:15], v[56:59], v[196:199], v[12:15]
 ds_read_b64_tr_b16 v[74:75], v96 offset:4608
 v_mfma_f32_16x16x32_bf16 v[16:19], v[60:63], v[192:195], v[16:19]
 ds_read_b64_tr_b16 v[76:77], v97 offset:4096
 v_mfma_f32_16x16x32_bf16 v[20:23], v[60:63], v[196:199], v[20:23]
 ds_read_b64_tr_b16 v[78:79], v97 offset:4608
 v_mfma_f32_16x16x32_bf16 v[24:27], v[64:67], v[192:195], v[24:27]
 ds_read_b64_tr_b16 v[80:81], v98 offset:4096
 v_mfma_f32_16x16x32_bf16 v[28:31], v[64:67], v[196:199], v[28:31]
 ds_read_b64_tr_b16 v[82:83], v98 offset:4608
 v_mfma_f32_16x16x32_bf16 v[32:35], v[68:71], v[192:195], v[32:35]
 ds_read_b64_tr_b16 v[84:85], v99 offset:4096
 v_mfma_f32_16x16x32_bf16 v[36:39], v[68:71], v[196:199], v[36:39]
 ds_read_b64_tr_b16 v[86:87], v99 offset:4608
 s_waitcnt lgkmcnt(0)
 v_mfma_f32_16x16x32_bf16 v[8:11], v[72:75], v[200:203], v[8:11]
 v_mfma_f32_16x16x32_bf16 v[12:15], v[72:75], v[204:207], v[12:15]
 v_mfma_f32_16x16x32_bf16 v[16:19], v[76:79], v[200:203], v[16:19]
 v_mfma_f32_16x16x32_bf16 v[20:23], v[76:79], v[204:207], v[20:23]
 v_mfma_f32_16x16x32_bf16 v[24:27], v[80:83], v[200:203], v[24:27]
 v_mfma_f32_16x16x32_bf16 v[28:31], v[80:83], v[204:207], v[28:31]
 v_mfma_f32_16x16x32_bf16 v[32:35], v[84:87], v[200:203], v[32:35]
 v_mfma_f32_16x16x32_bf16 v[36:39], v[84:87], v[204:207], v[36:39]
 s_waitcnt vmcnt(16)
 ds_read_b64_tr_b16 v[56:57], v96 offset:8192
 ds_read_b64_tr_b16 v[58:59], v96 offset:8704
 ds_read_b64_tr_b16 v[60:61], v97 offset:8192
 ds_read_b64_tr_b16 v[62:63], v97 offset:8704
 ds_read_b64_tr_b16 v[64:65], v98 offset:8192
 ds_read_b64_tr_b16 v[66:67], v98 offset:8704
 ds_read_b64_tr_b16 v[68:69], v99 offset:8192
 ds_read_b64_tr_b16 v[70:71], v99 offset:8704
 s_add_u32 m0, s26, 0
 s_add_u32 s13, s21, 128
 buffer_load_dwordx4 v91, s[84:87], s13 offen lds
 s_add_u32 m0, s26, 1024
 s_add_u32 s13, s21, 7296
 buffer_load_dwordx4 v91, s[84:87], s13 offen lds
 s_add_u32 m0, s26, 2048
 s_add_u32 s13, s21, 14464
 buffer_load_dwordx4 v91, s[84:87], s13 offen lds
 s_add_u32 m0, s26, 3072
 s_add_u32 s13, s21, 21632
 buffer_load_dwordx4 v91, s[84:87], s13 offen lds
 s_add_u32 m0, s26, 4096
 s_add_u32 s13, s21, 28800
 buffer_load_dwordx4 v91, s[84:87], s13 offen lds
 s_add_u32 m0, s26, 5120
 s_add_u32 s13, s21, 35968
 buffer_load_dwordx4 v91, s[84:87], s13 offen lds
 s_add_u32 m0, s26, 6144
 s_add_u32 s13, s21, 43136
 buffer_load_dwordx4 v91, s[84:87], s13 offen lds
 s_add_u32 m0, s26, 7168
 s_add_u32 s13, s21, 50304
 buffer_load_dwordx4 v91, s[84:87], s13 offen lds
 s_waitcnt lgkmcnt(0)
 v_mfma_f32_16x16x32_bf16 v[8:11], v[56:59], v[208:211], v[8:11]
 ds_read_b64_tr_b16 v[72:73], v96 offset:12288
 v_mfma_f32_16x16x32_bf16 v[12:15], v[56:59], v[212:215], v[12:15]
 ds_read_b64_tr_b16 v[74:75], v96 offset:12800
 v_mfma_f32_16x16x32_bf16 v[16:19], v[60:63], v[208:211], v[16:19]
 ds_read_b64_tr_b16 v[76:77], v97 offset:12288
 v_mfma_f32_16x16x32_bf16 v[20:23], v[60:63], v[212:215], v[20:23]
 ds_read_b64_tr_b16 v[78:79], v97 offset:12800
 v_mfma_f32_16x16x32_bf16 v[24:27], v[64:67], v[208:211], v[24:27]
 ds_read_b64_tr_b16 v[80:81], v98 offset:12288
 v_mfma_f32_16x16x32_bf16 v[28:31], v[64:67], v[212:215], v[28:31]
 ds_read_b64_tr_b16 v[82:83], v98 offset:12800
 v_mfma_f32_16x16x32_bf16 v[32:35], v[68:71], v[208:211], v[32:35]
 ds_read_b64_tr_b16 v[84:85], v99 offset:12288
 v_mfma_f32_16x16x32_bf16 v[36:39], v[68:71], v[212:215], v[36:39]
 ds_read_b64_tr_b16 v[86:87], v99 offset:12800
 s_waitcnt lgkmcnt(0)
 v_mfma_f32_16x16x32_bf16 v[8:11], v[72:75], v[216:219], v[8:11]
 v_mfma_f32_16x16x32_bf16 v[12:15], v[72:75], v[220:223], v[12:15]
 v_mfma_f32_16x16x32_bf16 v[16:19], v[76:79], v[216:219], v[16:19]
 v_mfma_f32_16x16x32_bf16 v[20:23], v[76:79], v[220:223], v[20:23]
 v_mfma_f32_16x16x32_bf16 v[24:27], v[80:83], v[216:219], v[24:27]
 v_mfma_f32_16x16x32_bf16 v[28:31], v[80:83], v[220:223], v[28:31]
 v_mfma_f32_16x16x32_bf16 v[32:35], v[84:87], v[216:219], v[32:35]
 v_mfma_f32_16x16x32_bf16 v[36:39], v[84:87], v[220:223], v[36:39]
 s_waitcnt vmcnt(16)
 ds_read_b64_tr_b16 v[56:57], v96 offset:16384
 ds_read_b64_tr_b16 v[58:59], v96 offset:16896
 ds_read_b64_tr_b16 v[60:61], v97 offset:16384
 ds_read_b64_tr_b16 v[62:63], v97 offset:16896
 ds_read_b64_tr_b16 v[64:65], v98 offset:16384
 ds_read_b64_tr_b16 v[66:67], v98 offset:16896
 ds_read_b64_tr_b16 v[68:69], v99 offset:16384
 ds_read_b64_tr_b16 v[70:71], v99 offset:16896
 s_add_u32 m0, s26, 8192
 s_add_u32 s13, s21, 256
 buffer_load_dwordx4 v91, s[84:87], s13 offen lds
 s_add_u32 m0, s26, 9216
 s_add_u32 s13, s21, 7424
 buffer_load_dwordx4 v91, s[84:87], s13 offen lds
 s_add_u32 m0, s26, 10240
 s_add_u32 s13, s21, 14592
 buffer_load_dwordx4 v91, s[84:87], s13 offen lds
 s_add_u32 m0, s26, 11264
 s_add_u32 s13, s21, 21760
 buffer_load_dwordx4 v91, s[84:87], s13 offen lds
 s_add_u32 m0, s26, 12288
 s_add_u32 s13, s21, 28928
 buffer_load_dwordx4 v91, s[84:87], s13 offen lds
 s_add_u32 m0, s26, 13312
 s_add_u32 s13, s21, 36096
 buffer_load_dwordx4 v91, s[84:87], s13 offen lds
 s_add_u32 m0, s26, 14336
 s_add_u32 s13, s21, 43264
 buffer_load_dwordx4 v91, s[84:87], s13 offen lds
 s_add_u32 m0, s26, 15360
 s_add_u32 s13, s21, 50432
 buffer_load_dwordx4 v91, s[84:87], s13 offen lds
 s_waitcnt lgkmcnt(0)
 v_mfma_f32_16x16x32_bf16 v[8:11], v[56:59], v[224:227], v[8:11]
 ds_read_b64_tr_b16 v[72:73], v96 offset:20480
 v_mfma_f32_16x16x32_bf16 v[12:15], v[56:59], v[228:231], v[12:15]
 ds_read_b64_tr_b16 v[74:75], v96 offset:20992
 v_mfma_f32_16x16x32_bf16 v[16:19], v[60:63], v[224:227], v[16:19]
 ds_read_b64_tr_b16 v[76:77], v97 offset:20480
 v_mfma_f32_16x16x32_bf16 v[20:23], v[60:63], v[228:231], v[20:23]
 ds_read_b64_tr_b16 v[78:79], v97 offset:20992
 v_mfma_f32_16x16x32_bf16 v[24:27], v[64:67], v[224:227], v[24:27]
 ds_read_b64_tr_b16 v[80:81], v98 offset:20480
 v_mfma_f32_16x16x32_bf16 v[28:31], v[64:67], v[228:231], v[28:31]
 ds_read_b64_tr_b16 v[82:83], v98 offset:20992
 v_mfma_f32_16x16x32_bf16 v[32:35], v[68:71], v[224:227], v[32:35]
 ds_read_b64_tr_b16 v[84:85], v99 offset:20480
 v_mfma_f32_16x16x32_bf16 v[36:39], v[68:71], v[228:231], v[36:39]
 ds_read_b64_tr_b16 v[86:87], v99 offset:20992
 s_waitcnt lgkmcnt(0)
 v_mfma_f32_16x16x32_bf16 v[8:11], v[72:75], v[232:235], v[8:11]
 v_mfma_f32_16x16x32_bf16 v[12:15], v[72:75], v[236:239], v[12:15]
 v_mfma_f32_16x16x32_bf16 v[16:19], v[76:79], v[232:235], v[16:19]
 v_mfma_f32_16x16x32_bf16 v[20:23], v[76:79], v[236:239], v[20:23]
 v_mfma_f32_16x16x32_bf16 v[24:27], v[80:83], v[232:235], v[24:27]
 v_mfma_f32_16x16x32_bf16 v[28:31], v[80:83], v[236:239], v[28:31]
 v_mfma_f32_16x16x32_bf16 v[32:35], v[84:87], v[232:235], v[32:35]
 v_mfma_f32_16x16x32_bf16 v[36:39], v[84:87], v[236:239], v[36:39]
 s_waitcnt vmcnt(16)
 ds_read_b64_tr_b16 v[56:57], v100 offset:24576
 ds_read_b64_tr_b16 v[58:59], v100 offset:26624
 ds_read_b64_tr_b16 v[60:61], v101 offset:24576
 ds_read_b64_tr_b16 v[62:63], v101 offset:26624
 ds_read_b64_tr_b16 v[64:65], v102 offset:24576
 ds_read_b64_tr_b16 v[66:67], v102 offset:26624
 ds_read_b64_tr_b16 v[68:69], v103 offset:24576
 ds_read_b64_tr_b16 v[70:71], v103 offset:26624
 s_add_u32 m0, s26, 16384
 s_add_u32 s13, s21, 384
 buffer_load_dwordx4 v91, s[84:87], s13 offen lds
 s_add_u32 m0, s26, 17408
 s_add_u32 s13, s21, 7552
 buffer_load_dwordx4 v91, s[84:87], s13 offen lds
 s_add_u32 m0, s26, 18432
 s_add_u32 s13, s21, 14720
 buffer_load_dwordx4 v91, s[84:87], s13 offen lds
 s_add_u32 m0, s26, 19456
 s_add_u32 s13, s21, 21888
 buffer_load_dwordx4 v91, s[84:87], s13 offen lds
 s_add_u32 m0, s26, 20480
 s_add_u32 s13, s21, 29056
 buffer_load_dwordx4 v91, s[84:87], s13 offen lds
 s_add_u32 m0, s26, 21504
 s_add_u32 s13, s21, 36224
 buffer_load_dwordx4 v91, s[84:87], s13 offen lds
 s_add_u32 m0, s26, 22528
 s_add_u32 s13, s21, 43392
 buffer_load_dwordx4 v91, s[84:87], s13 offen lds
 s_add_u32 m0, s26, 23552
 s_add_u32 s13, s21, 50560
 buffer_load_dwordx4 v91, s[84:87], s13 offen lds
 ds_read_b64 v[104:105], v92
 ds_read_b64 v[106:107], v92 offset:32
 ds_read_b64 v[108:109], v92 offset:64
 ds_read_b64 v[110:111], v92 offset:96
 s_waitcnt lgkmcnt(0)
 v_lshlrev_b32 v112, 16, v104
 v_and_b32 v113, s34, v104
 v_lshlrev_b32 v114, 16, v105
 v_and_b32 v115, s34, v105
 v_cvt_pk_bf16_f32 v116, v8, v9
 v_cvt_pk_bf16_f32 v117, v10, v11
 v_lshlrev_b32 v8, 16, v116
 v_and_b32 v9, s34, v116
 v_lshlrev_b32 v10, 16, v117
 v_and_b32 v11, s34, v117
 v_pk_add_f32 v[8:9], v[8:9], v[112:113]
 v_pk_add_f32 v[10:11], v[10:11], v[114:115]
 v_cvt_pk_bf16_f32 v116, v8, v9
 v_cvt_pk_bf16_f32 v117, v10, v11
 v_lshlrev_b32 v8, 16, v116
 v_and_b32 v9, s34, v116
 v_lshlrev_b32 v10, 16, v117
 v_and_b32 v11, s34, v117
 v_max_f32 v8, 0, v8
 v_max_f32 v9, 0, v9
 v_max_f32 v10, 0, v10
 v_max_f32 v11, 0, v11
 v_pk_mul_f32 v[8:9], v[8:9], v[8:9]
 v_pk_mul_f32 v[10:11], v[10:11], v[10:11]
 v_cvt_pk_bf16_f32 v40, v8, v9
 v_cvt_pk_bf16_f32 v41, v10, v11
 v_cvt_pk_bf16_f32 v116, v12, v13
 v_cvt_pk_bf16_f32 v117, v14, v15
 v_lshlrev_b32 v12, 16, v116
 v_and_b32 v13, s34, v116
 v_lshlrev_b32 v14, 16, v117
 v_and_b32 v15, s34, v117
 v_pk_add_f32 v[12:13], v[12:13], v[112:113]
 v_pk_add_f32 v[14:15], v[14:15], v[114:115]
 v_cvt_pk_bf16_f32 v116, v12, v13
 v_cvt_pk_bf16_f32 v117, v14, v15
 v_lshlrev_b32 v12, 16, v116
 v_and_b32 v13, s34, v116
 v_lshlrev_b32 v14, 16, v117
 v_and_b32 v15, s34, v117
 v_max_f32 v12, 0, v12
 v_max_f32 v13, 0, v13
 v_max_f32 v14, 0, v14
 v_max_f32 v15, 0, v15
 v_pk_mul_f32 v[12:13], v[12:13], v[12:13]
 v_pk_mul_f32 v[14:15], v[14:15], v[14:15]
 v_cvt_pk_bf16_f32 v44, v12, v13
 v_cvt_pk_bf16_f32 v45, v14, v15
 v_lshlrev_b32 v112, 16, v106
 v_and_b32 v113, s34, v106
 v_lshlrev_b32 v114, 16, v107
 v_and_b32 v115, s34, v107
 v_cvt_pk_bf16_f32 v116, v16, v17
 v_cvt_pk_bf16_f32 v117, v18, v19
 v_lshlrev_b32 v16, 16, v116
 v_and_b32 v17, s34, v116
 v_lshlrev_b32 v18, 16, v117
 v_and_b32 v19, s34, v117
 v_pk_add_f32 v[16:17], v[16:17], v[112:113]
 v_pk_add_f32 v[18:19], v[18:19], v[114:115]
 v_cvt_pk_bf16_f32 v116, v16, v17
 v_cvt_pk_bf16_f32 v117, v18, v19
 v_lshlrev_b32 v16, 16, v116
 v_and_b32 v17, s34, v116
 v_lshlrev_b32 v18, 16, v117
 v_and_b32 v19, s34, v117
 v_max_f32 v16, 0, v16
 v_max_f32 v17, 0, v17
 v_max_f32 v18, 0, v18
 v_max_f32 v19, 0, v19
 v_pk_mul_f32 v[16:17], v[16:17], v[16:17]
 v_pk_mul_f32 v[18:19], v[18:19], v[18:19]
 v_cvt_pk_bf16_f32 v42, v16, v17
 v_cvt_pk_bf16_f32 v43, v18, v19
 v_cvt_pk_bf16_f32 v116, v20, v21
 v_cvt_pk_bf16_f32 v117, v22, v23
 v_lshlrev_b32 v20, 16, v116
 v_and_b32 v21, s34, v116
 v_lshlrev_b32 v22, 16, v117
 v_and_b32 v23, s34, v117
 v_pk_add_f32 v[20:21], v[20:21], v[112:113]
 v_pk_add_f32 v[22:23], v[22:23], v[114:115]
 v_cvt_pk_bf16_f32 v116, v20, v21
 v_cvt_pk_bf16_f32 v117, v22, v23
 v_lshlrev_b32 v20, 16, v116
 v_and_b32 v21, s34, v116
 v_lshlrev_b32 v22, 16, v117
 v_and_b32 v23, s34, v117
 v_max_f32 v20, 0, v20
 v_max_f32 v21, 0, v21
 v_max_f32 v22, 0, v22
 v_max_f32 v23, 0, v23
 v_pk_mul_f32 v[20:21], v[20:21], v[20:21]
 v_pk_mul_f32 v[22:23], v[22:23], v[22:23]
 v_cvt_pk_bf16_f32 v46, v20, v21
 v_cvt_pk_bf16_f32 v47, v22, v23
 v_lshlrev_b32 v112, 16, v108
 v_and_b32 v113, s34, v108
 v_lshlrev_b32 v114, 16, v109
 v_and_b32 v115, s34, v109
 v_cvt_pk_bf16_f32 v116, v24, v25
 v_cvt_pk_bf16_f32 v117, v26, v27
 v_lshlrev_b32 v24, 16, v116
 v_and_b32 v25, s34, v116
 v_lshlrev_b32 v26, 16, v117
 v_and_b32 v27, s34, v117
 v_pk_add_f32 v[24:25], v[24:25], v[112:113]
 v_pk_add_f32 v[26:27], v[26:27], v[114:115]
 v_cvt_pk_bf16_f32 v116, v24, v25
 v_cvt_pk_bf16_f32 v117, v26, v27
 v_lshlrev_b32 v24, 16, v116
 v_and_b32 v25, s34, v116
 v_lshlrev_b32 v26, 16, v117
 v_and_b32 v27, s34, v117
 v_max_f32 v24, 0, v24
 v_max_f32 v25, 0, v25
 v_max_f32 v26, 0, v26
 v_max_f32 v27, 0, v27
 v_pk_mul_f32 v[24:25], v[24:25], v[24:25]
 v_pk_mul_f32 v[26:27], v[26:27], v[26:27]
 v_cvt_pk_bf16_f32 v48, v24, v25
 v_cvt_pk_bf16_f32 v49, v26, v27
 v_cvt_pk_bf16_f32 v116, v28, v29
 v_cvt_pk_bf16_f32 v117, v30, v31
 v_lshlrev_b32 v28, 16, v116
 v_and_b32 v29, s34, v116
 v_lshlrev_b32 v30, 16, v117
 v_and_b32 v31, s34, v117
 v_pk_add_f32 v[28:29], v[28:29], v[112:113]
 v_pk_add_f32 v[30:31], v[30:31], v[114:115]
 v_cvt_pk_bf16_f32 v116, v28, v29
 v_cvt_pk_bf16_f32 v117, v30, v31
 v_lshlrev_b32 v28, 16, v116
 v_and_b32 v29, s34, v116
 v_lshlrev_b32 v30, 16, v117
 v_and_b32 v31, s34, v117
 v_max_f32 v28, 0, v28
 v_max_f32 v29, 0, v29
 v_max_f32 v30, 0, v30
 v_max_f32 v31, 0, v31
 v_pk_mul_f32 v[28:29], v[28:29], v[28:29]
 v_pk_mul_f32 v[30:31], v[30:31], v[30:31]
 v_cvt_pk_bf16_f32 v52, v28, v29
 v_cvt_pk_bf16_f32 v53, v30, v31
 v_lshlrev_b32 v112, 16, v110
 v_and_b32 v113, s34, v110
 v_lshlrev_b32 v114, 16, v111
 v_and_b32 v115, s34, v111
 v_cvt_pk_bf16_f32 v116, v32, v33
 v_cvt_pk_bf16_f32 v117, v34, v35
 v_lshlrev_b32 v32, 16, v116
 v_and_b32 v33, s34, v116
 v_lshlrev_b32 v34, 16, v117
 v_and_b32 v35, s34, v117
 v_pk_add_f32 v[32:33], v[32:33], v[112:113]
 v_pk_add_f32 v[34:35], v[34:35], v[114:115]
 v_cvt_pk_bf16_f32 v116, v32, v33
 v_cvt_pk_bf16_f32 v117, v34, v35
 v_lshlrev_b32 v32, 16, v116
 v_and_b32 v33, s34, v116
 v_lshlrev_b32 v34, 16, v117
 v_and_b32 v35, s34, v117
 v_max_f32 v32, 0, v32
 v_max_f32 v33, 0, v33
 v_max_f32 v34, 0, v34
 v_max_f32 v35, 0, v35
 v_pk_mul_f32 v[32:33], v[32:33], v[32:33]
 v_pk_mul_f32 v[34:35], v[34:35], v[34:35]
 v_cvt_pk_bf16_f32 v50, v32, v33
 v_cvt_pk_bf16_f32 v51, v34, v35
 v_cvt_pk_bf16_f32 v116, v36, v37
 v_cvt_pk_bf16_f32 v117, v38, v39
 v_lshlrev_b32 v36, 16, v116
 v_and_b32 v37, s34, v116
 v_lshlrev_b32 v38, 16, v117
 v_and_b32 v39, s34, v117
 v_pk_add_f32 v[36:37], v[36:37], v[112:113]
 v_pk_add_f32 v[38:39], v[38:39], v[114:115]
 v_cvt_pk_bf16_f32 v116, v36, v37
 v_cvt_pk_bf16_f32 v117, v38, v39
 v_lshlrev_b32 v36, 16, v116
 v_and_b32 v37, s34, v116
 v_lshlrev_b32 v38, 16, v117
 v_and_b32 v39, s34, v117
 v_max_f32 v36, 0, v36
 v_max_f32 v37, 0, v37
 v_max_f32 v38, 0, v38
 v_max_f32 v39, 0, v39
 v_pk_mul_f32 v[36:37], v[36:37], v[36:37]
 v_pk_mul_f32 v[38:39], v[38:39], v[38:39]
 v_cvt_pk_bf16_f32 v54, v36, v37
 v_cvt_pk_bf16_f32 v55, v38, v39
 v_add_u32 v92, s29, v92
 s_waitcnt lgkmcnt(0)
 v_mfma_f32_16x16x32_bf16 a[0:3], v[56:59], v[40:43], a[0:3]
 ds_read_b64_tr_b16 v[72:73], v100 offset:28672
 v_mfma_f32_16x16x32_bf16 a[4:7], v[56:59], v[44:47], a[4:7]
 ds_read_b64_tr_b16 v[74:75], v100 offset:30720
 v_mfma_f32_16x16x32_bf16 a[8:11], v[60:63], v[40:43], a[8:11]
 ds_read_b64_tr_b16 v[76:77], v101 offset:28672
 v_mfma_f32_16x16x32_bf16 a[12:15], v[60:63], v[44:47], a[12:15]
 ds_read_b64_tr_b16 v[78:79], v101 offset:30720
 v_mfma_f32_16x16x32_bf16 a[16:19], v[64:67], v[40:43], a[16:19]
 ds_read_b64_tr_b16 v[80:81], v102 offset:28672
 v_mfma_f32_16x16x32_bf16 a[20:23], v[64:67], v[44:47], a[20:23]
 ds_read_b64_tr_b16 v[82:83], v102 offset:30720
 v_mfma_f32_16x16x32_bf16 a[24:27], v[68:71], v[40:43], a[24:27]
 ds_read_b64_tr_b16 v[84:85], v103 offset:28672
 v_mfma_f32_16x16x32_bf16 a[28:31], v[68:71], v[44:47], a[28:31]
 ds_read_b64_tr_b16 v[86:87], v103 offset:30720
 s_waitcnt lgkmcnt(0)
 v_mfma_f32_16x16x32_bf16 a[0:3], v[72:75], v[48:51], a[0:3]
 v_mfma_f32_16x16x32_bf16 a[4:7], v[72:75], v[52:55], a[4:7]
 v_mfma_f32_16x16x32_bf16 a[8:11], v[76:79], v[48:51], a[8:11]
 v_mfma_f32_16x16x32_bf16 a[12:15], v[76:79], v[52:55], a[12:15]
 v_mfma_f32_16x16x32_bf16 a[16:19], v[80:83], v[48:51], a[16:19]
 v_mfma_f32_16x16x32_bf16 a[20:23], v[80:83], v[52:55], a[20:23]
 v_mfma_f32_16x16x32_bf16 a[24:27], v[84:87], v[48:51], a[24:27]
 v_mfma_f32_16x16x32_bf16 a[28:31], v[84:87], v[52:55], a[28:31]
 s_waitcnt vmcnt(16)
 ds_read_b64_tr_b16 v[56:57], v100
 ds_read_b64_tr_b16 v[58:59], v100 offset:2048
 ds_read_b64_tr_b16 v[60:61], v101
 ds_read_b64_tr_b16 v[62:63], v101 offset:2048
 ds_read_b64_tr_b16 v[64:65], v102
 ds_read_b64_tr_b16 v[66:67], v102 offset:2048
 ds_read_b64_tr_b16 v[68:69], v103
 ds_read_b64_tr_b16 v[70:71], v103 offset:2048
 s_add_u32 m0, s26, 24576
 s_add_u32 s13, s21, 512
 buffer_load_dwordx4 v91, s[84:87], s13 offen lds
 s_add_u32 m0, s26, 25600
 s_add_u32 s13, s21, 7680
 buffer_load_dwordx4 v91, s[84:87], s13 offen lds
 s_add_u32 m0, s26, 26624
 s_add_u32 s13, s21, 14848
 buffer_load_dwordx4 v91, s[84:87], s13 offen lds
 s_add_u32 m0, s26, 27648
 s_add_u32 s13, s21, 22016
 buffer_load_dwordx4 v91, s[84:87], s13 offen lds
 s_add_u32 m0, s26, 28672
 s_add_u32 s13, s21, 29184
 buffer_load_dwordx4 v91, s[84:87], s13 offen lds
 s_add_u32 m0, s26, 29696
 s_add_u32 s13, s21, 36352
 buffer_load_dwordx4 v91, s[84:87], s13 offen lds
 s_add_u32 m0, s26, 30720
 s_add_u32 s13, s21, 43520
 buffer_load_dwordx4 v91, s[84:87], s13 offen lds
 s_add_u32 m0, s26, 31744
 s_add_u32 s13, s21, 50688
 buffer_load_dwordx4 v91, s[84:87], s13 offen lds
 s_waitcnt lgkmcnt(0)
 v_mfma_f32_16x16x32_bf16 a[32:35], v[56:59], v[40:43], a[32:35]
 ds_read_b64_tr_b16 v[72:73], v100 offset:4096
 v_mfma_f32_16x16x32_bf16 a[36:39], v[56:59], v[44:47], a[36:39]
 ds_read_b64_tr_b16 v[74:75], v100 offset:6144
 v_mfma_f32_16x16x32_bf16 a[40:43], v[60:63], v[40:43], a[40:43]
 ds_read_b64_tr_b16 v[76:77], v101 offset:4096
 v_mfma_f32_16x16x32_bf16 a[44:47], v[60:63], v[44:47], a[44:47]
 ds_read_b64_tr_b16 v[78:79], v101 offset:6144
 v_mfma_f32_16x16x32_bf16 a[48:51], v[64:67], v[40:43], a[48:51]
 ds_read_b64_tr_b16 v[80:81], v102 offset:4096
 v_mfma_f32_16x16x32_bf16 a[52:55], v[64:67], v[44:47], a[52:55]
 ds_read_b64_tr_b16 v[82:83], v102 offset:6144
 v_mfma_f32_16x16x32_bf16 a[56:59], v[68:71], v[40:43], a[56:59]
 ds_read_b64_tr_b16 v[84:85], v103 offset:4096
 v_mfma_f32_16x16x32_bf16 a[60:63], v[68:71], v[44:47], a[60:63]
 ds_read_b64_tr_b16 v[86:87], v103 offset:6144
 s_waitcnt lgkmcnt(0)
 v_mfma_f32_16x16x32_bf16 a[32:35], v[72:75], v[48:51], a[32:35]
 v_mfma_f32_16x16x32_bf16 a[36:39], v[72:75], v[52:55], a[36:39]
 v_mfma_f32_16x16x32_bf16 a[40:43], v[76:79], v[48:51], a[40:43]
 v_mfma_f32_16x16x32_bf16 a[44:47], v[76:79], v[52:55], a[44:47]
 v_mfma_f32_16x16x32_bf16 a[48:51], v[80:83], v[48:51], a[48:51]
 v_mfma_f32_16x16x32_bf16 a[52:55], v[80:83], v[52:55], a[52:55]
 v_mfma_f32_16x16x32_bf16 a[56:59], v[84:87], v[48:51], a[56:59]
 v_mfma_f32_16x16x32_bf16 a[60:63], v[84:87], v[52:55], a[60:63]
 s_waitcnt vmcnt(16)
 ds_read_b64_tr_b16 v[56:57], v100 offset:8192
 ds_read_b64_tr_b16 v[58:59], v100 offset:10240
 ds_read_b64_tr_b16 v[60:61], v101 offset:8192
 ds_read_b64_tr_b16 v[62:63], v101 offset:10240
 ds_read_b64_tr_b16 v[64:65], v102 offset:8192
 ds_read_b64_tr_b16 v[66:67], v102 offset:10240
 ds_read_b64_tr_b16 v[68:69], v103 offset:8192
 ds_read_b64_tr_b16 v[70:71], v103 offset:10240
 s_add_u32 m0, s26, 0
 s_add_u32 s13, s21, 640
 buffer_load_dwordx4 v91, s[84:87], s13 offen lds
 s_add_u32 m0, s26, 1024
 s_add_u32 s13, s21, 7808
 buffer_load_dwordx4 v91, s[84:87], s13 offen lds
 s_add_u32 m0, s26, 2048
 s_add_u32 s13, s21, 14976
 buffer_load_dwordx4 v91, s[84:87], s13 offen lds
 s_add_u32 m0, s26, 3072
 s_add_u32 s13, s21, 22144
 buffer_load_dwordx4 v91, s[84:87], s13 offen lds
 s_add_u32 m0, s26, 4096
 s_add_u32 s13, s21, 29312
 buffer_load_dwordx4 v91, s[84:87], s13 offen lds
 s_add_u32 m0, s26, 5120
 s_add_u32 s13, s21, 36480
 buffer_load_dwordx4 v91, s[84:87], s13 offen lds
 s_add_u32 m0, s26, 6144
 s_add_u32 s13, s21, 43648
 buffer_load_dwordx4 v91, s[84:87], s13 offen lds
 s_add_u32 m0, s26, 7168
 s_add_u32 s13, s21, 50816
 buffer_load_dwordx4 v91, s[84:87], s13 offen lds
 s_waitcnt lgkmcnt(0)
 v_mfma_f32_16x16x32_bf16 a[64:67], v[56:59], v[40:43], a[64:67]
 ds_read_b64_tr_b16 v[72:73], v100 offset:12288
 v_mfma_f32_16x16x32_bf16 a[68:71], v[56:59], v[44:47], a[68:71]
 ds_read_b64_tr_b16 v[74:75], v100 offset:14336
 v_mfma_f32_16x16x32_bf16 a[72:75], v[60:63], v[40:43], a[72:75]
 ds_read_b64_tr_b16 v[76:77], v101 offset:12288
 v_mfma_f32_16x16x32_bf16 a[76:79], v[60:63], v[44:47], a[76:79]
 ds_read_b64_tr_b16 v[78:79], v101 offset:14336
 v_mfma_f32_16x16x32_bf16 a[80:83], v[64:67], v[40:43], a[80:83]
 ds_read_b64_tr_b16 v[80:81], v102 offset:12288
 v_mfma_f32_16x16x32_bf16 a[84:87], v[64:67], v[44:47], a[84:87]
 ds_read_b64_tr_b16 v[82:83], v102 offset:14336
 v_mfma_f32_16x16x32_bf16 a[88:91], v[68:71], v[40:43], a[88:91]
 ds_read_b64_tr_b16 v[84:85], v103 offset:12288
 v_mfma_f32_16x16x32_bf16 a[92:95], v[68:71], v[44:47], a[92:95]
 ds_read_b64_tr_b16 v[86:87], v103 offset:14336
 s_waitcnt lgkmcnt(0)
 v_mfma_f32_16x16x32_bf16 a[64:67], v[72:75], v[48:51], a[64:67]
 v_mfma_f32_16x16x32_bf16 a[68:71], v[72:75], v[52:55], a[68:71]
 v_mfma_f32_16x16x32_bf16 a[72:75], v[76:79], v[48:51], a[72:75]
 v_mfma_f32_16x16x32_bf16 a[76:79], v[76:79], v[52:55], a[76:79]
 v_mfma_f32_16x16x32_bf16 a[80:83], v[80:83], v[48:51], a[80:83]
 v_mfma_f32_16x16x32_bf16 a[84:87], v[80:83], v[52:55], a[84:87]
 v_mfma_f32_16x16x32_bf16 a[88:91], v[84:87], v[48:51], a[88:91]
 v_mfma_f32_16x16x32_bf16 a[92:95], v[84:87], v[52:55], a[92:95]
 s_waitcnt vmcnt(16)
 ds_read_b64_tr_b16 v[56:57], v100 offset:16384
 ds_read_b64_tr_b16 v[58:59], v100 offset:18432
 ds_read_b64_tr_b16 v[60:61], v101 offset:16384
 ds_read_b64_tr_b16 v[62:63], v101 offset:18432
 ds_read_b64_tr_b16 v[64:65], v102 offset:16384
 ds_read_b64_tr_b16 v[66:67], v102 offset:18432
 ds_read_b64_tr_b16 v[68:69], v103 offset:16384
 ds_read_b64_tr_b16 v[70:71], v103 offset:18432
 s_add_u32 m0, s26, 8192
 s_add_u32 s13, s21, 768
 buffer_load_dwordx4 v91, s[84:87], s13 offen lds
 s_add_u32 m0, s26, 9216
 s_add_u32 s13, s21, 7936
 buffer_load_dwordx4 v91, s[84:87], s13 offen lds
 s_add_u32 m0, s26, 10240
 s_add_u32 s13, s21, 15104
 buffer_load_dwordx4 v91, s[84:87], s13 offen lds
 s_add_u32 m0, s26, 11264
 s_add_u32 s13, s21, 22272
 buffer_load_dwordx4 v91, s[84:87], s13 offen lds
 s_add_u32 m0, s26, 12288
 s_add_u32 s13, s21, 29440
 buffer_load_dwordx4 v91, s[84:87], s13 offen lds
 s_add_u32 m0, s26, 13312
 s_add_u32 s13, s21, 36608
 buffer_load_dwordx4 v91, s[84:87], s13 offen lds
 s_add_u32 m0, s26, 14336
 s_add_u32 s13, s21, 43776
 buffer_load_dwordx4 v91, s[84:87], s13 offen lds
 s_add_u32 m0, s26, 15360
 s_add_u32 s13, s21, 50944
 buffer_load_dwordx4 v91, s[84:87], s13 offen lds
 s_waitcnt lgkmcnt(0)
 v_mfma_f32_16x16x32_bf16 a[96:99], v[56:59], v[40:43], a[96:99]
 ds_read_b64_tr_b16 v[72:73], v100 offset:20480
 v_mfma_f32_16x16x32_bf16 a[100:103], v[56:59], v[44:47], a[100:103]
 ds_read_b64_tr_b16 v[74:75], v100 offset:22528
 v_mfma_f32_16x16x32_bf16 a[104:107], v[60:63], v[40:43], a[104:107]
 ds_read_b64_tr_b16 v[76:77], v101 offset:20480
 v_mfma_f32_16x16x32_bf16 a[108:111], v[60:63], v[44:47], a[108:111]
 ds_read_b64_tr_b16 v[78:79], v101 offset:22528
 v_mfma_f32_16x16x32_bf16 a[112:115], v[64:67], v[40:43], a[112:115]
 ds_read_b64_tr_b16 v[80:81], v102 offset:20480
 v_mfma_f32_16x16x32_bf16 a[116:119], v[64:67], v[44:47], a[116:119]
 ds_read_b64_tr_b16 v[82:83], v102 offset:22528
 v_mfma_f32_16x16x32_bf16 a[120:123], v[68:71], v[40:43], a[120:123]
 ds_read_b64_tr_b16 v[84:85], v103 offset:20480
 v_mfma_f32_16x16x32_bf16 a[124:127], v[68:71], v[44:47], a[124:127]
 ds_read_b64_tr_b16 v[86:87], v103 offset:22528
 s_waitcnt lgkmcnt(0)
 v_mfma_f32_16x16x32_bf16 a[96:99], v[72:75], v[48:51], a[96:99]
 v_mfma_f32_16x16x32_bf16 a[100:103], v[72:75], v[52:55], a[100:103]
 v_mfma_f32_16x16x32_bf16 a[104:107], v[76:79], v[48:51], a[104:107]
 v_mfma_f32_16x16x32_bf16 a[108:111], v[76:79], v[52:55], a[108:111]
 v_mfma_f32_16x16x32_bf16 a[112:115], v[80:83], v[48:51], a[112:115]
 v_mfma_f32_16x16x32_bf16 a[116:119], v[80:83], v[52:55], a[116:119]
 v_mfma_f32_16x16x32_bf16 a[120:123], v[84:87], v[48:51], a[120:123]
 v_mfma_f32_16x16x32_bf16 a[124:127], v[84:87], v[52:55], a[124:127]
 s_waitcnt vmcnt(16)
 ds_read_b64_tr_b16 v[56:57], v100 offset:24576
 ds_read_b64_tr_b16 v[58:59], v100 offset:26624
 ds_read_b64_tr_b16 v[60:61], v101 offset:24576
 ds_read_b64_tr_b16 v[62:63], v101 offset:26624
 ds_read_b64_tr_b16 v[64:65], v102 offset:24576
 ds_read_b64_tr_b16 v[66:67], v102 offset:26624
 ds_read_b64_tr_b16 v[68:69], v103 offset:24576
 ds_read_b64_tr_b16 v[70:71], v103 offset:26624
 s_add_u32 m0, s26, 16384
 s_add_u32 s13, s28, 0
 buffer_load_dwordx4 v89, s[80:83], s13 offen lds
 s_add_u32 m0, s26, 17408
 s_add_u32 s13, s28, 28672
 buffer_load_dwordx4 v90, s[80:83], s13 offen lds
 s_add_u32 m0, s26, 18432
 s_add_u32 s13, s28, 57344
 buffer_load_dwordx4 v89, s[80:83], s13 offen lds
 s_add_u32 m0, s26, 19456
 s_add_u32 s13, s28, 86016
 buffer_load_dwordx4 v90, s[80:83], s13 offen lds
 s_add_u32 m0, s26, 20480
 s_add_u32 s13, s28, 114688
 buffer_load_dwordx4 v89, s[80:83], s13 offen lds
 s_add_u32 m0, s26, 21504
 s_add_u32 s13, s28, 143360
 buffer_load_dwordx4 v90, s[80:83], s13 offen lds
 s_add_u32 m0, s26, 22528
 s_add_u32 s13, s28, 172032
 buffer_load_dwordx4 v89, s[80:83], s13 offen lds
 s_add_u32 m0, s26, 23552
 s_add_u32 s13, s28, 200704
 buffer_load_dwordx4 v90, s[80:83], s13 offen lds
 s_waitcnt lgkmcnt(0)
 v_mfma_f32_16x16x32_bf16 a[128:131], v[56:59], v[40:43], a[128:131]
 ds_read_b64_tr_b16 v[72:73], v100 offset:28672
 v_mfma_f32_16x16x32_bf16 a[132:135], v[56:59], v[44:47], a[132:135]
 ds_read_b64_tr_b16 v[74:75], v100 offset:30720
 v_mfma_f32_16x16x32_bf16 a[136:139], v[60:63], v[40:43], a[136:139]
 ds_read_b64_tr_b16 v[76:77], v101 offset:28672
 v_mfma_f32_16x16x32_bf16 a[140:143], v[60:63], v[44:47], a[140:143]
 ds_read_b64_tr_b16 v[78:79], v101 offset:30720
 v_mfma_f32_16x16x32_bf16 a[144:147], v[64:67], v[40:43], a[144:147]
 ds_read_b64_tr_b16 v[80:81], v102 offset:28672
 v_mfma_f32_16x16x32_bf16 a[148:151], v[64:67], v[44:47], a[148:151]
 ds_read_b64_tr_b16 v[82:83], v102 offset:30720
 v_mfma_f32_16x16x32_bf16 a[152:155], v[68:71], v[40:43], a[152:155]
 ds_read_b64_tr_b16 v[84:85], v103 offset:28672
 v_mfma_f32_16x16x32_bf16 a[156:159], v[68:71], v[44:47], a[156:159]
 ds_read_b64_tr_b16 v[86:87], v103 offset:30720
 s_waitcnt lgkmcnt(0)
 v_mfma_f32_16x16x32_bf16 a[128:131], v[72:75], v[48:51], a[128:131]
 v_mfma_f32_16x16x32_bf16 a[132:135], v[72:75], v[52:55], a[132:135]
 v_mfma_f32_16x16x32_bf16 a[136:139], v[76:79], v[48:51], a[136:139]
 v_mfma_f32_16x16x32_bf16 a[140:143], v[76:79], v[52:55], a[140:143]
 v_mfma_f32_16x16x32_bf16 a[144:147], v[80:83], v[48:51], a[144:147]
 v_mfma_f32_16x16x32_bf16 a[148:151], v[80:83], v[52:55], a[148:151]
 v_mfma_f32_16x16x32_bf16 a[152:155], v[84:87], v[48:51], a[152:155]
 v_mfma_f32_16x16x32_bf16 a[156:159], v[84:87], v[52:55], a[156:159]
 s_waitcnt vmcnt(16)
 ds_read_b64_tr_b16 v[56:57], v100
 ds_read_b64_tr_b16 v[58:59], v100 offset:2048
 ds_read_b64_tr_b16 v[60:61], v101
 ds_read_b64_tr_b16 v[62:63], v101 offset:2048
 ds_read_b64_tr_b16 v[64:65], v102
 ds_read_b64_tr_b16 v[66:67], v102 offset:2048
 ds_read_b64_tr_b16 v[68:69], v103
 ds_read_b64_tr_b16 v[70:71], v103 offset:2048
 s_add_u32 m0, s26, 24576
 s_add_u32 s13, s28, 229376
 buffer_load_dwordx4 v89, s[80:83], s13 offen lds
 s_add_u32 m0, s26, 25600
 s_add_u32 s13, s28, 258048
 buffer_load_dwordx4 v90, s[80:83], s13 offen lds
 s_add_u32 m0, s26, 26624
 s_add_u32 s13, s28, 286720
 buffer_load_dwordx4 v89, s[80:83], s13 offen lds
 s_add_u32 m0, s26, 27648
 s_add_u32 s13, s28, 315392
 buffer_load_dwordx4 v90, s[80:83], s13 offen lds
 s_add_u32 m0, s26, 28672
 s_add_u32 s13, s28, 344064
 buffer_load_dwordx4 v89, s[80:83], s13 offen lds
 s_add_u32 m0, s26, 29696
 s_add_u32 s13, s28, 372736
 buffer_load_dwordx4 v90, s[80:83], s13 offen lds
 s_add_u32 m0, s26, 30720
 s_add_u32 s13, s28, 401408
 buffer_load_dwordx4 v89, s[80:83], s13 offen lds
 s_add_u32 m0, s26, 31744
 s_add_u32 s13, s28, 430080
 buffer_load_dwordx4 v90, s[80:83], s13 offen lds
 s_waitcnt lgkmcnt(0)
 v_mfma_f32_16x16x32_bf16 a[160:163], v[56:59], v[40:43], a[160:163]
 ds_read_b64_tr_b16 v[72:73], v100 offset:4096
 v_mfma_f32_16x16x32_bf16 a[164:167], v[56:59], v[44:47], a[164:167]
 ds_read_b64_tr_b16 v[74:75], v100 offset:6144
 v_mfma_f32_16x16x32_bf16 a[168:171], v[60:63], v[40:43], a[168:171]
 ds_read_b64_tr_b16 v[76:77], v101 offset:4096
 v_mfma_f32_16x16x32_bf16 a[172:175], v[60:63], v[44:47], a[172:175]
 ds_read_b64_tr_b16 v[78:79], v101 offset:6144
 v_mfma_f32_16x16x32_bf16 a[176:179], v[64:67], v[40:43], a[176:179]
 ds_read_b64_tr_b16 v[80:81], v102 offset:4096
 v_mfma_f32_16x16x32_bf16 a[180:183], v[64:67], v[44:47], a[180:183]
 ds_read_b64_tr_b16 v[82:83], v102 offset:6144
 v_mfma_f32_16x16x32_bf16 a[184:187], v[68:71], v[40:43], a[184:187]
 ds_read_b64_tr_b16 v[84:85], v103 offset:4096
 v_mfma_f32_16x16x32_bf16 a[188:191], v[68:71], v[44:47], a[188:191]
 ds_read_b64_tr_b16 v[86:87], v103 offset:6144
 s_waitcnt lgkmcnt(0)
 v_mfma_f32_16x16x32_bf16 a[160:163], v[72:75], v[48:51], a[160:163]
 v_mfma_f32_16x16x32_bf16 a[164:167], v[72:75], v[52:55], a[164:167]
 v_mfma_f32_16x16x32_bf16 a[168:171], v[76:79], v[48:51], a[168:171]
 v_mfma_f32_16x16x32_bf16 a[172:175], v[76:79], v[52:55], a[172:175]
 v_mfma_f32_16x16x32_bf16 a[176:179], v[80:83], v[48:51], a[176:179]
 v_mfma_f32_16x16x32_bf16 a[180:183], v[80:83], v[52:55], a[180:183]
 v_mfma_f32_16x16x32_bf16 a[184:187], v[84:87], v[48:51], a[184:187]
 v_mfma_f32_16x16x32_bf16 a[188:191], v[84:87], v[52:55], a[188:191]
 s_waitcnt vmcnt(16)
 ds_read_b64_tr_b16 v[56:57], v100 offset:8192
 ds_read_b64_tr_b16 v[58:59], v100 offset:10240
 ds_read_b64_tr_b16 v[60:61], v101 offset:8192
 ds_read_b64_tr_b16 v[62:63], v101 offset:10240
 ds_read_b64_tr_b16 v[64:65], v102 offset:8192
 ds_read_b64_tr_b16 v[66:67], v102 offset:10240
 ds_read_b64_tr_b16 v[68:69], v103 offset:8192
 ds_read_b64_tr_b16 v[70:71], v103 offset:10240
 s_add_u32 m0, s26, 0
 s_add_u32 s13, s28, 458752
 buffer_load_dwordx4 v89, s[80:83], s13 offen lds
 s_add_u32 m0, s26, 1024
 s_add_u32 s13, s28, 487424
 buffer_load_dwordx4 v90, s[80:83], s13 offen lds
 s_add_u32 m0, s26, 2048
 s_add_u32 s13, s28, 516096
 buffer_load_dwordx4 v89, s[80:83], s13 offen lds
 s_add_u32 m0, s26, 3072
 s_add_u32 s13, s28, 544768
 buffer_load_dwordx4 v90, s[80:83], s13 offen lds
 s_add_u32 m0, s26, 4096
 s_add_u32 s13, s28, 573440
 buffer_load_dwordx4 v89, s[80:83], s13 offen lds
 s_add_u32 m0, s26, 5120
 s_add_u32 s13, s28, 602112
 buffer_load_dwordx4 v90, s[80:83], s13 offen lds
 s_add_u32 m0, s26, 6144
 s_add_u32 s13, s28, 630784
 buffer_load_dwordx4 v89, s[80:83], s13 offen lds
 s_add_u32 m0, s26, 7168
 s_add_u32 s13, s28, 659456
 buffer_load_dwordx4 v90, s[80:83], s13 offen lds
 s_waitcnt lgkmcnt(0)
 v_mfma_f32_16x16x32_bf16 a[192:195], v[56:59], v[40:43], a[192:195]
 ds_read_b64_tr_b16 v[72:73], v100 offset:12288
 v_mfma_f32_16x16x32_bf16 a[196:199], v[56:59], v[44:47], a[196:199]
 ds_read_b64_tr_b16 v[74:75], v100 offset:14336
 v_mfma_f32_16x16x32_bf16 a[200:203], v[60:63], v[40:43], a[200:203]
 ds_read_b64_tr_b16 v[76:77], v101 offset:12288
 v_mfma_f32_16x16x32_bf16 a[204:207], v[60:63], v[44:47], a[204:207]
 ds_read_b64_tr_b16 v[78:79], v101 offset:14336
 v_mfma_f32_16x16x32_bf16 a[208:211], v[64:67], v[40:43], a[208:211]
 ds_read_b64_tr_b16 v[80:81], v102 offset:12288
 v_mfma_f32_16x16x32_bf16 a[212:215], v[64:67], v[44:47], a[212:215]
 ds_read_b64_tr_b16 v[82:83], v102 offset:14336
 v_mfma_f32_16x16x32_bf16 a[216:219], v[68:71], v[40:43], a[216:219]
 ds_read_b64_tr_b16 v[84:85], v103 offset:12288
 v_mfma_f32_16x16x32_bf16 a[220:223], v[68:71], v[44:47], a[220:223]
 ds_read_b64_tr_b16 v[86:87], v103 offset:14336
 s_waitcnt lgkmcnt(0)
 v_mfma_f32_16x16x32_bf16 a[192:195], v[72:75], v[48:51], a[192:195]
 v_mfma_f32_16x16x32_bf16 a[196:199], v[72:75], v[52:55], a[196:199]
 v_mfma_f32_16x16x32_bf16 a[200:203], v[76:79], v[48:51], a[200:203]
 v_mfma_f32_16x16x32_bf16 a[204:207], v[76:79], v[52:55], a[204:207]
 v_mfma_f32_16x16x32_bf16 a[208:211], v[80:83], v[48:51], a[208:211]
 v_mfma_f32_16x16x32_bf16 a[212:215], v[80:83], v[52:55], a[212:215]
 v_mfma_f32_16x16x32_bf16 a[216:219], v[84:87], v[48:51], a[216:219]
 v_mfma_f32_16x16x32_bf16 a[220:223], v[84:87], v[52:55], a[220:223]
 s_lshl_b32 s13, s27, 7
 s_add_u32 s20, s22, s13
 s_mul_i32 s13, s27, 57344
 s_add_u32 s21, s23, s13
 s_add_u32 s27, s27, 1
 s_mov_b32 s29, 128
 s_cmp_eq_u32 s27, 7
 s_cselect_b32 s27, 0, s27
 s_cselect_b32 s29, -768, s29
 s_lshl_b32 s13, s27, 7
 s_add_u32 s28, s22, s13
 s_add_u32 s30, s30, 1
 s_cmp_eq_u32 s30, 7
 s_cbranch_scc1 L_ffn_71_end
 s_waitcnt vmcnt(16)
 ds_read_b64_tr_b16 v[56:57], v96 offset:16384
 ds_read_b64_tr_b16 v[58:59], v96 offset:16896
 ds_read_b64_tr_b16 v[60:61], v97 offset:16384
 ds_read_b64_tr_b16 v[62:63], v97 offset:16896
 ds_read_b64_tr_b16 v[64:65], v98 offset:16384
 ds_read_b64_tr_b16 v[66:67], v98 offset:16896
 ds_read_b64_tr_b16 v[68:69], v99 offset:16384
 ds_read_b64_tr_b16 v[70:71], v99 offset:16896
 s_add_u32 m0, s26, 8192
 s_add_u32 s13, s20, 688128
 buffer_load_dwordx4 v89, s[80:83], s13 offen lds
 s_add_u32 m0, s26, 9216
 s_add_u32 s13, s20, 716800
 buffer_load_dwordx4 v90, s[80:83], s13 offen lds
 s_add_u32 m0, s26, 10240
 s_add_u32 s13, s20, 745472
 buffer_load_dwordx4 v89, s[80:83], s13 offen lds
 s_add_u32 m0, s26, 11264
 s_add_u32 s13, s20, 774144
 buffer_load_dwordx4 v90, s[80:83], s13 offen lds
 s_add_u32 m0, s26, 12288
 s_add_u32 s13, s20, 802816
 buffer_load_dwordx4 v89, s[80:83], s13 offen lds
 s_add_u32 m0, s26, 13312
 s_add_u32 s13, s20, 831488
 buffer_load_dwordx4 v90, s[80:83], s13 offen lds
 s_add_u32 m0, s26, 14336
 s_add_u32 s13, s20, 860160
 buffer_load_dwordx4 v89, s[80:83], s13 offen lds
 s_add_u32 m0, s26, 15360
 s_add_u32 s13, s20, 888832
 buffer_load_dwordx4 v90, s[80:83], s13 offen lds
 s_waitcnt lgkmcnt(0)
 v_mfma_f32_16x16x32_bf16 v[8:11], v[56:59], v[128:131], 0
 ds_read_b64_tr_b16 v[72:73], v96 offset:20480
 v_mfma_f32_16x16x32_bf16 v[12:15], v[56:59], v[132:135], 0
 ds_read_b64_tr_b16 v[74:75], v96 offset:20992
 v_mfma_f32_16x16x32_bf16 v[16:19], v[60:63], v[128:131], 0
 ds_read_b64_tr_b16 v[76:77], v97 offset:20480
 v_mfma_f32_16x16x32_bf16 v[20:23], v[60:63], v[132:135], 0
 ds_read_b64_tr_b16 v[78:79], v97 offset:20992
 v_mfma_f32_16x16x32_bf16 v[24:27], v[64:67], v[128:131], 0
 ds_read_b64_tr_b16 v[80:81], v98 offset:20480
 v_mfma_f32_16x16x32_bf16 v[28:31], v[64:67], v[132:135], 0
 ds_read_b64_tr_b16 v[82:83], v98 offset:20992
 v_mfma_f32_16x16x32_bf16 v[32:35], v[68:71], v[128:131], 0
 ds_read_b64_tr_b16 v[84:85], v99 offset:20480
 v_mfma_f32_16x16x32_bf16 v[36:39], v[68:71], v[132:135], 0
 ds_read_b64_tr_b16 v[86:87], v99 offset:20992
 s_waitcnt lgkmcnt(0)
 v_mfma_f32_16x16x32_bf16 v[8:11], v[72:75], v[136:139], v[8:11]
 v_mfma_f32_16x16x32_bf16 v[12:15], v[72:75], v[140:143], v[12:15]
 v_mfma_f32_16x16x32_bf16 v[16:19], v[76:79], v[136:139], v[16:19]
 v_mfma_f32_16x16x32_bf16 v[20:23], v[76:79], v[140:143], v[20:23]
 v_mfma_f32_16x16x32_bf16 v[24:27], v[80:83], v[136:139], v[24:27]
 v_mfma_f32_16x16x32_bf16 v[28:31], v[80:83], v[140:143], v[28:31]
 v_mfma_f32_16x16x32_bf16 v[32:35], v[84:87], v[136:139], v[32:35]
 v_mfma_f32_16x16x32_bf16 v[36:39], v[84:87], v[140:143], v[36:39]
 s_waitcnt vmcnt(16)
 ds_read_b64_tr_b16 v[56:57], v96 offset:24576
 ds_read_b64_tr_b16 v[58:59], v96 offset:25088
 ds_read_b64_tr_b16 v[60:61], v97 offset:24576
 ds_read_b64_tr_b16 v[62:63], v97 offset:25088
 ds_read_b64_tr_b16 v[64:65], v98 offset:24576
 ds_read_b64_tr_b16 v[66:67], v98 offset:25088
 ds_read_b64_tr_b16 v[68:69], v99 offset:24576
 ds_read_b64_tr_b16 v[70:71], v99 offset:25088
 s_add_u32 m0, s26, 16384
 s_add_u32 s13, s20, 917504
 buffer_load_dwordx4 v89, s[80:83], s13 offen lds
 s_add_u32 m0, s26, 17408
 s_add_u32 s13, s20, 946176
 buffer_load_dwordx4 v90, s[80:83], s13 offen lds
 s_add_u32 m0, s26, 18432
 s_add_u32 s13, s20, 974848
 buffer_load_dwordx4 v89, s[80:83], s13 offen lds
 s_add_u32 m0, s26, 19456
 s_add_u32 s13, s20, 1003520
 buffer_load_dwordx4 v90, s[80:83], s13 offen lds
 s_add_u32 m0, s26, 20480
 s_add_u32 s13, s20, 1032192
 buffer_load_dwordx4 v89, s[80:83], s13 offen lds
 s_add_u32 m0, s26, 21504
 s_add_u32 s13, s20, 1060864
 buffer_load_dwordx4 v90, s[80:83], s13 offen lds
 s_add_u32 m0, s26, 22528
 s_add_u32 s13, s20, 1089536
 buffer_load_dwordx4 v89, s[80:83], s13 offen lds
 s_add_u32 m0, s26, 23552
 s_add_u32 s13, s20, 1118208
 buffer_load_dwordx4 v90, s[80:83], s13 offen lds
 s_waitcnt lgkmcnt(0)
 v_mfma_f32_16x16x32_bf16 v[8:11], v[56:59], v[144:147], v[8:11]
 ds_read_b64_tr_b16 v[72:73], v96 offset:28672
 v_mfma_f32_16x16x32_bf16 v[12:15], v[56:59], v[148:151], v[12:15]
 ds_read_b64_tr_b16 v[74:75], v96 offset:29184
 v_mfma_f32_16x16x32_bf16 v[16:19], v[60:63], v[144:147], v[16:19]
 ds_read_b64_tr_b16 v[76:77], v97 offset:28672
 v_mfma_f32_16x16x32_bf16 v[20:23], v[60:63], v[148:151], v[20:23]
 ds_read_b64_tr_b16 v[78:79], v97 offset:29184
 v_mfma_f32_16x16x32_bf16 v[24:27], v[64:67], v[144:147], v[24:27]
 ds_read_b64_tr_b16 v[80:81], v98 offset:28672
 v_mfma_f32_16x16x32_bf16 v[28:31], v[64:67], v[148:151], v[28:31]
 ds_read_b64_tr_b16 v[82:83], v98 offset:29184
 v_mfma_f32_16x16x32_bf16 v[32:35], v[68:71], v[144:147], v[32:35]
 ds_read_b64_tr_b16 v[84:85], v99 offset:28672
 v_mfma_f32_16x16x32_bf16 v[36:39], v[68:71], v[148:151], v[36:39]
 ds_read_b64_tr_b16 v[86:87], v99 offset:29184
 s_waitcnt lgkmcnt(0)
 v_mfma_f32_16x16x32_bf16 v[8:11], v[72:75], v[152:155], v[8:11]
 v_mfma_f32_16x16x32_bf16 v[12:15], v[72:75], v[156:159], v[12:15]
 v_mfma_f32_16x16x32_bf16 v[16:19], v[76:79], v[152:155], v[16:19]
 v_mfma_f32_16x16x32_bf16 v[20:23], v[76:79], v[156:159], v[20:23]
 v_mfma_f32_16x16x32_bf16 v[24:27], v[80:83], v[152:155], v[24:27]
 v_mfma_f32_16x16x32_bf16 v[28:31], v[80:83], v[156:159], v[28:31]
 v_mfma_f32_16x16x32_bf16 v[32:35], v[84:87], v[152:155], v[32:35]
 v_mfma_f32_16x16x32_bf16 v[36:39], v[84:87], v[156:159], v[36:39]
 s_waitcnt vmcnt(16)
 ds_read_b64_tr_b16 v[56:57], v96
 ds_read_b64_tr_b16 v[58:59], v96 offset:512
 ds_read_b64_tr_b16 v[60:61], v97
 ds_read_b64_tr_b16 v[62:63], v97 offset:512
 ds_read_b64_tr_b16 v[64:65], v98
 ds_read_b64_tr_b16 v[66:67], v98 offset:512
 ds_read_b64_tr_b16 v[68:69], v99
 ds_read_b64_tr_b16 v[70:71], v99 offset:512
 s_add_u32 m0, s26, 24576
 s_add_u32 s13, s20, 1146880
 buffer_load_dwordx4 v89, s[80:83], s13 offen lds
 s_add_u32 m0, s26, 25600
 s_add_u32 s13, s20, 1175552
 buffer_load_dwordx4 v90, s[80:83], s13 offen lds
 s_add_u32 m0, s26, 26624
 s_add_u32 s13, s20, 1204224
 buffer_load_dwordx4 v89, s[80:83], s13 offen lds
 s_add_u32 m0, s26, 27648
 s_add_u32 s13, s20, 1232896
 buffer_load_dwordx4 v90, s[80:83], s13 offen lds
 s_add_u32 m0, s26, 28672
 s_add_u32 s13, s20, 1261568
 buffer_load_dwordx4 v89, s[80:83], s13 offen lds
 s_add_u32 m0, s26, 29696
 s_add_u32 s13, s20, 1290240
 buffer_load_dwordx4 v90, s[80:83], s13 offen lds
 s_add_u32 m0, s26, 30720
 s_add_u32 s13, s20, 1318912
 buffer_load_dwordx4 v89, s[80:83], s13 offen lds
 s_add_u32 m0, s26, 31744
 s_add_u32 s13, s20, 1347584
 buffer_load_dwordx4 v90, s[80:83], s13 offen lds
 s_waitcnt lgkmcnt(0)
 v_mfma_f32_16x16x32_bf16 v[8:11], v[56:59], v[160:163], v[8:11]
 ds_read_b64_tr_b16 v[72:73], v96 offset:4096
 v_mfma_f32_16x16x32_bf16 v[12:15], v[56:59], v[164:167], v[12:15]
 ds_read_b64_tr_b16 v[74:75], v96 offset:4608
 v_mfma_f32_16x16x32_bf16 v[16:19], v[60:63], v[160:163], v[16:19]
 ds_read_b64_tr_b16 v[76:77], v97 offset:4096
 v_mfma_f32_16x16x32_bf16 v[20:23], v[60:63], v[164:167], v[20:23]
 ds_read_b64_tr_b16 v[78:79], v97 offset:4608
 v_mfma_f32_16x16x32_bf16 v[24:27], v[64:67], v[160:163], v[24:27]
 ds_read_b64_tr_b16 v[80:81], v98 offset:4096
 v_mfma_f32_16x16x32_bf16 v[28:31], v[64:67], v[164:167], v[28:31]
 ds_read_b64_tr_b16 v[82:83], v98 offset:4608
 v_mfma_f32_16x16x32_bf16 v[32:35], v[68:71], v[160:163], v[32:35]
 ds_read_b64_tr_b16 v[84:85], v99 offset:4096
 v_mfma_f32_16x16x32_bf16 v[36:39], v[68:71], v[164:167], v[36:39]
 ds_read_b64_tr_b16 v[86:87], v99 offset:4608
 s_waitcnt lgkmcnt(0)
 v_mfma_f32_16x16x32_bf16 v[8:11], v[72:75], v[168:171], v[8:11]
 v_mfma_f32_16x16x32_bf16 v[12:15], v[72:75], v[172:175], v[12:15]
 v_mfma_f32_16x16x32_bf16 v[16:19], v[76:79], v[168:171], v[16:19]
 v_mfma_f32_16x16x32_bf16 v[20:23], v[76:79], v[172:175], v[20:23]
 v_mfma_f32_16x16x32_bf16 v[24:27], v[80:83], v[168:171], v[24:27]
 v_mfma_f32_16x16x32_bf16 v[28:31], v[80:83], v[172:175], v[28:31]
 v_mfma_f32_16x16x32_bf16 v[32:35], v[84:87], v[168:171], v[32:35]
 v_mfma_f32_16x16x32_bf16 v[36:39], v[84:87], v[172:175], v[36:39]
 s_waitcnt vmcnt(16)
 ds_read_b64_tr_b16 v[56:57], v96 offset:8192
 ds_read_b64_tr_b16 v[58:59], v96 offset:8704
 ds_read_b64_tr_b16 v[60:61], v97 offset:8192
 ds_read_b64_tr_b16 v[62:63], v97 offset:8704
 ds_read_b64_tr_b16 v[64:65], v98 offset:8192
 ds_read_b64_tr_b16 v[66:67], v98 offset:8704
 ds_read_b64_tr_b16 v[68:69], v99 offset:8192
 ds_read_b64_tr_b16 v[70:71], v99 offset:8704
 s_add_u32 m0, s26, 0
 s_add_u32 s13, s20, 1376256
 buffer_load_dwordx4 v89, s[80:83], s13 offen lds
 s_add_u32 m0, s26, 1024
 s_add_u32 s13, s20, 1404928
 buffer_load_dwordx4 v90, s[80:83], s13 offen lds
 s_add_u32 m0, s26, 2048
 s_add_u32 s13, s20, 1433600
 buffer_load_dwordx4 v89, s[80:83], s13 offen lds
 s_add_u32 m0, s26, 3072
 s_add_u32 s13, s20, 1462272
 buffer_load_dwordx4 v90, s[80:83], s13 offen lds
 s_add_u32 m0, s26, 4096
 s_add_u32 s13, s20, 1490944
 buffer_load_dwordx4 v89, s[80:83], s13 offen lds
 s_add_u32 m0, s26, 5120
 s_add_u32 s13, s20, 1519616
 buffer_load_dwordx4 v90, s[80:83], s13 offen lds
 s_add_u32 m0, s26, 6144
 s_add_u32 s13, s20, 1548288
 buffer_load_dwordx4 v89, s[80:83], s13 offen lds
 s_add_u32 m0, s26, 7168
 s_add_u32 s13, s20, 1576960
 buffer_load_dwordx4 v90, s[80:83], s13 offen lds
 s_waitcnt lgkmcnt(0)
 v_mfma_f32_16x16x32_bf16 v[8:11], v[56:59], v[176:179], v[8:11]
 ds_read_b64_tr_b16 v[72:73], v96 offset:12288
 v_mfma_f32_16x16x32_bf16 v[12:15], v[56:59], v[180:183], v[12:15]
 ds_read_b64_tr_b16 v[74:75], v96 offset:12800
 v_mfma_f32_16x16x32_bf16 v[16:19], v[60:63], v[176:179], v[16:19]
 ds_read_b64_tr_b16 v[76:77], v97 offset:12288
 v_mfma_f32_16x16x32_bf16 v[20:23], v[60:63], v[180:183], v[20:23]
 ds_read_b64_tr_b16 v[78:79], v97 offset:12800
 v_mfma_f32_16x16x32_bf16 v[24:27], v[64:67], v[176:179], v[24:27]
 ds_read_b64_tr_b16 v[80:81], v98 offset:12288
 v_mfma_f32_16x16x32_bf16 v[28:31], v[64:67], v[180:183], v[28:31]
 ds_read_b64_tr_b16 v[82:83], v98 offset:12800
 v_mfma_f32_16x16x32_bf16 v[32:35], v[68:71], v[176:179], v[32:35]
 ds_read_b64_tr_b16 v[84:85], v99 offset:12288
 v_mfma_f32_16x16x32_bf16 v[36:39], v[68:71], v[180:183], v[36:39]
 ds_read_b64_tr_b16 v[86:87], v99 offset:12800
 s_waitcnt lgkmcnt(0)
 v_mfma_f32_16x16x32_bf16 v[8:11], v[72:75], v[184:187], v[8:11]
 v_mfma_f32_16x16x32_bf16 v[12:15], v[72:75], v[188:191], v[12:15]
 v_mfma_f32_16x16x32_bf16 v[16:19], v[76:79], v[184:187], v[16:19]
 v_mfma_f32_16x16x32_bf16 v[20:23], v[76:79], v[188:191], v[20:23]
 v_mfma_f32_16x16x32_bf16 v[24:27], v[80:83], v[184:187], v[24:27]
 v_mfma_f32_16x16x32_bf16 v[28:31], v[80:83], v[188:191], v[28:31]
 v_mfma_f32_16x16x32_bf16 v[32:35], v[84:87], v[184:187], v[32:35]
 v_mfma_f32_16x16x32_bf16 v[36:39], v[84:87], v[188:191], v[36:39]
 s_waitcnt vmcnt(16)
 ds_read_b64_tr_b16 v[56:57], v96 offset:16384
 ds_read_b64_tr_b16 v[58:59], v96 offset:16896
 ds_read_b64_tr_b16 v[60:61], v97 offset:16384
 ds_read_b64_tr_b16 v[62:63], v97 offset:16896
 ds_read_b64_tr_b16 v[64:65], v98 offset:16384
 ds_read_b64_tr_b16 v[66:67], v98 offset:16896
 ds_read_b64_tr_b16 v[68:69], v99 offset:16384
 ds_read_b64_tr_b16 v[70:71], v99 offset:16896
 s_add_u32 m0, s26, 8192
 s_add_u32 s13, s21, 0
 buffer_load_dwordx4 v91, s[84:87], s13 offen lds
 s_add_u32 m0, s26, 9216
 s_add_u32 s13, s21, 7168
 buffer_load_dwordx4 v91, s[84:87], s13 offen lds
 s_add_u32 m0, s26, 10240
 s_add_u32 s13, s21, 14336
 buffer_load_dwordx4 v91, s[84:87], s13 offen lds
 s_add_u32 m0, s26, 11264
 s_add_u32 s13, s21, 21504
 buffer_load_dwordx4 v91, s[84:87], s13 offen lds
 s_add_u32 m0, s26, 12288
 s_add_u32 s13, s21, 28672
 buffer_load_dwordx4 v91, s[84:87], s13 offen lds
 s_add_u32 m0, s26, 13312
 s_add_u32 s13, s21, 35840
 buffer_load_dwordx4 v91, s[84:87], s13 offen lds
 s_add_u32 m0, s26, 14336
 s_add_u32 s13, s21, 43008
 buffer_load_dwordx4 v91, s[84:87], s13 offen lds
 s_add_u32 m0, s26, 15360
 s_add_u32 s13, s21, 50176
 buffer_load_dwordx4 v91, s[84:87], s13 offen lds
 s_waitcnt lgkmcnt(0)
 v_mfma_f32_16x16x32_bf16 v[8:11], v[56:59], v[192:195], v[8:11]
 ds_read_b64_tr_b16 v[72:73], v96 offset:20480
 v_mfma_f32_16x16x32_bf16 v[12:15], v[56:59], v[196:199], v[12:15]
 ds_read_b64_tr_b16 v[74:75], v96 offset:20992
 v_mfma_f32_16x16x32_bf16 v[16:19], v[60:63], v[192:195], v[16:19]
 ds_read_b64_tr_b16 v[76:77], v97 offset:20480
 v_mfma_f32_16x16x32_bf16 v[20:23], v[60:63], v[196:199], v[20:23]
 ds_read_b64_tr_b16 v[78:79], v97 offset:20992
 v_mfma_f32_16x16x32_bf16 v[24:27], v[64:67], v[192:195], v[24:27]
 ds_read_b64_tr_b16 v[80:81], v98 offset:20480
 v_mfma_f32_16x16x32_bf16 v[28:31], v[64:67], v[196:199], v[28:31]
 ds_read_b64_tr_b16 v[82:83], v98 offset:20992
 v_mfma_f32_16x16x32_bf16 v[32:35], v[68:71], v[192:195], v[32:35]
 ds_read_b64_tr_b16 v[84:85], v99 offset:20480
 v_mfma_f32_16x16x32_bf16 v[36:39], v[68:71], v[196:199], v[36:39]
 ds_read_b64_tr_b16 v[86:87], v99 offset:20992
 s_waitcnt lgkmcnt(0)
 v_mfma_f32_16x16x32_bf16 v[8:11], v[72:75], v[200:203], v[8:11]
 v_mfma_f32_16x16x32_bf16 v[12:15], v[72:75], v[204:207], v[12:15]
 v_mfma_f32_16x16x32_bf16 v[16:19], v[76:79], v[200:203], v[16:19]
 v_mfma_f32_16x16x32_bf16 v[20:23], v[76:79], v[204:207], v[20:23]
 v_mfma_f32_16x16x32_bf16 v[24:27], v[80:83], v[200:203], v[24:27]
 v_mfma_f32_16x16x32_bf16 v[28:31], v[80:83], v[204:207], v[28:31]
 v_mfma_f32_16x16x32_bf16 v[32:35], v[84:87], v[200:203], v[32:35]
 v_mfma_f32_16x16x32_bf16 v[36:39], v[84:87], v[204:207], v[36:39]
 s_waitcnt vmcnt(16)
 ds_read_b64_tr_b16 v[56:57], v96 offset:24576
 ds_read_b64_tr_b16 v[58:59], v96 offset:25088
 ds_read_b64_tr_b16 v[60:61], v97 offset:24576
 ds_read_b64_tr_b16 v[62:63], v97 offset:25088
 ds_read_b64_tr_b16 v[64:65], v98 offset:24576
 ds_read_b64_tr_b16 v[66:67], v98 offset:25088
 ds_read_b64_tr_b16 v[68:69], v99 offset:24576
 ds_read_b64_tr_b16 v[70:71], v99 offset:25088
 s_add_u32 m0, s26, 16384
 s_add_u32 s13, s21, 128
 buffer_load_dwordx4 v91, s[84:87], s13 offen lds
 s_add_u32 m0, s26, 17408
 s_add_u32 s13, s21, 7296
 buffer_load_dwordx4 v91, s[84:87], s13 offen lds
 s_add_u32 m0, s26, 18432
 s_add_u32 s13, s21, 14464
 buffer_load_dwordx4 v91, s[84:87], s13 offen lds
 s_add_u32 m0, s26, 19456
 s_add_u32 s13, s21, 21632
 buffer_load_dwordx4 v91, s[84:87], s13 offen lds
 s_add_u32 m0, s26, 20480
 s_add_u32 s13, s21, 28800
 buffer_load_dwordx4 v91, s[84:87], s13 offen lds
 s_add_u32 m0, s26, 21504
 s_add_u32 s13, s21, 35968
 buffer_load_dwordx4 v91, s[84:87], s13 offen lds
 s_add_u32 m0, s26, 22528
 s_add_u32 s13, s21, 43136
 buffer_load_dwordx4 v91, s[84:87], s13 offen lds
 s_add_u32 m0, s26, 23552
 s_add_u32 s13, s21, 50304
 buffer_load_dwordx4 v91, s[84:87], s13 offen lds
 s_waitcnt lgkmcnt(0)
 v_mfma_f32_16x16x32_bf16 v[8:11], v[56:59], v[208:211], v[8:11]
 ds_read_b64_tr_b16 v[72:73], v96 offset:28672
 v_mfma_f32_16x16x32_bf16 v[12:15], v[56:59], v[212:215], v[12:15]
 ds_read_b64_tr_b16 v[74:75], v96 offset:29184
 v_mfma_f32_16x16x32_bf16 v[16:19], v[60:63], v[208:211], v[16:19]
 ds_read_b64_tr_b16 v[76:77], v97 offset:28672
 v_mfma_f32_16x16x32_bf16 v[20:23], v[60:63], v[212:215], v[20:23]
 ds_read_b64_tr_b16 v[78:79], v97 offset:29184
 v_mfma_f32_16x16x32_bf16 v[24:27], v[64:67], v[208:211], v[24:27]
 ds_read_b64_tr_b16 v[80:81], v98 offset:28672
 v_mfma_f32_16x16x32_bf16 v[28:31], v[64:67], v[212:215], v[28:31]
 ds_read_b64_tr_b16 v[82:83], v98 offset:29184
 v_mfma_f32_16x16x32_bf16 v[32:35], v[68:71], v[208:211], v[32:35]
 ds_read_b64_tr_b16 v[84:85], v99 offset:28672
 v_mfma_f32_16x16x32_bf16 v[36:39], v[68:71], v[212:215], v[36:39]
 ds_read_b64_tr_b16 v[86:87], v99 offset:29184
 s_waitcnt lgkmcnt(0)
 v_mfma_f32_16x16x32_bf16 v[8:11], v[72:75], v[216:219], v[8:11]
 v_mfma_f32_16x16x32_bf16 v[12:15], v[72:75], v[220:223], v[12:15]
 v_mfma_f32_16x16x32_bf16 v[16:19], v[76:79], v[216:219], v[16:19]
 v_mfma_f32_16x16x32_bf16 v[20:23], v[76:79], v[220:223], v[20:23]
 v_mfma_f32_16x16x32_bf16 v[24:27], v[80:83], v[216:219], v[24:27]
 v_mfma_f32_16x16x32_bf16 v[28:31], v[80:83], v[220:223], v[28:31]
 v_mfma_f32_16x16x32_bf16 v[32:35], v[84:87], v[216:219], v[32:35]
 v_mfma_f32_16x16x32_bf16 v[36:39], v[84:87], v[220:223], v[36:39]
 s_waitcnt vmcnt(16)
 ds_read_b64_tr_b16 v[56:57], v96
 ds_read_b64_tr_b16 v[58:59], v96 offset:512
 ds_read_b64_tr_b16 v[60:61], v97
 ds_read_b64_tr_b16 v[62:63], v97 offset:512
 ds_read_b64_tr_b16 v[64:65], v98
 ds_read_b64_tr_b16 v[66:67], v98 offset:512
 ds_read_b64_tr_b16 v[68:69], v99
 ds_read_b64_tr_b16 v[70:71], v99 offset:512
 s_add_u32 m0, s26, 24576
 s_add_u32 s13, s21, 256
 buffer_load_dwordx4 v91, s[84:87], s13 offen lds
 s_add_u32 m0, s26, 25600
 s_add_u32 s13, s21, 7424
 buffer_load_dwordx4 v91, s[84:87], s13 offen lds
 s_add_u32 m0, s26, 26624
 s_add_u32 s13, s21, 14592
 buffer_load_dwordx4 v91, s[84:87], s13 offen lds
 s_add_u32 m0, s26, 27648
 s_add_u32 s13, s21, 21760
 buffer_load_dwordx4 v91, s[84:87], s13 offen lds
 s_add_u32 m0, s26, 28672
 s_add_u32 s13, s21, 28928
 buffer_load_dwordx4 v91, s[84:87], s13 offen lds
 s_add_u32 m0, s26, 29696
 s_add_u32 s13, s21, 36096
 buffer_load_dwordx4 v91, s[84:87], s13 offen lds
 s_add_u32 m0, s26, 30720
 s_add_u32 s13, s21, 43264
 buffer_load_dwordx4 v91, s[84:87], s13 offen lds
 s_add_u32 m0, s26, 31744
 s_add_u32 s13, s21, 50432
 buffer_load_dwordx4 v91, s[84:87], s13 offen lds
 s_waitcnt lgkmcnt(0)
 v_mfma_f32_16x16x32_bf16 v[8:11], v[56:59], v[224:227], v[8:11]
 ds_read_b64_tr_b16 v[72:73], v96 offset:4096
 v_mfma_f32_16x16x32_bf16 v[12:15], v[56:59], v[228:231], v[12:15]
 ds_read_b64_tr_b16 v[74:75], v96 offset:4608
 v_mfma_f32_16x16x32_bf16 v[16:19], v[60:63], v[224:227], v[16:19]
 ds_read_b64_tr_b16 v[76:77], v97 offset:4096
 v_mfma_f32_16x16x32_bf16 v[20:23], v[60:63], v[228:231], v[20:23]
 ds_read_b64_tr_b16 v[78:79], v97 offset:4608
 v_mfma_f32_16x16x32_bf16 v[24:27], v[64:67], v[224:227], v[24:27]
 ds_read_b64_tr_b16 v[80:81], v98 offset:4096
 v_mfma_f32_16x16x32_bf16 v[28:31], v[64:67], v[228:231], v[28:31]
 ds_read_b64_tr_b16 v[82:83], v98 offset:4608
 v_mfma_f32_16x16x32_bf16 v[32:35], v[68:71], v[224:227], v[32:35]
 ds_read_b64_tr_b16 v[84:85], v99 offset:4096
 v_mfma_f32_16x16x32_bf16 v[36:39], v[68:71], v[228:231], v[36:39]
 ds_read_b64_tr_b16 v[86:87], v99 offset:4608
 s_waitcnt lgkmcnt(0)
 v_mfma_f32_16x16x32_bf16 v[8:11], v[72:75], v[232:235], v[8:11]
 v_mfma_f32_16x16x32_bf16 v[12:15], v[72:75], v[236:239], v[12:15]
 v_mfma_f32_16x16x32_bf16 v[16:19], v[76:79], v[232:235], v[16:19]
 v_mfma_f32_16x16x32_bf16 v[20:23], v[76:79], v[236:239], v[20:23]
 v_mfma_f32_16x16x32_bf16 v[24:27], v[80:83], v[232:235], v[24:27]
 v_mfma_f32_16x16x32_bf16 v[28:31], v[80:83], v[236:239], v[28:31]
 v_mfma_f32_16x16x32_bf16 v[32:35], v[84:87], v[232:235], v[32:35]
 v_mfma_f32_16x16x32_bf16 v[36:39], v[84:87], v[236:239], v[36:39]
 s_waitcnt vmcnt(16)
 ds_read_b64_tr_b16 v[56:57], v100 offset:8192
 ds_read_b64_tr_b16 v[58:59], v100 offset:10240
 ds_read_b64_tr_b16 v[60:61], v101 offset:8192
 ds_read_b64_tr_b16 v[62:63], v101 offset:10240
 ds_read_b64_tr_b16 v[64:65], v102 offset:8192
 ds_read_b64_tr_b16 v[66:67], v102 offset:10240
 ds_read_b64_tr_b16 v[68:69], v103 offset:8192
 ds_read_b64_tr_b16 v[70:71], v103 offset:10240
 s_add_u32 m0, s26, 0
 s_add_u32 s13, s21, 384
 buffer_load_dwordx4 v91, s[84:87], s13 offen lds
 s_add_u32 m0, s26, 1024
 s_add_u32 s13, s21, 7552
 buffer_load_dwordx4 v91, s[84:87], s13 offen lds
 s_add_u32 m0, s26, 2048
 s_add_u32 s13, s21, 14720
 buffer_load_dwordx4 v91, s[84:87], s13 offen lds
 s_add_u32 m0, s26, 3072
 s_add_u32 s13, s21, 21888
 buffer_load_dwordx4 v91, s[84:87], s13 offen lds
 s_add_u32 m0, s26, 4096
 s_add_u32 s13, s21, 29056
 buffer_load_dwordx4 v91, s[84:87], s13 offen lds
 s_add_u32 m0, s26, 5120
 s_add_u32 s13, s21, 36224
 buffer_load_dwordx4 v91, s[84:87], s13 offen lds
 s_add_u32 m0, s26, 6144
 s_add_u32 s13, s21, 43392
 buffer_load_dwordx4 v91, s[84:87], s13 offen lds
 s_add_u32 m0, s26, 7168
 s_add_u32 s13, s21, 50560
 buffer_load_dwordx4 v91, s[84:87], s13 offen lds
 ds_read_b64 v[104:105], v92
 ds_read_b64 v[106:107], v92 offset:32
 ds_read_b64 v[108:109], v92 offset:64
 ds_read_b64 v[110:111], v92 offset:96
 s_waitcnt lgkmcnt(0)
 v_lshlrev_b32 v112, 16, v104
 v_and_b32 v113, s34, v104
 v_lshlrev_b32 v114, 16, v105
 v_and_b32 v115, s34, v105
 v_cvt_pk_bf16_f32 v116, v8, v9
 v_cvt_pk_bf16_f32 v117, v10, v11
 v_lshlrev_b32 v8, 16, v116
 v_and_b32 v9, s34, v116
 v_lshlrev_b32 v10, 16, v117
 v_and_b32 v11, s34, v117
 v_pk_add_f32 v[8:9], v[8:9], v[112:113]
 v_pk_add_f32 v[10:11], v[10:11], v[114:115]
 v_cvt_pk_bf16_f32 v116, v8, v9
 v_cvt_pk_bf16_f32 v117, v10, v11
 v_lshlrev_b32 v8, 16, v116
 v_and_b32 v9, s34, v116
 v_lshlrev_b32 v10, 16, v117
 v_and_b32 v11, s34, v117
 v_max_f32 v8, 0, v8
 v_max_f32 v9, 0, v9
 v_max_f32 v10, 0, v10
 v_max_f32 v11, 0, v11
 v_pk_mul_f32 v[8:9], v[8:9], v[8:9]
 v_pk_mul_f32 v[10:11], v[10:11], v[10:11]
 v_cvt_pk_bf16_f32 v40, v8, v9
 v_cvt_pk_bf16_f32 v41, v10, v11
 v_cvt_pk_bf16_f32 v116, v12, v13
 v_cvt_pk_bf16_f32 v117, v14, v15
 v_lshlrev_b32 v12, 16, v116
 v_and_b32 v13, s34, v116
 v_lshlrev_b32 v14, 16, v117
 v_and_b32 v15, s34, v117
 v_pk_add_f32 v[12:13], v[12:13], v[112:113]
 v_pk_add_f32 v[14:15], v[14:15], v[114:115]
 v_cvt_pk_bf16_f32 v116, v12, v13
 v_cvt_pk_bf16_f32 v117, v14, v15
 v_lshlrev_b32 v12, 16, v116
 v_and_b32 v13, s34, v116
 v_lshlrev_b32 v14, 16, v117
 v_and_b32 v15, s34, v117
 v_max_f32 v12, 0, v12
 v_max_f32 v13, 0, v13
 v_max_f32 v14, 0, v14
 v_max_f32 v15, 0, v15
 v_pk_mul_f32 v[12:13], v[12:13], v[12:13]
 v_pk_mul_f32 v[14:15], v[14:15], v[14:15]
 v_cvt_pk_bf16_f32 v44, v12, v13
 v_cvt_pk_bf16_f32 v45, v14, v15
 v_lshlrev_b32 v112, 16, v106
 v_and_b32 v113, s34, v106
 v_lshlrev_b32 v114, 16, v107
 v_and_b32 v115, s34, v107
 v_cvt_pk_bf16_f32 v116, v16, v17
 v_cvt_pk_bf16_f32 v117, v18, v19
 v_lshlrev_b32 v16, 16, v116
 v_and_b32 v17, s34, v116
 v_lshlrev_b32 v18, 16, v117
 v_and_b32 v19, s34, v117
 v_pk_add_f32 v[16:17], v[16:17], v[112:113]
 v_pk_add_f32 v[18:19], v[18:19], v[114:115]
 v_cvt_pk_bf16_f32 v116, v16, v17
 v_cvt_pk_bf16_f32 v117, v18, v19
 v_lshlrev_b32 v16, 16, v116
 v_and_b32 v17, s34, v116
 v_lshlrev_b32 v18, 16, v117
 v_and_b32 v19, s34, v117
 v_max_f32 v16, 0, v16
 v_max_f32 v17, 0, v17
 v_max_f32 v18, 0, v18
 v_max_f32 v19, 0, v19
 v_pk_mul_f32 v[16:17], v[16:17], v[16:17]
 v_pk_mul_f32 v[18:19], v[18:19], v[18:19]
 v_cvt_pk_bf16_f32 v42, v16, v17
 v_cvt_pk_bf16_f32 v43, v18, v19
 v_cvt_pk_bf16_f32 v116, v20, v21
 v_cvt_pk_bf16_f32 v117, v22, v23
 v_lshlrev_b32 v20, 16, v116
 v_and_b32 v21, s34, v116
 v_lshlrev_b32 v22, 16, v117
 v_and_b32 v23, s34, v117
 v_pk_add_f32 v[20:21], v[20:21], v[112:113]
 v_pk_add_f32 v[22:23], v[22:23], v[114:115]
 v_cvt_pk_bf16_f32 v116, v20, v21
 v_cvt_pk_bf16_f32 v117, v22, v23
 v_lshlrev_b32 v20, 16, v116
 v_and_b32 v21, s34, v116
 v_lshlrev_b32 v22, 16, v117
 v_and_b32 v23, s34, v117
 v_max_f32 v20, 0, v20
 v_max_f32 v21, 0, v21
 v_max_f32 v22, 0, v22
 v_max_f32 v23, 0, v23
 v_pk_mul_f32 v[20:21], v[20:21], v[20:21]
 v_pk_mul_f32 v[22:23], v[22:23], v[22:23]
 v_cvt_pk_bf16_f32 v46, v20, v21
 v_cvt_pk_bf16_f32 v47, v22, v23
 v_lshlrev_b32 v112, 16, v108
 v_and_b32 v113, s34, v108
 v_lshlrev_b32 v114, 16, v109
 v_and_b32 v115, s34, v109
 v_cvt_pk_bf16_f32 v116, v24, v25
 v_cvt_pk_bf16_f32 v117, v26, v27
 v_lshlrev_b32 v24, 16, v116
 v_and_b32 v25, s34, v116
 v_lshlrev_b32 v26, 16, v117
 v_and_b32 v27, s34, v117
 v_pk_add_f32 v[24:25], v[24:25], v[112:113]
 v_pk_add_f32 v[26:27], v[26:27], v[114:115]
 v_cvt_pk_bf16_f32 v116, v24, v25
 v_cvt_pk_bf16_f32 v117, v26, v27
 v_lshlrev_b32 v24, 16, v116
 v_and_b32 v25, s34, v116
 v_lshlrev_b32 v26, 16, v117
 v_and_b32 v27, s34, v117
 v_max_f32 v24, 0, v24
 v_max_f32 v25, 0, v25
 v_max_f32 v26, 0, v26
 v_max_f32 v27, 0, v27
 v_pk_mul_f32 v[24:25], v[24:25], v[24:25]
 v_pk_mul_f32 v[26:27], v[26:27], v[26:27]
 v_cvt_pk_bf16_f32 v48, v24, v25
 v_cvt_pk_bf16_f32 v49, v26, v27
 v_cvt_pk_bf16_f32 v116, v28, v29
 v_cvt_pk_bf16_f32 v117, v30, v31
 v_lshlrev_b32 v28, 16, v116
 v_and_b32 v29, s34, v116
 v_lshlrev_b32 v30, 16, v117
 v_and_b32 v31, s34, v117
 v_pk_add_f32 v[28:29], v[28:29], v[112:113]
 v_pk_add_f32 v[30:31], v[30:31], v[114:115]
 v_cvt_pk_bf16_f32 v116, v28, v29
 v_cvt_pk_bf16_f32 v117, v30, v31
 v_lshlrev_b32 v28, 16, v116
 v_and_b32 v29, s34, v116
 v_lshlrev_b32 v30, 16, v117
 v_and_b32 v31, s34, v117
 v_max_f32 v28, 0, v28
 v_max_f32 v29, 0, v29
 v_max_f32 v30, 0, v30
 v_max_f32 v31, 0, v31
 v_pk_mul_f32 v[28:29], v[28:29], v[28:29]
 v_pk_mul_f32 v[30:31], v[30:31], v[30:31]
 v_cvt_pk_bf16_f32 v52, v28, v29
 v_cvt_pk_bf16_f32 v53, v30, v31
 v_lshlrev_b32 v112, 16, v110
 v_and_b32 v113, s34, v110
 v_lshlrev_b32 v114, 16, v111
 v_and_b32 v115, s34, v111
 v_cvt_pk_bf16_f32 v116, v32, v33
 v_cvt_pk_bf16_f32 v117, v34, v35
 v_lshlrev_b32 v32, 16, v116
 v_and_b32 v33, s34, v116
 v_lshlrev_b32 v34, 16, v117
 v_and_b32 v35, s34, v117
 v_pk_add_f32 v[32:33], v[32:33], v[112:113]
 v_pk_add_f32 v[34:35], v[34:35], v[114:115]
 v_cvt_pk_bf16_f32 v116, v32, v33
 v_cvt_pk_bf16_f32 v117, v34, v35
 v_lshlrev_b32 v32, 16, v116
 v_and_b32 v33, s34, v116
 v_lshlrev_b32 v34, 16, v117
 v_and_b32 v35, s34, v117
 v_max_f32 v32, 0, v32
 v_max_f32 v33, 0, v33
 v_max_f32 v34, 0, v34
 v_max_f32 v35, 0, v35
 v_pk_mul_f32 v[32:33], v[32:33], v[32:33]
 v_pk_mul_f32 v[34:35], v[34:35], v[34:35]
 v_cvt_pk_bf16_f32 v50, v32, v33
 v_cvt_pk_bf16_f32 v51, v34, v35
 v_cvt_pk_bf16_f32 v116, v36, v37
 v_cvt_pk_bf16_f32 v117, v38, v39
 v_lshlrev_b32 v36, 16, v116
 v_and_b32 v37, s34, v116
 v_lshlrev_b32 v38, 16, v117
 v_and_b32 v39, s34, v117
 v_pk_add_f32 v[36:37], v[36:37], v[112:113]
 v_pk_add_f32 v[38:39], v[38:39], v[114:115]
 v_cvt_pk_bf16_f32 v116, v36, v37
 v_cvt_pk_bf16_f32 v117, v38, v39
 v_lshlrev_b32 v36, 16, v116
 v_and_b32 v37, s34, v116
 v_lshlrev_b32 v38, 16, v117
 v_and_b32 v39, s34, v117
 v_max_f32 v36, 0, v36
 v_max_f32 v37, 0, v37
 v_max_f32 v38, 0, v38
 v_max_f32 v39, 0, v39
 v_pk_mul_f32 v[36:37], v[36:37], v[36:37]
 v_pk_mul_f32 v[38:39], v[38:39], v[38:39]
 v_cvt_pk_bf16_f32 v54, v36, v37
 v_cvt_pk_bf16_f32 v55, v38, v39
 v_add_u32 v92, s29, v92
 s_waitcnt lgkmcnt(0)
 v_mfma_f32_16x16x32_bf16 a[0:3], v[56:59], v[40:43], a[0:3]
 ds_read_b64_tr_b16 v[72:73], v100 offset:12288
 v_mfma_f32_16x16x32_bf16 a[4:7], v[56:59], v[44:47], a[4:7]
 ds_read_b64_tr_b16 v[74:75], v100 offset:14336
 v_mfma_f32_16x16x32_bf16 a[8:11], v[60:63], v[40:43], a[8:11]
 ds_read_b64_tr_b16 v[76:77], v101 offset:12288
 v_mfma_f32_16x16x32_bf16 a[12:15], v[60:63], v[44:47], a[12:15]
 ds_read_b64_tr_b16 v[78:79], v101 offset:14336
 v_mfma_f32_16x16x32_bf16 a[16:19], v[64:67], v[40:43], a[16:19]
 ds_read_b64_tr_b16 v[80:81], v102 offset:12288
 v_mfma_f32_16x16x32_bf16 a[20:23], v[64:67], v[44:47], a[20:23]
 ds_read_b64_tr_b16 v[82:83], v102 offset:14336
 v_mfma_f32_16x16x32_bf16 a[24:27], v[68:71], v[40:43], a[24:27]
 ds_read_b64_tr_b16 v[84:85], v103 offset:12288
 v_mfma_f32_16x16x32_bf16 a[28:31], v[68:71], v[44:47], a[28:31]
 ds_read_b64_tr_b16 v[86:87], v103 offset:14336
 s_waitcnt lgkmcnt(0)
 v_mfma_f32_16x16x32_bf16 a[0:3], v[72:75], v[48:51], a[0:3]
 v_mfma_f32_16x16x32_bf16 a[4:7], v[72:75], v[52:55], a[4:7]
 v_mfma_f32_16x16x32_bf16 a[8:11], v[76:79], v[48:51], a[8:11]
 v_mfma_f32_16x16x32_bf16 a[12:15], v[76:79], v[52:55], a[12:15]
 v_mfma_f32_16x16x32_bf16 a[16:19], v[80:83], v[48:51], a[16:19]
 v_mfma_f32_16x16x32_bf16 a[20:23], v[80:83], v[52:55], a[20:23]
 v_mfma_f32_16x16x32_bf16 a[24:27], v[84:87], v[48:51], a[24:27]
 v_mfma_f32_16x16x32_bf16 a[28:31], v[84:87], v[52:55], a[28:31]
 s_waitcnt vmcnt(16)
 ds_read_b64_tr_b16 v[56:57], v100 offset:16384
 ds_read_b64_tr_b16 v[58:59], v100 offset:18432
 ds_read_b64_tr_b16 v[60:61], v101 offset:16384
 ds_read_b64_tr_b16 v[62:63], v101 offset:18432
 ds_read_b64_tr_b16 v[64:65], v102 offset:16384
 ds_read_b64_tr_b16 v[66:67], v102 offset:18432
 ds_read_b64_tr_b16 v[68:69], v103 offset:16384
 ds_read_b64_tr_b16 v[70:71], v103 offset:18432
 s_add_u32 m0, s26, 8192
 s_add_u32 s13, s21, 512
 buffer_load_dwordx4 v91, s[84:87], s13 offen lds
 s_add_u32 m0, s26, 9216
 s_add_u32 s13, s21, 7680
 buffer_load_dwordx4 v91, s[84:87], s13 offen lds
 s_add_u32 m0, s26, 10240
 s_add_u32 s13, s21, 14848
 buffer_load_dwordx4 v91, s[84:87], s13 offen lds
 s_add_u32 m0, s26, 11264
 s_add_u32 s13, s21, 22016
 buffer_load_dwordx4 v91, s[84:87], s13 offen lds
 s_add_u32 m0, s26, 12288
 s_add_u32 s13, s21, 29184
 buffer_load_dwordx4 v91, s[84:87], s13 offen lds
 s_add_u32 m0, s26, 13312
 s_add_u32 s13, s21, 36352
 buffer_load_dwordx4 v91, s[84:87], s13 offen lds
 s_add_u32 m0, s26, 14336
 s_add_u32 s13, s21, 43520
 buffer_load_dwordx4 v91, s[84:87], s13 offen lds
 s_add_u32 m0, s26, 15360
 s_add_u32 s13, s21, 50688
 buffer_load_dwordx4 v91, s[84:87], s13 offen lds
 s_waitcnt lgkmcnt(0)
 v_mfma_f32_16x16x32_bf16 a[32:35], v[56:59], v[40:43], a[32:35]
 ds_read_b64_tr_b16 v[72:73], v100 offset:20480
 v_mfma_f32_16x16x32_bf16 a[36:39], v[56:59], v[44:47], a[36:39]
 ds_read_b64_tr_b16 v[74:75], v100 offset:22528
 v_mfma_f32_16x16x32_bf16 a[40:43], v[60:63], v[40:43], a[40:43]
 ds_read_b64_tr_b16 v[76:77], v101 offset:20480
 v_mfma_f32_16x16x32_bf16 a[44:47], v[60:63], v[44:47], a[44:47]
 ds_read_b64_tr_b16 v[78:79], v101 offset:22528
 v_mfma_f32_16x16x32_bf16 a[48:51], v[64:67], v[40:43], a[48:51]
 ds_read_b64_tr_b16 v[80:81], v102 offset:20480
 v_mfma_f32_16x16x32_bf16 a[52:55], v[64:67], v[44:47], a[52:55]
 ds_read_b64_tr_b16 v[82:83], v102 offset:22528
 v_mfma_f32_16x16x32_bf16 a[56:59], v[68:71], v[40:43], a[56:59]
 ds_read_b64_tr_b16 v[84:85], v103 offset:20480
 v_mfma_f32_16x16x32_bf16 a[60:63], v[68:71], v[44:47], a[60:63]
 ds_read_b64_tr_b16 v[86:87], v103 offset:22528
 s_waitcnt lgkmcnt(0)
 v_mfma_f32_16x16x32_bf16 a[32:35], v[72:75], v[48:51], a[32:35]
 v_mfma_f32_16x16x32_bf16 a[36:39], v[72:75], v[52:55], a[36:39]
 v_mfma_f32_16x16x32_bf16 a[40:43], v[76:79], v[48:51], a[40:43]
 v_mfma_f32_16x16x32_bf16 a[44:47], v[76:79], v[52:55], a[44:47]
 v_mfma_f32_16x16x32_bf16 a[48:51], v[80:83], v[48:51], a[48:51]
 v_mfma_f32_16x16x32_bf16 a[52:55], v[80:83], v[52:55], a[52:55]
 v_mfma_f32_16x16x32_bf16 a[56:59], v[84:87], v[48:51], a[56:59]
 v_mfma_f32_16x16x32_bf16 a[60:63], v[84:87], v[52:55], a[60:63]
 s_waitcnt vmcnt(16)
 ds_read_b64_tr_b16 v[56:57], v100 offset:24576
 ds_read_b64_tr_b16 v[58:59], v100 offset:26624
 ds_read_b64_tr_b16 v[60:61], v101 offset:24576
 ds_read_b64_tr_b16 v[62:63], v101 offset:26624
 ds_read_b64_tr_b16 v[64:65], v102 offset:24576
 ds_read_b64_tr_b16 v[66:67], v102 offset:26624
 ds_read_b64_tr_b16 v[68:69], v103 offset:24576
 ds_read_b64_tr_b16 v[70:71], v103 offset:26624
 s_add_u32 m0, s26, 16384
 s_add_u32 s13, s21, 640
 buffer_load_dwordx4 v91, s[84:87], s13 offen lds
 s_add_u32 m0, s26, 17408
 s_add_u32 s13, s21, 7808
 buffer_load_dwordx4 v91, s[84:87], s13 offen lds
 s_add_u32 m0, s26, 18432
 s_add_u32 s13, s21, 14976
 buffer_load_dwordx4 v91, s[84:87], s13 offen lds
 s_add_u32 m0, s26, 19456
 s_add_u32 s13, s21, 22144
 buffer_load_dwordx4 v91, s[84:87], s13 offen lds
 s_add_u32 m0, s26, 20480
 s_add_u32 s13, s21, 29312
 buffer_load_dwordx4 v91, s[84:87], s13 offen lds
 s_add_u32 m0, s26, 21504
 s_add_u32 s13, s21, 36480
 buffer_load_dwordx4 v91, s[84:87], s13 offen lds
 s_add_u32 m0, s26, 22528
 s_add_u32 s13, s21, 43648
 buffer_load_dwordx4 v91, s[84:87], s13 offen lds
 s_add_u32 m0, s26, 23552
 s_add_u32 s13, s21, 50816
 buffer_load_dwordx4 v91, s[84:87], s13 offen lds
 s_waitcnt lgkmcnt(0)
 v_mfma_f32_16x16x32_bf16 a[64:67], v[56:59], v[40:43], a[64:67]
 ds_read_b64_tr_b16 v[72:73], v100 offset:28672
 v_mfma_f32_16x16x32_bf16 a[68:71], v[56:59], v[44:47], a[68:71]
 ds_read_b64_tr_b16 v[74:75], v100 offset:30720
 v_mfma_f32_16x16x32_bf16 a[72:75], v[60:63], v[40:43], a[72:75]
 ds_read_b64_tr_b16 v[76:77], v101 offset:28672
 v_mfma_f32_16x16x32_bf16 a[76:79], v[60:63], v[44:47], a[76:79]
 ds_read_b64_tr_b16 v[78:79], v101 offset:30720
 v_mfma_f32_16x16x32_bf16 a[80:83], v[64:67], v[40:43], a[80:83]
 ds_read_b64_tr_b16 v[80:81], v102 offset:28672
 v_mfma_f32_16x16x32_bf16 a[84:87], v[64:67], v[44:47], a[84:87]
 ds_read_b64_tr_b16 v[82:83], v102 offset:30720
 v_mfma_f32_16x16x32_bf16 a[88:91], v[68:71], v[40:43], a[88:91]
 ds_read_b64_tr_b16 v[84:85], v103 offset:28672
 v_mfma_f32_16x16x32_bf16 a[92:95], v[68:71], v[44:47], a[92:95]
 ds_read_b64_tr_b16 v[86:87], v103 offset:30720
 s_waitcnt lgkmcnt(0)
 v_mfma_f32_16x16x32_bf16 a[64:67], v[72:75], v[48:51], a[64:67]
 v_mfma_f32_16x16x32_bf16 a[68:71], v[72:75], v[52:55], a[68:71]
 v_mfma_f32_16x16x32_bf16 a[72:75], v[76:79], v[48:51], a[72:75]
 v_mfma_f32_16x16x32_bf16 a[76:79], v[76:79], v[52:55], a[76:79]
 v_mfma_f32_16x16x32_bf16 a[80:83], v[80:83], v[48:51], a[80:83]
 v_mfma_f32_16x16x32_bf16 a[84:87], v[80:83], v[52:55], a[84:87]
 v_mfma_f32_16x16x32_bf16 a[88:91], v[84:87], v[48:51], a[88:91]
 v_mfma_f32_16x16x32_bf16 a[92:95], v[84:87], v[52:55], a[92:95]
 s_waitcnt vmcnt(16)
 ds_read_b64_tr_b16 v[56:57], v100
 ds_read_b64_tr_b16 v[58:59], v100 offset:2048
 ds_read_b64_tr_b16 v[60:61], v101
 ds_read_b64_tr_b16 v[62:63], v101 offset:2048
 ds_read_b64_tr_b16 v[64:65], v102
 ds_read_b64_tr_b16 v[66:67], v102 offset:2048
 ds_read_b64_tr_b16 v[68:69], v103
 ds_read_b64_tr_b16 v[70:71], v103 offset:2048
 s_add_u32 m0, s26, 24576
 s_add_u32 s13, s21, 768
 buffer_load_dwordx4 v91, s[84:87], s13 offen lds
 s_add_u32 m0, s26, 25600
 s_add_u32 s13, s21, 7936
 buffer_load_dwordx4 v91, s[84:87], s13 offen lds
 s_add_u32 m0, s26, 26624
 s_add_u32 s13, s21, 15104
 buffer_load_dwordx4 v91, s[84:87], s13 offen lds
 s_add_u32 m0, s26, 27648
 s_add_u32 s13, s21, 22272
 buffer_load_dwordx4 v91, s[84:87], s13 offen lds
 s_add_u32 m0, s26, 28672
 s_add_u32 s13, s21, 29440
 buffer_load_dwordx4 v91, s[84:87], s13 offen lds
 s_add_u32 m0, s26, 29696
 s_add_u32 s13, s21, 36608
 buffer_load_dwordx4 v91, s[84:87], s13 offen lds
 s_add_u32 m0, s26, 30720
 s_add_u32 s13, s21, 43776
 buffer_load_dwordx4 v91, s[84:87], s13 offen lds
 s_add_u32 m0, s26, 31744
 s_add_u32 s13, s21, 50944
 buffer_load_dwordx4 v91, s[84:87], s13 offen lds
 s_waitcnt lgkmcnt(0)
 v_mfma_f32_16x16x32_bf16 a[96:99], v[56:59], v[40:43], a[96:99]
 ds_read_b64_tr_b16 v[72:73], v100 offset:4096
 v_mfma_f32_16x16x32_bf16 a[100:103], v[56:59], v[44:47], a[100:103]
 ds_read_b64_tr_b16 v[74:75], v100 offset:6144
 v_mfma_f32_16x16x32_bf16 a[104:107], v[60:63], v[40:43], a[104:107]
 ds_read_b64_tr_b16 v[76:77], v101 offset:4096
 v_mfma_f32_16x16x32_bf16 a[108:111], v[60:63], v[44:47], a[108:111]
 ds_read_b64_tr_b16 v[78:79], v101 offset:6144
 v_mfma_f32_16x16x32_bf16 a[112:115], v[64:67], v[40:43], a[112:115]
 ds_read_b64_tr_b16 v[80:81], v102 offset:4096
 v_mfma_f32_16x16x32_bf16 a[116:119], v[64:67], v[44:47], a[116:119]
 ds_read_b64_tr_b16 v[82:83], v102 offset:6144
 v_mfma_f32_16x16x32_bf16 a[120:123], v[68:71], v[40:43], a[120:123]
 ds_read_b64_tr_b16 v[84:85], v103 offset:4096
 v_mfma_f32_16x16x32_bf16 a[124:127], v[68:71], v[44:47], a[124:127]
 ds_read_b64_tr_b16 v[86:87], v103 offset:6144
 s_waitcnt lgkmcnt(0)
 v_mfma_f32_16x16x32_bf16 a[96:99], v[72:75], v[48:51], a[96:99]
 v_mfma_f32_16x16x32_bf16 a[100:103], v[72:75], v[52:55], a[100:103]
 v_mfma_f32_16x16x32_bf16 a[104:107], v[76:79], v[48:51], a[104:107]
 v_mfma_f32_16x16x32_bf16 a[108:111], v[76:79], v[52:55], a[108:111]
 v_mfma_f32_16x16x32_bf16 a[112:115], v[80:83], v[48:51], a[112:115]
 v_mfma_f32_16x16x32_bf16 a[116:119], v[80:83], v[52:55], a[116:119]
 v_mfma_f32_16x16x32_bf16 a[120:123], v[84:87], v[48:51], a[120:123]
 v_mfma_f32_16x16x32_bf16 a[124:127], v[84:87], v[52:55], a[124:127]
 s_waitcnt vmcnt(16)
 ds_read_b64_tr_b16 v[56:57], v100 offset:8192
 ds_read_b64_tr_b16 v[58:59], v100 offset:10240
 ds_read_b64_tr_b16 v[60:61], v101 offset:8192
 ds_read_b64_tr_b16 v[62:63], v101 offset:10240
 ds_read_b64_tr_b16 v[64:65], v102 offset:8192
 ds_read_b64_tr_b16 v[66:67], v102 offset:10240
 ds_read_b64_tr_b16 v[68:69], v103 offset:8192
 ds_read_b64_tr_b16 v[70:71], v103 offset:10240
 s_add_u32 m0, s26, 0
 s_add_u32 s13, s28, 0
 buffer_load_dwordx4 v89, s[80:83], s13 offen lds
 s_add_u32 m0, s26, 1024
 s_add_u32 s13, s28, 28672
 buffer_load_dwordx4 v90, s[80:83], s13 offen lds
 s_add_u32 m0, s26, 2048
 s_add_u32 s13, s28, 57344
 buffer_load_dwordx4 v89, s[80:83], s13 offen lds
 s_add_u32 m0, s26, 3072
 s_add_u32 s13, s28, 86016
 buffer_load_dwordx4 v90, s[80:83], s13 offen lds
 s_add_u32 m0, s26, 4096
 s_add_u32 s13, s28, 114688
 buffer_load_dwordx4 v89, s[80:83], s13 offen lds
 s_add_u32 m0, s26, 5120
 s_add_u32 s13, s28, 143360
 buffer_load_dwordx4 v90, s[80:83], s13 offen lds
 s_add_u32 m0, s26, 6144
 s_add_u32 s13, s28, 172032
 buffer_load_dwordx4 v89, s[80:83], s13 offen lds
 s_add_u32 m0, s26, 7168
 s_add_u32 s13, s28, 200704
 buffer_load_dwordx4 v90, s[80:83], s13 offen lds
 s_waitcnt lgkmcnt(0)
 v_mfma_f32_16x16x32_bf16 a[128:131], v[56:59], v[40:43], a[128:131]
 ds_read_b64_tr_b16 v[72:73], v100 offset:12288
 v_mfma_f32_16x16x32_bf16 a[132:135], v[56:59], v[44:47], a[132:135]
 ds_read_b64_tr_b16 v[74:75], v100 offset:14336
 v_mfma_f32_16x16x32_bf16 a[136:139], v[60:63], v[40:43], a[136:139]
 ds_read_b64_tr_b16 v[76:77], v101 offset:12288
 v_mfma_f32_16x16x32_bf16 a[140:143], v[60:63], v[44:47], a[140:143]
 ds_read_b64_tr_b16 v[78:79], v101 offset:14336
 v_mfma_f32_16x16x32_bf16 a[144:147], v[64:67], v[40:43], a[144:147]
 ds_read_b64_tr_b16 v[80:81], v102 offset:12288
 v_mfma_f32_16x16x32_bf16 a[148:151], v[64:67], v[44:47], a[148:151]
 ds_read_b64_tr_b16 v[82:83], v102 offset:14336
 v_mfma_f32_16x16x32_bf16 a[152:155], v[68:71], v[40:43], a[152:155]
 ds_read_b64_tr_b16 v[84:85], v103 offset:12288
 v_mfma_f32_16x16x32_bf16 a[156:159], v[68:71], v[44:47], a[156:159]
 ds_read_b64_tr_b16 v[86:87], v103 offset:14336
 s_waitcnt lgkmcnt(0)
 v_mfma_f32_16x16x32_bf16 a[128:131], v[72:75], v[48:51], a[128:131]
 v_mfma_f32_16x16x32_bf16 a[132:135], v[72:75], v[52:55], a[132:135]
 v_mfma_f32_16x16x32_bf16 a[136:139], v[76:79], v[48:51], a[136:139]
 v_mfma_f32_16x16x32_bf16 a[140:143], v[76:79], v[52:55], a[140:143]
 v_mfma_f32_16x16x32_bf16 a[144:147], v[80:83], v[48:51], a[144:147]
 v_mfma_f32_16x16x32_bf16 a[148:151], v[80:83], v[52:55], a[148:151]
 v_mfma_f32_16x16x32_bf16 a[152:155], v[84:87], v[48:51], a[152:155]
 v_mfma_f32_16x16x32_bf16 a[156:159], v[84:87], v[52:55], a[156:159]
 s_waitcnt vmcnt(16)
 ds_read_b64_tr_b16 v[56:57], v100 offset:16384
 ds_read_b64_tr_b16 v[58:59], v100 offset:18432
 ds_read_b64_tr_b16 v[60:61], v101 offset:16384
 ds_read_b64_tr_b16 v[62:63], v101 offset:18432
 ds_read_b64_tr_b16 v[64:65], v102 offset:16384
 ds_read_b64_tr_b16 v[66:67], v102 offset:18432
 ds_read_b64_tr_b16 v[68:69], v103 offset:16384
 ds_read_b64_tr_b16 v[70:71], v103 offset:18432
 s_add_u32 m0, s26, 8192
 s_add_u32 s13, s28, 229376
 buffer_load_dwordx4 v89, s[80:83], s13 offen lds
 s_add_u32 m0, s26, 9216
 s_add_u32 s13, s28, 258048
 buffer_load_dwordx4 v90, s[80:83], s13 offen lds
 s_add_u32 m0, s26, 10240
 s_add_u32 s13, s28, 286720
 buffer_load_dwordx4 v89, s[80:83], s13 offen lds
 s_add_u32 m0, s26, 11264
 s_add_u32 s13, s28, 315392
 buffer_load_dwordx4 v90, s[80:83], s13 offen lds
 s_add_u32 m0, s26, 12288
 s_add_u32 s13, s28, 344064
 buffer_load_dwordx4 v89, s[80:83], s13 offen lds
 s_add_u32 m0, s26, 13312
 s_add_u32 s13, s28, 372736
 buffer_load_dwordx4 v90, s[80:83], s13 offen lds
 s_add_u32 m0, s26, 14336
 s_add_u32 s13, s28, 401408
 buffer_load_dwordx4 v89, s[80:83], s13 offen lds
 s_add_u32 m0, s26, 15360
 s_add_u32 s13, s28, 430080
 buffer_load_dwordx4 v90, s[80:83], s13 offen lds
 s_waitcnt lgkmcnt(0)
 v_mfma_f32_16x16x32_bf16 a[160:163], v[56:59], v[40:43], a[160:163]
 ds_read_b64_tr_b16 v[72:73], v100 offset:20480
 v_mfma_f32_16x16x32_bf16 a[164:167], v[56:59], v[44:47], a[164:167]
 ds_read_b64_tr_b16 v[74:75], v100 offset:22528
 v_mfma_f32_16x16x32_bf16 a[168:171], v[60:63], v[40:43], a[168:171]
 ds_read_b64_tr_b16 v[76:77], v101 offset:20480
 v_mfma_f32_16x16x32_bf16 a[172:175], v[60:63], v[44:47], a[172:175]
 ds_read_b64_tr_b16 v[78:79], v101 offset:22528
 v_mfma_f32_16x16x32_bf16 a[176:179], v[64:67], v[40:43], a[176:179]
 ds_read_b64_tr_b16 v[80:81], v102 offset:20480
 v_mfma_f32_16x16x32_bf16 a[180:183], v[64:67], v[44:47], a[180:183]
 ds_read_b64_tr_b16 v[82:83], v102 offset:22528
 v_mfma_f32_16x16x32_bf16 a[184:187], v[68:71], v[40:43], a[184:187]
 ds_read_b64_tr_b16 v[84:85], v103 offset:20480
 v_mfma_f32_16x16x32_bf16 a[188:191], v[68:71], v[44:47], a[188:191]
 ds_read_b64_tr_b16 v[86:87], v103 offset:22528
 s_waitcnt lgkmcnt(0)
 v_mfma_f32_16x16x32_bf16 a[160:163], v[72:75], v[48:51], a[160:163]
 v_mfma_f32_16x16x32_bf16 a[164:167], v[72:75], v[52:55], a[164:167]
 v_mfma_f32_16x16x32_bf16 a[168:171], v[76:79], v[48:51], a[168:171]
 v_mfma_f32_16x16x32_bf16 a[172:175], v[76:79], v[52:55], a[172:175]
 v_mfma_f32_16x16x32_bf16 a[176:179], v[80:83], v[48:51], a[176:179]
 v_mfma_f32_16x16x32_bf16 a[180:183], v[80:83], v[52:55], a[180:183]
 v_mfma_f32_16x16x32_bf16 a[184:187], v[84:87], v[48:51], a[184:187]
 v_mfma_f32_16x16x32_bf16 a[188:191], v[84:87], v[52:55], a[188:191]
 s_waitcnt vmcnt(16)
 ds_read_b64_tr_b16 v[56:57], v100 offset:24576
 ds_read_b64_tr_b16 v[58:59], v100 offset:26624
 ds_read_b64_tr_b16 v[60:61], v101 offset:24576
 ds_read_b64_tr_b16 v[62:63], v101 offset:26624
 ds_read_b64_tr_b16 v[64:65], v102 offset:24576
 ds_read_b64_tr_b16 v[66:67], v102 offset:26624
 ds_read_b64_tr_b16 v[68:69], v103 offset:24576
 ds_read_b64_tr_b16 v[70:71], v103 offset:26624
 s_add_u32 m0, s26, 16384
 s_add_u32 s13, s28, 458752
 buffer_load_dwordx4 v89, s[80:83], s13 offen lds
 s_add_u32 m0, s26, 17408
 s_add_u32 s13, s28, 487424
 buffer_load_dwordx4 v90, s[80:83], s13 offen lds
 s_add_u32 m0, s26, 18432
 s_add_u32 s13, s28, 516096
 buffer_load_dwordx4 v89, s[80:83], s13 offen lds
 s_add_u32 m0, s26, 19456
 s_add_u32 s13, s28, 544768
 buffer_load_dwordx4 v90, s[80:83], s13 offen lds
 s_add_u32 m0, s26, 20480
 s_add_u32 s13, s28, 573440
 buffer_load_dwordx4 v89, s[80:83], s13 offen lds
 s_add_u32 m0, s26, 21504
 s_add_u32 s13, s28, 602112
 buffer_load_dwordx4 v90, s[80:83], s13 offen lds
 s_add_u32 m0, s26, 22528
 s_add_u32 s13, s28, 630784
 buffer_load_dwordx4 v89, s[80:83], s13 offen lds
 s_add_u32 m0, s26, 23552
 s_add_u32 s13, s28, 659456
 buffer_load_dwordx4 v90, s[80:83], s13 offen lds
 s_waitcnt lgkmcnt(0)
 v_mfma_f32_16x16x32_bf16 a[192:195], v[56:59], v[40:43], a[192:195]
 ds_read_b64_tr_b16 v[72:73], v100 offset:28672
 v_mfma_f32_16x16x32_bf16 a[196:199], v[56:59], v[44:47], a[196:199]
 ds_read_b64_tr_b16 v[74:75], v100 offset:30720
 v_mfma_f32_16x16x32_bf16 a[200:203], v[60:63], v[40:43], a[200:203]
 ds_read_b64_tr_b16 v[76:77], v101 offset:28672
 v_mfma_f32_16x16x32_bf16 a[204:207], v[60:63], v[44:47], a[204:207]
 ds_read_b64_tr_b16 v[78:79], v101 offset:30720
 v_mfma_f32_16x16x32_bf16 a[208:211], v[64:67], v[40:43], a[208:211]
 ds_read_b64_tr_b16 v[80:81], v102 offset:28672
 v_mfma_f32_16x16x32_bf16 a[212:215], v[64:67], v[44:47], a[212:215]
 ds_read_b64_tr_b16 v[82:83], v102 offset:30720
 v_mfma_f32_16x16x32_bf16 a[216:219], v[68:71], v[40:43], a[216:219]
 ds_read_b64_tr_b16 v[84:85], v103 offset:28672
 v_mfma_f32_16x16x32_bf16 a[220:223], v[68:71], v[44:47], a[220:223]
 ds_read_b64_tr_b16 v[86:87], v103 offset:30720
 s_waitcnt lgkmcnt(0)
 v_mfma_f32_16x16x32_bf16 a[192:195], v[72:75], v[48:51], a[192:195]
 v_mfma_f32_16x16x32_bf16 a[196:199], v[72:75], v[52:55], a[196:199]
 v_mfma_f32_16x16x32_bf16 a[200:203], v[76:79], v[48:51], a[200:203]
 v_mfma_f32_16x16x32_bf16 a[204:207], v[76:79], v[52:55], a[204:207]
 v_mfma_f32_16x16x32_bf16 a[208:211], v[80:83], v[48:51], a[208:211]
 v_mfma_f32_16x16x32_bf16 a[212:215], v[80:83], v[52:55], a[212:215]
 v_mfma_f32_16x16x32_bf16 a[216:219], v[84:87], v[48:51], a[216:219]
 v_mfma_f32_16x16x32_bf16 a[220:223], v[84:87], v[52:55], a[220:223]
 s_lshl_b32 s13, s27, 7
 s_add_u32 s20, s22, s13
 s_mul_i32 s13, s27, 57344
 s_add_u32 s21, s23, s13
 s_add_u32 s27, s27, 1
 s_mov_b32 s29, 128
 s_cmp_eq_u32 s27, 7
 s_cselect_b32 s27, 0, s27
 s_cselect_b32 s29, -768, s29
 s_lshl_b32 s13, s27, 7
 s_add_u32 s28, s22, s13
 s_add_u32 s30, s30, 1
 s_branch L_ffn_71
L_ffn_71_end:
 s_waitcnt vmcnt(0)
 s_barrier
 s_mul_i32 s13, s12, 28672
 v_add_u32 v3, s13, v88
 s_mul_i32 s13, s12, 7168
 v_add_u32 v4, s13, v88
 v_add_u32 v5, 57344, v4
 s_mul_i32 s13, s12, 224
 s_add_u32 s14, s13, 135168
 v_lshlrev_b32 v7, 3, v1
 v_add_u32 v92, s14, v7
 s_mul_i32 s13, s12, 7168
 v_lshlrev_b32 v6, 3, v0
 v_add_u32 v6, s13, v6
 s_mul_i32 s22, s11, 28672
 s_add_u32 s22, s22, 48496640
 s_add_u32 s23, s22, 4096
 s_mov_b32 s24, 0xbfb8aa3b
 ds_write_b128 v3, a[0:3]
 ds_write_b128 v3, a[8:11] offset:1024
 ds_write_b128 v3, a[16:19] offset:2048
 ds_write_b128 v3, a[24:27] offset:3072
 ds_write_b128 v3, a[32:35] offset:4096
 ds_write_b128 v3, a[40:43] offset:5120
 ds_write_b128 v3, a[48:51] offset:6144
 ds_write_b128 v3, a[56:59] offset:7168
 ds_write_b128 v3, a[64:67] offset:8192
 ds_write_b128 v3, a[72:75] offset:9216
 ds_write_b128 v3, a[80:83] offset:10240
 ds_write_b128 v3, a[88:91] offset:11264
 ds_write_b128 v3, a[96:99] offset:12288
 ds_write_b128 v3, a[104:107] offset:13312
 ds_write_b128 v3, a[112:115] offset:14336
 ds_write_b128 v3, a[120:123] offset:15360
 ds_write_b128 v3, a[128:131] offset:16384
 ds_write_b128 v3, a[136:139] offset:17408
 ds_write_b128 v3, a[144:147] offset:18432
 ds_write_b128 v3, a[152:155] offset:19456
 ds_write_b128 v3, a[160:163] offset:20480
 ds_write_b128 v3, a[168:171] offset:21504
 ds_write_b128 v3, a[176:179] offset:22528
 ds_write_b128 v3, a[184:187] offset:23552
 ds_write_b128 v3, a[192:195] offset:24576
 ds_write_b128 v3, a[200:203] offset:25600
 ds_write_b128 v3, a[208:211] offset:26624
 ds_write_b128 v3, a[216:219] offset:27648
 s_waitcnt lgkmcnt(0)
 s_barrier
 ds_read_b128 v[8:11], v4
 ds_read_b128 v[12:15], v4 offset:28672
 ds_read_b128 v[16:19], v5
 ds_read_b128 v[20:23], v5 offset:28672
 ds_read_b64 v[24:25], v92
 s_waitcnt lgkmcnt(0)
 v_pk_add_f32 v[8:9], v[8:9], v[12:13]
 v_pk_add_f32 v[10:11], v[10:11], v[14:15]
 v_pk_add_f32 v[16:17], v[16:17], v[20:21]
 v_pk_add_f32 v[18:19], v[18:19], v[22:23]
 v_pk_add_f32 v[8:9], v[8:9], v[16:17]
 v_pk_add_f32 v[10:11], v[10:11], v[18:19]
 v_lshlrev_b32 v16, 16, v24
 v_and_b32 v17, s34, v24
 v_lshlrev_b32 v18, 16, v25
 v_and_b32 v19, s34, v25
 v_cvt_pk_bf16_f32 v12, v8, v9
 v_cvt_pk_bf16_f32 v13, v10, v11
 v_lshlrev_b32 v8, 16, v12
 v_and_b32 v9, s34, v12
 v_lshlrev_b32 v10, 16, v13
 v_and_b32 v11, s34, v13
 v_pk_add_f32 v[8:9], v[8:9], v[16:17]
 v_pk_add_f32 v[10:11], v[10:11], v[18:19]
 v_cvt_pk_bf16_f32 v12, v8, v9
 v_cvt_pk_bf16_f32 v13, v10, v11
 v_lshlrev_b32 v8, 16, v12
 v_and_b32 v9, s34, v12
 v_lshlrev_b32 v10, 16, v13
 v_and_b32 v11, s34, v13
 v_mul_f32 v12, s24, v8
 v_mul_f32 v13, s24, v9
 v_mul_f32 v14, s24, v10
 v_mul_f32 v15, s24, v11
 v_exp_f32 v12, v12
 v_exp_f32 v13, v13
 v_exp_f32 v14, v14
 v_exp_f32 v15, v15
 v_add_f32 v12, 1.0, v12
 v_add_f32 v13, 1.0, v13
 v_add_f32 v14, 1.0, v14
 v_add_f32 v15, 1.0, v15
 v_rcp_f32 v12, v12
 v_rcp_f32 v13, v13
 v_rcp_f32 v14, v14
 v_rcp_f32 v15, v15
 v_mul_f32 v8, v8, v12
 v_mul_f32 v9, v9, v13
 v_mul_f32 v10, v10, v14
 v_mul_f32 v11, v11, v15
 v_cvt_pk_bf16_f32 v26, v8, v9
 v_cvt_pk_bf16_f32 v27, v10, v11
 buffer_store_dwordx2 v[26:27], v6, s[64:67], s22 offen sc1
 ds_read_b128 v[8:11], v4 offset:1024
 ds_read_b128 v[12:15], v4 offset:29696
 ds_read_b128 v[16:19], v5 offset:1024
 ds_read_b128 v[20:23], v5 offset:29696
 ds_read_b64 v[24:25], v92 offset:32
 s_waitcnt lgkmcnt(0)
 v_pk_add_f32 v[8:9], v[8:9], v[12:13]
 v_pk_add_f32 v[10:11], v[10:11], v[14:15]
 v_pk_add_f32 v[16:17], v[16:17], v[20:21]
 v_pk_add_f32 v[18:19], v[18:19], v[22:23]
 v_pk_add_f32 v[8:9], v[8:9], v[16:17]
 v_pk_add_f32 v[10:11], v[10:11], v[18:19]
 v_lshlrev_b32 v16, 16, v24
 v_and_b32 v17, s34, v24
 v_lshlrev_b32 v18, 16, v25
 v_and_b32 v19, s34, v25
 v_cvt_pk_bf16_f32 v12, v8, v9
 v_cvt_pk_bf16_f32 v13, v10, v11
 v_lshlrev_b32 v8, 16, v12
 v_and_b32 v9, s34, v12
 v_lshlrev_b32 v10, 16, v13
 v_and_b32 v11, s34, v13
 v_pk_add_f32 v[8:9], v[8:9], v[16:17]
 v_pk_add_f32 v[10:11], v[10:11], v[18:19]
 v_cvt_pk_bf16_f32 v12, v8, v9
 v_cvt_pk_bf16_f32 v13, v10, v11
 v_lshlrev_b32 v8, 16, v12
 v_and_b32 v9, s34, v12
 v_lshlrev_b32 v10, 16, v13
 v_and_b32 v11, s34, v13
 v_mul_f32 v12, s24, v8
 v_mul_f32 v13, s24, v9
 v_mul_f32 v14, s24, v10
 v_mul_f32 v15, s24, v11
 v_exp_f32 v12, v12
 v_exp_f32 v13, v13
 v_exp_f32 v14, v14
 v_exp_f32 v15, v15
 v_add_f32 v12, 1.0, v12
 v_add_f32 v13, 1.0, v13
 v_add_f32 v14, 1.0, v14
 v_add_f32 v15, 1.0, v15
 v_rcp_f32 v12, v12
 v_rcp_f32 v13, v13
 v_rcp_f32 v14, v14
 v_rcp_f32 v15, v15
 v_mul_f32 v8, v8, v12
 v_mul_f32 v9, v9, v13
 v_mul_f32 v10, v10, v14
 v_mul_f32 v11, v11, v15
 v_cvt_pk_bf16_f32 v28, v8, v9
 v_cvt_pk_bf16_f32 v29, v10, v11
 buffer_store_dwordx2 v[28:29], v6, s[64:67], s22 offen offset:1024 sc1
 ds_read_b128 v[8:11], v4 offset:2048
 ds_read_b128 v[12:15], v4 offset:30720
 ds_read_b128 v[16:19], v5 offset:2048
 ds_read_b128 v[20:23], v5 offset:30720
 ds_read_b64 v[24:25], v92 offset:64
 s_waitcnt lgkmcnt(0)
 v_pk_add_f32 v[8:9], v[8:9], v[12:13]
 v_pk_add_f32 v[10:11], v[10:11], v[14:15]
 v_pk_add_f32 v[16:17], v[16:17], v[20:21]
 v_pk_add_f32 v[18:19], v[18:19], v[22:23]
 v_pk_add_f32 v[8:9], v[8:9], v[16:17]
 v_pk_add_f32 v[10:11], v[10:11], v[18:19]
 v_lshlrev_b32 v16, 16, v24
 v_and_b32 v17, s34, v24
 v_lshlrev_b32 v18, 16, v25
 v_and_b32 v19, s34, v25
 v_cvt_pk_bf16_f32 v12, v8, v9
 v_cvt_pk_bf16_f32 v13, v10, v11
 v_lshlrev_b32 v8, 16, v12
 v_and_b32 v9, s34, v12
 v_lshlrev_b32 v10, 16, v13
 v_and_b32 v11, s34, v13
 v_pk_add_f32 v[8:9], v[8:9], v[16:17]
 v_pk_add_f32 v[10:11], v[10:11], v[18:19]
 v_cvt_pk_bf16_f32 v12, v8, v9
 v_cvt_pk_bf16_f32 v13, v10, v11
 v_lshlrev_b32 v8, 16, v12
 v_and_b32 v9, s34, v12
 v_lshlrev_b32 v10, 16, v13
 v_and_b32 v11, s34, v13
 v_mul_f32 v12, s24, v8
 v_mul_f32 v13, s24, v9
 v_mul_f32 v14, s24, v10
 v_mul_f32 v15, s24, v11
 v_exp_f32 v12, v12
 v_exp_f32 v13, v13
 v_exp_f32 v14, v14
 v_exp_f32 v15, v15
 v_add_f32 v12, 1.0, v12
 v_add_f32 v13, 1.0, v13
 v_add_f32 v14, 1.0, v14
 v_add_f32 v15, 1.0, v15
 v_rcp_f32 v12, v12
 v_rcp_f32 v13, v13
 v_rcp_f32 v14, v14
 v_rcp_f32 v15, v15
 v_mul_f32 v8, v8, v12
 v_mul_f32 v9, v9, v13
 v_mul_f32 v10, v10, v14
 v_mul_f32 v11, v11, v15
 v_cvt_pk_bf16_f32 v26, v8, v9
 v_cvt_pk_bf16_f32 v27, v10, v11
 buffer_store_dwordx2 v[26:27], v6, s[64:67], s22 offen offset:2048 sc1
 ds_read_b128 v[8:11], v4 offset:3072
 ds_read_b128 v[12:15], v4 offset:31744
 ds_read_b128 v[16:19], v5 offset:3072
 ds_read_b128 v[20:23], v5 offset:31744
 ds_read_b64 v[24:25], v92 offset:96
 s_waitcnt lgkmcnt(0)
 v_pk_add_f32 v[8:9], v[8:9], v[12:13]
 v_pk_add_f32 v[10:11], v[10:11], v[14:15]
 v_pk_add_f32 v[16:17], v[16:17], v[20:21]
 v_pk_add_f32 v[18:19], v[18:19], v[22:23]
 v_pk_add_f32 v[8:9], v[8:9], v[16:17]
 v_pk_add_f32 v[10:11], v[10:11], v[18:19]
 v_lshlrev_b32 v16, 16, v24
 v_and_b32 v17, s34, v24
 v_lshlrev_b32 v18, 16, v25
 v_and_b32 v19, s34, v25
 v_cvt_pk_bf16_f32 v12, v8, v9
 v_cvt_pk_bf16_f32 v13, v10, v11
 v_lshlrev_b32 v8, 16, v12
 v_and_b32 v9, s34, v12
 v_lshlrev_b32 v10, 16, v13
 v_and_b32 v11, s34, v13
 v_pk_add_f32 v[8:9], v[8:9], v[16:17]
 v_pk_add_f32 v[10:11], v[10:11], v[18:19]
 v_cvt_pk_bf16_f32 v12, v8, v9
 v_cvt_pk_bf16_f32 v13, v10, v11
 v_lshlrev_b32 v8, 16, v12
 v_and_b32 v9, s34, v12
 v_lshlrev_b32 v10, 16, v13
 v_and_b32 v11, s34, v13
 v_mul_f32 v12, s24, v8
 v_mul_f32 v13, s24, v9
 v_mul_f32 v14, s24, v10
 v_mul_f32 v15, s24, v11
 v_exp_f32 v12, v12
 v_exp_f32 v13, v13
 v_exp_f32 v14, v14
 v_exp_f32 v15, v15
 v_add_f32 v12, 1.0, v12
 v_add_f32 v13, 1.0, v13
 v_add_f32 v14, 1.0, v14
 v_add_f32 v15, 1.0, v15
 v_rcp_f32 v12, v12
 v_rcp_f32 v13, v13
 v_rcp_f32 v14, v14
 v_rcp_f32 v15, v15
 v_mul_f32 v8, v8, v12
 v_mul_f32 v9, v9, v13
 v_mul_f32 v10, v10, v14
 v_mul_f32 v11, v11, v15
 v_cvt_pk_bf16_f32 v28, v8, v9
 v_cvt_pk_bf16_f32 v29, v10, v11
 buffer_store_dwordx2 v[28:29], v6, s[64:67], s22 offen offset:3072 sc1
 ds_read_b128 v[8:11], v4 offset:4096
 ds_read_b128 v[12:15], v4 offset:32768
 ds_read_b128 v[16:19], v5 offset:4096
 ds_read_b128 v[20:23], v5 offset:32768
 ds_read_b64 v[24:25], v92 offset:128
 s_waitcnt lgkmcnt(0)
 v_pk_add_f32 v[8:9], v[8:9], v[12:13]
 v_pk_add_f32 v[10:11], v[10:11], v[14:15]
 v_pk_add_f32 v[16:17], v[16:17], v[20:21]
 v_pk_add_f32 v[18:19], v[18:19], v[22:23]
 v_pk_add_f32 v[8:9], v[8:9], v[16:17]
 v_pk_add_f32 v[10:11], v[10:11], v[18:19]
 v_lshlrev_b32 v16, 16, v24
 v_and_b32 v17, s34, v24
 v_lshlrev_b32 v18, 16, v25
 v_and_b32 v19, s34, v25
 v_cvt_pk_bf16_f32 v12, v8, v9
 v_cvt_pk_bf16_f32 v13, v10, v11
 v_lshlrev_b32 v8, 16, v12
 v_and_b32 v9, s34, v12
 v_lshlrev_b32 v10, 16, v13
 v_and_b32 v11, s34, v13
 v_pk_add_f32 v[8:9], v[8:9], v[16:17]
 v_pk_add_f32 v[10:11], v[10:11], v[18:19]
 v_cvt_pk_bf16_f32 v12, v8, v9
 v_cvt_pk_bf16_f32 v13, v10, v11
 v_lshlrev_b32 v8, 16, v12
 v_and_b32 v9, s34, v12
 v_lshlrev_b32 v10, 16, v13
 v_and_b32 v11, s34, v13
 v_mul_f32 v12, s24, v8
 v_mul_f32 v13, s24, v9
 v_mul_f32 v14, s24, v10
 v_mul_f32 v15, s24, v11
 v_exp_f32 v12, v12
 v_exp_f32 v13, v13
 v_exp_f32 v14, v14
 v_exp_f32 v15, v15
 v_add_f32 v12, 1.0, v12
 v_add_f32 v13, 1.0, v13
 v_add_f32 v14, 1.0, v14
 v_add_f32 v15, 1.0, v15
 v_rcp_f32 v12, v12
 v_rcp_f32 v13, v13
 v_rcp_f32 v14, v14
 v_rcp_f32 v15, v15
 v_mul_f32 v8, v8, v12
 v_mul_f32 v9, v9, v13
 v_mul_f32 v10, v10, v14
 v_mul_f32 v11, v11, v15
 v_cvt_pk_bf16_f32 v26, v8, v9
 v_cvt_pk_bf16_f32 v27, v10, v11
 buffer_store_dwordx2 v[26:27], v6, s[64:67], s23 offen sc1
 ds_read_b128 v[8:11], v4 offset:5120
 ds_read_b128 v[12:15], v4 offset:33792
 ds_read_b128 v[16:19], v5 offset:5120
 ds_read_b128 v[20:23], v5 offset:33792
 ds_read_b64 v[24:25], v92 offset:160
 s_waitcnt lgkmcnt(0)
 v_pk_add_f32 v[8:9], v[8:9], v[12:13]
 v_pk_add_f32 v[10:11], v[10:11], v[14:15]
 v_pk_add_f32 v[16:17], v[16:17], v[20:21]
 v_pk_add_f32 v[18:19], v[18:19], v[22:23]
 v_pk_add_f32 v[8:9], v[8:9], v[16:17]
 v_pk_add_f32 v[10:11], v[10:11], v[18:19]
 v_lshlrev_b32 v16, 16, v24
 v_and_b32 v17, s34, v24
 v_lshlrev_b32 v18, 16, v25
 v_and_b32 v19, s34, v25
 v_cvt_pk_bf16_f32 v12, v8, v9
 v_cvt_pk_bf16_f32 v13, v10, v11
 v_lshlrev_b32 v8, 16, v12
 v_and_b32 v9, s34, v12
 v_lshlrev_b32 v10, 16, v13
 v_and_b32 v11, s34, v13
 v_pk_add_f32 v[8:9], v[8:9], v[16:17]
 v_pk_add_f32 v[10:11], v[10:11], v[18:19]
 v_cvt_pk_bf16_f32 v12, v8, v9
 v_cvt_pk_bf16_f32 v13, v10, v11
 v_lshlrev_b32 v8, 16, v12
 v_and_b32 v9, s34, v12
 v_lshlrev_b32 v10, 16, v13
 v_and_b32 v11, s34, v13
 v_mul_f32 v12, s24, v8
 v_mul_f32 v13, s24, v9
 v_mul_f32 v14, s24, v10
 v_mul_f32 v15, s24, v11
 v_exp_f32 v12, v12
 v_exp_f32 v13, v13
 v_exp_f32 v14, v14
 v_exp_f32 v15, v15
 v_add_f32 v12, 1.0, v12
 v_add_f32 v13, 1.0, v13
 v_add_f32 v14, 1.0, v14
 v_add_f32 v15, 1.0, v15
 v_rcp_f32 v12, v12
 v_rcp_f32 v13, v13
 v_rcp_f32 v14, v14
 v_rcp_f32 v15, v15
 v_mul_f32 v8, v8, v12
 v_mul_f32 v9, v9, v13
 v_mul_f32 v10, v10, v14
 v_mul_f32 v11, v11, v15
 v_cvt_pk_bf16_f32 v28, v8, v9
 v_cvt_pk_bf16_f32 v29, v10, v11
 buffer_store_dwordx2 v[28:29], v6, s[64:67], s23 offen offset:1024 sc1
 ds_read_b128 v[8:11], v4 offset:6144
 ds_read_b128 v[12:15], v4 offset:34816
 ds_read_b128 v[16:19], v5 offset:6144
 ds_read_b128 v[20:23], v5 offset:34816
 ds_read_b64 v[24:25], v92 offset:192
 s_waitcnt lgkmcnt(0)
 v_pk_add_f32 v[8:9], v[8:9], v[12:13]
 v_pk_add_f32 v[10:11], v[10:11], v[14:15]
 v_pk_add_f32 v[16:17], v[16:17], v[20:21]
 v_pk_add_f32 v[18:19], v[18:19], v[22:23]
 v_pk_add_f32 v[8:9], v[8:9], v[16:17]
 v_pk_add_f32 v[10:11], v[10:11], v[18:19]
 v_lshlrev_b32 v16, 16, v24
 v_and_b32 v17, s34, v24
 v_lshlrev_b32 v18, 16, v25
 v_and_b32 v19, s34, v25
 v_cvt_pk_bf16_f32 v12, v8, v9
 v_cvt_pk_bf16_f32 v13, v10, v11
 v_lshlrev_b32 v8, 16, v12
 v_and_b32 v9, s34, v12
 v_lshlrev_b32 v10, 16, v13
 v_and_b32 v11, s34, v13
 v_pk_add_f32 v[8:9], v[8:9], v[16:17]
 v_pk_add_f32 v[10:11], v[10:11], v[18:19]
 v_cvt_pk_bf16_f32 v12, v8, v9
 v_cvt_pk_bf16_f32 v13, v10, v11
 v_lshlrev_b32 v8, 16, v12
 v_and_b32 v9, s34, v12
 v_lshlrev_b32 v10, 16, v13
 v_and_b32 v11, s34, v13
 v_mul_f32 v12, s24, v8
 v_mul_f32 v13, s24, v9
 v_mul_f32 v14, s24, v10
 v_mul_f32 v15, s24, v11
 v_exp_f32 v12, v12
 v_exp_f32 v13, v13
 v_exp_f32 v14, v14
 v_exp_f32 v15, v15
 v_add_f32 v12, 1.0, v12
 v_add_f32 v13, 1.0, v13
 v_add_f32 v14, 1.0, v14
 v_add_f32 v15, 1.0, v15
 v_rcp_f32 v12, v12
 v_rcp_f32 v13, v13
 v_rcp_f32 v14, v14
 v_rcp_f32 v15, v15
 v_mul_f32 v8, v8, v12
 v_mul_f32 v9, v9, v13
 v_mul_f32 v10, v10, v14
 v_mul_f32 v11, v11, v15
 v_cvt_pk_bf16_f32 v26, v8, v9
 v_cvt_pk_bf16_f32 v27, v10, v11
 buffer_store_dwordx2 v[26:27], v6, s[64:67], s23 offen offset:2048 sc1
 s_barrier
 ds_write_b128 v3, a[4:7]
 ds_write_b128 v3, a[12:15] offset:1024
 ds_write_b128 v3, a[20:23] offset:2048
 ds_write_b128 v3, a[28:31] offset:3072
 ds_write_b128 v3, a[36:39] offset:4096
 ds_write_b128 v3, a[44:47] offset:5120
 ds_write_b128 v3, a[52:55] offset:6144
 ds_write_b128 v3, a[60:63] offset:7168
 ds_write_b128 v3, a[68:71] offset:8192
 ds_write_b128 v3, a[76:79] offset:9216
 ds_write_b128 v3, a[84:87] offset:10240
 ds_write_b128 v3, a[92:95] offset:11264
 ds_write_b128 v3, a[100:103] offset:12288
 ds_write_b128 v3, a[108:111] offset:13312
 ds_write_b128 v3, a[116:119] offset:14336
 ds_write_b128 v3, a[124:127] offset:15360
 ds_write_b128 v3, a[132:135] offset:16384
 ds_write_b128 v3, a[140:143] offset:17408
 ds_write_b128 v3, a[148:151] offset:18432
 ds_write_b128 v3, a[156:159] offset:19456
 ds_write_b128 v3, a[164:167] offset:20480
 ds_write_b128 v3, a[172:175] offset:21504
 ds_write_b128 v3, a[180:183] offset:22528
 ds_write_b128 v3, a[188:191] offset:23552
 ds_write_b128 v3, a[196:199] offset:24576
 ds_write_b128 v3, a[204:207] offset:25600
 ds_write_b128 v3, a[212:215] offset:26624
 ds_write_b128 v3, a[220:223] offset:27648
 s_waitcnt lgkmcnt(0)
 s_barrier
 ds_read_b128 v[8:11], v4
 ds_read_b128 v[12:15], v4 offset:28672
 ds_read_b128 v[16:19], v5
 ds_read_b128 v[20:23], v5 offset:28672
 ds_read_b64 v[24:25], v92
 s_waitcnt lgkmcnt(0)
 v_pk_add_f32 v[8:9], v[8:9], v[12:13]
 v_pk_add_f32 v[10:11], v[10:11], v[14:15]
 v_pk_add_f32 v[16:17], v[16:17], v[20:21]
 v_pk_add_f32 v[18:19], v[18:19], v[22:23]
 v_pk_add_f32 v[8:9], v[8:9], v[16:17]
 v_pk_add_f32 v[10:11], v[10:11], v[18:19]
 v_lshlrev_b32 v16, 16, v24
 v_and_b32 v17, s34, v24
 v_lshlrev_b32 v18, 16, v25
 v_and_b32 v19, s34, v25
 v_cvt_pk_bf16_f32 v12, v8, v9
 v_cvt_pk_bf16_f32 v13, v10, v11
 v_lshlrev_b32 v8, 16, v12
 v_and_b32 v9, s34, v12
 v_lshlrev_b32 v10, 16, v13
 v_and_b32 v11, s34, v13
 v_pk_add_f32 v[8:9], v[8:9], v[16:17]
 v_pk_add_f32 v[10:11], v[10:11], v[18:19]
 v_cvt_pk_bf16_f32 v12, v8, v9
 v_cvt_pk_bf16_f32 v13, v10, v11
 v_lshlrev_b32 v8, 16, v12
 v_and_b32 v9, s34, v12
 v_lshlrev_b32 v10, 16, v13
 v_and_b32 v11, s34, v13
 v_mul_f32 v12, s24, v8
 v_mul_f32 v13, s24, v9
 v_mul_f32 v14, s24, v10
 v_mul_f32 v15, s24, v11
 v_exp_f32 v12, v12
 v_exp_f32 v13, v13
 v_exp_f32 v14, v14
 v_exp_f32 v15, v15
 v_add_f32 v12, 1.0, v12
 v_add_f32 v13, 1.0, v13
 v_add_f32 v14, 1.0, v14
 v_add_f32 v15, 1.0, v15
 v_rcp_f32 v12, v12
 v_rcp_f32 v13, v13
 v_rcp_f32 v14, v14
 v_rcp_f32 v15, v15
 v_mul_f32 v8, v8, v12
 v_mul_f32 v9, v9, v13
 v_mul_f32 v10, v10, v14
 v_mul_f32 v11, v11, v15
 v_cvt_pk_bf16_f32 v26, v8, v9
 v_cvt_pk_bf16_f32 v27, v10, v11
 buffer_store_dwordx2 v[26:27], v6, s[64:67], s22 offen offset:512 sc1
 ds_read_b128 v[8:11], v4 offset:1024
 ds_read_b128 v[12:15], v4 offset:29696
 ds_read_b128 v[16:19], v5 offset:1024
 ds_read_b128 v[20:23], v5 offset:29696
 ds_read_b64 v[24:25], v92 offset:32
 s_waitcnt lgkmcnt(0)
 v_pk_add_f32 v[8:9], v[8:9], v[12:13]
 v_pk_add_f32 v[10:11], v[10:11], v[14:15]
 v_pk_add_f32 v[16:17], v[16:17], v[20:21]
 v_pk_add_f32 v[18:19], v[18:19], v[22:23]
 v_pk_add_f32 v[8:9], v[8:9], v[16:17]
 v_pk_add_f32 v[10:11], v[10:11], v[18:19]
 v_lshlrev_b32 v16, 16, v24
 v_and_b32 v17, s34, v24
 v_lshlrev_b32 v18, 16, v25
 v_and_b32 v19, s34, v25
 v_cvt_pk_bf16_f32 v12, v8, v9
 v_cvt_pk_bf16_f32 v13, v10, v11
 v_lshlrev_b32 v8, 16, v12
 v_and_b32 v9, s34, v12
 v_lshlrev_b32 v10, 16, v13
 v_and_b32 v11, s34, v13
 v_pk_add_f32 v[8:9], v[8:9], v[16:17]
 v_pk_add_f32 v[10:11], v[10:11], v[18:19]
 v_cvt_pk_bf16_f32 v12, v8, v9
 v_cvt_pk_bf16_f32 v13, v10, v11
 v_lshlrev_b32 v8, 16, v12
 v_and_b32 v9, s34, v12
 v_lshlrev_b32 v10, 16, v13
 v_and_b32 v11, s34, v13
 v_mul_f32 v12, s24, v8
 v_mul_f32 v13, s24, v9
 v_mul_f32 v14, s24, v10
 v_mul_f32 v15, s24, v11
 v_exp_f32 v12, v12
 v_exp_f32 v13, v13
 v_exp_f32 v14, v14
 v_exp_f32 v15, v15
 v_add_f32 v12, 1.0, v12
 v_add_f32 v13, 1.0, v13
 v_add_f32 v14, 1.0, v14
 v_add_f32 v15, 1.0, v15
 v_rcp_f32 v12, v12
 v_rcp_f32 v13, v13
 v_rcp_f32 v14, v14
 v_rcp_f32 v15, v15
 v_mul_f32 v8, v8, v12
 v_mul_f32 v9, v9, v13
 v_mul_f32 v10, v10, v14
 v_mul_f32 v11, v11, v15
 v_cvt_pk_bf16_f32 v28, v8, v9
 v_cvt_pk_bf16_f32 v29, v10, v11
 buffer_store_dwordx2 v[28:29], v6, s[64:67], s22 offen offset:1536 sc1
 ds_read_b128 v[8:11], v4 offset:2048
 ds_read_b128 v[12:15], v4 offset:30720
 ds_read_b128 v[16:19], v5 offset:2048
 ds_read_b128 v[20:23], v5 offset:30720
 ds_read_b64 v[24:25], v92 offset:64
 s_waitcnt lgkmcnt(0)
 v_pk_add_f32 v[8:9], v[8:9], v[12:13]
 v_pk_add_f32 v[10:11], v[10:11], v[14:15]
 v_pk_add_f32 v[16:17], v[16:17], v[20:21]
 v_pk_add_f32 v[18:19], v[18:19], v[22:23]
 v_pk_add_f32 v[8:9], v[8:9], v[16:17]
 v_pk_add_f32 v[10:11], v[10:11], v[18:19]
 v_lshlrev_b32 v16, 16, v24
 v_and_b32 v17, s34, v24
 v_lshlrev_b32 v18, 16, v25
 v_and_b32 v19, s34, v25
 v_cvt_pk_bf16_f32 v12, v8, v9
 v_cvt_pk_bf16_f32 v13, v10, v11
 v_lshlrev_b32 v8, 16, v12
 v_and_b32 v9, s34, v12
 v_lshlrev_b32 v10, 16, v13
 v_and_b32 v11, s34, v13
 v_pk_add_f32 v[8:9], v[8:9], v[16:17]
 v_pk_add_f32 v[10:11], v[10:11], v[18:19]
 v_cvt_pk_bf16_f32 v12, v8, v9
 v_cvt_pk_bf16_f32 v13, v10, v11
 v_lshlrev_b32 v8, 16, v12
 v_and_b32 v9, s34, v12
 v_lshlrev_b32 v10, 16, v13
 v_and_b32 v11, s34, v13
 v_mul_f32 v12, s24, v8
 v_mul_f32 v13, s24, v9
 v_mul_f32 v14, s24, v10
 v_mul_f32 v15, s24, v11
 v_exp_f32 v12, v12
 v_exp_f32 v13, v13
 v_exp_f32 v14, v14
 v_exp_f32 v15, v15
 v_add_f32 v12, 1.0, v12
 v_add_f32 v13, 1.0, v13
 v_add_f32 v14, 1.0, v14
 v_add_f32 v15, 1.0, v15
 v_rcp_f32 v12, v12
 v_rcp_f32 v13, v13
 v_rcp_f32 v14, v14
 v_rcp_f32 v15, v15
 v_mul_f32 v8, v8, v12
 v_mul_f32 v9, v9, v13
 v_mul_f32 v10, v10, v14
 v_mul_f32 v11, v11, v15
 v_cvt_pk_bf16_f32 v26, v8, v9
 v_cvt_pk_bf16_f32 v27, v10, v11
 buffer_store_dwordx2 v[26:27], v6, s[64:67], s22 offen offset:2560 sc1
 ds_read_b128 v[8:11], v4 offset:3072
 ds_read_b128 v[12:15], v4 offset:31744
 ds_read_b128 v[16:19], v5 offset:3072
 ds_read_b128 v[20:23], v5 offset:31744
 ds_read_b64 v[24:25], v92 offset:96
 s_waitcnt lgkmcnt(0)
 v_pk_add_f32 v[8:9], v[8:9], v[12:13]
 v_pk_add_f32 v[10:11], v[10:11], v[14:15]
 v_pk_add_f32 v[16:17], v[16:17], v[20:21]
 v_pk_add_f32 v[18:19], v[18:19], v[22:23]
 v_pk_add_f32 v[8:9], v[8:9], v[16:17]
 v_pk_add_f32 v[10:11], v[10:11], v[18:19]
 v_lshlrev_b32 v16, 16, v24
 v_and_b32 v17, s34, v24
 v_lshlrev_b32 v18, 16, v25
 v_and_b32 v19, s34, v25
 v_cvt_pk_bf16_f32 v12, v8, v9
 v_cvt_pk_bf16_f32 v13, v10, v11
 v_lshlrev_b32 v8, 16, v12
 v_and_b32 v9, s34, v12
 v_lshlrev_b32 v10, 16, v13
 v_and_b32 v11, s34, v13
 v_pk_add_f32 v[8:9], v[8:9], v[16:17]
 v_pk_add_f32 v[10:11], v[10:11], v[18:19]
 v_cvt_pk_bf16_f32 v12, v8, v9
 v_cvt_pk_bf16_f32 v13, v10, v11
 v_lshlrev_b32 v8, 16, v12
 v_and_b32 v9, s34, v12
 v_lshlrev_b32 v10, 16, v13
 v_and_b32 v11, s34, v13
 v_mul_f32 v12, s24, v8
 v_mul_f32 v13, s24, v9
 v_mul_f32 v14, s24, v10
 v_mul_f32 v15, s24, v11
 v_exp_f32 v12, v12
 v_exp_f32 v13, v13
 v_exp_f32 v14, v14
 v_exp_f32 v15, v15
 v_add_f32 v12, 1.0, v12
 v_add_f32 v13, 1.0, v13
 v_add_f32 v14, 1.0, v14
 v_add_f32 v15, 1.0, v15
 v_rcp_f32 v12, v12
 v_rcp_f32 v13, v13
 v_rcp_f32 v14, v14
 v_rcp_f32 v15, v15
 v_mul_f32 v8, v8, v12
 v_mul_f32 v9, v9, v13
 v_mul_f32 v10, v10, v14
 v_mul_f32 v11, v11, v15
 v_cvt_pk_bf16_f32 v28, v8, v9
 v_cvt_pk_bf16_f32 v29, v10, v11
 buffer_store_dwordx2 v[28:29], v6, s[64:67], s22 offen offset:3584 sc1
 ds_read_b128 v[8:11], v4 offset:4096
 ds_read_b128 v[12:15], v4 offset:32768
 ds_read_b128 v[16:19], v5 offset:4096
 ds_read_b128 v[20:23], v5 offset:32768
 ds_read_b64 v[24:25], v92 offset:128
 s_waitcnt lgkmcnt(0)
 v_pk_add_f32 v[8:9], v[8:9], v[12:13]
 v_pk_add_f32 v[10:11], v[10:11], v[14:15]
 v_pk_add_f32 v[16:17], v[16:17], v[20:21]
 v_pk_add_f32 v[18:19], v[18:19], v[22:23]
 v_pk_add_f32 v[8:9], v[8:9], v[16:17]
 v_pk_add_f32 v[10:11], v[10:11], v[18:19]
 v_lshlrev_b32 v16, 16, v24
 v_and_b32 v17, s34, v24
 v_lshlrev_b32 v18, 16, v25
 v_and_b32 v19, s34, v25
 v_cvt_pk_bf16_f32 v12, v8, v9
 v_cvt_pk_bf16_f32 v13, v10, v11
 v_lshlrev_b32 v8, 16, v12
 v_and_b32 v9, s34, v12
 v_lshlrev_b32 v10, 16, v13
 v_and_b32 v11, s34, v13
 v_pk_add_f32 v[8:9], v[8:9], v[16:17]
 v_pk_add_f32 v[10:11], v[10:11], v[18:19]
 v_cvt_pk_bf16_f32 v12, v8, v9
 v_cvt_pk_bf16_f32 v13, v10, v11
 v_lshlrev_b32 v8, 16, v12
 v_and_b32 v9, s34, v12
 v_lshlrev_b32 v10, 16, v13
 v_and_b32 v11, s34, v13
 v_mul_f32 v12, s24, v8
 v_mul_f32 v13, s24, v9
 v_mul_f32 v14, s24, v10
 v_mul_f32 v15, s24, v11
 v_exp_f32 v12, v12
 v_exp_f32 v13, v13
 v_exp_f32 v14, v14
 v_exp_f32 v15, v15
 v_add_f32 v12, 1.0, v12
 v_add_f32 v13, 1.0, v13
 v_add_f32 v14, 1.0, v14
 v_add_f32 v15, 1.0, v15
 v_rcp_f32 v12, v12
 v_rcp_f32 v13, v13
 v_rcp_f32 v14, v14
 v_rcp_f32 v15, v15
 v_mul_f32 v8, v8, v12
 v_mul_f32 v9, v9, v13
 v_mul_f32 v10, v10, v14
 v_mul_f32 v11, v11, v15
 v_cvt_pk_bf16_f32 v26, v8, v9
 v_cvt_pk_bf16_f32 v27, v10, v11
 buffer_store_dwordx2 v[26:27], v6, s[64:67], s23 offen offset:512 sc1
 ds_read_b128 v[8:11], v4 offset:5120
 ds_read_b128 v[12:15], v4 offset:33792
 ds_read_b128 v[16:19], v5 offset:5120
 ds_read_b128 v[20:23], v5 offset:33792
 ds_read_b64 v[24:25], v92 offset:160
 s_waitcnt lgkmcnt(0)
 v_pk_add_f32 v[8:9], v[8:9], v[12:13]
 v_pk_add_f32 v[10:11], v[10:11], v[14:15]
 v_pk_add_f32 v[16:17], v[16:17], v[20:21]
 v_pk_add_f32 v[18:19], v[18:19], v[22:23]
 v_pk_add_f32 v[8:9], v[8:9], v[16:17]
 v_pk_add_f32 v[10:11], v[10:11], v[18:19]
 v_lshlrev_b32 v16, 16, v24
 v_and_b32 v17, s34, v24
 v_lshlrev_b32 v18, 16, v25
 v_and_b32 v19, s34, v25
 v_cvt_pk_bf16_f32 v12, v8, v9
 v_cvt_pk_bf16_f32 v13, v10, v11
 v_lshlrev_b32 v8, 16, v12
 v_and_b32 v9, s34, v12
 v_lshlrev_b32 v10, 16, v13
 v_and_b32 v11, s34, v13
 v_pk_add_f32 v[8:9], v[8:9], v[16:17]
 v_pk_add_f32 v[10:11], v[10:11], v[18:19]
 v_cvt_pk_bf16_f32 v12, v8, v9
 v_cvt_pk_bf16_f32 v13, v10, v11
 v_lshlrev_b32 v8, 16, v12
 v_and_b32 v9, s34, v12
 v_lshlrev_b32 v10, 16, v13
 v_and_b32 v11, s34, v13
 v_mul_f32 v12, s24, v8
 v_mul_f32 v13, s24, v9
 v_mul_f32 v14, s24, v10
 v_mul_f32 v15, s24, v11
 v_exp_f32 v12, v12
 v_exp_f32 v13, v13
 v_exp_f32 v14, v14
 v_exp_f32 v15, v15
 v_add_f32 v12, 1.0, v12
 v_add_f32 v13, 1.0, v13
 v_add_f32 v14, 1.0, v14
 v_add_f32 v15, 1.0, v15
 v_rcp_f32 v12, v12
 v_rcp_f32 v13, v13
 v_rcp_f32 v14, v14
 v_rcp_f32 v15, v15
 v_mul_f32 v8, v8, v12
 v_mul_f32 v9, v9, v13
 v_mul_f32 v10, v10, v14
 v_mul_f32 v11, v11, v15
 v_cvt_pk_bf16_f32 v28, v8, v9
 v_cvt_pk_bf16_f32 v29, v10, v11
 buffer_store_dwordx2 v[28:29], v6, s[64:67], s23 offen offset:1536 sc1
 ds_read_b128 v[8:11], v4 offset:6144
 ds_read_b128 v[12:15], v4 offset:34816
 ds_read_b128 v[16:19], v5 offset:6144
 ds_read_b128 v[20:23], v5 offset:34816
 ds_read_b64 v[24:25], v92 offset:192
 s_waitcnt lgkmcnt(0)
 v_pk_add_f32 v[8:9], v[8:9], v[12:13]
 v_pk_add_f32 v[10:11], v[10:11], v[14:15]
 v_pk_add_f32 v[16:17], v[16:17], v[20:21]
 v_pk_add_f32 v[18:19], v[18:19], v[22:23]
 v_pk_add_f32 v[8:9], v[8:9], v[16:17]
 v_pk_add_f32 v[10:11], v[10:11], v[18:19]
 v_lshlrev_b32 v16, 16, v24
 v_and_b32 v17, s34, v24
 v_lshlrev_b32 v18, 16, v25
 v_and_b32 v19, s34, v25
 v_cvt_pk_bf16_f32 v12, v8, v9
 v_cvt_pk_bf16_f32 v13, v10, v11
 v_lshlrev_b32 v8, 16, v12
 v_and_b32 v9, s34, v12
 v_lshlrev_b32 v10, 16, v13
 v_and_b32 v11, s34, v13
 v_pk_add_f32 v[8:9], v[8:9], v[16:17]
 v_pk_add_f32 v[10:11], v[10:11], v[18:19]
 v_cvt_pk_bf16_f32 v12, v8, v9
 v_cvt_pk_bf16_f32 v13, v10, v11
 v_lshlrev_b32 v8, 16, v12
 v_and_b32 v9, s34, v12
 v_lshlrev_b32 v10, 16, v13
 v_and_b32 v11, s34, v13
 v_mul_f32 v12, s24, v8
 v_mul_f32 v13, s24, v9
 v_mul_f32 v14, s24, v10
 v_mul_f32 v15, s24, v11
 v_exp_f32 v12, v12
 v_exp_f32 v13, v13
 v_exp_f32 v14, v14
 v_exp_f32 v15, v15
 v_add_f32 v12, 1.0, v12
 v_add_f32 v13, 1.0, v13
 v_add_f32 v14, 1.0, v14
 v_add_f32 v15, 1.0, v15
 v_rcp_f32 v12, v12
 v_rcp_f32 v13, v13
 v_rcp_f32 v14, v14
 v_rcp_f32 v15, v15
 v_mul_f32 v8, v8, v12
 v_mul_f32 v9, v9, v13
 v_mul_f32 v10, v10, v14
 v_mul_f32 v11, v11, v15
 v_cvt_pk_bf16_f32 v26, v8, v9
 v_cvt_pk_bf16_f32 v27, v10, v11
 buffer_store_dwordx2 v[26:27], v6, s[64:67], s23 offen offset:2560 sc1
 s_waitcnt vmcnt(0)
 s_barrier
 s_cmp_lg_u32 s12, 0
 s_cbranch_scc1 L_exit
 s_lshl_b32 s13, s11, 7
 s_add_u32 s13, s13, 52264960
 s_mov_b64 exec, 1
 buffer_store_dword v93, v93, s[64:67], s13 offen sc1
 s_branch L_exit
L_last:
 s_endpgm
.section .rodata,"a"
.p2align 6
.amdhsa_kernel recurrent_scan__memory_aug_recurrent_mem_tr__dense_activation_squared_relu__prompt_kernel
  .amdhsa_next_free_vgpr 512
  .amdhsa_next_free_sgpr 102
  .amdhsa_accum_offset 256
  .amdhsa_group_segment_fixed_size 0
  .amdhsa_kernarg_size 120
  .amdhsa_user_sgpr_count 2
  .amdhsa_user_sgpr_kernarg_segment_ptr 1
  .amdhsa_system_sgpr_workgroup_id_x 1
.end_amdhsa_kernel
```
